```python
import torch

def _softmax(x, axis=-1):
    return torch.softmax(x, dim=axis)
def _gelu(x):
    return torch.nn.functional.gelu(x, approximate="tanh")
def _silu(x):
    return torch.nn.functional.silu(x)
def _sigmoid(x):
    return torch.sigmoid(x)
def _layernorm(x, axis=-1, eps=1e-5):
    m = x.mean(dim=axis, keepdim=True)
    v = x.var(dim=axis, keepdim=True, unbiased=False)
    return (x - m) / torch.sqrt(v + eps)
def _scatter_add(tgt, idx, src, axis=0):
    return tgt.clone().index_add_(axis, idx, src)
def _segment_sum(src, seg, n):
    out = torch.zeros((n,) + src.shape[1:], dtype=src.dtype)
    return out.index_add_(0, seg, src)
def _pad(x, pw):
    flat = tuple(v for pair in reversed(pw) for v in pair)
    return torch.nn.functional.pad(x, flat)

kernel_name = 'gated_mix__sliding_local_dilated__compressed_kv_cla__prompt'

def setup_inputs():

    _w = (lambda a: (lambda t: t.to(torch.bfloat16) if t.is_floating_point() else t)(torch.as_tensor(a)))
    def _A_setup():
        B, S, D = 1, 2048, 512
        return {
            "x": _w((lambda *s: torch.randn(*s, dtype=torch.bfloat16) * 0.05)(B, S, D)),
            "wqkv": _w((lambda *s: torch.randn(*s, dtype=torch.bfloat16) * 1.6)(D, 3 * D)),
            "wo": _w((lambda *s: torch.randn(*s, dtype=torch.bfloat16) * 0.05)(D, D)),
        }
    _A_in = _A_setup()

    def _B_setup():
        B, H, Sq, Sk, D, M = 1, 32, 2048, 2048, 128, 512
        Dc = 4 * D
        return {
            "x": _w((lambda *s: torch.randn(*s, dtype=torch.bfloat16) * 0.05)(B, Sq, M)),
            "c_kv": _w((lambda *s: torch.randn(*s, dtype=torch.bfloat16) * 1.6)(B, Sk, Dc)),
            "w_q": _w((lambda *s: torch.randn(*s, dtype=torch.bfloat16) * 6.4)(M, H, D) * (M ** -0.5)),
            "w_uk": _w((lambda *s: torch.randn(*s, dtype=torch.bfloat16) * 6.4)(Dc, H, D) * (Dc ** -0.5)),
            "w_uv": _w((lambda *s: torch.randn(*s, dtype=torch.bfloat16) * 1.6)(Dc, H, D) * (Dc ** -0.5)),
            "w_o": _w((lambda *s: torch.randn(*s, dtype=torch.bfloat16) * 1.6)(H, D, M) * ((H * D) ** -0.5)),
        }
    _B_in = _B_setup()

    return {
        "A_x": _A_in["x"],
        "A_wqkv": _A_in["wqkv"],
        "A_wo": _A_in["wo"],
        "B_x": _B_in["x"],
        "B_c_kv": _B_in["c_kv"],
        "B_w_q": _B_in["w_q"],
        "B_w_uk": _B_in["w_uk"],
        "B_w_uv": _B_in["w_uv"],
        "B_w_o": _B_in["w_o"],
        "gate_w": _w((lambda *s: torch.randn(*s, dtype=torch.bfloat16) * 0.05)(512) * 16.0),
    }

def reference(A_x, A_wqkv, A_wo, B_x, B_c_kv, B_w_q, B_w_uk, B_w_uv, B_w_o, gate_w):
    def _A_ref(x, wqkv, wo):
        B, S, D = x.shape
        H = 32; Dh = D // H
        W, dil = 8, 2
        qkv = (lambda x, *d: x.permute(*d))((x @ wqkv).reshape(B, S, 3, H, Dh), 2, 0, 3, 1, 4)
        q, k, v = qkv[0], qkv[1], qkv[2]
        scale = Dh ** -0.5
        pos = torch.arange(S)
        off = torch.arange(W) * dil
        idx = pos[:, None] - off[None, :]
        mask = idx >= 0
        idx_c = torch.where(mask, idx, 0).reshape(-1)
        kg = k[:, :, idx_c, :].reshape(B, H, S, W, Dh)
        vg = v[:, :, idx_c, :].reshape(B, H, S, W, Dh)
        logits = torch.einsum("bhsd,bhswd->bhsw", q, kg) * scale
        logits = torch.where(mask[None, None, :, :], logits, -1e9)
        attn = _softmax(logits, axis=-1)
        o = torch.einsum("bhsw,bhswd->bhsd", attn, vg)
        return (lambda x, *d: x.permute(*d))(o, 0, 2, 1, 3).reshape(B, S, D) @ wo

    def _B_ref(x, c_kv, w_q, w_uk, w_uv, w_o):
        B, Sq, M = x.shape[0], x.shape[1], x.shape[2]
        Sk = c_kv.shape[1]
        H, D = w_q.shape[1], w_q.shape[2]
        q = torch.einsum("bqm,mhd->bhqd", x, w_q)
        k = torch.einsum("bkc,chd->bhkd", c_kv, w_uk)
        v = torch.einsum("bkc,chd->bhkd", c_kv, w_uv)
        scores = torch.einsum("bhqd,bhkd->bhqk", q, k) * (D ** -0.5)
        off = Sk - Sq
        qi = torch.arange(Sq)[:, None]
        kj = torch.arange(Sk)[None, :]
        cmask = kj <= (qi + off)
        scores = torch.where(cmask[None, None], scores, -1e9)
        p = _softmax(scores, axis=-1)
        ctx = torch.einsum("bhqk,bhkd->bhqd", p, v)
        return torch.einsum("bhqd,hdm->bqm", ctx, w_o)

    x = A_x
    g = _sigmoid((x * gate_w).sum(-1, keepdims=True))
    a = _A_ref(x, A_wqkv, A_wo)
    b = _B_ref(x, B_c_kv, B_w_q, B_w_uk, B_w_uv, B_w_o)
    return g * a + (1 - g) * b
```

```asm
; @launch grid=(256,1,1) block=(256,1,1) lds=163840
.amdgcn_target "amdgcn-amd-amdhsa--gfx950"
.text
.globl gated_mix__sliding_local_dilated__compressed_kv_cla__prompt_kernel
.p2align 8
.type gated_mix__sliding_local_dilated__compressed_kv_cla__prompt_kernel,@function
gated_mix__sliding_local_dilated__compressed_kv_cla__prompt_kernel:
 s_cmp_ge_u32 s2, 256
 s_cbranch_scc1 L_fdone_1
 s_load_dwordx16 s[36:51], s[0:1], 0
 s_load_dwordx8 s[52:59], s[0:1], 64
 s_load_dwordx2 s[60:61], s[0:1], 96
 s_getpc_b64 s[64:65]
L_pc_4:
 s_lshr_b32 s22, s2, 3
 v_lshrrev_b32 v30, 6, v0
 v_and_b32 v127, 15, v0
 v_lshlrev_b32 v127, 5, v127
 v_add_lshl_u32 v127, v127, s22, 2
 v_add_lshl_u32 v127, v127, v30, 7
 v_min_u32 v127, L_rarecode_3-L_pc_4, v127
 global_load_dword v122, v127, s[64:65]
 v_lshrrev_b32 v30, 6, v0
 v_and_b32 v0, 63, v0
 v_readfirstlane_b32 s3, v30
 s_and_b32 s20, s2, 7
 s_lshl_b32 s20, s20, 2
 s_lshr_b32 s22, s2, 3
 s_and_b32 s22, s22, 3
 s_add_u32 s20, s20, s22
 s_lshr_b32 s21, s2, 5
 v_lshlrev_b32 v1, 4, v0
 v_lshrrev_b32 v30, 3, v0
 v_lshrrev_b32 v31, 4, v0
 v_and_b32 v32, 7, v0
 v_xor_b32 v33, v31, v32
 v_lshlrev_b32 v33, 4, v33
 v_lshl_add_u32 v2, v30, 10, v33
 v_add_u32 v4, 14336, v2
 v_xor_b32 v33, 64, v2
 v_add_u32 v3, 7168, v33
 v_add_u32 v5, 21504, v33
 v_and_b32 v33, 15, v0
 v_lshlrev_b32 v34, 2, v31
 v_xor_b32 v33, v33, v34
 v_lshlrev_b32 v33, 4, v33
 v_lshl_add_u32 v6, v31, 13, v33
 v_add_u32 v7, 31744, v6
 v_xor_b32 v33, 32, v6
 v_add_u32 v8, 63488, v33
 v_add_u32 v9, 95232, v33
 s_sub_u32 s22, 15, s21
 s_bitcmp1_b32 s3, 0
 s_cselect_b32 s22, s22, s21
 s_lshl_b32 s22, s22, 1
 s_lshr_b32 s23, s3, 1
 s_add_u32 s22, s22, s23
 s_lshl_b32 s25, s22, 16
 s_add_u32 s26, s25, 32768
 s_lshl_b32 s29, s3, 13
 s_mov_b32 s30, s29
 s_and_b32 s22, s3, 1
 s_lshl_b32 s22, s22, 18
 s_lshl_b32 s27, s20, 8
 s_add_u32 s27, s27, s22
 s_and_b32 s94, s2, 31
 s_add_u32 s62, s27, 0x20000
 v_and_b32 v33, 15, v0
 v_lshrrev_b32 v34, 1, v33
 v_xor_b32 v34, v34, v31
 v_lshlrev_b32 v34, 4, v34
 v_lshl_add_u32 v40, v33, 7, v34
 s_and_b32 s22, s3, 1
 s_lshl_b32 s22, s22, 14
 s_add_u32 s22, s22, 65536
 v_add_u32 v12, s22, v40
 v_xor_b32 v13, 64, v12
 v_lshrrev_b32 v35, 2, v0
 v_and_b32 v35, 3, v35
 v_lshl_add_u32 v36, v31, 3, v35
 v_bfe_u32 v37, v0, 1, 1
 v_and_b32 v34, 1, v31
 v_lshl_add_u32 v37, v34, 1, v37
 v_and_b32 v38, 1, v0
 v_lshlrev_b32 v38, 3, v38
 v_lshlrev_b32 v39, 2, v35
 v_xor_b32 v39, v39, v37
 v_lshlrev_b32 v39, 4, v39
 v_lshl_add_u32 v39, v36, 8, v39
 s_lshr_b32 s97, s3, 1
 s_lshl_b32 s97, s97, 14
 s_add_u32 s22, s97, 98304
 v_add3_u32 v39, v39, v38, s22
 v_xor_b32 v14, 0, v39
 v_xor_b32 v15, 32, v39
 v_xor_b32 v16, 64, v39
 v_xor_b32 v17, 96, v39
 v_xor_b32 v18, 128, v39
 v_xor_b32 v19, 160, v39
 v_xor_b32 v20, 192, v39
 v_xor_b32 v21, 224, v39
 s_lshr_b32 s22, s2, 3
 s_lshl_b32 s22, s22, 1
 s_and_b32 s23, s3, 1
 s_add_u32 s22, s22, s23
 s_lshl_b32 s22, s22, 14
 s_and_b32 s23, s2, 7
 s_lshl_b32 s23, s23, 10
 s_add_u32 s22, s22, s23
 v_lshrrev_b32 v42, 3, v33
 v_lshlrev_b32 v42, 13, v42
 v_lshl_add_u32 v42, v32, 7, v42
 v_add_u32 v55, s22, v42
 s_lshl_b32 s22, s2, 2
 s_add_u32 s22, s22, s3
 s_lshl_b32 s22, s22, 4
 v_add_lshl_u32 v50, v33, s22, 7
 s_waitcnt lgkmcnt(0)
 s_mov_b32 s100, s56
 s_mov_b32 s101, s57
 s_mov_b32 s4, s44
 s_mov_b32 s5, s45
 s_mov_b32 s6, 0x200000
 s_mov_b32 s7, 0x20000
 s_cmp_lt_u32 s3, 2
 s_cselect_b32 s8, s48, s50
 s_cselect_b32 s9, s49, s51
 s_mov_b32 s10, 0x400000
 s_mov_b32 s11, 0x20000
 s_add_u32 m0, s30, 98304
 s_nop 0
 buffer_load_dwordx4 v6, s[8:11], s27 offen offset:0  lds
 buffer_load_dwordx4 v7, s[8:11], s27 offen offset:1024  lds
 buffer_load_dwordx4 v8, s[8:11], s27 offen offset:2048  lds
 buffer_load_dwordx4 v9, s[8:11], s27 offen offset:3072  lds
 s_add_u32 m0, s29, 65536
 s_add_u32 s27, s27, 524288
 buffer_load_dwordx4 v2, s[4:7], s25 offen offset:0  lds
 buffer_load_dwordx4 v3, s[4:7], s25 offen offset:1024  lds
 buffer_load_dwordx4 v4, s[4:7], s25 offen offset:2048  lds
 buffer_load_dwordx4 v5, s[4:7], s25 offen offset:3072  lds
 s_add_u32 m0, s30, 102400
 s_add_u32 s25, s25, 128
 buffer_load_dwordx4 v6, s[8:11], s62 offen offset:0  lds
 buffer_load_dwordx4 v7, s[8:11], s62 offen offset:1024  lds
 buffer_load_dwordx4 v8, s[8:11], s62 offen offset:2048  lds
 buffer_load_dwordx4 v9, s[8:11], s62 offen offset:3072  lds
 s_add_u32 m0, s29, 69632
 s_add_u32 s62, s62, 524288
 buffer_load_dwordx4 v2, s[4:7], s26 offen offset:0  lds
 buffer_load_dwordx4 v3, s[4:7], s26 offen offset:1024  lds
 buffer_load_dwordx4 v4, s[4:7], s26 offen offset:2048  lds
 buffer_load_dwordx4 v5, s[4:7], s26 offen offset:3072  lds
 s_add_u32 s26, s26, 128
 s_mov_b64 s[0:1], s[64:65]
 s_mov_b32 s16, s60
 s_mov_b32 s17, s61
 s_mov_b32 s18, 0x10000000
 s_mov_b32 s19, 0x20000
 s_mov_b32 s12, s54
 s_mov_b32 s13, s55
 s_mov_b32 s14, 0x400
 s_mov_b32 s15, 0x20000
 s_mov_b32 s35, 0x100000
 buffer_load_dword v122, v55, s[8:11], s35 offen
 s_mov_b32 s98, s40
 s_mov_b32 s99, s41
 s_mov_b32 s40, s58
 s_mov_b32 s41, s59
 s_mov_b32 s42, 0x100
 s_mov_b32 s43, 0x20000
 s_mov_b32 s58, s98
 s_mov_b32 s59, s99
 s_add_u32 m0, s30, 131072
 s_nop 0
 buffer_load_dwordx4 v6, s[8:11], s27 offen offset:0  lds
 buffer_load_dwordx4 v7, s[8:11], s27 offen offset:1024  lds
 buffer_load_dwordx4 v8, s[8:11], s27 offen offset:2048  lds
 buffer_load_dwordx4 v9, s[8:11], s27 offen offset:3072  lds
 s_add_u32 m0, s30, 135168
 s_add_u32 s27, s27, 524288
 buffer_load_dwordx4 v6, s[8:11], s62 offen offset:0  lds
 buffer_load_dwordx4 v7, s[8:11], s62 offen offset:1024  lds
 buffer_load_dwordx4 v8, s[8:11], s62 offen offset:2048  lds
 buffer_load_dwordx4 v9, s[8:11], s62 offen offset:3072  lds
 s_add_u32 s62, s62, 524288
 s_add_u32 m0, s29, 0
 s_nop 0
 buffer_load_dwordx4 v2, s[4:7], s25 offen offset:0  lds
 buffer_load_dwordx4 v3, s[4:7], s25 offen offset:1024  lds
 buffer_load_dwordx4 v4, s[4:7], s25 offen offset:2048  lds
 buffer_load_dwordx4 v5, s[4:7], s25 offen offset:3072  lds
 s_add_u32 m0, s29, 4096
 s_add_u32 s25, s25, 128
 buffer_load_dwordx4 v2, s[4:7], s26 offen offset:0  lds
 buffer_load_dwordx4 v3, s[4:7], s26 offen offset:1024  lds
 buffer_load_dwordx4 v4, s[4:7], s26 offen offset:2048  lds
 buffer_load_dwordx4 v5, s[4:7], s26 offen offset:3072  lds
 s_add_u32 s26, s26, 128
 s_waitcnt vmcnt(17)
 s_barrier
 ds_read_b64_tr_b16 v[60:61], v14 offset:0
 ds_read_b64_tr_b16 v[62:63], v14 offset:1024
 ds_read_b64_tr_b16 v[64:65], v14 offset:8192
 ds_read_b64_tr_b16 v[66:67], v14 offset:9216
 ds_read_b128 v[128:131], v12 offset:0
 ds_read_b128 v[132:135], v12 offset:2048
 ds_read_b128 v[136:139], v12 offset:4096
 ds_read_b128 v[140:143], v12 offset:6144
 ds_read_b128 v[144:147], v12 offset:8192
 ds_read_b128 v[148:151], v12 offset:10240
 ds_read_b128 v[152:155], v12 offset:12288
 ds_read_b128 v[156:159], v12 offset:14336
 ds_read_b128 v[160:163], v13 offset:0
 ds_read_b128 v[164:167], v13 offset:2048
 ds_read_b128 v[168:171], v13 offset:4096
 ds_read_b128 v[172:175], v13 offset:6144
 ds_read_b128 v[176:179], v13 offset:8192
 ds_read_b128 v[180:183], v13 offset:10240
 ds_read_b128 v[184:187], v13 offset:12288
 ds_read_b128 v[188:191], v13 offset:14336
 ds_read_b64_tr_b16 v[68:69], v15 offset:0
 ds_read_b64_tr_b16 v[70:71], v15 offset:1024
 ds_read_b64_tr_b16 v[72:73], v15 offset:8192
 ds_read_b64_tr_b16 v[74:75], v15 offset:9216
 ds_read_b64_tr_b16 v[76:77], v16 offset:0
 ds_read_b64_tr_b16 v[78:79], v16 offset:1024
 ds_read_b64_tr_b16 v[80:81], v16 offset:8192
 ds_read_b64_tr_b16 v[82:83], v16 offset:9216
 v_subrev_u32 v12, 0x10000, v12
 v_subrev_u32 v13, 0x10000, v13
 s_cmp_ge_u32 s3, 2
 s_cbranch_scc1 L_kvV_5
 s_waitcnt lgkmcnt(8)
 v_mfma_f32_16x16x32_bf16 a[192:195], v[60:63], v[128:131], 0
 ds_read_b64_tr_b16 v[84:85], v17 offset:0
 v_mfma_f32_16x16x32_bf16 a[192:195], v[64:67], v[160:163], a[192:195]
 ds_read_b64_tr_b16 v[86:87], v17 offset:1024
 v_mfma_f32_16x16x32_bf16 a[200:203], v[60:63], v[132:135], 0
 s_lshl_b32 s22, s3, 6
 v_mfma_f32_16x16x32_bf16 a[200:203], v[64:67], v[164:167], a[200:203]
 v_add_u32 v120, s22, v0
 v_mfma_f32_16x16x32_bf16 a[208:211], v[60:63], v[136:139], 0
 v_lshlrev_b32 v120, 12, v120
 v_mfma_f32_16x16x32_bf16 a[208:211], v[64:67], v[168:171], a[208:211]
 v_min_u32 v121, 1, v120
 v_mfma_f32_16x16x32_bf16 a[216:219], v[60:63], v[140:143], 0
 v_lshlrev_b32 v121, 29, v121
 v_mfma_f32_16x16x32_bf16 a[216:219], v[64:67], v[172:175], a[216:219]
 s_getreg_b32 s22, hwreg(HW_REG_XCC_ID, 0, 4)
 v_mfma_f32_16x16x32_bf16 a[0:3], v[60:63], v[144:147], 0
 ds_read_b64_tr_b16 v[88:89], v17 offset:8192
 v_mfma_f32_16x16x32_bf16 a[0:3], v[64:67], v[176:179], a[0:3]
 ds_read_b64_tr_b16 v[90:91], v17 offset:9216
 s_mul_i32 s23, s22, s22
 v_mfma_f32_16x16x32_bf16 a[8:11], v[60:63], v[148:151], 0
 s_lshl_b32 s23, s23, 8
 v_mfma_f32_16x16x32_bf16 a[8:11], v[64:67], v[180:183], a[8:11]
 s_add_u32 s23, s23, s22
 v_mfma_f32_16x16x32_bf16 a[16:19], v[60:63], v[152:155], 0
 s_lshl_b32 s23, s23, 8
 v_mfma_f32_16x16x32_bf16 a[16:19], v[64:67], v[184:187], a[16:19]
 s_add_u32 s63, s23, 1
 v_mfma_f32_16x16x32_bf16 a[24:27], v[60:63], v[156:159], 0
 v_mov_b32 v125, s63
 v_mfma_f32_16x16x32_bf16 a[24:27], v[64:67], v[188:191], a[24:27]
 s_waitcnt lgkmcnt(8)
 v_mfma_f32_16x16x32_bf16 a[196:199], v[68:71], v[128:131], 0
 ds_read_b64_tr_b16 v[60:61], v18 offset:0
 s_lshl_b32 s63, s63, 3
 v_mfma_f32_16x16x32_bf16 a[196:199], v[72:75], v[160:163], a[196:199]
 ds_read_b64_tr_b16 v[62:63], v18 offset:1024
 v_mfma_f32_16x16x32_bf16 a[204:207], v[68:71], v[132:135], 0
 s_and_b32 s99, s2, 7
 v_mfma_f32_16x16x32_bf16 a[204:207], v[72:75], v[164:167], a[204:207]
 s_lshl_b32 s99, s99, 2
 v_mfma_f32_16x16x32_bf16 a[212:215], v[68:71], v[136:139], 0
 s_add_u32 m0, s29, 32768
 s_lshl_b32 s32, s20, 2
 v_mfma_f32_16x16x32_bf16 a[212:215], v[72:75], v[168:171], a[212:215]
 s_nop 0
 v_and_b32 v126, 31, v0
 v_mfma_f32_16x16x32_bf16 a[220:223], v[68:71], v[140:143], 0
 s_lshl_b32 s22, s3, 12
 v_mfma_f32_16x16x32_bf16 a[220:223], v[72:75], v[172:175], a[220:223]
 buffer_load_dwordx4 v2, s[4:7], s25 offen offset:0  lds
 v_mfma_f32_16x16x32_bf16 a[4:7], v[68:71], v[144:147], 0
 ds_read_b64_tr_b16 v[64:65], v18 offset:8192
 v_mfma_f32_16x16x32_bf16 a[4:7], v[72:75], v[176:179], a[4:7]
 ds_read_b64_tr_b16 v[66:67], v18 offset:9216
 v_lshl_add_u32 v126, v126, 2, s22
 v_mfma_f32_16x16x32_bf16 a[12:15], v[68:71], v[148:151], 0
 s_min_u32 s22, s3, 1
 v_mfma_f32_16x16x32_bf16 a[12:15], v[72:75], v[180:183], a[12:15]
 s_lshl_b32 s22, s22, 29
 v_mfma_f32_16x16x32_bf16 a[20:23], v[68:71], v[152:155], 0
 v_and_b32 v124, 7, v0
 v_mfma_f32_16x16x32_bf16 a[20:23], v[72:75], v[184:187], a[20:23]
 v_lshl_add_u32 v124, v124, 2, s22
 v_mfma_f32_16x16x32_bf16 a[28:31], v[68:71], v[156:159], 0
 buffer_load_dwordx4 v3, s[4:7], s25 offen offset:1024  lds
 v_mfma_f32_16x16x32_bf16 a[28:31], v[72:75], v[188:191], a[28:31]
 s_waitcnt lgkmcnt(8)
 s_lshl_b32 s55, s20, 7
 v_mfma_f32_16x16x32_bf16 a[224:227], v[76:79], v[128:131], 0
 ds_read_b64_tr_b16 v[68:69], v19 offset:0
 v_mfma_f32_16x16x32_bf16 a[224:227], v[80:83], v[160:163], a[224:227]
 ds_read_b64_tr_b16 v[70:71], v19 offset:1024
 v_mfma_f32_16x16x32_bf16 a[232:235], v[76:79], v[132:135], 0
 s_add_u32 s55, s55, 0x6304000
 v_mfma_f32_16x16x32_bf16 a[232:235], v[80:83], v[164:167], a[232:235]
 s_lshl_b32 s94, s21, 2
 v_mfma_f32_16x16x32_bf16 a[240:243], v[76:79], v[136:139], 0
 buffer_load_dwordx4 v4, s[4:7], s25 offen offset:2048  lds
 v_mfma_f32_16x16x32_bf16 a[240:243], v[80:83], v[168:171], a[240:243]
 s_add_u32 s94, s94, s55
 v_mfma_f32_16x16x32_bf16 a[248:251], v[76:79], v[140:143], 0
 s_lshr_b32 s71, s20, 3
 v_mfma_f32_16x16x32_bf16 a[248:251], v[80:83], v[172:175], a[248:251]
 s_lshl_b32 s64, s71, 3
 v_mfma_f32_16x16x32_bf16 a[32:35], v[76:79], v[144:147], 0
 ds_read_b64_tr_b16 v[72:73], v19 offset:8192
 s_add_u32 s64, s64, s21
 v_mfma_f32_16x16x32_bf16 a[32:35], v[80:83], v[176:179], a[32:35]
 ds_read_b64_tr_b16 v[74:75], v19 offset:9216
 v_mfma_f32_16x16x32_bf16 a[40:43], v[76:79], v[148:151], 0
 s_lshl_b32 s64, s64, 5
 v_mfma_f32_16x16x32_bf16 a[40:43], v[80:83], v[180:183], a[40:43]
 buffer_load_dwordx4 v5, s[4:7], s25 offen offset:3072  lds
 v_mfma_f32_16x16x32_bf16 a[48:51], v[76:79], v[152:155], 0
 s_and_b32 s70, s20, 7
 v_mfma_f32_16x16x32_bf16 a[48:51], v[80:83], v[184:187], a[48:51]
 s_add_u32 s64, s64, s70
 v_mfma_f32_16x16x32_bf16 a[56:59], v[76:79], v[156:159], 0
 s_lshl_b32 s64, s64, 2
 v_mfma_f32_16x16x32_bf16 a[56:59], v[80:83], v[188:191], a[56:59]
 s_waitcnt lgkmcnt(8)
 s_add_u32 s64, s64, 0x6300000
 v_mfma_f32_16x16x32_bf16 a[228:231], v[84:87], v[128:131], 0
 ds_read_b64_tr_b16 v[76:77], v20 offset:0
 v_mfma_f32_16x16x32_bf16 a[228:231], v[88:91], v[160:163], a[228:231]
 ds_read_b64_tr_b16 v[78:79], v20 offset:1024
 s_add_u32 m0, s29, 36864
 v_mfma_f32_16x16x32_bf16 a[236:239], v[84:87], v[132:135], 0
 s_sub_u32 s70, 15, s21
 v_mfma_f32_16x16x32_bf16 a[236:239], v[88:91], v[164:167], a[236:239]
 s_add_u32 s25, s25, 128
 s_bitcmp1_b32 s2, 0
 s_cselect_b32 s60, s70, s21
 v_mfma_f32_16x16x32_bf16 a[244:247], v[84:87], v[136:139], 0
 v_mfma_f32_16x16x32_bf16 a[244:247], v[88:91], v[168:171], a[244:247]
 buffer_load_dwordx4 v2, s[4:7], s26 offen offset:0  lds
 v_mfma_f32_16x16x32_bf16 a[252:255], v[84:87], v[140:143], 0
 s_lshl_b32 s65, s60, 2
 v_mfma_f32_16x16x32_bf16 a[252:255], v[88:91], v[172:175], a[252:255]
 s_and_b32 s70, s20, 3
 v_mfma_f32_16x16x32_bf16 a[36:39], v[84:87], v[144:147], 0
 ds_read_b64_tr_b16 v[80:81], v20 offset:8192
 v_mfma_f32_16x16x32_bf16 a[36:39], v[88:91], v[176:179], a[36:39]
 ds_read_b64_tr_b16 v[82:83], v20 offset:9216
 s_add_u32 s61, s65, s70
 v_mfma_f32_16x16x32_bf16 a[44:47], v[84:87], v[148:151], 0
 v_mfma_f32_16x16x32_bf16 a[44:47], v[88:91], v[180:183], a[44:47]
 s_lshl_b32 s65, s61, 5
 v_mfma_f32_16x16x32_bf16 a[52:55], v[84:87], v[152:155], 0
 buffer_load_dwordx4 v3, s[4:7], s26 offen offset:1024  lds
 v_mfma_f32_16x16x32_bf16 a[52:55], v[88:91], v[184:187], a[52:55]
 s_add_u32 s65, s65, s71
 v_mfma_f32_16x16x32_bf16 a[60:63], v[84:87], v[156:159], 0
 s_lshl_b32 s65, s65, 2
 v_mfma_f32_16x16x32_bf16 a[60:63], v[88:91], v[188:191], a[60:63]
 s_waitcnt lgkmcnt(8)
 s_add_u32 s65, s65, 0x6301000
 v_mfma_f32_16x16x32_bf16 a[128:131], v[60:63], v[128:131], 0
 ds_read_b64_tr_b16 v[84:85], v21 offset:0
 v_mov_b32 v28, 0
 v_mfma_f32_16x16x32_bf16 a[128:131], v[64:67], v[160:163], a[128:131]
 ds_read_b64_tr_b16 v[86:87], v21 offset:1024
 v_mfma_f32_16x16x32_bf16 a[136:139], v[60:63], v[132:135], 0
 buffer_load_dwordx4 v4, s[4:7], s26 offen offset:2048  lds
 v_mfma_f32_16x16x32_bf16 a[136:139], v[64:67], v[164:167], a[136:139]
 buffer_store_dword v28, v121, s[16:19], s64 offen sc1
 v_mfma_f32_16x16x32_bf16 a[144:147], v[60:63], v[136:139], 0
 v_mfma_f32_16x16x32_bf16 a[144:147], v[64:67], v[168:171], a[144:147]
 v_mfma_f32_16x16x32_bf16 a[152:155], v[60:63], v[140:143], 0
 v_mfma_f32_16x16x32_bf16 a[152:155], v[64:67], v[172:175], a[152:155]
 v_mfma_f32_16x16x32_bf16 a[64:67], v[60:63], v[144:147], 0
 ds_read_b64_tr_b16 v[88:89], v21 offset:8192
 v_mfma_f32_16x16x32_bf16 a[64:67], v[64:67], v[176:179], a[64:67]
 ds_read_b64_tr_b16 v[90:91], v21 offset:9216
 v_mfma_f32_16x16x32_bf16 a[72:75], v[60:63], v[148:151], 0
 buffer_load_dwordx4 v5, s[4:7], s26 offen offset:3072  lds
 v_mfma_f32_16x16x32_bf16 a[72:75], v[64:67], v[180:183], a[72:75]
 buffer_store_dword v28, v121, s[16:19], s65 offen sc1
 v_mfma_f32_16x16x32_bf16 a[80:83], v[60:63], v[152:155], 0
 v_mfma_f32_16x16x32_bf16 a[80:83], v[64:67], v[184:187], a[80:83]
 v_mfma_f32_16x16x32_bf16 a[88:91], v[60:63], v[156:159], 0
 s_add_u32 s26, s26, 128
 v_mfma_f32_16x16x32_bf16 a[88:91], v[64:67], v[188:191], a[88:91]
 s_waitcnt lgkmcnt(8)
 v_mfma_f32_16x16x32_bf16 a[132:135], v[68:71], v[128:131], 0
 buffer_load_dword v122, v50, s[4:7], 0 offen
 v_mfma_f32_16x16x32_bf16 a[132:135], v[72:75], v[160:163], a[132:135]
 v_mfma_f32_16x16x32_bf16 a[140:143], v[68:71], v[132:135], 0
 v_mfma_f32_16x16x32_bf16 a[140:143], v[72:75], v[164:167], a[140:143]
 buffer_store_dword v28, v121, s[16:19], s94 offen sc1
 v_mfma_f32_16x16x32_bf16 a[148:151], v[68:71], v[136:139], 0
 v_mfma_f32_16x16x32_bf16 a[148:151], v[72:75], v[168:171], a[148:151]
 v_mfma_f32_16x16x32_bf16 a[156:159], v[68:71], v[140:143], 0
 v_mfma_f32_16x16x32_bf16 a[156:159], v[72:75], v[172:175], a[156:159]
 s_waitcnt vmcnt(12) lgkmcnt(0)
 s_barrier
 v_mfma_f32_16x16x32_bf16 a[68:71], v[68:71], v[144:147], 0
 ds_read_b64_tr_b16 v[60:61], v14 offset:32768
 s_add_u32 m0, s30, 98304
 v_mfma_f32_16x16x32_bf16 a[68:71], v[72:75], v[176:179], a[68:71]
 ds_read_b64_tr_b16 v[62:63], v14 offset:33792
 s_nop 0
 v_mfma_f32_16x16x32_bf16 a[76:79], v[68:71], v[148:151], 0
 ds_read_b64_tr_b16 v[64:65], v14 offset:40960
 v_mfma_f32_16x16x32_bf16 a[76:79], v[72:75], v[180:183], a[76:79]
 ds_read_b64_tr_b16 v[66:67], v14 offset:41984
 v_mfma_f32_16x16x32_bf16 a[84:87], v[68:71], v[152:155], 0
 ds_read_b128 v[192:195], v12 offset:0
 v_mfma_f32_16x16x32_bf16 a[84:87], v[72:75], v[184:187], a[84:87]
 ds_read_b128 v[224:227], v13 offset:0
 v_mfma_f32_16x16x32_bf16 a[92:95], v[68:71], v[156:159], 0
 ds_read_b128 v[196:199], v12 offset:2048
 v_mfma_f32_16x16x32_bf16 a[92:95], v[72:75], v[188:191], a[92:95]
 ds_read_b128 v[228:231], v13 offset:2048
 v_mfma_f32_16x16x32_bf16 a[160:163], v[76:79], v[128:131], 0
 ds_read_b128 v[200:203], v12 offset:4096
 v_and_b32 v41, 15, v0
 v_mfma_f32_16x16x32_bf16 a[160:163], v[80:83], v[160:163], a[160:163]
 ds_read_b64_tr_b16 v[68:69], v15 offset:32768
 v_mfma_f32_16x16x32_bf16 a[168:171], v[76:79], v[132:135], 0
 ds_read_b64_tr_b16 v[70:71], v15 offset:33792
 v_mfma_f32_16x16x32_bf16 a[168:171], v[80:83], v[164:167], a[168:171]
 ds_read_b128 v[232:235], v13 offset:4096
 v_mfma_f32_16x16x32_bf16 a[176:179], v[76:79], v[136:139], 0
 ds_read_b128 v[204:207], v12 offset:6144
 v_mfma_f32_16x16x32_bf16 a[176:179], v[80:83], v[168:171], a[176:179]
 ds_read_b128 v[236:239], v13 offset:6144
 v_mfma_f32_16x16x32_bf16 a[184:187], v[76:79], v[140:143], 0
 ds_read_b128 v[208:211], v12 offset:8192
 buffer_load_dwordx4 v6, s[8:11], s27 offen offset:0  lds
 v_mfma_f32_16x16x32_bf16 a[184:187], v[80:83], v[172:175], a[184:187]
 ds_read_b128 v[240:243], v13 offset:8192
 s_lshr_b32 s22, s2, 3
 v_mfma_f32_16x16x32_bf16 a[96:99], v[76:79], v[144:147], 0
 ds_read_b64_tr_b16 v[72:73], v15 offset:40960
 v_mfma_f32_16x16x32_bf16 a[96:99], v[80:83], v[176:179], a[96:99]
 ds_read_b64_tr_b16 v[74:75], v15 offset:41984
 v_mfma_f32_16x16x32_bf16 a[104:107], v[76:79], v[148:151], 0
 ds_read_b128 v[212:215], v12 offset:10240
 v_mfma_f32_16x16x32_bf16 a[104:107], v[80:83], v[180:183], a[104:107]
 ds_read_b128 v[244:247], v13 offset:10240
 buffer_load_dwordx4 v7, s[8:11], s27 offen offset:1024  lds
 v_mfma_f32_16x16x32_bf16 a[112:115], v[76:79], v[152:155], 0
 ds_read_b128 v[216:219], v12 offset:12288
 v_mfma_f32_16x16x32_bf16 a[112:115], v[80:83], v[184:187], a[112:115]
 ds_read_b128 v[248:251], v13 offset:12288
 v_mfma_f32_16x16x32_bf16 a[120:123], v[76:79], v[156:159], 0
 buffer_load_dwordx4 v8, s[8:11], s27 offen offset:2048  lds
 v_mfma_f32_16x16x32_bf16 a[120:123], v[80:83], v[188:191], a[120:123]
 ds_read_b128 v[220:223], v12 offset:14336
 v_mfma_f32_16x16x32_bf16 a[164:167], v[84:87], v[128:131], 0
 ds_read_b128 v[252:255], v13 offset:14336
 v_mfma_f32_16x16x32_bf16 a[164:167], v[88:91], v[160:163], a[164:167]
 ds_read_b64_tr_b16 v[76:77], v16 offset:32768
 s_lshl_b32 s22, s22, 2
 v_mfma_f32_16x16x32_bf16 a[172:175], v[84:87], v[132:135], 0
 ds_read_b64_tr_b16 v[78:79], v16 offset:33792
 v_add_u32 v12, 0x8000, v12
 v_mfma_f32_16x16x32_bf16 a[172:175], v[88:91], v[164:167], a[172:175]
 v_add_u32 v13, 0x8000, v13
 v_mfma_f32_16x16x32_bf16 a[180:183], v[84:87], v[136:139], 0
 buffer_load_dwordx4 v9, s[8:11], s27 offen offset:3072  lds
 v_mfma_f32_16x16x32_bf16 a[180:183], v[88:91], v[168:171], a[180:183]
 s_add_u32 m0, s30, 102400
 s_add_u32 s27, s27, 524288
 v_mfma_f32_16x16x32_bf16 a[188:191], v[84:87], v[140:143], 0
 buffer_load_dwordx4 v6, s[8:11], s62 offen offset:0  lds
 v_mfma_f32_16x16x32_bf16 a[188:191], v[88:91], v[172:175], a[188:191]
 buffer_load_dwordx4 v7, s[8:11], s62 offen offset:1024  lds
 v_mfma_f32_16x16x32_bf16 a[100:103], v[84:87], v[144:147], 0
 ds_read_b64_tr_b16 v[80:81], v16 offset:40960
 v_mfma_f32_16x16x32_bf16 a[100:103], v[88:91], v[176:179], a[100:103]
 ds_read_b64_tr_b16 v[82:83], v16 offset:41984
 v_mfma_f32_16x16x32_bf16 a[108:111], v[84:87], v[148:151], 0
 buffer_load_dwordx4 v8, s[8:11], s62 offen offset:2048  lds
 v_mfma_f32_16x16x32_bf16 a[108:111], v[88:91], v[180:183], a[108:111]
 v_mfma_f32_16x16x32_bf16 a[116:119], v[84:87], v[152:155], 0
 buffer_load_dwordx4 v9, s[8:11], s62 offen offset:3072  lds
 v_mfma_f32_16x16x32_bf16 a[116:119], v[88:91], v[184:187], a[116:119]
 s_add_u32 s22, s22, s3
 v_mfma_f32_16x16x32_bf16 a[124:127], v[84:87], v[156:159], 0
 s_add_u32 s62, s62, 524288
 v_mfma_f32_16x16x32_bf16 a[124:127], v[88:91], v[188:191], a[124:127]
 s_waitcnt lgkmcnt(4)
 s_mov_b32 s35, 0x200000
 v_mfma_f32_16x16x32_bf16 a[192:195], v[60:63], v[192:195], a[192:195]
 ds_read_b64_tr_b16 v[84:85], v17 offset:32768
 v_mfma_f32_16x16x32_bf16 a[192:195], v[64:67], v[224:227], a[192:195]
 ds_read_b64_tr_b16 v[86:87], v17 offset:33792
 s_lshl_b32 s23, s22, 14
 v_mfma_f32_16x16x32_bf16 a[200:203], v[64:67], v[228:231], a[200:203]
 buffer_load_dword v122, v55, s[8:11], s35 offen
 v_mfma_f32_16x16x32_bf16 a[200:203], v[60:63], v[196:199], a[200:203]
 v_mfma_f32_16x16x32_bf16 a[208:211], v[60:63], v[200:203], a[208:211]
 s_add_u32 m0, s29, 65536
 v_mfma_f32_16x16x32_bf16 a[208:211], v[64:67], v[232:235], a[208:211]
 v_mfma_f32_16x16x32_bf16 a[216:219], v[64:67], v[236:239], a[216:219]
 s_nop 0
 s_and_b32 s24, s2, 7
 v_mfma_f32_16x16x32_bf16 a[216:219], v[60:63], v[204:207], a[216:219]
 v_mfma_f32_16x16x32_bf16 a[0:3], v[60:63], v[208:211], a[0:3]
 ds_read_b64_tr_b16 v[88:89], v17 offset:40960
 v_mfma_f32_16x16x32_bf16 a[0:3], v[64:67], v[240:243], a[0:3]
 ds_read_b64_tr_b16 v[90:91], v17 offset:41984
 v_mfma_f32_16x16x32_bf16 a[8:11], v[64:67], v[244:247], a[8:11]
 buffer_load_dwordx4 v2, s[4:7], s25 offen offset:0  lds
 v_mfma_f32_16x16x32_bf16 a[8:11], v[60:63], v[212:215], a[8:11]
 s_lshl_b32 s24, s24, 10
 v_mfma_f32_16x16x32_bf16 a[16:19], v[60:63], v[216:219], a[16:19]
 v_mfma_f32_16x16x32_bf16 a[16:19], v[64:67], v[248:251], a[16:19]
 v_mfma_f32_16x16x32_bf16 a[24:27], v[64:67], v[252:255], a[24:27]
 s_add_u32 s23, s23, s24
 v_mfma_f32_16x16x32_bf16 a[24:27], v[60:63], v[220:223], a[24:27]
 v_mfma_f32_16x16x32_bf16 a[196:199], v[68:71], v[192:195], a[196:199]
 ds_read_b64_tr_b16 v[60:61], v18 offset:32768
 v_mfma_f32_16x16x32_bf16 a[196:199], v[72:75], v[224:227], a[196:199]
 ds_read_b64_tr_b16 v[62:63], v18 offset:33792
 v_mfma_f32_16x16x32_bf16 a[204:207], v[72:75], v[228:231], a[204:207]
 buffer_load_dwordx4 v3, s[4:7], s25 offen offset:1024  lds
 v_mfma_f32_16x16x32_bf16 a[204:207], v[68:71], v[196:199], a[204:207]
 v_mfma_f32_16x16x32_bf16 a[212:215], v[68:71], v[200:203], a[212:215]
 v_lshrrev_b32 v42, 3, v41
 v_mfma_f32_16x16x32_bf16 a[212:215], v[72:75], v[232:235], a[212:215]
 v_mfma_f32_16x16x32_bf16 a[220:223], v[72:75], v[236:239], a[220:223]
 v_mfma_f32_16x16x32_bf16 a[220:223], v[68:71], v[204:207], a[220:223]
 v_lshlrev_b32 v42, 13, v42
 v_mfma_f32_16x16x32_bf16 a[4:7], v[68:71], v[208:211], a[4:7]
 ds_read_b64_tr_b16 v[64:65], v18 offset:40960
 v_mfma_f32_16x16x32_bf16 a[4:7], v[72:75], v[240:243], a[4:7]
 ds_read_b64_tr_b16 v[66:67], v18 offset:41984
 v_mfma_f32_16x16x32_bf16 a[12:15], v[72:75], v[244:247], a[12:15]
 buffer_load_dwordx4 v4, s[4:7], s25 offen offset:2048  lds
 v_mfma_f32_16x16x32_bf16 a[12:15], v[68:71], v[212:215], a[12:15]
 v_mfma_f32_16x16x32_bf16 a[20:23], v[68:71], v[216:219], a[20:23]
 v_lshl_add_u32 v42, v32, 7, v42
 v_mfma_f32_16x16x32_bf16 a[20:23], v[72:75], v[248:251], a[20:23]
 v_mfma_f32_16x16x32_bf16 a[28:31], v[72:75], v[252:255], a[28:31]
 v_mfma_f32_16x16x32_bf16 a[28:31], v[68:71], v[220:223], a[28:31]
 s_waitcnt lgkmcnt(8)
 v_mfma_f32_16x16x32_bf16 a[224:227], v[76:79], v[192:195], a[224:227]
 ds_read_b64_tr_b16 v[68:69], v19 offset:32768
 v_add_u32 v51, s23, v42
 v_mfma_f32_16x16x32_bf16 a[224:227], v[80:83], v[224:227], a[224:227]
 ds_read_b64_tr_b16 v[70:71], v19 offset:33792
 v_mfma_f32_16x16x32_bf16 a[232:235], v[80:83], v[228:231], a[232:235]
 buffer_load_dwordx4 v5, s[4:7], s25 offen offset:3072  lds
 v_mfma_f32_16x16x32_bf16 a[232:235], v[76:79], v[196:199], a[232:235]
 v_mfma_f32_16x16x32_bf16 a[240:243], v[76:79], v[200:203], a[240:243]
 v_mfma_f32_16x16x32_bf16 a[240:243], v[80:83], v[232:235], a[240:243]
 v_add_u32 v52, 0x200000, v51
 v_mfma_f32_16x16x32_bf16 a[248:251], v[80:83], v[236:239], a[248:251]
 v_mfma_f32_16x16x32_bf16 a[248:251], v[76:79], v[204:207], a[248:251]
 v_mfma_f32_16x16x32_bf16 a[32:35], v[76:79], v[208:211], a[32:35]
 ds_read_b64_tr_b16 v[72:73], v19 offset:40960
 s_add_u32 m0, s29, 69632
 v_mfma_f32_16x16x32_bf16 a[32:35], v[80:83], v[240:243], a[32:35]
 ds_read_b64_tr_b16 v[74:75], v19 offset:41984
 v_mfma_f32_16x16x32_bf16 a[40:43], v[80:83], v[244:247], a[40:43]
 s_lshl_b32 s23, s22, 14
 v_mfma_f32_16x16x32_bf16 a[40:43], v[76:79], v[212:215], a[40:43]
 s_add_u32 s25, s25, 128
 v_mfma_f32_16x16x32_bf16 a[48:51], v[76:79], v[216:219], a[48:51]
 v_mfma_f32_16x16x32_bf16 a[48:51], v[80:83], v[248:251], a[48:51]
 buffer_load_dwordx4 v2, s[4:7], s26 offen offset:0  lds
 v_mfma_f32_16x16x32_bf16 a[56:59], v[80:83], v[252:255], a[56:59]
 v_and_b32 v42, 1, v31
 v_mfma_f32_16x16x32_bf16 a[56:59], v[76:79], v[220:223], a[56:59]
 s_waitcnt lgkmcnt(8)
 v_mfma_f32_16x16x32_bf16 a[228:231], v[84:87], v[192:195], a[228:231]
 ds_read_b64_tr_b16 v[76:77], v20 offset:32768
 v_mfma_f32_16x16x32_bf16 a[228:231], v[88:91], v[224:227], a[228:231]
 ds_read_b64_tr_b16 v[78:79], v20 offset:33792
 v_mfma_f32_16x16x32_bf16 a[236:239], v[88:91], v[228:231], a[236:239]
 v_mfma_f32_16x16x32_bf16 a[236:239], v[84:87], v[196:199], a[236:239]
 v_lshlrev_b32 v42, 7, v42
 v_mfma_f32_16x16x32_bf16 a[244:247], v[84:87], v[200:203], a[244:247]
 v_mfma_f32_16x16x32_bf16 a[244:247], v[88:91], v[232:235], a[244:247]
 buffer_load_dwordx4 v3, s[4:7], s26 offen offset:1024  lds
 v_mfma_f32_16x16x32_bf16 a[252:255], v[88:91], v[236:239], a[252:255]
 v_mfma_f32_16x16x32_bf16 a[252:255], v[84:87], v[204:207], a[252:255]
 v_lshl_add_u32 v42, v41, 10, v42
 v_mfma_f32_16x16x32_bf16 a[36:39], v[84:87], v[208:211], a[36:39]
 ds_read_b64_tr_b16 v[80:81], v20 offset:40960
 v_mfma_f32_16x16x32_bf16 a[36:39], v[88:91], v[240:243], a[36:39]
 ds_read_b64_tr_b16 v[82:83], v20 offset:41984
 v_mfma_f32_16x16x32_bf16 a[44:47], v[88:91], v[244:247], a[44:47]
 v_mfma_f32_16x16x32_bf16 a[44:47], v[84:87], v[212:215], a[44:47]
 v_add_u32 v54, s23, v42
 v_mfma_f32_16x16x32_bf16 a[52:55], v[84:87], v[216:219], a[52:55]
 v_mfma_f32_16x16x32_bf16 a[52:55], v[88:91], v[248:251], a[52:55]
 buffer_load_dwordx4 v4, s[4:7], s26 offen offset:2048  lds
 v_mfma_f32_16x16x32_bf16 a[60:63], v[88:91], v[252:255], a[60:63]
 v_mfma_f32_16x16x32_bf16 a[60:63], v[84:87], v[220:223], a[60:63]
 s_waitcnt lgkmcnt(8)
 v_mfma_f32_16x16x32_bf16 a[128:131], v[60:63], v[192:195], a[128:131]
 ds_read_b64_tr_b16 v[84:85], v21 offset:32768
 s_mul_i32 s22, s22, 12288
 v_mfma_f32_16x16x32_bf16 a[128:131], v[64:67], v[224:227], a[128:131]
 ds_read_b64_tr_b16 v[86:87], v21 offset:33792
 v_mfma_f32_16x16x32_bf16 a[136:139], v[64:67], v[228:231], a[136:139]
 v_mfma_f32_16x16x32_bf16 a[136:139], v[60:63], v[196:199], a[136:139]
 v_mfma_f32_16x16x32_bf16 a[144:147], v[60:63], v[200:203], a[144:147]
 s_lshr_b32 s24, s24, 3
 v_mfma_f32_16x16x32_bf16 a[144:147], v[64:67], v[232:235], a[144:147]
 buffer_load_dwordx4 v5, s[4:7], s26 offen offset:3072  lds
 v_mfma_f32_16x16x32_bf16 a[152:155], v[64:67], v[236:239], a[152:155]
 v_mfma_f32_16x16x32_bf16 a[152:155], v[60:63], v[204:207], a[152:155]
 v_mfma_f32_16x16x32_bf16 a[64:67], v[60:63], v[208:211], a[64:67]
 ds_read_b64_tr_b16 v[88:89], v21 offset:40960
 v_mfma_f32_16x16x32_bf16 a[64:67], v[64:67], v[240:243], a[64:67]
 ds_read_b64_tr_b16 v[90:91], v21 offset:41984
 s_add_u32 s22, s22, s24
 v_mfma_f32_16x16x32_bf16 a[72:75], v[64:67], v[244:247], a[72:75]
 v_mfma_f32_16x16x32_bf16 a[72:75], v[60:63], v[212:215], a[72:75]
 v_mfma_f32_16x16x32_bf16 a[80:83], v[60:63], v[216:219], a[80:83]
 v_mfma_f32_16x16x32_bf16 a[80:83], v[64:67], v[248:251], a[80:83]
 s_add_u32 s26, s26, 128
 v_min_u32 v41, 11, v41
 v_mfma_f32_16x16x32_bf16 a[88:91], v[64:67], v[252:255], a[88:91]
 v_mfma_f32_16x16x32_bf16 a[88:91], v[60:63], v[220:223], a[88:91]
 s_waitcnt lgkmcnt(8)
 v_mfma_f32_16x16x32_bf16 a[132:135], v[68:71], v[192:195], a[132:135]
 v_lshl_add_u32 v53, v41, 10, s22
 v_mfma_f32_16x16x32_bf16 a[132:135], v[72:75], v[224:227], a[132:135]
 v_mfma_f32_16x16x32_bf16 a[140:143], v[72:75], v[228:231], a[140:143]
 v_mfma_f32_16x16x32_bf16 a[140:143], v[68:71], v[196:199], a[140:143]
 v_mfma_f32_16x16x32_bf16 a[148:151], v[68:71], v[200:203], a[148:151]
 v_mfma_f32_16x16x32_bf16 a[148:151], v[72:75], v[232:235], a[148:151]
 v_mfma_f32_16x16x32_bf16 a[156:159], v[72:75], v[236:239], a[156:159]
 v_mfma_f32_16x16x32_bf16 a[156:159], v[68:71], v[204:207], a[156:159]
 s_waitcnt vmcnt(9) lgkmcnt(0)
 s_barrier
 v_mfma_f32_16x16x32_bf16 a[68:71], v[68:71], v[208:211], a[68:71]
 ds_read_b64_tr_b16 v[60:61], v14 offset:0
 s_add_u32 m0, s30, 131072
 v_mfma_f32_16x16x32_bf16 a[68:71], v[72:75], v[240:243], a[68:71]
 ds_read_b64_tr_b16 v[62:63], v14 offset:1024
 s_nop 0
 v_mfma_f32_16x16x32_bf16 a[76:79], v[72:75], v[244:247], a[76:79]
 ds_read_b64_tr_b16 v[64:65], v14 offset:8192
 v_lshrrev_b32 v39, 1, v35
 v_mfma_f32_16x16x32_bf16 a[76:79], v[68:71], v[212:215], a[76:79]
 ds_read_b64_tr_b16 v[66:67], v14 offset:9216
 v_mfma_f32_16x16x32_bf16 a[84:87], v[68:71], v[216:219], a[84:87]
 ds_read_b128 v[128:131], v12 offset:0
 v_mfma_f32_16x16x32_bf16 a[84:87], v[72:75], v[248:251], a[84:87]
 ds_read_b128 v[160:163], v13 offset:0
 v_mfma_f32_16x16x32_bf16 a[92:95], v[72:75], v[252:255], a[92:95]
 ds_read_b128 v[132:135], v12 offset:2048
 v_lshlrev_b32 v39, 2, v39
 v_mfma_f32_16x16x32_bf16 a[92:95], v[68:71], v[220:223], a[92:95]
 ds_read_b128 v[164:167], v13 offset:2048
 v_mfma_f32_16x16x32_bf16 a[160:163], v[76:79], v[192:195], a[160:163]
 ds_read_b128 v[136:139], v12 offset:4096
 v_mfma_f32_16x16x32_bf16 a[160:163], v[80:83], v[224:227], a[160:163]
 ds_read_b64_tr_b16 v[68:69], v15 offset:0
 v_mfma_f32_16x16x32_bf16 a[168:171], v[80:83], v[228:231], a[168:171]
 ds_read_b64_tr_b16 v[70:71], v15 offset:1024
 v_mfma_f32_16x16x32_bf16 a[168:171], v[76:79], v[196:199], a[168:171]
 ds_read_b128 v[168:171], v13 offset:4096
 v_xor_b32 v39, v39, v37
 v_mfma_f32_16x16x32_bf16 a[176:179], v[76:79], v[200:203], a[176:179]
 ds_read_b128 v[140:143], v12 offset:6144
 v_mfma_f32_16x16x32_bf16 a[176:179], v[80:83], v[232:235], a[176:179]
 ds_read_b128 v[172:175], v13 offset:6144
 buffer_load_dwordx4 v6, s[8:11], s27 offen offset:0  lds
 v_mfma_f32_16x16x32_bf16 a[184:187], v[80:83], v[236:239], a[184:187]
 ds_read_b128 v[144:147], v12 offset:8192
 v_mfma_f32_16x16x32_bf16 a[184:187], v[76:79], v[204:207], a[184:187]
 ds_read_b128 v[176:179], v13 offset:8192
 v_mfma_f32_16x16x32_bf16 a[96:99], v[76:79], v[208:211], a[96:99]
 ds_read_b64_tr_b16 v[72:73], v15 offset:8192
 v_mfma_f32_16x16x32_bf16 a[96:99], v[80:83], v[240:243], a[96:99]
 ds_read_b64_tr_b16 v[74:75], v15 offset:9216
 buffer_load_dwordx4 v7, s[8:11], s27 offen offset:1024  lds
 v_mfma_f32_16x16x32_bf16 a[104:107], v[80:83], v[244:247], a[104:107]
 ds_read_b128 v[148:151], v12 offset:10240
 v_lshlrev_b32 v39, 4, v39
 v_mfma_f32_16x16x32_bf16 a[104:107], v[76:79], v[212:215], a[104:107]
 ds_read_b128 v[180:183], v13 offset:10240
 v_mfma_f32_16x16x32_bf16 a[112:115], v[76:79], v[216:219], a[112:115]
 ds_read_b128 v[152:155], v12 offset:12288
 v_mfma_f32_16x16x32_bf16 a[112:115], v[80:83], v[248:251], a[112:115]
 ds_read_b128 v[184:187], v13 offset:12288
 v_mfma_f32_16x16x32_bf16 a[120:123], v[80:83], v[252:255], a[120:123]
 buffer_load_dwordx4 v8, s[8:11], s27 offen offset:2048  lds
 v_mfma_f32_16x16x32_bf16 a[120:123], v[76:79], v[220:223], a[120:123]
 ds_read_b128 v[156:159], v12 offset:14336
 v_mfma_f32_16x16x32_bf16 a[164:167], v[84:87], v[192:195], a[164:167]
 ds_read_b128 v[188:191], v13 offset:14336
 v_lshl_add_u32 v39, v36, 7, v39
 v_mfma_f32_16x16x32_bf16 a[164:167], v[88:91], v[224:227], a[164:167]
 ds_read_b64_tr_b16 v[76:77], v16 offset:0
 v_mfma_f32_16x16x32_bf16 a[172:175], v[88:91], v[228:231], a[172:175]
 ds_read_b64_tr_b16 v[78:79], v16 offset:1024
 v_add_u32 v12, 0x8000, v12
 v_mfma_f32_16x16x32_bf16 a[172:175], v[84:87], v[196:199], a[172:175]
 buffer_load_dwordx4 v9, s[8:11], s27 offen offset:3072  lds
 v_add_u32 v13, 0x8000, v13
 v_mfma_f32_16x16x32_bf16 a[180:183], v[84:87], v[200:203], a[180:183]
 s_add_u32 m0, s30, 135168
 s_add_u32 s27, s27, 524288
 v_mfma_f32_16x16x32_bf16 a[180:183], v[88:91], v[232:235], a[180:183]
 buffer_load_dwordx4 v6, s[8:11], s62 offen offset:0  lds
 v_mfma_f32_16x16x32_bf16 a[188:191], v[88:91], v[236:239], a[188:191]
 buffer_load_dwordx4 v7, s[8:11], s62 offen offset:1024  lds
 v_mfma_f32_16x16x32_bf16 a[188:191], v[84:87], v[204:207], a[188:191]
 buffer_load_dwordx4 v8, s[8:11], s62 offen offset:2048  lds
 v_mfma_f32_16x16x32_bf16 a[100:103], v[84:87], v[208:211], a[100:103]
 ds_read_b64_tr_b16 v[80:81], v16 offset:8192
 v_mfma_f32_16x16x32_bf16 a[100:103], v[88:91], v[240:243], a[100:103]
 ds_read_b64_tr_b16 v[82:83], v16 offset:9216
 v_mfma_f32_16x16x32_bf16 a[108:111], v[88:91], v[244:247], a[108:111]
 buffer_load_dwordx4 v9, s[8:11], s62 offen offset:3072  lds
 v_mfma_f32_16x16x32_bf16 a[108:111], v[84:87], v[212:215], a[108:111]
 v_add_u32 v39, v39, v38
 v_mfma_f32_16x16x32_bf16 a[116:119], v[84:87], v[216:219], a[116:119]
 v_mfma_f32_16x16x32_bf16 a[116:119], v[88:91], v[248:251], a[116:119]
 s_add_u32 s62, s62, 524288
 s_mov_b32 s35, 0x300000
 v_add_u32 v39, 114688, v39
 v_mfma_f32_16x16x32_bf16 a[124:127], v[88:91], v[252:255], a[124:127]
 buffer_load_dword v122, v55, s[8:11], s35 offen
 v_mfma_f32_16x16x32_bf16 a[124:127], v[84:87], v[220:223], a[124:127]
 s_waitcnt lgkmcnt(4)
 v_mfma_f32_16x16x32_bf16 a[192:195], v[60:63], v[128:131], a[192:195]
 ds_read_b64_tr_b16 v[84:85], v17 offset:0
 v_mfma_f32_16x16x32_bf16 a[192:195], v[64:67], v[160:163], a[192:195]
 ds_read_b64_tr_b16 v[86:87], v17 offset:1024
 v_xor_b32 v22, 0, v39
 v_mfma_f32_16x16x32_bf16 a[200:203], v[64:67], v[164:167], a[200:203]
 buffer_atomic_add v125, v120, s[40:43], s32 offen sc1
 v_mfma_f32_16x16x32_bf16 a[200:203], v[60:63], v[132:135], a[200:203]
 v_mfma_f32_16x16x32_bf16 a[208:211], v[60:63], v[136:139], a[208:211]
 s_add_u32 m0, s29, 0
 v_mfma_f32_16x16x32_bf16 a[208:211], v[64:67], v[168:171], a[208:211]
 v_xor_b32 v23, 32, v39
 v_mfma_f32_16x16x32_bf16 a[216:219], v[64:67], v[172:175], a[216:219]
 s_nop 0
 v_mfma_f32_16x16x32_bf16 a[216:219], v[60:63], v[140:143], a[216:219]
 v_xor_b32 v24, 64, v39
 v_mfma_f32_16x16x32_bf16 a[0:3], v[60:63], v[144:147], a[0:3]
 ds_read_b64_tr_b16 v[88:89], v17 offset:8192
 v_mfma_f32_16x16x32_bf16 a[0:3], v[64:67], v[176:179], a[0:3]
 ds_read_b64_tr_b16 v[90:91], v17 offset:9216
 v_mfma_f32_16x16x32_bf16 a[8:11], v[64:67], v[180:183], a[8:11]
 buffer_load_dwordx4 v2, s[4:7], s25 offen offset:0  lds
 v_mfma_f32_16x16x32_bf16 a[8:11], v[60:63], v[148:151], a[8:11]
 s_and_b32 s22, s20, 3
 v_mfma_f32_16x16x32_bf16 a[16:19], v[60:63], v[152:155], a[16:19]
 v_mfma_f32_16x16x32_bf16 a[16:19], v[64:67], v[184:187], a[16:19]
 s_and_b32 s23, s2, 7
 v_mfma_f32_16x16x32_bf16 a[24:27], v[64:67], v[188:191], a[24:27]
 v_mfma_f32_16x16x32_bf16 a[24:27], v[60:63], v[156:159], a[24:27]
 v_mfma_f32_16x16x32_bf16 a[196:199], v[68:71], v[128:131], a[196:199]
 ds_read_b64_tr_b16 v[60:61], v18 offset:0
 s_lshl_b32 s23, s23, 7
 v_mfma_f32_16x16x32_bf16 a[196:199], v[72:75], v[160:163], a[196:199]
 ds_read_b64_tr_b16 v[62:63], v18 offset:1024
 v_mfma_f32_16x16x32_bf16 a[204:207], v[72:75], v[164:167], a[204:207]
 buffer_load_dwordx4 v3, s[4:7], s25 offen offset:1024  lds
 v_mfma_f32_16x16x32_bf16 a[204:207], v[68:71], v[132:135], a[204:207]
 v_mfma_f32_16x16x32_bf16 a[212:215], v[68:71], v[136:139], a[212:215]
 s_lshl_b32 s24, s22, 5
 v_mfma_f32_16x16x32_bf16 a[212:215], v[72:75], v[168:171], a[212:215]
 v_mfma_f32_16x16x32_bf16 a[220:223], v[72:75], v[172:175], a[220:223]
 s_add_u32 s24, s24, s23
 v_mfma_f32_16x16x32_bf16 a[220:223], v[68:71], v[140:143], a[220:223]
 v_mfma_f32_16x16x32_bf16 a[4:7], v[68:71], v[144:147], a[4:7]
 ds_read_b64_tr_b16 v[64:65], v18 offset:8192
 v_mfma_f32_16x16x32_bf16 a[4:7], v[72:75], v[176:179], a[4:7]
 ds_read_b64_tr_b16 v[66:67], v18 offset:9216
 s_add_u32 s24, s24, 1984
 v_mfma_f32_16x16x32_bf16 a[12:15], v[72:75], v[180:183], a[12:15]
 buffer_load_dwordx4 v4, s[4:7], s25 offen offset:2048  lds
 v_mfma_f32_16x16x32_bf16 a[12:15], v[68:71], v[148:151], a[12:15]
 v_mfma_f32_16x16x32_bf16 a[20:23], v[68:71], v[152:155], a[20:23]
 s_lshr_b32 s34, s22, 1
 v_mfma_f32_16x16x32_bf16 a[20:23], v[72:75], v[184:187], a[20:23]
 v_mfma_f32_16x16x32_bf16 a[28:31], v[72:75], v[188:191], a[28:31]
 v_mfma_f32_16x16x32_bf16 a[28:31], v[68:71], v[156:159], a[28:31]
 s_waitcnt lgkmcnt(8)
 s_lshl_b32 s34, s34, 10
 v_mfma_f32_16x16x32_bf16 a[224:227], v[76:79], v[128:131], a[224:227]
 ds_read_b64_tr_b16 v[68:69], v19 offset:0
 v_mfma_f32_16x16x32_bf16 a[224:227], v[80:83], v[160:163], a[224:227]
 ds_read_b64_tr_b16 v[70:71], v19 offset:1024
 v_mfma_f32_16x16x32_bf16 a[232:235], v[80:83], v[164:167], a[232:235]
 buffer_load_dwordx4 v5, s[4:7], s25 offen offset:3072  lds
 v_mfma_f32_16x16x32_bf16 a[232:235], v[76:79], v[132:135], a[232:235]
 s_add_u32 s23, s23, s34
 v_mfma_f32_16x16x32_bf16 a[240:243], v[76:79], v[136:139], a[240:243]
 v_mfma_f32_16x16x32_bf16 a[240:243], v[80:83], v[168:171], a[240:243]
 s_and_b32 s34, s22, 1
 v_mfma_f32_16x16x32_bf16 a[248:251], v[80:83], v[172:175], a[248:251]
 v_mfma_f32_16x16x32_bf16 a[248:251], v[76:79], v[140:143], a[248:251]
 s_lshl_b32 s34, s34, 6
 v_mfma_f32_16x16x32_bf16 a[32:35], v[76:79], v[144:147], a[32:35]
 ds_read_b64_tr_b16 v[72:73], v19 offset:8192
 s_add_u32 m0, s29, 4096
 v_mfma_f32_16x16x32_bf16 a[32:35], v[80:83], v[176:179], a[32:35]
 ds_read_b64_tr_b16 v[74:75], v19 offset:9216
 v_mfma_f32_16x16x32_bf16 a[40:43], v[80:83], v[180:183], a[40:43]
 v_mfma_f32_16x16x32_bf16 a[40:43], v[76:79], v[148:151], a[40:43]
 s_add_u32 s25, s25, 128
 s_add_u32 s23, s23, s34
 v_mfma_f32_16x16x32_bf16 a[48:51], v[76:79], v[152:155], a[48:51]
 v_mfma_f32_16x16x32_bf16 a[48:51], v[80:83], v[184:187], a[48:51]
 buffer_load_dwordx4 v2, s[4:7], s26 offen offset:0  lds
 v_mfma_f32_16x16x32_bf16 a[56:59], v[80:83], v[188:191], a[56:59]
 v_and_b32 v33, 1, v31
 v_mfma_f32_16x16x32_bf16 a[56:59], v[76:79], v[156:159], a[56:59]
 s_waitcnt lgkmcnt(8)
 v_mfma_f32_16x16x32_bf16 a[228:231], v[84:87], v[128:131], a[228:231]
 ds_read_b64_tr_b16 v[76:77], v20 offset:0
 v_mfma_f32_16x16x32_bf16 a[228:231], v[88:91], v[160:163], a[228:231]
 ds_read_b64_tr_b16 v[78:79], v20 offset:1024
 v_lshlrev_b32 v33, 2, v33
 v_mfma_f32_16x16x32_bf16 a[236:239], v[88:91], v[164:167], a[236:239]
 v_mfma_f32_16x16x32_bf16 a[236:239], v[84:87], v[132:135], a[236:239]
 v_mfma_f32_16x16x32_bf16 a[244:247], v[84:87], v[136:139], a[244:247]
 v_xor_b32 v33, v33, v32
 v_mfma_f32_16x16x32_bf16 a[244:247], v[88:91], v[168:171], a[244:247]
 buffer_load_dwordx4 v3, s[4:7], s26 offen offset:1024  lds
 v_mfma_f32_16x16x32_bf16 a[252:255], v[88:91], v[172:175], a[252:255]
 v_mfma_f32_16x16x32_bf16 a[252:255], v[84:87], v[140:143], a[252:255]
 v_mul_u32_u24 v34, 3072, v30
 v_mfma_f32_16x16x32_bf16 a[36:39], v[84:87], v[144:147], a[36:39]
 ds_read_b64_tr_b16 v[80:81], v20 offset:8192
 v_mfma_f32_16x16x32_bf16 a[36:39], v[88:91], v[176:179], a[36:39]
 ds_read_b64_tr_b16 v[82:83], v20 offset:9216
 v_mfma_f32_16x16x32_bf16 a[44:47], v[88:91], v[180:183], a[44:47]
 v_mov_b32 v36, s23
 v_mfma_f32_16x16x32_bf16 a[44:47], v[84:87], v[148:151], a[44:47]
 v_mfma_f32_16x16x32_bf16 a[52:55], v[84:87], v[152:155], a[52:55]
 v_mov_b32 v37, s24
 v_mfma_f32_16x16x32_bf16 a[52:55], v[88:91], v[184:187], a[52:55]
 buffer_load_dwordx4 v4, s[4:7], s26 offen offset:2048  lds
 v_mfma_f32_16x16x32_bf16 a[60:63], v[88:91], v[188:191], a[60:63]
 v_mfma_f32_16x16x32_bf16 a[60:63], v[84:87], v[156:159], a[60:63]
 s_waitcnt lgkmcnt(8)
 v_mov_b32 v38, 0x1000000
 v_mfma_f32_16x16x32_bf16 a[128:131], v[60:63], v[128:131], a[128:131]
 ds_read_b64_tr_b16 v[84:85], v21 offset:0
 v_mfma_f32_16x16x32_bf16 a[128:131], v[64:67], v[160:163], a[128:131]
 ds_read_b64_tr_b16 v[86:87], v21 offset:1024
 v_mfma_f32_16x16x32_bf16 a[136:139], v[64:67], v[164:167], a[136:139]
 v_mfma_f32_16x16x32_bf16 a[136:139], v[60:63], v[132:135], a[136:139]
 v_cmp_gt_u32 vcc, 4, v33
 v_mfma_f32_16x16x32_bf16 a[144:147], v[60:63], v[136:139], a[144:147]
 v_mfma_f32_16x16x32_bf16 a[144:147], v[64:67], v[168:171], a[144:147]
 buffer_load_dwordx4 v5, s[4:7], s26 offen offset:3072  lds
 v_mfma_f32_16x16x32_bf16 a[152:155], v[64:67], v[172:175], a[152:155]
 v_cmp_gt_u32 s[66:67], 6, v33
 v_mfma_f32_16x16x32_bf16 a[152:155], v[60:63], v[140:143], a[152:155]
 v_mfma_f32_16x16x32_bf16 a[64:67], v[60:63], v[144:147], a[64:67]
 ds_read_b64_tr_b16 v[88:89], v21 offset:8192
 v_mfma_f32_16x16x32_bf16 a[64:67], v[64:67], v[176:179], a[64:67]
 ds_read_b64_tr_b16 v[90:91], v21 offset:9216
 v_lshl_add_u32 v35, v33, 4, v34
 v_mfma_f32_16x16x32_bf16 a[72:75], v[64:67], v[180:183], a[72:75]
 v_mfma_f32_16x16x32_bf16 a[72:75], v[60:63], v[148:151], a[72:75]
 v_cndmask_b32 v39, v37, v36, vcc
 v_mfma_f32_16x16x32_bf16 a[80:83], v[60:63], v[152:155], a[80:83]
 v_mfma_f32_16x16x32_bf16 a[80:83], v[64:67], v[184:187], a[80:83]
 s_add_u32 s26, s26, 128
 v_mfma_f32_16x16x32_bf16 a[88:91], v[64:67], v[188:191], a[88:91]
 v_cndmask_b32 v39, v38, v39, s[66:67]
 v_mfma_f32_16x16x32_bf16 a[88:91], v[60:63], v[156:159], a[88:91]
 s_waitcnt lgkmcnt(8)
 v_mfma_f32_16x16x32_bf16 a[132:135], v[68:71], v[128:131], a[132:135]
 v_add_u32 v10, v35, v39
 v_mfma_f32_16x16x32_bf16 a[132:135], v[72:75], v[160:163], a[132:135]
 v_mfma_f32_16x16x32_bf16 a[140:143], v[72:75], v[164:167], a[140:143]
 v_xor_b32 v33, 2, v33
 v_mfma_f32_16x16x32_bf16 a[140:143], v[68:71], v[132:135], a[140:143]
 v_mfma_f32_16x16x32_bf16 a[148:151], v[68:71], v[136:139], a[148:151]
 v_add_u32 v34, 23552, v34
 v_mfma_f32_16x16x32_bf16 a[148:151], v[72:75], v[168:171], a[148:151]
 v_mfma_f32_16x16x32_bf16 a[156:159], v[72:75], v[172:175], a[156:159]
 v_cmp_gt_u32 vcc, 4, v33
 v_mfma_f32_16x16x32_bf16 a[156:159], v[68:71], v[140:143], a[156:159]
 s_waitcnt vmcnt(10) lgkmcnt(0)
 s_barrier
 v_mfma_f32_16x16x32_bf16 a[68:71], v[68:71], v[144:147], a[68:71]
 ds_read_b64_tr_b16 v[60:61], v14 offset:32768
 s_add_u32 m0, s30, 98304
 v_mfma_f32_16x16x32_bf16 a[68:71], v[72:75], v[176:179], a[68:71]
 ds_read_b64_tr_b16 v[62:63], v14 offset:33792
 s_nop 0
 v_mfma_f32_16x16x32_bf16 a[76:79], v[72:75], v[180:183], a[76:79]
 ds_read_b64_tr_b16 v[64:65], v14 offset:40960
 v_mfma_f32_16x16x32_bf16 a[76:79], v[68:71], v[148:151], a[76:79]
 ds_read_b64_tr_b16 v[66:67], v14 offset:41984
 v_mfma_f32_16x16x32_bf16 a[84:87], v[68:71], v[152:155], a[84:87]
 ds_read_b128 v[192:195], v12 offset:0
 v_mfma_f32_16x16x32_bf16 a[84:87], v[72:75], v[184:187], a[84:87]
 ds_read_b128 v[224:227], v13 offset:0
 v_cmp_gt_u32 s[66:67], 6, v33
 v_mfma_f32_16x16x32_bf16 a[92:95], v[72:75], v[188:191], a[92:95]
 ds_read_b128 v[196:199], v12 offset:2048
 v_mfma_f32_16x16x32_bf16 a[92:95], v[68:71], v[156:159], a[92:95]
 ds_read_b128 v[228:231], v13 offset:2048
 v_mfma_f32_16x16x32_bf16 a[160:163], v[76:79], v[128:131], a[160:163]
 ds_read_b128 v[200:203], v12 offset:4096
 v_mfma_f32_16x16x32_bf16 a[160:163], v[80:83], v[160:163], a[160:163]
 ds_read_b64_tr_b16 v[68:69], v15 offset:32768
 v_mfma_f32_16x16x32_bf16 a[168:171], v[80:83], v[164:167], a[168:171]
 ds_read_b64_tr_b16 v[70:71], v15 offset:33792
 v_lshl_add_u32 v35, v33, 4, v34
 v_mfma_f32_16x16x32_bf16 a[168:171], v[76:79], v[132:135], a[168:171]
 ds_read_b128 v[232:235], v13 offset:4096
 v_mfma_f32_16x16x32_bf16 a[176:179], v[76:79], v[136:139], a[176:179]
 ds_read_b128 v[204:207], v12 offset:6144
 v_mfma_f32_16x16x32_bf16 a[176:179], v[80:83], v[168:171], a[176:179]
 ds_read_b128 v[236:239], v13 offset:6144
 buffer_load_dwordx4 v6, s[8:11], s27 offen offset:0  lds
 v_mfma_f32_16x16x32_bf16 a[184:187], v[80:83], v[172:175], a[184:187]
 ds_read_b128 v[208:211], v12 offset:8192
 v_mfma_f32_16x16x32_bf16 a[184:187], v[76:79], v[140:143], a[184:187]
 ds_read_b128 v[240:243], v13 offset:8192
 v_cndmask_b32 v39, v37, v36, vcc
 v_mfma_f32_16x16x32_bf16 a[96:99], v[76:79], v[144:147], a[96:99]
 ds_read_b64_tr_b16 v[72:73], v15 offset:40960
 v_mfma_f32_16x16x32_bf16 a[96:99], v[80:83], v[176:179], a[96:99]
 ds_read_b64_tr_b16 v[74:75], v15 offset:41984
 buffer_load_dwordx4 v7, s[8:11], s27 offen offset:1024  lds
 v_mfma_f32_16x16x32_bf16 a[104:107], v[80:83], v[180:183], a[104:107]
 ds_read_b128 v[212:215], v12 offset:10240
 v_mfma_f32_16x16x32_bf16 a[104:107], v[76:79], v[148:151], a[104:107]
 ds_read_b128 v[244:247], v13 offset:10240
 v_mfma_f32_16x16x32_bf16 a[112:115], v[76:79], v[152:155], a[112:115]
 ds_read_b128 v[216:219], v12 offset:12288
 v_mfma_f32_16x16x32_bf16 a[112:115], v[80:83], v[184:187], a[112:115]
 ds_read_b128 v[248:251], v13 offset:12288
 v_cndmask_b32 v39, v38, v39, s[66:67]
 v_mfma_f32_16x16x32_bf16 a[120:123], v[80:83], v[188:191], a[120:123]
 buffer_load_dwordx4 v8, s[8:11], s27 offen offset:2048  lds
 v_mfma_f32_16x16x32_bf16 a[120:123], v[76:79], v[156:159], a[120:123]
 ds_read_b128 v[220:223], v12 offset:14336
 v_mfma_f32_16x16x32_bf16 a[164:167], v[84:87], v[128:131], a[164:167]
 ds_read_b128 v[252:255], v13 offset:14336
 v_mfma_f32_16x16x32_bf16 a[164:167], v[88:91], v[160:163], a[164:167]
 ds_read_b64_tr_b16 v[76:77], v16 offset:32768
 v_mfma_f32_16x16x32_bf16 a[172:175], v[88:91], v[164:167], a[172:175]
 ds_read_b64_tr_b16 v[78:79], v16 offset:33792
 v_subrev_u32 v12, 0x10000, v12
 v_mfma_f32_16x16x32_bf16 a[172:175], v[84:87], v[132:135], a[172:175]
 v_subrev_u32 v13, 0x10000, v13
 v_mfma_f32_16x16x32_bf16 a[180:183], v[84:87], v[136:139], a[180:183]
 buffer_load_dwordx4 v9, s[8:11], s27 offen offset:3072  lds
 v_mfma_f32_16x16x32_bf16 a[180:183], v[88:91], v[168:171], a[180:183]
 s_add_u32 m0, s30, 102400
 s_add_u32 s27, s27, 524288
 v_add_u32 v11, v35, v39
 v_mfma_f32_16x16x32_bf16 a[188:191], v[88:91], v[172:175], a[188:191]
 buffer_load_dwordx4 v6, s[8:11], s62 offen offset:0  lds
 v_mfma_f32_16x16x32_bf16 a[188:191], v[84:87], v[140:143], a[188:191]
 buffer_load_dwordx4 v7, s[8:11], s62 offen offset:1024  lds
 v_mfma_f32_16x16x32_bf16 a[100:103], v[84:87], v[144:147], a[100:103]
 ds_read_b64_tr_b16 v[80:81], v16 offset:40960
 v_mfma_f32_16x16x32_bf16 a[100:103], v[88:91], v[176:179], a[100:103]
 ds_read_b64_tr_b16 v[82:83], v16 offset:41984
 v_mfma_f32_16x16x32_bf16 a[108:111], v[88:91], v[180:183], a[108:111]
 buffer_load_dwordx4 v8, s[8:11], s62 offen offset:2048  lds
 v_mfma_f32_16x16x32_bf16 a[108:111], v[84:87], v[148:151], a[108:111]
 buffer_load_dwordx4 v9, s[8:11], s62 offen offset:3072  lds
 v_mfma_f32_16x16x32_bf16 a[116:119], v[84:87], v[152:155], a[116:119]
 v_mfma_f32_16x16x32_bf16 a[116:119], v[88:91], v[184:187], a[116:119]
 s_add_u32 s62, s62, 524288
 s_lshl_b32 s22, s22, 11
 v_mfma_f32_16x16x32_bf16 a[124:127], v[88:91], v[188:191], a[124:127]
 global_load_dword v122, v50, s[36:37]
 v_mfma_f32_16x16x32_bf16 a[124:127], v[84:87], v[156:159], a[124:127]
 s_waitcnt lgkmcnt(4)
 v_mfma_f32_16x16x32_bf16 a[192:195], v[60:63], v[192:195], a[192:195]
 ds_read_b64_tr_b16 v[84:85], v17 offset:32768
 s_lshl_b32 s23, s3, 13
 v_mfma_f32_16x16x32_bf16 a[192:195], v[64:67], v[224:227], a[192:195]
 ds_read_b64_tr_b16 v[86:87], v17 offset:33792
 v_mfma_f32_16x16x32_bf16 a[200:203], v[64:67], v[228:231], a[200:203]
 global_load_dword v122, v127, s[0:1]
 v_mfma_f32_16x16x32_bf16 a[200:203], v[60:63], v[196:199], a[200:203]
 v_mfma_f32_16x16x32_bf16 a[208:211], v[60:63], v[200:203], a[208:211]
 s_add_u32 m0, s29, 32768
 s_add_u32 s22, s22, s23
 v_mfma_f32_16x16x32_bf16 a[208:211], v[64:67], v[232:235], a[208:211]
 v_mfma_f32_16x16x32_bf16 a[216:219], v[64:67], v[236:239], a[216:219]
 s_nop 0
 s_add_u32 s22, s22, 32768
 v_mfma_f32_16x16x32_bf16 a[216:219], v[60:63], v[204:207], a[216:219]
 v_mfma_f32_16x16x32_bf16 a[0:3], v[60:63], v[208:211], a[0:3]
 ds_read_b64_tr_b16 v[88:89], v17 offset:40960
 v_mfma_f32_16x16x32_bf16 a[0:3], v[64:67], v[240:243], a[0:3]
 ds_read_b64_tr_b16 v[90:91], v17 offset:41984
 v_add_u32 v26, s22, v40
 v_mfma_f32_16x16x32_bf16 a[8:11], v[64:67], v[244:247], a[8:11]
 buffer_load_dwordx4 v2, s[4:7], s25 offen offset:0  lds
 v_mfma_f32_16x16x32_bf16 a[8:11], v[60:63], v[212:215], a[8:11]
 v_mfma_f32_16x16x32_bf16 a[16:19], v[60:63], v[216:219], a[16:19]
 v_mfma_f32_16x16x32_bf16 a[16:19], v[64:67], v[248:251], a[16:19]
 v_xor_b32 v27, 64, v26
 v_mfma_f32_16x16x32_bf16 a[24:27], v[64:67], v[252:255], a[24:27]
 v_mfma_f32_16x16x32_bf16 a[24:27], v[60:63], v[220:223], a[24:27]
 v_lshlrev_b32 v25, 4, v31
 v_mfma_f32_16x16x32_bf16 a[196:199], v[68:71], v[192:195], a[196:199]
 ds_read_b64_tr_b16 v[60:61], v18 offset:32768
 v_mfma_f32_16x16x32_bf16 a[196:199], v[72:75], v[224:227], a[196:199]
 ds_read_b64_tr_b16 v[62:63], v18 offset:33792
 v_mfma_f32_16x16x32_bf16 a[204:207], v[72:75], v[228:231], a[204:207]
 buffer_load_dwordx4 v3, s[4:7], s25 offen offset:1024  lds
 v_mfma_f32_16x16x32_bf16 a[204:207], v[68:71], v[196:199], a[204:207]
 v_add_u32 v25, 122880, v25
 v_mfma_f32_16x16x32_bf16 a[212:215], v[68:71], v[200:203], a[212:215]
 v_mfma_f32_16x16x32_bf16 a[212:215], v[72:75], v[232:235], a[212:215]
 s_lshl_b32 s23, s21, 2
 v_mfma_f32_16x16x32_bf16 a[220:223], v[72:75], v[236:239], a[220:223]
 v_mfma_f32_16x16x32_bf16 a[220:223], v[68:71], v[204:207], a[220:223]
 v_mfma_f32_16x16x32_bf16 a[4:7], v[68:71], v[208:211], a[4:7]
 ds_read_b64_tr_b16 v[64:65], v18 offset:40960
 s_add_u32 s93, s23, s3
 v_mfma_f32_16x16x32_bf16 a[4:7], v[72:75], v[240:243], a[4:7]
 ds_read_b64_tr_b16 v[66:67], v18 offset:41984
 v_mfma_f32_16x16x32_bf16 a[12:15], v[72:75], v[244:247], a[12:15]
 buffer_load_dwordx4 v4, s[4:7], s25 offen offset:2048  lds
 v_mfma_f32_16x16x32_bf16 a[12:15], v[68:71], v[212:215], a[12:15]
 v_mfma_f32_16x16x32_bf16 a[20:23], v[68:71], v[216:219], a[20:23]
 s_sub_u32 s92, 60, s23
 v_mfma_f32_16x16x32_bf16 a[20:23], v[72:75], v[248:251], a[20:23]
 v_mfma_f32_16x16x32_bf16 a[28:31], v[72:75], v[252:255], a[28:31]
 s_add_u32 s92, s92, s3
 v_mfma_f32_16x16x32_bf16 a[28:31], v[68:71], v[220:223], a[28:31]
 s_waitcnt lgkmcnt(8)
 v_mfma_f32_16x16x32_bf16 a[224:227], v[76:79], v[192:195], a[224:227]
 ds_read_b64_tr_b16 v[68:69], v19 offset:32768
 v_mfma_f32_16x16x32_bf16 a[224:227], v[80:83], v[224:227], a[224:227]
 ds_read_b64_tr_b16 v[70:71], v19 offset:33792
 s_lshr_b32 s22, s3, 1
 v_mfma_f32_16x16x32_bf16 a[232:235], v[80:83], v[228:231], a[232:235]
 buffer_load_dwordx4 v5, s[4:7], s25 offen offset:3072  lds
 v_mfma_f32_16x16x32_bf16 a[232:235], v[76:79], v[196:199], a[232:235]
 v_mfma_f32_16x16x32_bf16 a[240:243], v[76:79], v[200:203], a[240:243]
 s_lshl_b32 s22, s22, 5
 v_mfma_f32_16x16x32_bf16 a[240:243], v[80:83], v[232:235], a[240:243]
 v_mfma_f32_16x16x32_bf16 a[248:251], v[80:83], v[236:239], a[248:251]
 v_mfma_f32_16x16x32_bf16 a[248:251], v[76:79], v[204:207], a[248:251]
 s_add_u32 s22, s22, s20
 v_mfma_f32_16x16x32_bf16 a[32:35], v[76:79], v[208:211], a[32:35]
 ds_read_b64_tr_b16 v[72:73], v19 offset:40960
 s_add_u32 m0, s29, 36864
 v_mfma_f32_16x16x32_bf16 a[32:35], v[80:83], v[240:243], a[32:35]
 ds_read_b64_tr_b16 v[74:75], v19 offset:41984
 v_mfma_f32_16x16x32_bf16 a[40:43], v[80:83], v[244:247], a[40:43]
 s_add_u32 s22, s22, 44
 v_mfma_f32_16x16x32_bf16 a[40:43], v[76:79], v[212:215], a[40:43]
 s_add_u32 s25, s25, 128
 v_mfma_f32_16x16x32_bf16 a[48:51], v[76:79], v[216:219], a[48:51]
 v_mfma_f32_16x16x32_bf16 a[48:51], v[80:83], v[248:251], a[48:51]
 buffer_load_dwordx4 v2, s[4:7], s26 offen offset:0  lds
 v_mfma_f32_16x16x32_bf16 a[56:59], v[80:83], v[252:255], a[56:59]
 s_lshl_b32 s33, s22, 19
 v_mfma_f32_16x16x32_bf16 a[56:59], v[76:79], v[220:223], a[56:59]
 s_waitcnt lgkmcnt(8)
 v_mfma_f32_16x16x32_bf16 a[228:231], v[84:87], v[192:195], a[228:231]
 ds_read_b64_tr_b16 v[76:77], v20 offset:32768
 s_and_b32 s22, s3, 1
 v_mfma_f32_16x16x32_bf16 a[228:231], v[88:91], v[224:227], a[228:231]
 ds_read_b64_tr_b16 v[78:79], v20 offset:33792
 v_mfma_f32_16x16x32_bf16 a[236:239], v[88:91], v[228:231], a[236:239]
 v_mfma_f32_16x16x32_bf16 a[236:239], v[84:87], v[196:199], a[236:239]
 s_lshl_b32 s23, s21, 1
 v_mfma_f32_16x16x32_bf16 a[244:247], v[84:87], v[200:203], a[244:247]
 v_mfma_f32_16x16x32_bf16 a[244:247], v[88:91], v[232:235], a[244:247]
 buffer_load_dwordx4 v3, s[4:7], s26 offen offset:1024  lds
 v_mfma_f32_16x16x32_bf16 a[252:255], v[88:91], v[236:239], a[252:255]
 s_add_u32 s22, s22, s23
 v_mfma_f32_16x16x32_bf16 a[252:255], v[84:87], v[204:207], a[252:255]
 v_mfma_f32_16x16x32_bf16 a[36:39], v[84:87], v[208:211], a[36:39]
 ds_read_b64_tr_b16 v[80:81], v20 offset:40960
 v_mfma_f32_16x16x32_bf16 a[36:39], v[88:91], v[240:243], a[36:39]
 ds_read_b64_tr_b16 v[82:83], v20 offset:41984
 s_lshl_b32 s22, s22, 14
 v_mfma_f32_16x16x32_bf16 a[44:47], v[88:91], v[244:247], a[44:47]
 v_mfma_f32_16x16x32_bf16 a[44:47], v[84:87], v[212:215], a[44:47]
 v_mfma_f32_16x16x32_bf16 a[52:55], v[84:87], v[216:219], a[52:55]
 s_add_u32 s33, s33, s22
 v_mfma_f32_16x16x32_bf16 a[52:55], v[88:91], v[248:251], a[52:55]
 buffer_load_dwordx4 v4, s[4:7], s26 offen offset:2048  lds
 v_mfma_f32_16x16x32_bf16 a[60:63], v[88:91], v[252:255], a[60:63]
 v_mfma_f32_16x16x32_bf16 a[60:63], v[84:87], v[220:223], a[60:63]
 s_waitcnt lgkmcnt(8)
 s_lshl_b32 s22, s21, 16
 v_mfma_f32_16x16x32_bf16 a[128:131], v[60:63], v[192:195], a[128:131]
 ds_read_b64_tr_b16 v[84:85], v21 offset:32768
 v_mfma_f32_16x16x32_bf16 a[128:131], v[64:67], v[224:227], a[128:131]
 ds_read_b64_tr_b16 v[86:87], v21 offset:33792
 v_mfma_f32_16x16x32_bf16 a[136:139], v[64:67], v[228:231], a[136:139]
 s_sub_u32 s56, 487424, s22
 v_mfma_f32_16x16x32_bf16 a[136:139], v[60:63], v[196:199], a[136:139]
 v_mfma_f32_16x16x32_bf16 a[144:147], v[60:63], v[200:203], a[144:147]
 s_add_u32 s98, s33, 8192
 v_mfma_f32_16x16x32_bf16 a[144:147], v[64:67], v[232:235], a[144:147]
 buffer_load_dwordx4 v5, s[4:7], s26 offen offset:3072  lds
 v_mfma_f32_16x16x32_bf16 a[152:155], v[64:67], v[236:239], a[152:155]
 v_mfma_f32_16x16x32_bf16 a[152:155], v[60:63], v[204:207], a[152:155]
 s_lshl_b32 s22, s3, 13
 v_mfma_f32_16x16x32_bf16 a[64:67], v[60:63], v[208:211], a[64:67]
 ds_read_b64_tr_b16 v[88:89], v21 offset:40960
 v_mfma_f32_16x16x32_bf16 a[64:67], v[64:67], v[240:243], a[64:67]
 ds_read_b64_tr_b16 v[90:91], v21 offset:41984
 v_mfma_f32_16x16x32_bf16 a[72:75], v[64:67], v[244:247], a[72:75]
 v_mfma_f32_16x16x32_bf16 a[72:75], v[60:63], v[212:215], a[72:75]
 s_and_b32 s23, s3, 1
 v_mfma_f32_16x16x32_bf16 a[80:83], v[60:63], v[216:219], a[80:83]
 v_mfma_f32_16x16x32_bf16 a[80:83], v[64:67], v[248:251], a[80:83]
 s_add_u32 s26, s26, 128
 s_lshl_b32 s23, s23, 14
 v_mfma_f32_16x16x32_bf16 a[88:91], v[64:67], v[252:255], a[88:91]
 v_mfma_f32_16x16x32_bf16 a[88:91], v[60:63], v[220:223], a[88:91]
 s_waitcnt lgkmcnt(8)
 s_sub_u32 s96, s22, s23
 v_mfma_f32_16x16x32_bf16 a[132:135], v[68:71], v[192:195], a[132:135]
 v_mfma_f32_16x16x32_bf16 a[132:135], v[72:75], v[224:227], a[132:135]
 s_add_u32 s96, s96, 32768
 v_mfma_f32_16x16x32_bf16 a[140:143], v[72:75], v[228:231], a[140:143]
 v_mfma_f32_16x16x32_bf16 a[140:143], v[68:71], v[196:199], a[140:143]
 v_mfma_f32_16x16x32_bf16 a[148:151], v[68:71], v[200:203], a[148:151]
 v_mfma_f32_16x16x32_bf16 a[148:151], v[72:75], v[232:235], a[148:151]
 v_mfma_f32_16x16x32_bf16 a[156:159], v[72:75], v[236:239], a[156:159]
 v_mfma_f32_16x16x32_bf16 a[156:159], v[68:71], v[204:207], a[156:159]
 s_waitcnt vmcnt(10) lgkmcnt(0)
 s_barrier
 v_mfma_f32_16x16x32_bf16 a[68:71], v[68:71], v[208:211], a[68:71]
 ds_read_b64_tr_b16 v[60:61], v14 offset:0
 s_add_u32 m0, s30, 131072
 v_mfma_f32_16x16x32_bf16 a[68:71], v[72:75], v[240:243], a[68:71]
 ds_read_b64_tr_b16 v[62:63], v14 offset:1024
 s_nop 0
 v_mfma_f32_16x16x32_bf16 a[76:79], v[72:75], v[244:247], a[76:79]
 ds_read_b64_tr_b16 v[64:65], v14 offset:8192
 v_mfma_f32_16x16x32_bf16 a[76:79], v[68:71], v[212:215], a[76:79]
 ds_read_b64_tr_b16 v[66:67], v14 offset:9216
 v_mfma_f32_16x16x32_bf16 a[84:87], v[68:71], v[216:219], a[84:87]
 ds_read_b128 v[128:131], v12 offset:0
 v_mfma_f32_16x16x32_bf16 a[84:87], v[72:75], v[248:251], a[84:87]
 ds_read_b128 v[160:163], v13 offset:0
 v_mfma_f32_16x16x32_bf16 a[92:95], v[72:75], v[252:255], a[92:95]
 ds_read_b128 v[132:135], v12 offset:2048
 v_mfma_f32_16x16x32_bf16 a[92:95], v[68:71], v[220:223], a[92:95]
 ds_read_b128 v[164:167], v13 offset:2048
 v_mfma_f32_16x16x32_bf16 a[160:163], v[76:79], v[192:195], a[160:163]
 ds_read_b128 v[136:139], v12 offset:4096
 v_mfma_f32_16x16x32_bf16 a[160:163], v[80:83], v[224:227], a[160:163]
 ds_read_b64_tr_b16 v[68:69], v15 offset:0
 v_mfma_f32_16x16x32_bf16 a[168:171], v[80:83], v[228:231], a[168:171]
 ds_read_b64_tr_b16 v[70:71], v15 offset:1024
 v_mfma_f32_16x16x32_bf16 a[168:171], v[76:79], v[196:199], a[168:171]
 ds_read_b128 v[168:171], v13 offset:4096
 v_mfma_f32_16x16x32_bf16 a[176:179], v[76:79], v[200:203], a[176:179]
 ds_read_b128 v[140:143], v12 offset:6144
 v_mfma_f32_16x16x32_bf16 a[176:179], v[80:83], v[232:235], a[176:179]
 ds_read_b128 v[172:175], v13 offset:6144
 v_mfma_f32_16x16x32_bf16 a[184:187], v[80:83], v[236:239], a[184:187]
 ds_read_b128 v[144:147], v12 offset:8192
 buffer_load_dwordx4 v6, s[8:11], s27 offen offset:0  lds
 v_mfma_f32_16x16x32_bf16 a[184:187], v[76:79], v[204:207], a[184:187]
 ds_read_b128 v[176:179], v13 offset:8192
 v_mfma_f32_16x16x32_bf16 a[96:99], v[76:79], v[208:211], a[96:99]
 ds_read_b64_tr_b16 v[72:73], v15 offset:8192
 v_mfma_f32_16x16x32_bf16 a[96:99], v[80:83], v[240:243], a[96:99]
 ds_read_b64_tr_b16 v[74:75], v15 offset:9216
 v_mfma_f32_16x16x32_bf16 a[104:107], v[80:83], v[244:247], a[104:107]
 ds_read_b128 v[148:151], v12 offset:10240
 v_mfma_f32_16x16x32_bf16 a[104:107], v[76:79], v[212:215], a[104:107]
 ds_read_b128 v[180:183], v13 offset:10240
 buffer_load_dwordx4 v7, s[8:11], s27 offen offset:1024  lds
 v_mfma_f32_16x16x32_bf16 a[112:115], v[76:79], v[216:219], a[112:115]
 ds_read_b128 v[152:155], v12 offset:12288
 v_mfma_f32_16x16x32_bf16 a[112:115], v[80:83], v[248:251], a[112:115]
 ds_read_b128 v[184:187], v13 offset:12288
 v_mfma_f32_16x16x32_bf16 a[120:123], v[80:83], v[252:255], a[120:123]
 buffer_load_dwordx4 v8, s[8:11], s27 offen offset:2048  lds
 v_mfma_f32_16x16x32_bf16 a[120:123], v[76:79], v[220:223], a[120:123]
 ds_read_b128 v[156:159], v12 offset:14336
 v_mfma_f32_16x16x32_bf16 a[164:167], v[84:87], v[192:195], a[164:167]
 ds_read_b128 v[188:191], v13 offset:14336
 v_mfma_f32_16x16x32_bf16 a[164:167], v[88:91], v[224:227], a[164:167]
 ds_read_b64_tr_b16 v[76:77], v16 offset:0
 v_mfma_f32_16x16x32_bf16 a[172:175], v[88:91], v[228:231], a[172:175]
 ds_read_b64_tr_b16 v[78:79], v16 offset:1024
 v_add_u32 v12, 0x8000, v12
 v_mfma_f32_16x16x32_bf16 a[172:175], v[84:87], v[196:199], a[172:175]
 v_add_u32 v13, 0x8000, v13
 v_mfma_f32_16x16x32_bf16 a[180:183], v[84:87], v[200:203], a[180:183]
 buffer_load_dwordx4 v9, s[8:11], s27 offen offset:3072  lds
 v_mfma_f32_16x16x32_bf16 a[180:183], v[88:91], v[232:235], a[180:183]
 s_add_u32 m0, s30, 135168
 s_add_u32 s27, s27, 524288
 v_mfma_f32_16x16x32_bf16 a[188:191], v[88:91], v[236:239], a[188:191]
 buffer_load_dwordx4 v6, s[8:11], s62 offen offset:0  lds
 v_mfma_f32_16x16x32_bf16 a[188:191], v[84:87], v[204:207], a[188:191]
 buffer_load_dwordx4 v7, s[8:11], s62 offen offset:1024  lds
 v_mfma_f32_16x16x32_bf16 a[100:103], v[84:87], v[208:211], a[100:103]
 ds_read_b64_tr_b16 v[80:81], v16 offset:8192
 v_mfma_f32_16x16x32_bf16 a[100:103], v[88:91], v[240:243], a[100:103]
 ds_read_b64_tr_b16 v[82:83], v16 offset:9216
 v_mfma_f32_16x16x32_bf16 a[108:111], v[88:91], v[244:247], a[108:111]
 buffer_load_dwordx4 v8, s[8:11], s62 offen offset:2048  lds
 v_mfma_f32_16x16x32_bf16 a[108:111], v[84:87], v[212:215], a[108:111]
 v_mfma_f32_16x16x32_bf16 a[116:119], v[84:87], v[216:219], a[116:119]
 v_mfma_f32_16x16x32_bf16 a[116:119], v[88:91], v[248:251], a[116:119]
 buffer_load_dwordx4 v9, s[8:11], s62 offen offset:3072  lds
 v_mfma_f32_16x16x32_bf16 a[124:127], v[88:91], v[252:255], a[124:127]
 v_mfma_f32_16x16x32_bf16 a[124:127], v[84:87], v[220:223], a[124:127]
 s_waitcnt lgkmcnt(4)
 s_add_u32 s62, s62, 524288
 v_mfma_f32_16x16x32_bf16 a[192:195], v[60:63], v[128:131], a[192:195]
 ds_read_b64_tr_b16 v[84:85], v17 offset:0
 v_mfma_f32_16x16x32_bf16 a[192:195], v[64:67], v[160:163], a[192:195]
 ds_read_b64_tr_b16 v[86:87], v17 offset:1024
 v_mfma_f32_16x16x32_bf16 a[200:203], v[64:67], v[164:167], a[200:203]
 global_load_dword v122, v51, s[46:47]
 v_mfma_f32_16x16x32_bf16 a[200:203], v[60:63], v[132:135], a[200:203]
 v_mfma_f32_16x16x32_bf16 a[208:211], v[60:63], v[136:139], a[208:211]
 s_add_u32 m0, s29, 65536
 v_mfma_f32_16x16x32_bf16 a[208:211], v[64:67], v[168:171], a[208:211]
 v_mfma_f32_16x16x32_bf16 a[216:219], v[64:67], v[172:175], a[216:219]
 s_nop 0
 v_mfma_f32_16x16x32_bf16 a[216:219], v[60:63], v[140:143], a[216:219]
 v_mfma_f32_16x16x32_bf16 a[0:3], v[60:63], v[144:147], a[0:3]
 ds_read_b64_tr_b16 v[88:89], v17 offset:8192
 v_mfma_f32_16x16x32_bf16 a[0:3], v[64:67], v[176:179], a[0:3]
 ds_read_b64_tr_b16 v[90:91], v17 offset:9216
 v_mfma_f32_16x16x32_bf16 a[8:11], v[64:67], v[180:183], a[8:11]
 buffer_load_dwordx4 v2, s[4:7], s25 offen offset:0  lds
 v_mfma_f32_16x16x32_bf16 a[8:11], v[60:63], v[148:151], a[8:11]
 v_mfma_f32_16x16x32_bf16 a[16:19], v[60:63], v[152:155], a[16:19]
 v_mfma_f32_16x16x32_bf16 a[16:19], v[64:67], v[184:187], a[16:19]
 v_mfma_f32_16x16x32_bf16 a[24:27], v[64:67], v[188:191], a[24:27]
 v_mfma_f32_16x16x32_bf16 a[24:27], v[60:63], v[156:159], a[24:27]
 v_mfma_f32_16x16x32_bf16 a[196:199], v[68:71], v[128:131], a[196:199]
 ds_read_b64_tr_b16 v[60:61], v18 offset:0
 v_mfma_f32_16x16x32_bf16 a[196:199], v[72:75], v[160:163], a[196:199]
 ds_read_b64_tr_b16 v[62:63], v18 offset:1024
 v_mfma_f32_16x16x32_bf16 a[204:207], v[72:75], v[164:167], a[204:207]
 buffer_load_dwordx4 v3, s[4:7], s25 offen offset:1024  lds
 v_mfma_f32_16x16x32_bf16 a[204:207], v[68:71], v[132:135], a[204:207]
 v_mfma_f32_16x16x32_bf16 a[212:215], v[68:71], v[136:139], a[212:215]
 v_mfma_f32_16x16x32_bf16 a[212:215], v[72:75], v[168:171], a[212:215]
 v_mfma_f32_16x16x32_bf16 a[220:223], v[72:75], v[172:175], a[220:223]
 v_mfma_f32_16x16x32_bf16 a[220:223], v[68:71], v[140:143], a[220:223]
 v_mfma_f32_16x16x32_bf16 a[4:7], v[68:71], v[144:147], a[4:7]
 ds_read_b64_tr_b16 v[64:65], v18 offset:8192
 v_mfma_f32_16x16x32_bf16 a[4:7], v[72:75], v[176:179], a[4:7]
 ds_read_b64_tr_b16 v[66:67], v18 offset:9216
 v_mfma_f32_16x16x32_bf16 a[12:15], v[72:75], v[180:183], a[12:15]
 buffer_load_dwordx4 v4, s[4:7], s25 offen offset:2048  lds
 v_mfma_f32_16x16x32_bf16 a[12:15], v[68:71], v[148:151], a[12:15]
 v_mfma_f32_16x16x32_bf16 a[20:23], v[68:71], v[152:155], a[20:23]
 v_mfma_f32_16x16x32_bf16 a[20:23], v[72:75], v[184:187], a[20:23]
 v_mfma_f32_16x16x32_bf16 a[28:31], v[72:75], v[188:191], a[28:31]
 v_mfma_f32_16x16x32_bf16 a[28:31], v[68:71], v[156:159], a[28:31]
 s_waitcnt lgkmcnt(8)
 v_mfma_f32_16x16x32_bf16 a[224:227], v[76:79], v[128:131], a[224:227]
 ds_read_b64_tr_b16 v[68:69], v19 offset:0
 v_mfma_f32_16x16x32_bf16 a[224:227], v[80:83], v[160:163], a[224:227]
 ds_read_b64_tr_b16 v[70:71], v19 offset:1024
 v_mfma_f32_16x16x32_bf16 a[232:235], v[80:83], v[164:167], a[232:235]
 buffer_load_dwordx4 v5, s[4:7], s25 offen offset:3072  lds
 v_mfma_f32_16x16x32_bf16 a[232:235], v[76:79], v[132:135], a[232:235]
 v_mfma_f32_16x16x32_bf16 a[240:243], v[76:79], v[136:139], a[240:243]
 v_mfma_f32_16x16x32_bf16 a[240:243], v[80:83], v[168:171], a[240:243]
 v_mfma_f32_16x16x32_bf16 a[248:251], v[80:83], v[172:175], a[248:251]
 v_mfma_f32_16x16x32_bf16 a[248:251], v[76:79], v[140:143], a[248:251]
 v_mfma_f32_16x16x32_bf16 a[32:35], v[76:79], v[144:147], a[32:35]
 ds_read_b64_tr_b16 v[72:73], v19 offset:8192
 s_add_u32 m0, s29, 69632
 v_mfma_f32_16x16x32_bf16 a[32:35], v[80:83], v[176:179], a[32:35]
 ds_read_b64_tr_b16 v[74:75], v19 offset:9216
 v_mfma_f32_16x16x32_bf16 a[40:43], v[80:83], v[180:183], a[40:43]
 v_mfma_f32_16x16x32_bf16 a[40:43], v[76:79], v[148:151], a[40:43]
 s_add_u32 s25, s25, 128
 v_mfma_f32_16x16x32_bf16 a[48:51], v[76:79], v[152:155], a[48:51]
 v_mfma_f32_16x16x32_bf16 a[48:51], v[80:83], v[184:187], a[48:51]
 buffer_load_dwordx4 v2, s[4:7], s26 offen offset:0  lds
 v_mfma_f32_16x16x32_bf16 a[56:59], v[80:83], v[188:191], a[56:59]
 v_mfma_f32_16x16x32_bf16 a[56:59], v[76:79], v[156:159], a[56:59]
 s_waitcnt lgkmcnt(8)
 v_mfma_f32_16x16x32_bf16 a[228:231], v[84:87], v[128:131], a[228:231]
 ds_read_b64_tr_b16 v[76:77], v20 offset:0
 v_mfma_f32_16x16x32_bf16 a[228:231], v[88:91], v[160:163], a[228:231]
 ds_read_b64_tr_b16 v[78:79], v20 offset:1024
 v_mfma_f32_16x16x32_bf16 a[236:239], v[88:91], v[164:167], a[236:239]
 v_mfma_f32_16x16x32_bf16 a[236:239], v[84:87], v[132:135], a[236:239]
 v_mfma_f32_16x16x32_bf16 a[244:247], v[84:87], v[136:139], a[244:247]
 v_mfma_f32_16x16x32_bf16 a[244:247], v[88:91], v[168:171], a[244:247]
 buffer_load_dwordx4 v3, s[4:7], s26 offen offset:1024  lds
 v_mfma_f32_16x16x32_bf16 a[252:255], v[88:91], v[172:175], a[252:255]
 v_mfma_f32_16x16x32_bf16 a[252:255], v[84:87], v[140:143], a[252:255]
 v_mfma_f32_16x16x32_bf16 a[36:39], v[84:87], v[144:147], a[36:39]
 ds_read_b64_tr_b16 v[80:81], v20 offset:8192
 v_mfma_f32_16x16x32_bf16 a[36:39], v[88:91], v[176:179], a[36:39]
 ds_read_b64_tr_b16 v[82:83], v20 offset:9216
 v_mfma_f32_16x16x32_bf16 a[44:47], v[88:91], v[180:183], a[44:47]
 v_mfma_f32_16x16x32_bf16 a[44:47], v[84:87], v[148:151], a[44:47]
 v_mfma_f32_16x16x32_bf16 a[52:55], v[84:87], v[152:155], a[52:55]
 v_mfma_f32_16x16x32_bf16 a[52:55], v[88:91], v[184:187], a[52:55]
 buffer_load_dwordx4 v4, s[4:7], s26 offen offset:2048  lds
 v_mfma_f32_16x16x32_bf16 a[60:63], v[88:91], v[188:191], a[60:63]
 v_mfma_f32_16x16x32_bf16 a[60:63], v[84:87], v[156:159], a[60:63]
 s_waitcnt lgkmcnt(8)
 v_mfma_f32_16x16x32_bf16 a[128:131], v[60:63], v[128:131], a[128:131]
 ds_read_b64_tr_b16 v[84:85], v21 offset:0
 v_mfma_f32_16x16x32_bf16 a[128:131], v[64:67], v[160:163], a[128:131]
 ds_read_b64_tr_b16 v[86:87], v21 offset:1024
 v_mfma_f32_16x16x32_bf16 a[136:139], v[64:67], v[164:167], a[136:139]
 v_mfma_f32_16x16x32_bf16 a[136:139], v[60:63], v[132:135], a[136:139]
 v_mfma_f32_16x16x32_bf16 a[144:147], v[60:63], v[136:139], a[144:147]
 v_mfma_f32_16x16x32_bf16 a[144:147], v[64:67], v[168:171], a[144:147]
 buffer_load_dwordx4 v5, s[4:7], s26 offen offset:3072  lds
 v_mfma_f32_16x16x32_bf16 a[152:155], v[64:67], v[172:175], a[152:155]
 v_mfma_f32_16x16x32_bf16 a[152:155], v[60:63], v[140:143], a[152:155]
 v_mfma_f32_16x16x32_bf16 a[64:67], v[60:63], v[144:147], a[64:67]
 ds_read_b64_tr_b16 v[88:89], v21 offset:8192
 v_mfma_f32_16x16x32_bf16 a[64:67], v[64:67], v[176:179], a[64:67]
 ds_read_b64_tr_b16 v[90:91], v21 offset:9216
 v_mfma_f32_16x16x32_bf16 a[72:75], v[64:67], v[180:183], a[72:75]
 v_mfma_f32_16x16x32_bf16 a[72:75], v[60:63], v[148:151], a[72:75]
 v_mfma_f32_16x16x32_bf16 a[80:83], v[60:63], v[152:155], a[80:83]
 v_mfma_f32_16x16x32_bf16 a[80:83], v[64:67], v[184:187], a[80:83]
 s_add_u32 s26, s26, 128
 v_mfma_f32_16x16x32_bf16 a[88:91], v[64:67], v[188:191], a[88:91]
 v_mfma_f32_16x16x32_bf16 a[88:91], v[60:63], v[156:159], a[88:91]
 s_waitcnt lgkmcnt(8)
 v_mfma_f32_16x16x32_bf16 a[132:135], v[68:71], v[128:131], a[132:135]
 v_mfma_f32_16x16x32_bf16 a[132:135], v[72:75], v[160:163], a[132:135]
 v_mfma_f32_16x16x32_bf16 a[140:143], v[72:75], v[164:167], a[140:143]
 v_mfma_f32_16x16x32_bf16 a[140:143], v[68:71], v[132:135], a[140:143]
 v_mfma_f32_16x16x32_bf16 a[148:151], v[68:71], v[136:139], a[148:151]
 v_mfma_f32_16x16x32_bf16 a[148:151], v[72:75], v[168:171], a[148:151]
 v_mfma_f32_16x16x32_bf16 a[156:159], v[72:75], v[172:175], a[156:159]
 v_mfma_f32_16x16x32_bf16 a[156:159], v[68:71], v[140:143], a[156:159]
 s_waitcnt vmcnt(9) lgkmcnt(0)
 s_barrier
 v_mfma_f32_16x16x32_bf16 a[68:71], v[68:71], v[144:147], a[68:71]
 ds_read_b64_tr_b16 v[60:61], v14 offset:32768
 s_add_u32 m0, s30, 98304
 v_mfma_f32_16x16x32_bf16 a[68:71], v[72:75], v[176:179], a[68:71]
 ds_read_b64_tr_b16 v[62:63], v14 offset:33792
 s_nop 0
 v_mfma_f32_16x16x32_bf16 a[76:79], v[72:75], v[180:183], a[76:79]
 ds_read_b64_tr_b16 v[64:65], v14 offset:40960
 v_mfma_f32_16x16x32_bf16 a[76:79], v[68:71], v[148:151], a[76:79]
 ds_read_b64_tr_b16 v[66:67], v14 offset:41984
 v_mfma_f32_16x16x32_bf16 a[84:87], v[68:71], v[152:155], a[84:87]
 ds_read_b128 v[192:195], v12 offset:0
 v_mfma_f32_16x16x32_bf16 a[84:87], v[72:75], v[184:187], a[84:87]
 ds_read_b128 v[224:227], v13 offset:0
 v_mfma_f32_16x16x32_bf16 a[92:95], v[72:75], v[188:191], a[92:95]
 ds_read_b128 v[196:199], v12 offset:2048
 v_mfma_f32_16x16x32_bf16 a[92:95], v[68:71], v[156:159], a[92:95]
 ds_read_b128 v[228:231], v13 offset:2048
 v_mfma_f32_16x16x32_bf16 a[160:163], v[76:79], v[128:131], a[160:163]
 ds_read_b128 v[200:203], v12 offset:4096
 v_mfma_f32_16x16x32_bf16 a[160:163], v[80:83], v[160:163], a[160:163]
 ds_read_b64_tr_b16 v[68:69], v15 offset:32768
 v_mfma_f32_16x16x32_bf16 a[168:171], v[80:83], v[164:167], a[168:171]
 ds_read_b64_tr_b16 v[70:71], v15 offset:33792
 v_mfma_f32_16x16x32_bf16 a[168:171], v[76:79], v[132:135], a[168:171]
 ds_read_b128 v[232:235], v13 offset:4096
 v_mfma_f32_16x16x32_bf16 a[176:179], v[76:79], v[136:139], a[176:179]
 ds_read_b128 v[204:207], v12 offset:6144
 v_mfma_f32_16x16x32_bf16 a[176:179], v[80:83], v[168:171], a[176:179]
 ds_read_b128 v[236:239], v13 offset:6144
 buffer_load_dwordx4 v6, s[8:11], s27 offen offset:0  lds
 v_mfma_f32_16x16x32_bf16 a[184:187], v[80:83], v[172:175], a[184:187]
 ds_read_b128 v[208:211], v12 offset:8192
 v_mfma_f32_16x16x32_bf16 a[184:187], v[76:79], v[140:143], a[184:187]
 ds_read_b128 v[240:243], v13 offset:8192
 v_mfma_f32_16x16x32_bf16 a[96:99], v[76:79], v[144:147], a[96:99]
 ds_read_b64_tr_b16 v[72:73], v15 offset:40960
 v_mfma_f32_16x16x32_bf16 a[96:99], v[80:83], v[176:179], a[96:99]
 ds_read_b64_tr_b16 v[74:75], v15 offset:41984
 buffer_load_dwordx4 v7, s[8:11], s27 offen offset:1024  lds
 v_mfma_f32_16x16x32_bf16 a[104:107], v[80:83], v[180:183], a[104:107]
 ds_read_b128 v[212:215], v12 offset:10240
 v_mfma_f32_16x16x32_bf16 a[104:107], v[76:79], v[148:151], a[104:107]
 ds_read_b128 v[244:247], v13 offset:10240
 v_mfma_f32_16x16x32_bf16 a[112:115], v[76:79], v[152:155], a[112:115]
 ds_read_b128 v[216:219], v12 offset:12288
 v_mfma_f32_16x16x32_bf16 a[112:115], v[80:83], v[184:187], a[112:115]
 ds_read_b128 v[248:251], v13 offset:12288
 v_mfma_f32_16x16x32_bf16 a[120:123], v[80:83], v[188:191], a[120:123]
 buffer_load_dwordx4 v8, s[8:11], s27 offen offset:2048  lds
 v_mfma_f32_16x16x32_bf16 a[120:123], v[76:79], v[156:159], a[120:123]
 ds_read_b128 v[220:223], v12 offset:14336
 v_mfma_f32_16x16x32_bf16 a[164:167], v[84:87], v[128:131], a[164:167]
 ds_read_b128 v[252:255], v13 offset:14336
 v_mfma_f32_16x16x32_bf16 a[164:167], v[88:91], v[160:163], a[164:167]
 ds_read_b64_tr_b16 v[76:77], v16 offset:32768
 v_mfma_f32_16x16x32_bf16 a[172:175], v[88:91], v[164:167], a[172:175]
 ds_read_b64_tr_b16 v[78:79], v16 offset:33792
 v_add_u32 v12, 0x8000, v12
 v_mfma_f32_16x16x32_bf16 a[172:175], v[84:87], v[132:135], a[172:175]
 v_add_u32 v13, 0x8000, v13
 v_mfma_f32_16x16x32_bf16 a[180:183], v[84:87], v[136:139], a[180:183]
 buffer_load_dwordx4 v9, s[8:11], s27 offen offset:3072  lds
 v_mfma_f32_16x16x32_bf16 a[180:183], v[88:91], v[168:171], a[180:183]
 s_add_u32 m0, s30, 102400
 s_add_u32 s27, s27, 524288
 v_mfma_f32_16x16x32_bf16 a[188:191], v[88:91], v[172:175], a[188:191]
 buffer_load_dwordx4 v6, s[8:11], s62 offen offset:0  lds
 v_mfma_f32_16x16x32_bf16 a[188:191], v[84:87], v[140:143], a[188:191]
 buffer_load_dwordx4 v7, s[8:11], s62 offen offset:1024  lds
 v_mfma_f32_16x16x32_bf16 a[100:103], v[84:87], v[144:147], a[100:103]
 ds_read_b64_tr_b16 v[80:81], v16 offset:40960
 v_mfma_f32_16x16x32_bf16 a[100:103], v[88:91], v[176:179], a[100:103]
 ds_read_b64_tr_b16 v[82:83], v16 offset:41984
 v_mfma_f32_16x16x32_bf16 a[108:111], v[88:91], v[180:183], a[108:111]
 buffer_load_dwordx4 v8, s[8:11], s62 offen offset:2048  lds
 v_mfma_f32_16x16x32_bf16 a[108:111], v[84:87], v[148:151], a[108:111]
 buffer_load_dwordx4 v9, s[8:11], s62 offen offset:3072  lds
 v_mfma_f32_16x16x32_bf16 a[116:119], v[84:87], v[152:155], a[116:119]
 v_mfma_f32_16x16x32_bf16 a[116:119], v[88:91], v[184:187], a[116:119]
 s_add_u32 s62, s62, 524288
 v_mfma_f32_16x16x32_bf16 a[124:127], v[88:91], v[188:191], a[124:127]
 global_load_dword v122, v53, s[38:39]
 v_mfma_f32_16x16x32_bf16 a[124:127], v[84:87], v[156:159], a[124:127]
 s_waitcnt lgkmcnt(4)
 v_mfma_f32_16x16x32_bf16 a[192:195], v[60:63], v[192:195], a[192:195]
 ds_read_b64_tr_b16 v[84:85], v17 offset:32768
 v_mfma_f32_16x16x32_bf16 a[192:195], v[64:67], v[224:227], a[192:195]
 ds_read_b64_tr_b16 v[86:87], v17 offset:33792
 v_mfma_f32_16x16x32_bf16 a[200:203], v[64:67], v[228:231], a[200:203]
 global_load_dword v122, v127, s[0:1]
 v_mfma_f32_16x16x32_bf16 a[200:203], v[60:63], v[196:199], a[200:203]
 v_mfma_f32_16x16x32_bf16 a[208:211], v[60:63], v[200:203], a[208:211]
 s_add_u32 m0, s29, 0
 v_mfma_f32_16x16x32_bf16 a[208:211], v[64:67], v[232:235], a[208:211]
 v_mfma_f32_16x16x32_bf16 a[216:219], v[64:67], v[236:239], a[216:219]
 s_nop 0
 v_mfma_f32_16x16x32_bf16 a[216:219], v[60:63], v[204:207], a[216:219]
 v_mfma_f32_16x16x32_bf16 a[0:3], v[60:63], v[208:211], a[0:3]
 ds_read_b64_tr_b16 v[88:89], v17 offset:40960
 v_mfma_f32_16x16x32_bf16 a[0:3], v[64:67], v[240:243], a[0:3]
 ds_read_b64_tr_b16 v[90:91], v17 offset:41984
 v_mfma_f32_16x16x32_bf16 a[8:11], v[64:67], v[244:247], a[8:11]
 buffer_load_dwordx4 v2, s[4:7], s25 offen offset:0  lds
 v_mfma_f32_16x16x32_bf16 a[8:11], v[60:63], v[212:215], a[8:11]
 v_mfma_f32_16x16x32_bf16 a[16:19], v[60:63], v[216:219], a[16:19]
 v_mfma_f32_16x16x32_bf16 a[16:19], v[64:67], v[248:251], a[16:19]
 v_mfma_f32_16x16x32_bf16 a[24:27], v[64:67], v[252:255], a[24:27]
 v_mfma_f32_16x16x32_bf16 a[24:27], v[60:63], v[220:223], a[24:27]
 v_mfma_f32_16x16x32_bf16 a[196:199], v[68:71], v[192:195], a[196:199]
 ds_read_b64_tr_b16 v[60:61], v18 offset:32768
 v_mfma_f32_16x16x32_bf16 a[196:199], v[72:75], v[224:227], a[196:199]
 ds_read_b64_tr_b16 v[62:63], v18 offset:33792
 v_mfma_f32_16x16x32_bf16 a[204:207], v[72:75], v[228:231], a[204:207]
 buffer_load_dwordx4 v3, s[4:7], s25 offen offset:1024  lds
 v_mfma_f32_16x16x32_bf16 a[204:207], v[68:71], v[196:199], a[204:207]
 v_mfma_f32_16x16x32_bf16 a[212:215], v[68:71], v[200:203], a[212:215]
 v_mfma_f32_16x16x32_bf16 a[212:215], v[72:75], v[232:235], a[212:215]
 v_mfma_f32_16x16x32_bf16 a[220:223], v[72:75], v[236:239], a[220:223]
 v_mfma_f32_16x16x32_bf16 a[220:223], v[68:71], v[204:207], a[220:223]
 v_mfma_f32_16x16x32_bf16 a[4:7], v[68:71], v[208:211], a[4:7]
 ds_read_b64_tr_b16 v[64:65], v18 offset:40960
 v_mfma_f32_16x16x32_bf16 a[4:7], v[72:75], v[240:243], a[4:7]
 ds_read_b64_tr_b16 v[66:67], v18 offset:41984
 v_mfma_f32_16x16x32_bf16 a[12:15], v[72:75], v[244:247], a[12:15]
 buffer_load_dwordx4 v4, s[4:7], s25 offen offset:2048  lds
 v_mfma_f32_16x16x32_bf16 a[12:15], v[68:71], v[212:215], a[12:15]
 v_mfma_f32_16x16x32_bf16 a[20:23], v[68:71], v[216:219], a[20:23]
 v_mfma_f32_16x16x32_bf16 a[20:23], v[72:75], v[248:251], a[20:23]
 v_mfma_f32_16x16x32_bf16 a[28:31], v[72:75], v[252:255], a[28:31]
 v_mfma_f32_16x16x32_bf16 a[28:31], v[68:71], v[220:223], a[28:31]
 s_waitcnt lgkmcnt(8)
 v_mfma_f32_16x16x32_bf16 a[224:227], v[76:79], v[192:195], a[224:227]
 ds_read_b64_tr_b16 v[68:69], v19 offset:32768
 v_mfma_f32_16x16x32_bf16 a[224:227], v[80:83], v[224:227], a[224:227]
 ds_read_b64_tr_b16 v[70:71], v19 offset:33792
 v_mfma_f32_16x16x32_bf16 a[232:235], v[80:83], v[228:231], a[232:235]
 buffer_load_dwordx4 v5, s[4:7], s25 offen offset:3072  lds
 v_mfma_f32_16x16x32_bf16 a[232:235], v[76:79], v[196:199], a[232:235]
 v_mfma_f32_16x16x32_bf16 a[240:243], v[76:79], v[200:203], a[240:243]
 v_mfma_f32_16x16x32_bf16 a[240:243], v[80:83], v[232:235], a[240:243]
 v_mfma_f32_16x16x32_bf16 a[248:251], v[80:83], v[236:239], a[248:251]
 v_mfma_f32_16x16x32_bf16 a[248:251], v[76:79], v[204:207], a[248:251]
 v_mfma_f32_16x16x32_bf16 a[32:35], v[76:79], v[208:211], a[32:35]
 ds_read_b64_tr_b16 v[72:73], v19 offset:40960
 s_add_u32 m0, s29, 4096
 v_mfma_f32_16x16x32_bf16 a[32:35], v[80:83], v[240:243], a[32:35]
 ds_read_b64_tr_b16 v[74:75], v19 offset:41984
 v_mfma_f32_16x16x32_bf16 a[40:43], v[80:83], v[244:247], a[40:43]
 v_mfma_f32_16x16x32_bf16 a[40:43], v[76:79], v[212:215], a[40:43]
 s_add_u32 s25, s25, 128
 v_mfma_f32_16x16x32_bf16 a[48:51], v[76:79], v[216:219], a[48:51]
 v_mfma_f32_16x16x32_bf16 a[48:51], v[80:83], v[248:251], a[48:51]
 buffer_load_dwordx4 v2, s[4:7], s26 offen offset:0  lds
 v_mfma_f32_16x16x32_bf16 a[56:59], v[80:83], v[252:255], a[56:59]
 v_mfma_f32_16x16x32_bf16 a[56:59], v[76:79], v[220:223], a[56:59]
 s_waitcnt lgkmcnt(8)
 v_mfma_f32_16x16x32_bf16 a[228:231], v[84:87], v[192:195], a[228:231]
 ds_read_b64_tr_b16 v[76:77], v20 offset:32768
 v_mfma_f32_16x16x32_bf16 a[228:231], v[88:91], v[224:227], a[228:231]
 ds_read_b64_tr_b16 v[78:79], v20 offset:33792
 v_mfma_f32_16x16x32_bf16 a[236:239], v[88:91], v[228:231], a[236:239]
 v_mfma_f32_16x16x32_bf16 a[236:239], v[84:87], v[196:199], a[236:239]
 v_mfma_f32_16x16x32_bf16 a[244:247], v[84:87], v[200:203], a[244:247]
 v_mfma_f32_16x16x32_bf16 a[244:247], v[88:91], v[232:235], a[244:247]
 buffer_load_dwordx4 v3, s[4:7], s26 offen offset:1024  lds
 v_mfma_f32_16x16x32_bf16 a[252:255], v[88:91], v[236:239], a[252:255]
 v_mfma_f32_16x16x32_bf16 a[252:255], v[84:87], v[204:207], a[252:255]
 v_mfma_f32_16x16x32_bf16 a[36:39], v[84:87], v[208:211], a[36:39]
 ds_read_b64_tr_b16 v[80:81], v20 offset:40960
 v_mfma_f32_16x16x32_bf16 a[36:39], v[88:91], v[240:243], a[36:39]
 ds_read_b64_tr_b16 v[82:83], v20 offset:41984
 v_mfma_f32_16x16x32_bf16 a[44:47], v[88:91], v[244:247], a[44:47]
 v_mfma_f32_16x16x32_bf16 a[44:47], v[84:87], v[212:215], a[44:47]
 v_mfma_f32_16x16x32_bf16 a[52:55], v[84:87], v[216:219], a[52:55]
 v_mfma_f32_16x16x32_bf16 a[52:55], v[88:91], v[248:251], a[52:55]
 buffer_load_dwordx4 v4, s[4:7], s26 offen offset:2048  lds
 v_mfma_f32_16x16x32_bf16 a[60:63], v[88:91], v[252:255], a[60:63]
 v_mfma_f32_16x16x32_bf16 a[60:63], v[84:87], v[220:223], a[60:63]
 s_waitcnt lgkmcnt(8)
 v_mfma_f32_16x16x32_bf16 a[128:131], v[60:63], v[192:195], a[128:131]
 ds_read_b64_tr_b16 v[84:85], v21 offset:32768
 v_mfma_f32_16x16x32_bf16 a[128:131], v[64:67], v[224:227], a[128:131]
 ds_read_b64_tr_b16 v[86:87], v21 offset:33792
 v_mfma_f32_16x16x32_bf16 a[136:139], v[64:67], v[228:231], a[136:139]
 v_mfma_f32_16x16x32_bf16 a[136:139], v[60:63], v[196:199], a[136:139]
 v_mfma_f32_16x16x32_bf16 a[144:147], v[60:63], v[200:203], a[144:147]
 v_mfma_f32_16x16x32_bf16 a[144:147], v[64:67], v[232:235], a[144:147]
 buffer_load_dwordx4 v5, s[4:7], s26 offen offset:3072  lds
 v_mfma_f32_16x16x32_bf16 a[152:155], v[64:67], v[236:239], a[152:155]
 v_mfma_f32_16x16x32_bf16 a[152:155], v[60:63], v[204:207], a[152:155]
 v_mfma_f32_16x16x32_bf16 a[64:67], v[60:63], v[208:211], a[64:67]
 ds_read_b64_tr_b16 v[88:89], v21 offset:40960
 v_mfma_f32_16x16x32_bf16 a[64:67], v[64:67], v[240:243], a[64:67]
 ds_read_b64_tr_b16 v[90:91], v21 offset:41984
 v_mfma_f32_16x16x32_bf16 a[72:75], v[64:67], v[244:247], a[72:75]
 v_mfma_f32_16x16x32_bf16 a[72:75], v[60:63], v[212:215], a[72:75]
 v_mfma_f32_16x16x32_bf16 a[80:83], v[60:63], v[216:219], a[80:83]
 v_mfma_f32_16x16x32_bf16 a[80:83], v[64:67], v[248:251], a[80:83]
 s_add_u32 s26, s26, 128
 v_mfma_f32_16x16x32_bf16 a[88:91], v[64:67], v[252:255], a[88:91]
 v_mfma_f32_16x16x32_bf16 a[88:91], v[60:63], v[220:223], a[88:91]
 s_waitcnt lgkmcnt(8)
 v_mfma_f32_16x16x32_bf16 a[132:135], v[68:71], v[192:195], a[132:135]
 v_mfma_f32_16x16x32_bf16 a[132:135], v[72:75], v[224:227], a[132:135]
 v_mfma_f32_16x16x32_bf16 a[140:143], v[72:75], v[228:231], a[140:143]
 v_mfma_f32_16x16x32_bf16 a[140:143], v[68:71], v[196:199], a[140:143]
 v_mfma_f32_16x16x32_bf16 a[148:151], v[68:71], v[200:203], a[148:151]
 v_mfma_f32_16x16x32_bf16 a[148:151], v[72:75], v[232:235], a[148:151]
 v_mfma_f32_16x16x32_bf16 a[156:159], v[72:75], v[236:239], a[156:159]
 v_mfma_f32_16x16x32_bf16 a[156:159], v[68:71], v[204:207], a[156:159]
 s_waitcnt vmcnt(10) lgkmcnt(0)
 s_barrier
 v_mfma_f32_16x16x32_bf16 a[68:71], v[68:71], v[208:211], a[68:71]
 ds_read_b64_tr_b16 v[60:61], v14 offset:0
 s_add_u32 m0, s30, 131072
 v_mfma_f32_16x16x32_bf16 a[68:71], v[72:75], v[240:243], a[68:71]
 ds_read_b64_tr_b16 v[62:63], v14 offset:1024
 s_nop 0
 v_mfma_f32_16x16x32_bf16 a[76:79], v[72:75], v[244:247], a[76:79]
 ds_read_b64_tr_b16 v[64:65], v14 offset:8192
 v_mfma_f32_16x16x32_bf16 a[76:79], v[68:71], v[212:215], a[76:79]
 ds_read_b64_tr_b16 v[66:67], v14 offset:9216
 v_mfma_f32_16x16x32_bf16 a[84:87], v[68:71], v[216:219], a[84:87]
 ds_read_b128 v[128:131], v12 offset:0
 v_mfma_f32_16x16x32_bf16 a[84:87], v[72:75], v[248:251], a[84:87]
 ds_read_b128 v[160:163], v13 offset:0
 v_mfma_f32_16x16x32_bf16 a[92:95], v[72:75], v[252:255], a[92:95]
 ds_read_b128 v[132:135], v12 offset:2048
 v_mfma_f32_16x16x32_bf16 a[92:95], v[68:71], v[220:223], a[92:95]
 ds_read_b128 v[164:167], v13 offset:2048
 v_mfma_f32_16x16x32_bf16 a[160:163], v[76:79], v[192:195], a[160:163]
 ds_read_b128 v[136:139], v12 offset:4096
 v_mfma_f32_16x16x32_bf16 a[160:163], v[80:83], v[224:227], a[160:163]
 ds_read_b64_tr_b16 v[68:69], v15 offset:0
 v_mfma_f32_16x16x32_bf16 a[168:171], v[80:83], v[228:231], a[168:171]
 ds_read_b64_tr_b16 v[70:71], v15 offset:1024
 v_mfma_f32_16x16x32_bf16 a[168:171], v[76:79], v[196:199], a[168:171]
 ds_read_b128 v[168:171], v13 offset:4096
 v_mfma_f32_16x16x32_bf16 a[176:179], v[76:79], v[200:203], a[176:179]
 ds_read_b128 v[140:143], v12 offset:6144
 buffer_load_dwordx4 v6, s[8:11], s27 offen offset:0  lds
 v_mfma_f32_16x16x32_bf16 a[176:179], v[80:83], v[232:235], a[176:179]
 ds_read_b128 v[172:175], v13 offset:6144
 v_mfma_f32_16x16x32_bf16 a[184:187], v[80:83], v[236:239], a[184:187]
 ds_read_b128 v[144:147], v12 offset:8192
 v_mfma_f32_16x16x32_bf16 a[184:187], v[76:79], v[204:207], a[184:187]
 ds_read_b128 v[176:179], v13 offset:8192
 v_mfma_f32_16x16x32_bf16 a[96:99], v[76:79], v[208:211], a[96:99]
 ds_read_b64_tr_b16 v[72:73], v15 offset:8192
 v_mfma_f32_16x16x32_bf16 a[96:99], v[80:83], v[240:243], a[96:99]
 ds_read_b64_tr_b16 v[74:75], v15 offset:9216
 buffer_load_dwordx4 v7, s[8:11], s27 offen offset:1024  lds
 v_mfma_f32_16x16x32_bf16 a[104:107], v[80:83], v[244:247], a[104:107]
 ds_read_b128 v[148:151], v12 offset:10240
 v_mfma_f32_16x16x32_bf16 a[104:107], v[76:79], v[212:215], a[104:107]
 ds_read_b128 v[180:183], v13 offset:10240
 v_mfma_f32_16x16x32_bf16 a[112:115], v[76:79], v[216:219], a[112:115]
 ds_read_b128 v[152:155], v12 offset:12288
 v_mfma_f32_16x16x32_bf16 a[112:115], v[80:83], v[248:251], a[112:115]
 ds_read_b128 v[184:187], v13 offset:12288
 buffer_load_dwordx4 v8, s[8:11], s27 offen offset:2048  lds
 v_mfma_f32_16x16x32_bf16 a[120:123], v[80:83], v[252:255], a[120:123]
 buffer_load_dwordx4 v9, s[8:11], s27 offen offset:3072  lds
 v_mfma_f32_16x16x32_bf16 a[120:123], v[76:79], v[220:223], a[120:123]
 ds_read_b128 v[156:159], v12 offset:14336
 v_mfma_f32_16x16x32_bf16 a[164:167], v[84:87], v[192:195], a[164:167]
 ds_read_b128 v[188:191], v13 offset:14336
 s_add_u32 m0, s30, 135168
 v_mfma_f32_16x16x32_bf16 a[164:167], v[88:91], v[224:227], a[164:167]
 ds_read_b64_tr_b16 v[76:77], v16 offset:0
 s_add_u32 s27, s27, 524288
 v_mfma_f32_16x16x32_bf16 a[172:175], v[88:91], v[228:231], a[172:175]
 ds_read_b64_tr_b16 v[78:79], v16 offset:1024
 v_subrev_u32 v12, 0x10000, v12
 v_mfma_f32_16x16x32_bf16 a[172:175], v[84:87], v[196:199], a[172:175]
 v_subrev_u32 v13, 0x10000, v13
 v_mfma_f32_16x16x32_bf16 a[180:183], v[84:87], v[200:203], a[180:183]
 buffer_load_dwordx4 v6, s[8:11], s62 offen offset:0  lds
 v_mfma_f32_16x16x32_bf16 a[180:183], v[88:91], v[232:235], a[180:183]
 buffer_load_dwordx4 v7, s[8:11], s62 offen offset:1024  lds
 v_mfma_f32_16x16x32_bf16 a[188:191], v[88:91], v[236:239], a[188:191]
 v_mfma_f32_16x16x32_bf16 a[188:191], v[84:87], v[204:207], a[188:191]
 buffer_load_dwordx4 v8, s[8:11], s62 offen offset:2048  lds
 v_mfma_f32_16x16x32_bf16 a[100:103], v[84:87], v[208:211], a[100:103]
 ds_read_b64_tr_b16 v[80:81], v16 offset:8192
 v_mfma_f32_16x16x32_bf16 a[100:103], v[88:91], v[240:243], a[100:103]
 ds_read_b64_tr_b16 v[82:83], v16 offset:9216
 v_mfma_f32_16x16x32_bf16 a[108:111], v[88:91], v[244:247], a[108:111]
 buffer_load_dwordx4 v9, s[8:11], s62 offen offset:3072  lds
 v_mfma_f32_16x16x32_bf16 a[108:111], v[84:87], v[212:215], a[108:111]
 v_mfma_f32_16x16x32_bf16 a[116:119], v[84:87], v[216:219], a[116:119]
 s_add_u32 s62, s62, 524288
 v_mfma_f32_16x16x32_bf16 a[116:119], v[88:91], v[248:251], a[116:119]
 global_load_dword v122, v52, s[46:47]
 v_mfma_f32_16x16x32_bf16 a[124:127], v[88:91], v[252:255], a[124:127]
 v_mfma_f32_16x16x32_bf16 a[124:127], v[84:87], v[220:223], a[124:127]
 s_waitcnt lgkmcnt(4)
 v_mfma_f32_16x16x32_bf16 a[192:195], v[60:63], v[128:131], a[192:195]
 ds_read_b64_tr_b16 v[84:85], v17 offset:0
 v_mfma_f32_16x16x32_bf16 a[192:195], v[64:67], v[160:163], a[192:195]
 ds_read_b64_tr_b16 v[86:87], v17 offset:1024
 v_mfma_f32_16x16x32_bf16 a[200:203], v[64:67], v[164:167], a[200:203]
 buffer_load_dword v125, v126, s[40:43], 0 offen sc1
 v_mfma_f32_16x16x32_bf16 a[200:203], v[60:63], v[132:135], a[200:203]
 s_cmp_eq_u32 s3, 0
 s_cselect_b32 s45, 8, 0
 v_mfma_f32_16x16x32_bf16 a[208:211], v[60:63], v[136:139], a[208:211]
 s_mov_b32 s4, s36
 v_mfma_f32_16x16x32_bf16 a[208:211], v[64:67], v[168:171], a[208:211]
 s_mov_b32 s5, s37
 v_mfma_f32_16x16x32_bf16 a[216:219], v[64:67], v[172:175], a[216:219]
 v_mfma_f32_16x16x32_bf16 a[216:219], v[60:63], v[140:143], a[216:219]
 s_lshl_b32 s22, s3, 14
 v_mfma_f32_16x16x32_bf16 a[0:3], v[60:63], v[144:147], a[0:3]
 ds_read_b64_tr_b16 v[88:89], v17 offset:8192
 v_mfma_f32_16x16x32_bf16 a[0:3], v[64:67], v[176:179], a[0:3]
 ds_read_b64_tr_b16 v[90:91], v17 offset:9216
 v_mfma_f32_16x16x32_bf16 a[8:11], v[64:67], v[180:183], a[8:11]
 s_lshl_b32 s25, s92, 15
 v_mfma_f32_16x16x32_bf16 a[8:11], v[60:63], v[148:151], a[8:11]
 s_lshl_b32 s26, s93, 15
 v_mfma_f32_16x16x32_bf16 a[16:19], v[60:63], v[152:155], a[16:19]
 v_mfma_f32_16x16x32_bf16 a[16:19], v[64:67], v[184:187], a[16:19]
 s_sub_u32 s25, s25, s22
 v_mfma_f32_16x16x32_bf16 a[24:27], v[64:67], v[188:191], a[24:27]
 v_mfma_f32_16x16x32_bf16 a[24:27], v[60:63], v[156:159], a[24:27]
 s_sub_u32 s26, s26, s22
 v_mfma_f32_16x16x32_bf16 a[196:199], v[68:71], v[128:131], a[196:199]
 ds_read_b64_tr_b16 v[60:61], v18 offset:0
 v_mfma_f32_16x16x32_bf16 a[196:199], v[72:75], v[160:163], a[196:199]
 ds_read_b64_tr_b16 v[62:63], v18 offset:1024
 s_lshl_b32 s22, s22, 1
 v_mfma_f32_16x16x32_bf16 a[204:207], v[72:75], v[164:167], a[204:207]
 v_mfma_f32_16x16x32_bf16 a[204:207], v[68:71], v[132:135], a[204:207]
 s_sub_u32 s22, 98304, s22
 v_mfma_f32_16x16x32_bf16 a[212:215], v[68:71], v[136:139], a[212:215]
 v_mfma_f32_16x16x32_bf16 a[212:215], v[72:75], v[168:171], a[212:215]
 v_add_u32 v4, s22, v4
 v_mfma_f32_16x16x32_bf16 a[220:223], v[72:75], v[172:175], a[220:223]
 v_add_u32 v5, s22, v5
 v_mfma_f32_16x16x32_bf16 a[220:223], v[68:71], v[140:143], a[220:223]
 v_mfma_f32_16x16x32_bf16 a[4:7], v[68:71], v[144:147], a[4:7]
 ds_read_b64_tr_b16 v[64:65], v18 offset:8192
 s_add_u32 m0, s29, 32768
 v_mfma_f32_16x16x32_bf16 a[4:7], v[72:75], v[176:179], a[4:7]
 ds_read_b64_tr_b16 v[66:67], v18 offset:9216
 v_mfma_f32_16x16x32_bf16 a[12:15], v[72:75], v[180:183], a[12:15]
 v_mfma_f32_16x16x32_bf16 a[12:15], v[68:71], v[148:151], a[12:15]
 s_nop 0
 v_mfma_f32_16x16x32_bf16 a[20:23], v[68:71], v[152:155], a[20:23]
 buffer_load_dwordx4 v2, s[4:7], s25 offen offset:0  lds
 v_mfma_f32_16x16x32_bf16 a[20:23], v[72:75], v[184:187], a[20:23]
 v_mfma_f32_16x16x32_bf16 a[28:31], v[72:75], v[188:191], a[28:31]
 v_mfma_f32_16x16x32_bf16 a[28:31], v[68:71], v[156:159], a[28:31]
 s_waitcnt lgkmcnt(8)
 v_mfma_f32_16x16x32_bf16 a[224:227], v[76:79], v[128:131], a[224:227]
 ds_read_b64_tr_b16 v[68:69], v19 offset:0
 v_mfma_f32_16x16x32_bf16 a[224:227], v[80:83], v[160:163], a[224:227]
 ds_read_b64_tr_b16 v[70:71], v19 offset:1024
 v_mfma_f32_16x16x32_bf16 a[232:235], v[80:83], v[164:167], a[232:235]
 buffer_load_dwordx4 v3, s[4:7], s25 offen offset:1024  lds
 v_mfma_f32_16x16x32_bf16 a[232:235], v[76:79], v[132:135], a[232:235]
 v_mfma_f32_16x16x32_bf16 a[240:243], v[76:79], v[136:139], a[240:243]
 v_mfma_f32_16x16x32_bf16 a[240:243], v[80:83], v[168:171], a[240:243]
 v_mfma_f32_16x16x32_bf16 a[248:251], v[80:83], v[172:175], a[248:251]
 v_mfma_f32_16x16x32_bf16 a[248:251], v[76:79], v[140:143], a[248:251]
 buffer_load_dwordx4 v4, s[4:7], s25 offen offset:2048  lds
 v_mfma_f32_16x16x32_bf16 a[32:35], v[76:79], v[144:147], a[32:35]
 ds_read_b64_tr_b16 v[72:73], v19 offset:8192
 v_mfma_f32_16x16x32_bf16 a[32:35], v[80:83], v[176:179], a[32:35]
 ds_read_b64_tr_b16 v[74:75], v19 offset:9216
 v_mfma_f32_16x16x32_bf16 a[40:43], v[80:83], v[180:183], a[40:43]
 v_mfma_f32_16x16x32_bf16 a[40:43], v[76:79], v[148:151], a[40:43]
 v_mfma_f32_16x16x32_bf16 a[48:51], v[76:79], v[152:155], a[48:51]
 v_mfma_f32_16x16x32_bf16 a[48:51], v[80:83], v[184:187], a[48:51]
 buffer_load_dwordx4 v5, s[4:7], s25 offen offset:3072  lds
 v_mfma_f32_16x16x32_bf16 a[56:59], v[80:83], v[188:191], a[56:59]
 v_mfma_f32_16x16x32_bf16 a[56:59], v[76:79], v[156:159], a[56:59]
 s_waitcnt lgkmcnt(8)
 v_mfma_f32_16x16x32_bf16 a[228:231], v[84:87], v[128:131], a[228:231]
 ds_read_b64_tr_b16 v[76:77], v20 offset:0
 v_mfma_f32_16x16x32_bf16 a[228:231], v[88:91], v[160:163], a[228:231]
 ds_read_b64_tr_b16 v[78:79], v20 offset:1024
 v_mfma_f32_16x16x32_bf16 a[236:239], v[88:91], v[164:167], a[236:239]
 v_mfma_f32_16x16x32_bf16 a[236:239], v[84:87], v[132:135], a[236:239]
 s_add_u32 m0, s29, 36864
 v_mfma_f32_16x16x32_bf16 a[244:247], v[84:87], v[136:139], a[244:247]
 v_mfma_f32_16x16x32_bf16 a[244:247], v[88:91], v[168:171], a[244:247]
 s_add_u32 s25, s25, 128
 v_mfma_f32_16x16x32_bf16 a[252:255], v[88:91], v[172:175], a[252:255]
 v_mfma_f32_16x16x32_bf16 a[252:255], v[84:87], v[140:143], a[252:255]
 buffer_load_dwordx4 v2, s[4:7], s26 offen offset:0  lds
 v_mfma_f32_16x16x32_bf16 a[36:39], v[84:87], v[144:147], a[36:39]
 ds_read_b64_tr_b16 v[80:81], v20 offset:8192
 v_mfma_f32_16x16x32_bf16 a[36:39], v[88:91], v[176:179], a[36:39]
 ds_read_b64_tr_b16 v[82:83], v20 offset:9216
 v_mfma_f32_16x16x32_bf16 a[44:47], v[88:91], v[180:183], a[44:47]
 v_mfma_f32_16x16x32_bf16 a[44:47], v[84:87], v[148:151], a[44:47]
 v_mfma_f32_16x16x32_bf16 a[52:55], v[84:87], v[152:155], a[52:55]
 v_mfma_f32_16x16x32_bf16 a[52:55], v[88:91], v[184:187], a[52:55]
 buffer_load_dwordx4 v3, s[4:7], s26 offen offset:1024  lds
 v_mfma_f32_16x16x32_bf16 a[60:63], v[88:91], v[188:191], a[60:63]
 v_mfma_f32_16x16x32_bf16 a[60:63], v[84:87], v[156:159], a[60:63]
 s_waitcnt lgkmcnt(8)
 v_mfma_f32_16x16x32_bf16 a[128:131], v[60:63], v[128:131], a[128:131]
 ds_read_b64_tr_b16 v[84:85], v21 offset:0
 v_mfma_f32_16x16x32_bf16 a[128:131], v[64:67], v[160:163], a[128:131]
 ds_read_b64_tr_b16 v[86:87], v21 offset:1024
 v_mfma_f32_16x16x32_bf16 a[136:139], v[64:67], v[164:167], a[136:139]
 v_mfma_f32_16x16x32_bf16 a[136:139], v[60:63], v[132:135], a[136:139]
 buffer_load_dwordx4 v4, s[4:7], s26 offen offset:2048  lds
 v_mfma_f32_16x16x32_bf16 a[144:147], v[60:63], v[136:139], a[144:147]
 v_mfma_f32_16x16x32_bf16 a[144:147], v[64:67], v[168:171], a[144:147]
 v_mfma_f32_16x16x32_bf16 a[152:155], v[64:67], v[172:175], a[152:155]
 v_mfma_f32_16x16x32_bf16 a[152:155], v[60:63], v[140:143], a[152:155]
 v_mfma_f32_16x16x32_bf16 a[64:67], v[60:63], v[144:147], a[64:67]
 ds_read_b64_tr_b16 v[88:89], v21 offset:8192
 v_mfma_f32_16x16x32_bf16 a[64:67], v[64:67], v[176:179], a[64:67]
 ds_read_b64_tr_b16 v[90:91], v21 offset:9216
 v_mfma_f32_16x16x32_bf16 a[72:75], v[64:67], v[180:183], a[72:75]
 buffer_load_dwordx4 v5, s[4:7], s26 offen offset:3072  lds
 v_mfma_f32_16x16x32_bf16 a[72:75], v[60:63], v[148:151], a[72:75]
 v_mfma_f32_16x16x32_bf16 a[80:83], v[60:63], v[152:155], a[80:83]
 v_mfma_f32_16x16x32_bf16 a[80:83], v[64:67], v[184:187], a[80:83]
 v_mfma_f32_16x16x32_bf16 a[88:91], v[64:67], v[188:191], a[88:91]
 s_add_u32 s26, s26, 128
 v_mfma_f32_16x16x32_bf16 a[88:91], v[60:63], v[156:159], a[88:91]
 s_waitcnt lgkmcnt(8)
 v_mfma_f32_16x16x32_bf16 a[132:135], v[68:71], v[128:131], a[132:135]
 v_mfma_f32_16x16x32_bf16 a[132:135], v[72:75], v[160:163], a[132:135]
 v_mfma_f32_16x16x32_bf16 a[140:143], v[72:75], v[164:167], a[140:143]
 v_mfma_f32_16x16x32_bf16 a[140:143], v[68:71], v[132:135], a[140:143]
 v_mfma_f32_16x16x32_bf16 a[148:151], v[68:71], v[136:139], a[148:151]
 v_mfma_f32_16x16x32_bf16 a[148:151], v[72:75], v[168:171], a[148:151]
 v_mfma_f32_16x16x32_bf16 a[156:159], v[72:75], v[172:175], a[156:159]
 v_mfma_f32_16x16x32_bf16 a[156:159], v[68:71], v[140:143], a[156:159]
 s_waitcnt vmcnt(8) lgkmcnt(0)
 s_barrier
 v_and_b32 v120, 0xff, v125
 v_cmp_gt_u32 vcc, s45, v120
 s_cbranch_vccnz L_spin_7
L_spun_8:
 v_mfma_f32_16x16x32_bf16 a[68:71], v[68:71], v[144:147], a[68:71]
 ds_read_b64_tr_b16 v[60:61], v14 offset:32768
 s_mov_b32 m0, 122880
 v_mfma_f32_16x16x32_bf16 a[68:71], v[72:75], v[176:179], a[68:71]
 ds_read_b64_tr_b16 v[62:63], v14 offset:33792
 s_mov_b32 s8, s46
 v_mfma_f32_16x16x32_bf16 a[76:79], v[72:75], v[180:183], a[76:79]
 ds_read_b64_tr_b16 v[64:65], v14 offset:40960
 v_mfma_f32_16x16x32_bf16 a[76:79], v[68:71], v[148:151], a[76:79]
 ds_read_b64_tr_b16 v[66:67], v14 offset:41984
 v_mfma_f32_16x16x32_bf16 a[84:87], v[68:71], v[152:155], a[84:87]
 ds_read_b128 v[192:195], v12 offset:0
 v_mfma_f32_16x16x32_bf16 a[84:87], v[72:75], v[184:187], a[84:87]
 ds_read_b128 v[224:227], v13 offset:0
 v_mfma_f32_16x16x32_bf16 a[92:95], v[72:75], v[188:191], a[92:95]
 ds_read_b128 v[196:199], v12 offset:2048
 v_mfma_f32_16x16x32_bf16 a[92:95], v[68:71], v[156:159], a[92:95]
 ds_read_b128 v[228:231], v13 offset:2048
 v_mfma_f32_16x16x32_bf16 a[160:163], v[76:79], v[128:131], a[160:163]
 ds_read_b128 v[200:203], v12 offset:4096
 v_mfma_f32_16x16x32_bf16 a[160:163], v[80:83], v[160:163], a[160:163]
 ds_read_b64_tr_b16 v[68:69], v15 offset:32768
 v_mfma_f32_16x16x32_bf16 a[168:171], v[80:83], v[164:167], a[168:171]
 ds_read_b64_tr_b16 v[70:71], v15 offset:33792
 v_mfma_f32_16x16x32_bf16 a[168:171], v[76:79], v[132:135], a[168:171]
 ds_read_b128 v[232:235], v13 offset:4096
 buffer_load_dwordx4 v1, s[12:15], 0 offen lds
 v_mfma_f32_16x16x32_bf16 a[176:179], v[76:79], v[136:139], a[176:179]
 ds_read_b128 v[204:207], v12 offset:6144
 s_mov_b32 s9, s47
 v_mfma_f32_16x16x32_bf16 a[176:179], v[80:83], v[168:171], a[176:179]
 ds_read_b128 v[236:239], v13 offset:6144
 s_lshl_b32 s22, s3, 17
 v_mfma_f32_16x16x32_bf16 a[184:187], v[80:83], v[172:175], a[184:187]
 ds_read_b128 v[208:211], v12 offset:8192
 s_lshl_b32 s27, s20, 8
 v_mfma_f32_16x16x32_bf16 a[184:187], v[76:79], v[140:143], a[184:187]
 ds_read_b128 v[240:243], v13 offset:8192
 s_add_u32 s27, s27, s22
 v_mfma_f32_16x16x32_bf16 a[96:99], v[76:79], v[144:147], a[96:99]
 ds_read_b64_tr_b16 v[72:73], v15 offset:40960
 s_lshl_b32 s30, s3, 12
 v_mfma_f32_16x16x32_bf16 a[96:99], v[80:83], v[176:179], a[96:99]
 ds_read_b64_tr_b16 v[74:75], v15 offset:41984
 s_mov_b32 s12, s38
 v_mfma_f32_16x16x32_bf16 a[104:107], v[80:83], v[180:183], a[104:107]
 ds_read_b128 v[212:215], v12 offset:10240
 s_mov_b32 s13, s39
 v_mfma_f32_16x16x32_bf16 a[104:107], v[76:79], v[148:151], a[104:107]
 ds_read_b128 v[244:247], v13 offset:10240
 s_lshl_b32 s31, s3, 11
 v_mfma_f32_16x16x32_bf16 a[112:115], v[76:79], v[152:155], a[112:115]
 ds_read_b128 v[216:219], v12 offset:12288
 s_mul_i32 s28, s3, 49152
 v_mfma_f32_16x16x32_bf16 a[112:115], v[80:83], v[184:187], a[112:115]
 ds_read_b128 v[248:251], v13 offset:12288
 s_mov_b32 s14, 0x180000
 v_mfma_f32_16x16x32_bf16 a[120:123], v[80:83], v[188:191], a[120:123]
 s_add_u32 m0, s30, 98304
 s_nop 0
 v_mfma_f32_16x16x32_bf16 a[120:123], v[76:79], v[156:159], a[120:123]
 ds_read_b128 v[220:223], v12 offset:14336
 v_mfma_f32_16x16x32_bf16 a[164:167], v[84:87], v[128:131], a[164:167]
 ds_read_b128 v[252:255], v13 offset:14336
 v_mfma_f32_16x16x32_bf16 a[164:167], v[88:91], v[160:163], a[164:167]
 ds_read_b64_tr_b16 v[76:77], v16 offset:32768
 v_mfma_f32_16x16x32_bf16 a[172:175], v[88:91], v[164:167], a[172:175]
 ds_read_b64_tr_b16 v[78:79], v16 offset:33792
 v_add_u32 v12, s96, v12
 v_mfma_f32_16x16x32_bf16 a[172:175], v[84:87], v[132:135], a[172:175]
 v_add_u32 v13, s96, v13
 v_mfma_f32_16x16x32_bf16 a[180:183], v[84:87], v[136:139], a[180:183]
 buffer_load_dwordx4 v6, s[8:11], s27 offen offset:0  lds
 v_mfma_f32_16x16x32_bf16 a[180:183], v[88:91], v[168:171], a[180:183]
 buffer_load_dwordx4 v7, s[8:11], s27 offen offset:1024  lds
 v_mfma_f32_16x16x32_bf16 a[188:191], v[88:91], v[172:175], a[188:191]
 buffer_load_dwordx4 v8, s[8:11], s27 offen offset:2048  lds
 v_mfma_f32_16x16x32_bf16 a[188:191], v[84:87], v[140:143], a[188:191]
 v_mfma_f32_16x16x32_bf16 a[100:103], v[84:87], v[144:147], a[100:103]
 ds_read_b64_tr_b16 v[80:81], v16 offset:40960
 v_mfma_f32_16x16x32_bf16 a[100:103], v[88:91], v[176:179], a[100:103]
 ds_read_b64_tr_b16 v[82:83], v16 offset:41984
 v_mfma_f32_16x16x32_bf16 a[108:111], v[88:91], v[180:183], a[108:111]
 buffer_load_dwordx4 v9, s[8:11], s27 offen offset:3072  lds
 v_mfma_f32_16x16x32_bf16 a[108:111], v[84:87], v[148:151], a[108:111]
 s_add_u32 m0, s31, 114688
 s_add_u32 s27, s27, 524288
 v_mfma_f32_16x16x32_bf16 a[116:119], v[84:87], v[152:155], a[116:119]
 buffer_load_dwordx4 v10, s[12:15], s28 offen offset:0  lds
 v_mfma_f32_16x16x32_bf16 a[116:119], v[88:91], v[184:187], a[116:119]
 v_mfma_f32_16x16x32_bf16 a[124:127], v[88:91], v[188:191], a[124:127]
 buffer_load_dwordx4 v11, s[12:15], s28 offen offset:1024  lds
 v_mfma_f32_16x16x32_bf16 a[124:127], v[84:87], v[156:159], a[124:127]
 s_waitcnt lgkmcnt(4)
 v_mfma_f32_16x16x32_bf16 a[192:195], v[60:63], v[192:195], a[192:195]
 ds_read_b64_tr_b16 v[84:85], v17 offset:32768
 s_add_u32 s28, s28, 196608
 v_mfma_f32_16x16x32_bf16 a[192:195], v[64:67], v[224:227], a[192:195]
 ds_read_b64_tr_b16 v[86:87], v17 offset:33792
 v_mfma_f32_16x16x32_bf16 a[200:203], v[64:67], v[228:231], a[200:203]
 global_load_dword v122, v127, s[0:1]
 v_mfma_f32_16x16x32_bf16 a[200:203], v[60:63], v[196:199], a[200:203]
 v_mfma_f32_16x16x32_bf16 a[208:211], v[60:63], v[200:203], a[208:211]
 s_add_u32 m0, s29, 65536
 v_mfma_f32_16x16x32_bf16 a[208:211], v[64:67], v[232:235], a[208:211]
 s_nop 0
 v_mfma_f32_16x16x32_bf16 a[216:219], v[64:67], v[236:239], a[216:219]
 buffer_load_dwordx4 v2, s[4:7], s25 offen offset:0  lds
 v_mfma_f32_16x16x32_bf16 a[216:219], v[60:63], v[204:207], a[216:219]
 v_mfma_f32_16x16x32_bf16 a[0:3], v[60:63], v[208:211], a[0:3]
 ds_read_b64_tr_b16 v[88:89], v17 offset:40960
 v_mfma_f32_16x16x32_bf16 a[0:3], v[64:67], v[240:243], a[0:3]
 ds_read_b64_tr_b16 v[90:91], v17 offset:41984
 v_mfma_f32_16x16x32_bf16 a[8:11], v[64:67], v[244:247], a[8:11]
 v_mfma_f32_16x16x32_bf16 a[8:11], v[60:63], v[212:215], a[8:11]
 v_mfma_f32_16x16x32_bf16 a[16:19], v[60:63], v[216:219], a[16:19]
 buffer_load_dwordx4 v3, s[4:7], s25 offen offset:1024  lds
 v_mfma_f32_16x16x32_bf16 a[16:19], v[64:67], v[248:251], a[16:19]
 v_mfma_f32_16x16x32_bf16 a[24:27], v[64:67], v[252:255], a[24:27]
 v_mfma_f32_16x16x32_bf16 a[24:27], v[60:63], v[220:223], a[24:27]
 v_mfma_f32_16x16x32_bf16 a[196:199], v[68:71], v[192:195], a[196:199]
 ds_read_b64_tr_b16 v[60:61], v18 offset:32768
 v_mfma_f32_16x16x32_bf16 a[196:199], v[72:75], v[224:227], a[196:199]
 ds_read_b64_tr_b16 v[62:63], v18 offset:33792
 v_mfma_f32_16x16x32_bf16 a[204:207], v[72:75], v[228:231], a[204:207]
 buffer_load_dwordx4 v4, s[4:7], s25 offen offset:2048  lds
 v_mfma_f32_16x16x32_bf16 a[204:207], v[68:71], v[196:199], a[204:207]
 v_mfma_f32_16x16x32_bf16 a[212:215], v[68:71], v[200:203], a[212:215]
 v_mfma_f32_16x16x32_bf16 a[212:215], v[72:75], v[232:235], a[212:215]
 buffer_load_dwordx4 v5, s[4:7], s25 offen offset:3072  lds
 v_mfma_f32_16x16x32_bf16 a[220:223], v[72:75], v[236:239], a[220:223]
 v_mfma_f32_16x16x32_bf16 a[220:223], v[68:71], v[204:207], a[220:223]
 v_mfma_f32_16x16x32_bf16 a[4:7], v[68:71], v[208:211], a[4:7]
 ds_read_b64_tr_b16 v[64:65], v18 offset:40960
 v_mfma_f32_16x16x32_bf16 a[4:7], v[72:75], v[240:243], a[4:7]
 ds_read_b64_tr_b16 v[66:67], v18 offset:41984
 v_mfma_f32_16x16x32_bf16 a[12:15], v[72:75], v[244:247], a[12:15]
 s_add_u32 m0, s29, 69632
 v_mfma_f32_16x16x32_bf16 a[12:15], v[68:71], v[212:215], a[12:15]
 v_mfma_f32_16x16x32_bf16 a[20:23], v[68:71], v[216:219], a[20:23]
 s_add_u32 s25, s25, 128
 v_mfma_f32_16x16x32_bf16 a[20:23], v[72:75], v[248:251], a[20:23]
 buffer_load_dwordx4 v2, s[4:7], s26 offen offset:0  lds
 v_mfma_f32_16x16x32_bf16 a[28:31], v[72:75], v[252:255], a[28:31]
 v_mfma_f32_16x16x32_bf16 a[28:31], v[68:71], v[220:223], a[28:31]
 s_waitcnt lgkmcnt(8)
 v_mfma_f32_16x16x32_bf16 a[224:227], v[76:79], v[192:195], a[224:227]
 ds_read_b64_tr_b16 v[68:69], v19 offset:32768
 v_mfma_f32_16x16x32_bf16 a[224:227], v[80:83], v[224:227], a[224:227]
 ds_read_b64_tr_b16 v[70:71], v19 offset:33792
 v_mfma_f32_16x16x32_bf16 a[232:235], v[80:83], v[228:231], a[232:235]
 v_mfma_f32_16x16x32_bf16 a[232:235], v[76:79], v[196:199], a[232:235]
 buffer_load_dwordx4 v3, s[4:7], s26 offen offset:1024  lds
 v_mfma_f32_16x16x32_bf16 a[240:243], v[76:79], v[200:203], a[240:243]
 v_mfma_f32_16x16x32_bf16 a[240:243], v[80:83], v[232:235], a[240:243]
 v_mfma_f32_16x16x32_bf16 a[248:251], v[80:83], v[236:239], a[248:251]
 v_accvgpr_read_b32 v96, a192
 v_accvgpr_read_b32 v97, a193
 v_mfma_f32_16x16x32_bf16 a[248:251], v[76:79], v[204:207], a[248:251]
 buffer_load_dwordx4 v4, s[4:7], s26 offen offset:2048  lds
 v_mfma_f32_16x16x32_bf16 a[32:35], v[76:79], v[208:211], a[32:35]
 ds_read_b64_tr_b16 v[72:73], v19 offset:40960
 v_accvgpr_read_b32 v98, a194
 v_mfma_f32_16x16x32_bf16 a[32:35], v[80:83], v[240:243], a[32:35]
 ds_read_b64_tr_b16 v[74:75], v19 offset:41984
 v_accvgpr_read_b32 v99, a195
 v_mfma_f32_16x16x32_bf16 a[40:43], v[80:83], v[244:247], a[40:43]
 v_accvgpr_read_b32 v100, a196
 v_accvgpr_read_b32 v101, a197
 v_mfma_f32_16x16x32_bf16 a[40:43], v[76:79], v[212:215], a[40:43]
 v_accvgpr_read_b32 v102, a198
 v_accvgpr_read_b32 v103, a199
 v_mfma_f32_16x16x32_bf16 a[48:51], v[76:79], v[216:219], a[48:51]
 buffer_load_dwordx4 v5, s[4:7], s26 offen offset:3072  lds
 v_mfma_f32_16x16x32_bf16 a[48:51], v[80:83], v[248:251], a[48:51]
 v_cvt_pk_bf16_f32 v104, v96, v97
 v_cvt_pk_bf16_f32 v105, v98, v99
 v_mfma_f32_16x16x32_bf16 a[56:59], v[80:83], v[252:255], a[56:59]
 v_cvt_pk_bf16_f32 v106, v100, v101
 v_cvt_pk_bf16_f32 v107, v102, v103
 v_mfma_f32_16x16x32_bf16 a[56:59], v[76:79], v[220:223], a[56:59]
 s_waitcnt lgkmcnt(8)
 v_mfma_f32_16x16x32_bf16 a[228:231], v[84:87], v[192:195], a[228:231]
 ds_read_b64_tr_b16 v[76:77], v20 offset:32768
 v_mfma_f32_16x16x32_bf16 a[228:231], v[88:91], v[224:227], a[228:231]
 ds_read_b64_tr_b16 v[78:79], v20 offset:33792
 s_add_u32 s26, s26, 128
 v_mfma_f32_16x16x32_bf16 a[236:239], v[88:91], v[228:231], a[236:239]
 buffer_store_dwordx4 v[104:107], v1, s[16:19], s33 offen offset:0
 v_mfma_f32_16x16x32_bf16 a[236:239], v[84:87], v[196:199], a[236:239]
 v_cmp_ne_u32 vcc, s63, v125
 v_accvgpr_read_b32 v96, a200
 v_mfma_f32_16x16x32_bf16 a[244:247], v[84:87], v[200:203], a[244:247]
 v_mov_b32 v120, 1
 v_accvgpr_read_b32 v97, a201
 v_mfma_f32_16x16x32_bf16 a[244:247], v[88:91], v[232:235], a[244:247]
 v_accvgpr_read_b32 v98, a202
 v_accvgpr_read_b32 v99, a203
 v_mfma_f32_16x16x32_bf16 a[252:255], v[88:91], v[236:239], a[252:255]
 s_nop 0
 v_accvgpr_read_b32 v100, a204
 v_accvgpr_read_b32 v101, a205
 v_mfma_f32_16x16x32_bf16 a[252:255], v[84:87], v[204:207], a[252:255]
 s_lshr_b32 s22, vcc_lo, s99
 v_accvgpr_read_b32 v102, a206
 v_accvgpr_read_b32 v103, a207
 v_mfma_f32_16x16x32_bf16 a[36:39], v[84:87], v[208:211], a[36:39]
 ds_read_b64_tr_b16 v[80:81], v20 offset:40960
 v_cvt_pk_bf16_f32 v108, v96, v97
 v_mfma_f32_16x16x32_bf16 a[36:39], v[88:91], v[240:243], a[36:39]
 ds_read_b64_tr_b16 v[82:83], v20 offset:41984
 v_cvt_pk_bf16_f32 v109, v98, v99
 v_mfma_f32_16x16x32_bf16 a[44:47], v[88:91], v[244:247], a[44:47]
 s_and_b32 s22, s22, 15
 v_cvt_pk_bf16_f32 v110, v100, v101
 v_cvt_pk_bf16_f32 v111, v102, v103
 v_mfma_f32_16x16x32_bf16 a[44:47], v[84:87], v[212:215], a[44:47]
 s_cmp_eq_u32 s22, 0
 s_cselect_b32 s63, 1, s3
 v_mfma_f32_16x16x32_bf16 a[52:55], v[84:87], v[216:219], a[52:55]
 buffer_store_dwordx4 v[108:111], v1, s[16:19], s33 offen offset:1024
 v_mfma_f32_16x16x32_bf16 a[52:55], v[88:91], v[248:251], a[52:55]
 v_mfma_f32_16x16x32_bf16 a[60:63], v[88:91], v[252:255], a[60:63]
 s_cmp_eq_u32 s3, 0
 s_cselect_b32 s46, 1, 0
 s_cselect_b32 s47, 2, 0
 v_mfma_f32_16x16x32_bf16 a[60:63], v[84:87], v[220:223], a[60:63]
 s_waitcnt lgkmcnt(8)
 v_accvgpr_read_b32 v96, a208
 v_accvgpr_read_b32 v97, a209
 v_mfma_f32_16x16x32_bf16 a[128:131], v[60:63], v[192:195], a[128:131]
 ds_read_b64_tr_b16 v[84:85], v21 offset:32768
 v_accvgpr_read_b32 v98, a210
 v_mfma_f32_16x16x32_bf16 a[128:131], v[64:67], v[224:227], a[128:131]
 ds_read_b64_tr_b16 v[86:87], v21 offset:33792
 v_accvgpr_read_b32 v99, a211
 v_mfma_f32_16x16x32_bf16 a[136:139], v[64:67], v[228:231], a[136:139]
 v_accvgpr_read_b32 v100, a212
 v_accvgpr_read_b32 v101, a213
 v_mfma_f32_16x16x32_bf16 a[136:139], v[60:63], v[196:199], a[136:139]
 s_lshl_b32 s50, s3, 12
 v_accvgpr_read_b32 v102, a214
 v_accvgpr_read_b32 v103, a215
 v_mfma_f32_16x16x32_bf16 a[144:147], v[60:63], v[200:203], a[144:147]
 v_cvt_pk_bf16_f32 v112, v96, v97
 v_cvt_pk_bf16_f32 v113, v98, v99
 v_mfma_f32_16x16x32_bf16 a[144:147], v[64:67], v[232:235], a[144:147]
 s_lshl_b32 s51, s3, 13
 v_cvt_pk_bf16_f32 v114, v100, v101
 v_cvt_pk_bf16_f32 v115, v102, v103
 v_mfma_f32_16x16x32_bf16 a[152:155], v[64:67], v[236:239], a[152:155]
 s_lshl_b32 s22, s20, 19
 v_mfma_f32_16x16x32_bf16 a[152:155], v[60:63], v[204:207], a[152:155]
 s_lshl_b32 s57, s21, 15
 v_mfma_f32_16x16x32_bf16 a[64:67], v[60:63], v[208:211], a[64:67]
 ds_read_b64_tr_b16 v[88:89], v21 offset:40960
 v_mfma_f32_16x16x32_bf16 a[64:67], v[64:67], v[240:243], a[64:67]
 ds_read_b64_tr_b16 v[90:91], v21 offset:41984
 v_mfma_f32_16x16x32_bf16 a[72:75], v[64:67], v[244:247], a[72:75]
 buffer_store_dwordx4 v[112:115], v1, s[16:19], s98 offen offset:0
 s_add_u32 s22, s22, s57
 v_mfma_f32_16x16x32_bf16 a[72:75], v[60:63], v[212:215], a[72:75]
 s_add_u32 s48, s22, 0x1600000
 v_accvgpr_read_b32 v96, a216
 v_accvgpr_read_b32 v97, a217
 v_mfma_f32_16x16x32_bf16 a[80:83], v[60:63], v[216:219], a[80:83]
 v_accvgpr_read_b32 v98, a218
 v_accvgpr_read_b32 v99, a219
 v_mfma_f32_16x16x32_bf16 a[80:83], v[64:67], v[248:251], a[80:83]
 s_add_u32 s49, s22, 0x2600000
 v_accvgpr_read_b32 v100, a220
 v_accvgpr_read_b32 v101, a221
 v_mfma_f32_16x16x32_bf16 a[88:91], v[64:67], v[252:255], a[88:91]
 s_mov_b32 s54, 0x57800000
 v_accvgpr_read_b32 v102, a222
 v_accvgpr_read_b32 v103, a223
 v_mfma_f32_16x16x32_bf16 a[88:91], v[60:63], v[220:223], a[88:91]
 s_waitcnt lgkmcnt(8)
 v_cvt_pk_bf16_f32 v116, v96, v97
 v_cvt_pk_bf16_f32 v117, v98, v99
 v_mfma_f32_16x16x32_bf16 a[132:135], v[68:71], v[192:195], a[132:135]
 v_cvt_pk_bf16_f32 v118, v100, v101
 v_cvt_pk_bf16_f32 v119, v102, v103
 v_mfma_f32_16x16x32_bf16 a[132:135], v[72:75], v[224:227], a[132:135]
 buffer_store_dwordx4 v[116:119], v1, s[16:19], s98 offen offset:1024
 v_mfma_f32_16x16x32_bf16 a[140:143], v[72:75], v[228:231], a[140:143]
 v_mfma_f32_16x16x32_bf16 a[140:143], v[68:71], v[196:199], a[140:143]
 v_accvgpr_read_b32 v96, a224
 v_accvgpr_read_b32 v97, a225
 v_mfma_f32_16x16x32_bf16 a[148:151], v[68:71], v[200:203], a[148:151]
 v_accvgpr_read_b32 v98, a226
 v_accvgpr_read_b32 v99, a227
 v_mfma_f32_16x16x32_bf16 a[148:151], v[72:75], v[232:235], a[148:151]
 v_accvgpr_read_b32 v100, a228
 v_accvgpr_read_b32 v101, a229
 v_mfma_f32_16x16x32_bf16 a[156:159], v[72:75], v[236:239], a[156:159]
 v_accvgpr_read_b32 v102, a230
 v_accvgpr_read_b32 v103, a231
 v_mfma_f32_16x16x32_bf16 a[156:159], v[68:71], v[204:207], a[156:159]
 v_cvt_pk_bf16_f32 v104, v96, v97
 v_cvt_pk_bf16_f32 v105, v98, v99
 s_waitcnt vmcnt(13) lgkmcnt(0)
 s_barrier
 v_mfma_f32_16x16x32_bf16 a[68:71], v[68:71], v[208:211], a[68:71]
 v_subrev_u32 v14, s97, v14
 v_subrev_u32 v15, s97, v15
 v_mfma_f32_16x16x32_bf16 a[68:71], v[72:75], v[240:243], a[68:71]
 v_subrev_u32 v16, s97, v16
 v_subrev_u32 v17, s97, v17
 v_mfma_f32_16x16x32_bf16 a[76:79], v[72:75], v[244:247], a[76:79]
 v_subrev_u32 v18, s97, v18
 v_subrev_u32 v19, s97, v19
 v_mfma_f32_16x16x32_bf16 a[76:79], v[68:71], v[212:215], a[76:79]
 v_subrev_u32 v20, s97, v20
 v_subrev_u32 v21, s97, v21
 v_mfma_f32_16x16x32_bf16 a[84:87], v[68:71], v[216:219], a[84:87]
 ds_read_b64_tr_b16 v[60:61], v14 offset:0
 s_add_u32 m0, s30, 131072
 v_mfma_f32_16x16x32_bf16 a[84:87], v[72:75], v[248:251], a[84:87]
 ds_read_b64_tr_b16 v[62:63], v14 offset:1024
 s_nop 0
 v_mfma_f32_16x16x32_bf16 a[92:95], v[72:75], v[252:255], a[92:95]
 ds_read_b64_tr_b16 v[64:65], v14 offset:8192
 v_cvt_pk_bf16_f32 v106, v100, v101
 v_cvt_pk_bf16_f32 v107, v102, v103
 v_mfma_f32_16x16x32_bf16 a[92:95], v[68:71], v[220:223], a[92:95]
 ds_read_b64_tr_b16 v[66:67], v14 offset:9216
 v_mfma_f32_16x16x32_bf16 a[160:163], v[76:79], v[192:195], a[160:163]
 ds_read_b64_tr_b16 v[68:69], v15 offset:0
 buffer_store_dwordx4 v[104:107], v1, s[16:19], s33 offen offset:2048
 v_mfma_f32_16x16x32_bf16 a[160:163], v[80:83], v[224:227], a[160:163]
 ds_read_b64_tr_b16 v[70:71], v15 offset:1024
 v_accvgpr_read_b32 v96, a232
 v_mfma_f32_16x16x32_bf16 a[168:171], v[80:83], v[228:231], a[168:171]
 ds_read_b128 v[28:31], v12 offset:0
 v_accvgpr_read_b32 v97, a233
 v_mfma_f32_16x16x32_bf16 a[168:171], v[76:79], v[196:199], a[168:171]
 ds_read_b128 v[44:47], v13 offset:0
 v_accvgpr_read_b32 v98, a234
 v_mfma_f32_16x16x32_bf16 a[176:179], v[76:79], v[200:203], a[176:179]
 buffer_load_dwordx4 v6, s[8:11], s27 offen offset:0  lds
 v_mfma_f32_16x16x32_bf16 a[176:179], v[80:83], v[232:235], a[176:179]
 ds_read_b128 v[32:35], v12 offset:2048
 v_accvgpr_read_b32 v99, a235
 v_mfma_f32_16x16x32_bf16 a[184:187], v[80:83], v[236:239], a[184:187]
 ds_read_b128 v[48:51], v13 offset:2048
 v_accvgpr_read_b32 v100, a236
 v_mfma_f32_16x16x32_bf16 a[184:187], v[76:79], v[204:207], a[184:187]
 buffer_load_dwordx4 v7, s[8:11], s27 offen offset:1024  lds
 v_mfma_f32_16x16x32_bf16 a[96:99], v[76:79], v[208:211], a[96:99]
 ds_read_b128 v[36:39], v12 offset:4096
 v_accvgpr_read_b32 v101, a237
 v_mfma_f32_16x16x32_bf16 a[96:99], v[80:83], v[240:243], a[96:99]
 ds_read_b64_tr_b16 v[72:73], v15 offset:8192
 v_accvgpr_read_b32 v102, a238
 v_mfma_f32_16x16x32_bf16 a[104:107], v[80:83], v[244:247], a[104:107]
 ds_read_b64_tr_b16 v[74:75], v15 offset:9216
 v_accvgpr_read_b32 v103, a239
 v_cvt_pk_bf16_f32 v108, v96, v97
 v_mfma_f32_16x16x32_bf16 a[104:107], v[76:79], v[212:215], a[104:107]
 ds_read_b128 v[52:55], v13 offset:4096
 v_cvt_pk_bf16_f32 v109, v98, v99
 v_cvt_pk_bf16_f32 v110, v100, v101
 v_mfma_f32_16x16x32_bf16 a[112:115], v[76:79], v[216:219], a[112:115]
 ds_read_b128 v[40:43], v12 offset:6144
 v_cvt_pk_bf16_f32 v111, v102, v103
 buffer_store_dwordx4 v[108:111], v1, s[16:19], s33 offen offset:3072
 v_mfma_f32_16x16x32_bf16 a[112:115], v[80:83], v[248:251], a[112:115]
 ds_read_b128 v[56:59], v13 offset:6144
 v_accvgpr_read_b32 v96, a240
 v_mfma_f32_16x16x32_bf16 a[120:123], v[80:83], v[252:255], a[120:123]
 buffer_load_dwordx4 v8, s[8:11], s27 offen offset:2048  lds
 v_add_u32 v12, 0x8000, v12
 v_mfma_f32_16x16x32_bf16 a[120:123], v[76:79], v[220:223], a[120:123]
 v_add_u32 v13, 0x8000, v13
 v_mfma_f32_16x16x32_bf16 a[164:167], v[84:87], v[192:195], a[164:167]
 ds_read_b64_tr_b16 v[76:77], v16 offset:0
 v_accvgpr_read_b32 v97, a241
 v_mfma_f32_16x16x32_bf16 a[164:167], v[88:91], v[224:227], a[164:167]
 ds_read_b64_tr_b16 v[78:79], v16 offset:1024
 v_accvgpr_read_b32 v98, a242
 v_mfma_f32_16x16x32_bf16 a[172:175], v[88:91], v[228:231], a[172:175]
 buffer_load_dwordx4 v9, s[8:11], s27 offen offset:3072  lds
 v_mfma_f32_16x16x32_bf16 a[172:175], v[84:87], v[196:199], a[172:175]
 s_add_u32 m0, s31, 147456
 s_add_u32 s27, s27, 524288
 v_accvgpr_read_b32 v99, a243
 v_mfma_f32_16x16x32_bf16 a[180:183], v[84:87], v[200:203], a[180:183]
 buffer_load_dwordx4 v10, s[12:15], s28 offen offset:0  lds
 v_mfma_f32_16x16x32_bf16 a[180:183], v[88:91], v[232:235], a[180:183]
 buffer_load_dwordx4 v11, s[12:15], s28 offen offset:1024  lds
 v_mfma_f32_16x16x32_bf16 a[188:191], v[88:91], v[236:239], a[188:191]
 s_add_u32 s28, s28, 196608
 v_accvgpr_read_b32 v100, a244
 v_accvgpr_read_b32 v101, a245
 v_mfma_f32_16x16x32_bf16 a[188:191], v[84:87], v[204:207], a[188:191]
 v_accvgpr_read_b32 v102, a246
 v_accvgpr_read_b32 v103, a247
 v_mfma_f32_16x16x32_bf16 a[100:103], v[84:87], v[208:211], a[100:103]
 ds_read_b64_tr_b16 v[80:81], v16 offset:8192
 v_cvt_pk_bf16_f32 v112, v96, v97
 v_cvt_pk_bf16_f32 v113, v98, v99
 v_mfma_f32_16x16x32_bf16 a[100:103], v[88:91], v[240:243], a[100:103]
 ds_read_b64_tr_b16 v[82:83], v16 offset:9216
 v_cvt_pk_bf16_f32 v114, v100, v101
 v_cvt_pk_bf16_f32 v115, v102, v103
 v_mfma_f32_16x16x32_bf16 a[108:111], v[88:91], v[244:247], a[108:111]
 buffer_store_dwordx4 v[112:115], v1, s[16:19], s98 offen offset:2048
 v_mfma_f32_16x16x32_bf16 a[108:111], v[84:87], v[212:215], a[108:111]
 v_accvgpr_read_b32 v96, a248
 v_accvgpr_read_b32 v97, a249
 v_mfma_f32_16x16x32_bf16 a[116:119], v[84:87], v[216:219], a[116:119]
 v_accvgpr_read_b32 v98, a250
 v_accvgpr_read_b32 v99, a251
 v_mfma_f32_16x16x32_bf16 a[116:119], v[88:91], v[248:251], a[116:119]
 v_accvgpr_read_b32 v100, a252
 v_accvgpr_read_b32 v101, a253
 v_accvgpr_read_b32 v102, a254
 v_accvgpr_read_b32 v103, a255
 v_mfma_f32_16x16x32_bf16 a[124:127], v[88:91], v[252:255], a[124:127]
 v_cvt_pk_bf16_f32 v116, v96, v97
 v_cvt_pk_bf16_f32 v117, v98, v99
 v_cvt_pk_bf16_f32 v118, v100, v101
 v_mfma_f32_16x16x32_bf16 a[124:127], v[84:87], v[220:223], a[124:127]
 v_cvt_pk_bf16_f32 v119, v102, v103
 buffer_store_dwordx4 v[116:119], v1, s[16:19], s98 offen offset:3072
 s_add_u32 s33, s33, 4096
 s_add_u32 s98, s98, 4096
 s_branch L_qphase_6
L_kvV_5:
 s_waitcnt lgkmcnt(8)
 v_mfma_f32_16x16x32_bf16 a[192:195], v[128:131], v[60:63], 0
 ds_read_b64_tr_b16 v[84:85], v17 offset:0
 v_mfma_f32_16x16x32_bf16 a[192:195], v[160:163], v[64:67], a[192:195]
 ds_read_b64_tr_b16 v[86:87], v17 offset:1024
 v_mfma_f32_16x16x32_bf16 a[196:199], v[132:135], v[60:63], 0
 s_lshl_b32 s22, s3, 6
 v_mfma_f32_16x16x32_bf16 a[196:199], v[164:167], v[64:67], a[196:199]
 v_add_u32 v120, s22, v0
 v_mfma_f32_16x16x32_bf16 a[208:211], v[136:139], v[60:63], 0
 v_lshlrev_b32 v120, 12, v120
 v_mfma_f32_16x16x32_bf16 a[208:211], v[168:171], v[64:67], a[208:211]
 v_min_u32 v121, 1, v120
 v_mfma_f32_16x16x32_bf16 a[212:215], v[140:143], v[60:63], 0
 v_lshlrev_b32 v121, 29, v121
 v_mfma_f32_16x16x32_bf16 a[212:215], v[172:175], v[64:67], a[212:215]
 s_getreg_b32 s22, hwreg(HW_REG_XCC_ID, 0, 4)
 v_mfma_f32_16x16x32_bf16 a[0:3], v[144:147], v[60:63], 0
 ds_read_b64_tr_b16 v[88:89], v17 offset:8192
 v_mfma_f32_16x16x32_bf16 a[0:3], v[176:179], v[64:67], a[0:3]
 ds_read_b64_tr_b16 v[90:91], v17 offset:9216
 s_mul_i32 s23, s22, s22
 v_mfma_f32_16x16x32_bf16 a[4:7], v[148:151], v[60:63], 0
 s_lshl_b32 s23, s23, 8
 v_mfma_f32_16x16x32_bf16 a[4:7], v[180:183], v[64:67], a[4:7]
 s_add_u32 s23, s23, s22
 v_mfma_f32_16x16x32_bf16 a[16:19], v[152:155], v[60:63], 0
 s_lshl_b32 s23, s23, 8
 v_mfma_f32_16x16x32_bf16 a[16:19], v[184:187], v[64:67], a[16:19]
 s_add_u32 s63, s23, 1
 v_mfma_f32_16x16x32_bf16 a[20:23], v[156:159], v[60:63], 0
 v_mov_b32 v125, s63
 v_mfma_f32_16x16x32_bf16 a[20:23], v[188:191], v[64:67], a[20:23]
 s_waitcnt lgkmcnt(8)
 v_mfma_f32_16x16x32_bf16 a[200:203], v[128:131], v[68:71], 0
 ds_read_b64_tr_b16 v[60:61], v18 offset:0
 s_lshl_b32 s63, s63, 3
 v_mfma_f32_16x16x32_bf16 a[200:203], v[160:163], v[72:75], a[200:203]
 ds_read_b64_tr_b16 v[62:63], v18 offset:1024
 v_mfma_f32_16x16x32_bf16 a[204:207], v[132:135], v[68:71], 0
 s_and_b32 s99, s2, 7
 v_mfma_f32_16x16x32_bf16 a[204:207], v[164:167], v[72:75], a[204:207]
 s_lshl_b32 s99, s99, 2
 v_mfma_f32_16x16x32_bf16 a[216:219], v[136:139], v[68:71], 0
 s_add_u32 m0, s29, 32768
 s_lshl_b32 s32, s20, 2
 v_mfma_f32_16x16x32_bf16 a[216:219], v[168:171], v[72:75], a[216:219]
 s_nop 0
 v_and_b32 v126, 31, v0
 v_mfma_f32_16x16x32_bf16 a[220:223], v[140:143], v[68:71], 0
 s_lshl_b32 s22, s3, 12
 v_mfma_f32_16x16x32_bf16 a[220:223], v[172:175], v[72:75], a[220:223]
 buffer_load_dwordx4 v2, s[4:7], s25 offen offset:0  lds
 v_mfma_f32_16x16x32_bf16 a[8:11], v[144:147], v[68:71], 0
 ds_read_b64_tr_b16 v[64:65], v18 offset:8192
 v_mfma_f32_16x16x32_bf16 a[8:11], v[176:179], v[72:75], a[8:11]
 ds_read_b64_tr_b16 v[66:67], v18 offset:9216
 v_lshl_add_u32 v126, v126, 2, s22
 v_mfma_f32_16x16x32_bf16 a[12:15], v[148:151], v[68:71], 0
 s_min_u32 s22, s3, 1
 v_mfma_f32_16x16x32_bf16 a[12:15], v[180:183], v[72:75], a[12:15]
 s_lshl_b32 s22, s22, 29
 v_mfma_f32_16x16x32_bf16 a[24:27], v[152:155], v[68:71], 0
 v_and_b32 v124, 7, v0
 v_mfma_f32_16x16x32_bf16 a[24:27], v[184:187], v[72:75], a[24:27]
 v_lshl_add_u32 v124, v124, 2, s22
 v_mfma_f32_16x16x32_bf16 a[28:31], v[156:159], v[68:71], 0
 buffer_load_dwordx4 v3, s[4:7], s25 offen offset:1024  lds
 v_mfma_f32_16x16x32_bf16 a[28:31], v[188:191], v[72:75], a[28:31]
 s_waitcnt lgkmcnt(8)
 s_lshl_b32 s55, s20, 7
 v_mfma_f32_16x16x32_bf16 a[224:227], v[128:131], v[76:79], 0
 ds_read_b64_tr_b16 v[68:69], v19 offset:0
 v_mfma_f32_16x16x32_bf16 a[224:227], v[160:163], v[80:83], a[224:227]
 ds_read_b64_tr_b16 v[70:71], v19 offset:1024
 v_mfma_f32_16x16x32_bf16 a[228:231], v[132:135], v[76:79], 0
 s_add_u32 s55, s55, 0x6304000
 v_mfma_f32_16x16x32_bf16 a[228:231], v[164:167], v[80:83], a[228:231]
 s_lshl_b32 s94, s21, 2
 v_mfma_f32_16x16x32_bf16 a[240:243], v[136:139], v[76:79], 0
 buffer_load_dwordx4 v4, s[4:7], s25 offen offset:2048  lds
 v_mfma_f32_16x16x32_bf16 a[240:243], v[168:171], v[80:83], a[240:243]
 s_add_u32 s94, s94, s55
 v_mfma_f32_16x16x32_bf16 a[244:247], v[140:143], v[76:79], 0
 s_lshr_b32 s71, s20, 3
 v_mfma_f32_16x16x32_bf16 a[244:247], v[172:175], v[80:83], a[244:247]
 s_lshl_b32 s64, s71, 3
 v_mfma_f32_16x16x32_bf16 a[32:35], v[144:147], v[76:79], 0
 ds_read_b64_tr_b16 v[72:73], v19 offset:8192
 s_add_u32 s64, s64, s21
 v_mfma_f32_16x16x32_bf16 a[32:35], v[176:179], v[80:83], a[32:35]
 ds_read_b64_tr_b16 v[74:75], v19 offset:9216
 v_mfma_f32_16x16x32_bf16 a[36:39], v[148:151], v[76:79], 0
 s_lshl_b32 s64, s64, 5
 v_mfma_f32_16x16x32_bf16 a[36:39], v[180:183], v[80:83], a[36:39]
 buffer_load_dwordx4 v5, s[4:7], s25 offen offset:3072  lds
 v_mfma_f32_16x16x32_bf16 a[48:51], v[152:155], v[76:79], 0
 s_and_b32 s70, s20, 7
 v_mfma_f32_16x16x32_bf16 a[48:51], v[184:187], v[80:83], a[48:51]
 s_add_u32 s64, s64, s70
 v_mfma_f32_16x16x32_bf16 a[52:55], v[156:159], v[76:79], 0
 s_lshl_b32 s64, s64, 2
 v_mfma_f32_16x16x32_bf16 a[52:55], v[188:191], v[80:83], a[52:55]
 s_waitcnt lgkmcnt(8)
 s_add_u32 s64, s64, 0x6300000
 v_mfma_f32_16x16x32_bf16 a[232:235], v[128:131], v[84:87], 0
 ds_read_b64_tr_b16 v[76:77], v20 offset:0
 v_mfma_f32_16x16x32_bf16 a[232:235], v[160:163], v[88:91], a[232:235]
 ds_read_b64_tr_b16 v[78:79], v20 offset:1024
 s_add_u32 m0, s29, 36864
 v_mfma_f32_16x16x32_bf16 a[236:239], v[132:135], v[84:87], 0
 s_sub_u32 s70, 15, s21
 v_mfma_f32_16x16x32_bf16 a[236:239], v[164:167], v[88:91], a[236:239]
 s_add_u32 s25, s25, 128
 s_bitcmp1_b32 s2, 0
 s_cselect_b32 s60, s70, s21
 v_mfma_f32_16x16x32_bf16 a[248:251], v[136:139], v[84:87], 0
 v_mfma_f32_16x16x32_bf16 a[248:251], v[168:171], v[88:91], a[248:251]
 buffer_load_dwordx4 v2, s[4:7], s26 offen offset:0  lds
 v_mfma_f32_16x16x32_bf16 a[252:255], v[140:143], v[84:87], 0
 s_lshl_b32 s65, s60, 2
 v_mfma_f32_16x16x32_bf16 a[252:255], v[172:175], v[88:91], a[252:255]
 s_and_b32 s70, s20, 3
 v_mfma_f32_16x16x32_bf16 a[40:43], v[144:147], v[84:87], 0
 ds_read_b64_tr_b16 v[80:81], v20 offset:8192
 v_mfma_f32_16x16x32_bf16 a[40:43], v[176:179], v[88:91], a[40:43]
 ds_read_b64_tr_b16 v[82:83], v20 offset:9216
 s_add_u32 s61, s65, s70
 v_mfma_f32_16x16x32_bf16 a[44:47], v[148:151], v[84:87], 0
 v_mfma_f32_16x16x32_bf16 a[44:47], v[180:183], v[88:91], a[44:47]
 s_lshl_b32 s65, s61, 5
 v_mfma_f32_16x16x32_bf16 a[56:59], v[152:155], v[84:87], 0
 buffer_load_dwordx4 v3, s[4:7], s26 offen offset:1024  lds
 v_mfma_f32_16x16x32_bf16 a[56:59], v[184:187], v[88:91], a[56:59]
 s_add_u32 s65, s65, s71
 v_mfma_f32_16x16x32_bf16 a[60:63], v[156:159], v[84:87], 0
 s_lshl_b32 s65, s65, 2
 v_mfma_f32_16x16x32_bf16 a[60:63], v[188:191], v[88:91], a[60:63]
 s_waitcnt lgkmcnt(8)
 s_add_u32 s65, s65, 0x6301000
 v_mfma_f32_16x16x32_bf16 a[128:131], v[128:131], v[60:63], 0
 ds_read_b64_tr_b16 v[84:85], v21 offset:0
 v_mov_b32 v28, 0
 v_mfma_f32_16x16x32_bf16 a[128:131], v[160:163], v[64:67], a[128:131]
 ds_read_b64_tr_b16 v[86:87], v21 offset:1024
 v_mfma_f32_16x16x32_bf16 a[132:135], v[132:135], v[60:63], 0
 buffer_load_dwordx4 v4, s[4:7], s26 offen offset:2048  lds
 v_mfma_f32_16x16x32_bf16 a[132:135], v[164:167], v[64:67], a[132:135]
 buffer_store_dword v28, v121, s[16:19], s64 offen sc1
 v_mfma_f32_16x16x32_bf16 a[144:147], v[136:139], v[60:63], 0
 v_mfma_f32_16x16x32_bf16 a[144:147], v[168:171], v[64:67], a[144:147]
 v_mfma_f32_16x16x32_bf16 a[148:151], v[140:143], v[60:63], 0
 v_mfma_f32_16x16x32_bf16 a[148:151], v[172:175], v[64:67], a[148:151]
 v_mfma_f32_16x16x32_bf16 a[64:67], v[144:147], v[60:63], 0
 ds_read_b64_tr_b16 v[88:89], v21 offset:8192
 v_mfma_f32_16x16x32_bf16 a[64:67], v[176:179], v[64:67], a[64:67]
 ds_read_b64_tr_b16 v[90:91], v21 offset:9216
 v_mfma_f32_16x16x32_bf16 a[68:71], v[148:151], v[60:63], 0
 buffer_load_dwordx4 v5, s[4:7], s26 offen offset:3072  lds
 v_mfma_f32_16x16x32_bf16 a[68:71], v[180:183], v[64:67], a[68:71]
 buffer_store_dword v28, v121, s[16:19], s65 offen sc1
 v_mfma_f32_16x16x32_bf16 a[80:83], v[152:155], v[60:63], 0
 v_mfma_f32_16x16x32_bf16 a[80:83], v[184:187], v[64:67], a[80:83]
 v_mfma_f32_16x16x32_bf16 a[84:87], v[156:159], v[60:63], 0
 s_add_u32 s26, s26, 128
 v_mfma_f32_16x16x32_bf16 a[84:87], v[188:191], v[64:67], a[84:87]
 s_waitcnt lgkmcnt(8)
 v_mfma_f32_16x16x32_bf16 a[136:139], v[128:131], v[68:71], 0
 buffer_load_dword v122, v50, s[4:7], 0 offen
 v_mfma_f32_16x16x32_bf16 a[136:139], v[160:163], v[72:75], a[136:139]
 v_mfma_f32_16x16x32_bf16 a[140:143], v[132:135], v[68:71], 0
 v_mfma_f32_16x16x32_bf16 a[140:143], v[164:167], v[72:75], a[140:143]
 buffer_store_dword v28, v121, s[16:19], s94 offen sc1
 v_mfma_f32_16x16x32_bf16 a[152:155], v[136:139], v[68:71], 0
 v_mfma_f32_16x16x32_bf16 a[152:155], v[168:171], v[72:75], a[152:155]
 v_mfma_f32_16x16x32_bf16 a[156:159], v[140:143], v[68:71], 0
 v_mfma_f32_16x16x32_bf16 a[156:159], v[172:175], v[72:75], a[156:159]
 s_waitcnt vmcnt(12) lgkmcnt(0)
 s_barrier
 v_mfma_f32_16x16x32_bf16 a[72:75], v[144:147], v[68:71], 0
 ds_read_b64_tr_b16 v[60:61], v14 offset:32768
 s_add_u32 m0, s30, 98304
 v_mfma_f32_16x16x32_bf16 a[72:75], v[176:179], v[72:75], a[72:75]
 ds_read_b64_tr_b16 v[62:63], v14 offset:33792
 s_nop 0
 v_mfma_f32_16x16x32_bf16 a[76:79], v[148:151], v[68:71], 0
 ds_read_b64_tr_b16 v[64:65], v14 offset:40960
 v_mfma_f32_16x16x32_bf16 a[76:79], v[180:183], v[72:75], a[76:79]
 ds_read_b64_tr_b16 v[66:67], v14 offset:41984
 v_mfma_f32_16x16x32_bf16 a[88:91], v[152:155], v[68:71], 0
 ds_read_b128 v[192:195], v12 offset:0
 v_mfma_f32_16x16x32_bf16 a[88:91], v[184:187], v[72:75], a[88:91]
 ds_read_b128 v[224:227], v13 offset:0
 v_mfma_f32_16x16x32_bf16 a[92:95], v[156:159], v[68:71], 0
 ds_read_b128 v[196:199], v12 offset:2048
 v_mfma_f32_16x16x32_bf16 a[92:95], v[188:191], v[72:75], a[92:95]
 ds_read_b128 v[228:231], v13 offset:2048
 v_mfma_f32_16x16x32_bf16 a[160:163], v[128:131], v[76:79], 0
 ds_read_b128 v[200:203], v12 offset:4096
 v_and_b32 v41, 15, v0
 v_mfma_f32_16x16x32_bf16 a[160:163], v[160:163], v[80:83], a[160:163]
 ds_read_b64_tr_b16 v[68:69], v15 offset:32768
 v_mfma_f32_16x16x32_bf16 a[164:167], v[132:135], v[76:79], 0
 ds_read_b64_tr_b16 v[70:71], v15 offset:33792
 v_mfma_f32_16x16x32_bf16 a[164:167], v[164:167], v[80:83], a[164:167]
 ds_read_b128 v[232:235], v13 offset:4096
 v_mfma_f32_16x16x32_bf16 a[176:179], v[136:139], v[76:79], 0
 ds_read_b128 v[204:207], v12 offset:6144
 v_mfma_f32_16x16x32_bf16 a[176:179], v[168:171], v[80:83], a[176:179]
 ds_read_b128 v[236:239], v13 offset:6144
 v_mfma_f32_16x16x32_bf16 a[180:183], v[140:143], v[76:79], 0
 ds_read_b128 v[208:211], v12 offset:8192
 buffer_load_dwordx4 v6, s[8:11], s27 offen offset:0  lds
 v_mfma_f32_16x16x32_bf16 a[180:183], v[172:175], v[80:83], a[180:183]
 ds_read_b128 v[240:243], v13 offset:8192
 s_lshr_b32 s22, s2, 3
 v_mfma_f32_16x16x32_bf16 a[96:99], v[144:147], v[76:79], 0
 ds_read_b64_tr_b16 v[72:73], v15 offset:40960
 v_mfma_f32_16x16x32_bf16 a[96:99], v[176:179], v[80:83], a[96:99]
 ds_read_b64_tr_b16 v[74:75], v15 offset:41984
 v_mfma_f32_16x16x32_bf16 a[100:103], v[148:151], v[76:79], 0
 ds_read_b128 v[212:215], v12 offset:10240
 v_mfma_f32_16x16x32_bf16 a[100:103], v[180:183], v[80:83], a[100:103]
 ds_read_b128 v[244:247], v13 offset:10240
 buffer_load_dwordx4 v7, s[8:11], s27 offen offset:1024  lds
 v_mfma_f32_16x16x32_bf16 a[112:115], v[152:155], v[76:79], 0
 ds_read_b128 v[216:219], v12 offset:12288
 v_mfma_f32_16x16x32_bf16 a[112:115], v[184:187], v[80:83], a[112:115]
 ds_read_b128 v[248:251], v13 offset:12288
 v_mfma_f32_16x16x32_bf16 a[116:119], v[156:159], v[76:79], 0
 buffer_load_dwordx4 v8, s[8:11], s27 offen offset:2048  lds
 v_mfma_f32_16x16x32_bf16 a[116:119], v[188:191], v[80:83], a[116:119]
 ds_read_b128 v[220:223], v12 offset:14336
 v_mfma_f32_16x16x32_bf16 a[168:171], v[128:131], v[84:87], 0
 ds_read_b128 v[252:255], v13 offset:14336
 v_mfma_f32_16x16x32_bf16 a[168:171], v[160:163], v[88:91], a[168:171]
 ds_read_b64_tr_b16 v[76:77], v16 offset:32768
 s_lshl_b32 s22, s22, 2
 v_mfma_f32_16x16x32_bf16 a[172:175], v[132:135], v[84:87], 0
 ds_read_b64_tr_b16 v[78:79], v16 offset:33792
 v_add_u32 v12, 0x8000, v12
 v_mfma_f32_16x16x32_bf16 a[172:175], v[164:167], v[88:91], a[172:175]
 v_add_u32 v13, 0x8000, v13
 v_mfma_f32_16x16x32_bf16 a[184:187], v[136:139], v[84:87], 0
 buffer_load_dwordx4 v9, s[8:11], s27 offen offset:3072  lds
 v_mfma_f32_16x16x32_bf16 a[184:187], v[168:171], v[88:91], a[184:187]
 s_add_u32 m0, s30, 102400
 s_add_u32 s27, s27, 524288
 v_mfma_f32_16x16x32_bf16 a[188:191], v[140:143], v[84:87], 0
 buffer_load_dwordx4 v6, s[8:11], s62 offen offset:0  lds
 v_mfma_f32_16x16x32_bf16 a[188:191], v[172:175], v[88:91], a[188:191]
 buffer_load_dwordx4 v7, s[8:11], s62 offen offset:1024  lds
 v_mfma_f32_16x16x32_bf16 a[104:107], v[144:147], v[84:87], 0
 ds_read_b64_tr_b16 v[80:81], v16 offset:40960
 v_mfma_f32_16x16x32_bf16 a[104:107], v[176:179], v[88:91], a[104:107]
 ds_read_b64_tr_b16 v[82:83], v16 offset:41984
 v_mfma_f32_16x16x32_bf16 a[108:111], v[148:151], v[84:87], 0
 buffer_load_dwordx4 v8, s[8:11], s62 offen offset:2048  lds
 v_mfma_f32_16x16x32_bf16 a[108:111], v[180:183], v[88:91], a[108:111]
 v_mfma_f32_16x16x32_bf16 a[120:123], v[152:155], v[84:87], 0
 buffer_load_dwordx4 v9, s[8:11], s62 offen offset:3072  lds
 v_mfma_f32_16x16x32_bf16 a[120:123], v[184:187], v[88:91], a[120:123]
 s_add_u32 s22, s22, s3
 v_mfma_f32_16x16x32_bf16 a[124:127], v[156:159], v[84:87], 0
 s_add_u32 s62, s62, 524288
 v_mfma_f32_16x16x32_bf16 a[124:127], v[188:191], v[88:91], a[124:127]
 s_waitcnt lgkmcnt(4)
 s_mov_b32 s35, 0x200000
 v_mfma_f32_16x16x32_bf16 a[192:195], v[192:195], v[60:63], a[192:195]
 ds_read_b64_tr_b16 v[84:85], v17 offset:32768
 v_mfma_f32_16x16x32_bf16 a[192:195], v[224:227], v[64:67], a[192:195]
 ds_read_b64_tr_b16 v[86:87], v17 offset:33792
 s_lshl_b32 s23, s22, 14
 v_mfma_f32_16x16x32_bf16 a[196:199], v[228:231], v[64:67], a[196:199]
 buffer_load_dword v122, v55, s[8:11], s35 offen
 v_mfma_f32_16x16x32_bf16 a[196:199], v[196:199], v[60:63], a[196:199]
 v_mfma_f32_16x16x32_bf16 a[208:211], v[200:203], v[60:63], a[208:211]
 s_add_u32 m0, s29, 65536
 v_mfma_f32_16x16x32_bf16 a[208:211], v[232:235], v[64:67], a[208:211]
 v_mfma_f32_16x16x32_bf16 a[212:215], v[236:239], v[64:67], a[212:215]
 s_nop 0
 s_and_b32 s24, s2, 7
 v_mfma_f32_16x16x32_bf16 a[212:215], v[204:207], v[60:63], a[212:215]
 v_mfma_f32_16x16x32_bf16 a[0:3], v[208:211], v[60:63], a[0:3]
 ds_read_b64_tr_b16 v[88:89], v17 offset:40960
 v_mfma_f32_16x16x32_bf16 a[0:3], v[240:243], v[64:67], a[0:3]
 ds_read_b64_tr_b16 v[90:91], v17 offset:41984
 v_mfma_f32_16x16x32_bf16 a[4:7], v[244:247], v[64:67], a[4:7]
 buffer_load_dwordx4 v2, s[4:7], s25 offen offset:0  lds
 v_mfma_f32_16x16x32_bf16 a[4:7], v[212:215], v[60:63], a[4:7]
 s_lshl_b32 s24, s24, 10
 v_mfma_f32_16x16x32_bf16 a[16:19], v[216:219], v[60:63], a[16:19]
 v_mfma_f32_16x16x32_bf16 a[16:19], v[248:251], v[64:67], a[16:19]
 v_mfma_f32_16x16x32_bf16 a[20:23], v[252:255], v[64:67], a[20:23]
 s_add_u32 s23, s23, s24
 v_mfma_f32_16x16x32_bf16 a[20:23], v[220:223], v[60:63], a[20:23]
 v_mfma_f32_16x16x32_bf16 a[200:203], v[192:195], v[68:71], a[200:203]
 ds_read_b64_tr_b16 v[60:61], v18 offset:32768
 v_mfma_f32_16x16x32_bf16 a[200:203], v[224:227], v[72:75], a[200:203]
 ds_read_b64_tr_b16 v[62:63], v18 offset:33792
 v_mfma_f32_16x16x32_bf16 a[204:207], v[228:231], v[72:75], a[204:207]
 buffer_load_dwordx4 v3, s[4:7], s25 offen offset:1024  lds
 v_mfma_f32_16x16x32_bf16 a[204:207], v[196:199], v[68:71], a[204:207]
 v_mfma_f32_16x16x32_bf16 a[216:219], v[200:203], v[68:71], a[216:219]
 v_lshrrev_b32 v42, 3, v41
 v_mfma_f32_16x16x32_bf16 a[216:219], v[232:235], v[72:75], a[216:219]
 v_mfma_f32_16x16x32_bf16 a[220:223], v[236:239], v[72:75], a[220:223]
 v_mfma_f32_16x16x32_bf16 a[220:223], v[204:207], v[68:71], a[220:223]
 v_lshlrev_b32 v42, 13, v42
 v_mfma_f32_16x16x32_bf16 a[8:11], v[208:211], v[68:71], a[8:11]
 ds_read_b64_tr_b16 v[64:65], v18 offset:40960
 v_mfma_f32_16x16x32_bf16 a[8:11], v[240:243], v[72:75], a[8:11]
 ds_read_b64_tr_b16 v[66:67], v18 offset:41984
 v_mfma_f32_16x16x32_bf16 a[12:15], v[244:247], v[72:75], a[12:15]
 buffer_load_dwordx4 v4, s[4:7], s25 offen offset:2048  lds
 v_mfma_f32_16x16x32_bf16 a[12:15], v[212:215], v[68:71], a[12:15]
 v_mfma_f32_16x16x32_bf16 a[24:27], v[216:219], v[68:71], a[24:27]
 v_lshl_add_u32 v42, v32, 7, v42
 v_mfma_f32_16x16x32_bf16 a[24:27], v[248:251], v[72:75], a[24:27]
 v_mfma_f32_16x16x32_bf16 a[28:31], v[252:255], v[72:75], a[28:31]
 v_mfma_f32_16x16x32_bf16 a[28:31], v[220:223], v[68:71], a[28:31]
 s_waitcnt lgkmcnt(8)
 v_mfma_f32_16x16x32_bf16 a[224:227], v[192:195], v[76:79], a[224:227]
 ds_read_b64_tr_b16 v[68:69], v19 offset:32768
 v_add_u32 v51, s23, v42
 v_mfma_f32_16x16x32_bf16 a[224:227], v[224:227], v[80:83], a[224:227]
 ds_read_b64_tr_b16 v[70:71], v19 offset:33792
 v_mfma_f32_16x16x32_bf16 a[228:231], v[228:231], v[80:83], a[228:231]
 buffer_load_dwordx4 v5, s[4:7], s25 offen offset:3072  lds
 v_mfma_f32_16x16x32_bf16 a[228:231], v[196:199], v[76:79], a[228:231]
 v_mfma_f32_16x16x32_bf16 a[240:243], v[200:203], v[76:79], a[240:243]
 v_mfma_f32_16x16x32_bf16 a[240:243], v[232:235], v[80:83], a[240:243]
 v_add_u32 v52, 0x200000, v51
 v_mfma_f32_16x16x32_bf16 a[244:247], v[236:239], v[80:83], a[244:247]
 v_mfma_f32_16x16x32_bf16 a[244:247], v[204:207], v[76:79], a[244:247]
 v_mfma_f32_16x16x32_bf16 a[32:35], v[208:211], v[76:79], a[32:35]
 ds_read_b64_tr_b16 v[72:73], v19 offset:40960
 s_add_u32 m0, s29, 69632
 v_mfma_f32_16x16x32_bf16 a[32:35], v[240:243], v[80:83], a[32:35]
 ds_read_b64_tr_b16 v[74:75], v19 offset:41984
 v_mfma_f32_16x16x32_bf16 a[36:39], v[244:247], v[80:83], a[36:39]
 s_lshl_b32 s23, s22, 14
 v_mfma_f32_16x16x32_bf16 a[36:39], v[212:215], v[76:79], a[36:39]
 s_add_u32 s25, s25, 128
 v_mfma_f32_16x16x32_bf16 a[48:51], v[216:219], v[76:79], a[48:51]
 v_mfma_f32_16x16x32_bf16 a[48:51], v[248:251], v[80:83], a[48:51]
 buffer_load_dwordx4 v2, s[4:7], s26 offen offset:0  lds
 v_mfma_f32_16x16x32_bf16 a[52:55], v[252:255], v[80:83], a[52:55]
 v_and_b32 v42, 1, v31
 v_mfma_f32_16x16x32_bf16 a[52:55], v[220:223], v[76:79], a[52:55]
 s_waitcnt lgkmcnt(8)
 v_mfma_f32_16x16x32_bf16 a[232:235], v[192:195], v[84:87], a[232:235]
 ds_read_b64_tr_b16 v[76:77], v20 offset:32768
 v_mfma_f32_16x16x32_bf16 a[232:235], v[224:227], v[88:91], a[232:235]
 ds_read_b64_tr_b16 v[78:79], v20 offset:33792
 v_mfma_f32_16x16x32_bf16 a[236:239], v[228:231], v[88:91], a[236:239]
 v_mfma_f32_16x16x32_bf16 a[236:239], v[196:199], v[84:87], a[236:239]
 v_lshlrev_b32 v42, 7, v42
 v_mfma_f32_16x16x32_bf16 a[248:251], v[200:203], v[84:87], a[248:251]
 v_mfma_f32_16x16x32_bf16 a[248:251], v[232:235], v[88:91], a[248:251]
 buffer_load_dwordx4 v3, s[4:7], s26 offen offset:1024  lds
 v_mfma_f32_16x16x32_bf16 a[252:255], v[236:239], v[88:91], a[252:255]
 v_mfma_f32_16x16x32_bf16 a[252:255], v[204:207], v[84:87], a[252:255]
 v_lshl_add_u32 v42, v41, 10, v42
 v_mfma_f32_16x16x32_bf16 a[40:43], v[208:211], v[84:87], a[40:43]
 ds_read_b64_tr_b16 v[80:81], v20 offset:40960
 v_mfma_f32_16x16x32_bf16 a[40:43], v[240:243], v[88:91], a[40:43]
 ds_read_b64_tr_b16 v[82:83], v20 offset:41984
 v_mfma_f32_16x16x32_bf16 a[44:47], v[244:247], v[88:91], a[44:47]
 v_mfma_f32_16x16x32_bf16 a[44:47], v[212:215], v[84:87], a[44:47]
 v_add_u32 v54, s23, v42
 v_mfma_f32_16x16x32_bf16 a[56:59], v[216:219], v[84:87], a[56:59]
 v_mfma_f32_16x16x32_bf16 a[56:59], v[248:251], v[88:91], a[56:59]
 buffer_load_dwordx4 v4, s[4:7], s26 offen offset:2048  lds
 v_mfma_f32_16x16x32_bf16 a[60:63], v[252:255], v[88:91], a[60:63]
 v_mfma_f32_16x16x32_bf16 a[60:63], v[220:223], v[84:87], a[60:63]
 s_waitcnt lgkmcnt(8)
 v_mfma_f32_16x16x32_bf16 a[128:131], v[192:195], v[60:63], a[128:131]
 ds_read_b64_tr_b16 v[84:85], v21 offset:32768
 s_mul_i32 s22, s22, 12288
 v_mfma_f32_16x16x32_bf16 a[128:131], v[224:227], v[64:67], a[128:131]
 ds_read_b64_tr_b16 v[86:87], v21 offset:33792
 v_mfma_f32_16x16x32_bf16 a[132:135], v[228:231], v[64:67], a[132:135]
 v_mfma_f32_16x16x32_bf16 a[132:135], v[196:199], v[60:63], a[132:135]
 v_mfma_f32_16x16x32_bf16 a[144:147], v[200:203], v[60:63], a[144:147]
 s_lshr_b32 s24, s24, 3
 v_mfma_f32_16x16x32_bf16 a[144:147], v[232:235], v[64:67], a[144:147]
 buffer_load_dwordx4 v5, s[4:7], s26 offen offset:3072  lds
 v_mfma_f32_16x16x32_bf16 a[148:151], v[236:239], v[64:67], a[148:151]
 v_mfma_f32_16x16x32_bf16 a[148:151], v[204:207], v[60:63], a[148:151]
 v_mfma_f32_16x16x32_bf16 a[64:67], v[208:211], v[60:63], a[64:67]
 ds_read_b64_tr_b16 v[88:89], v21 offset:40960
 v_mfma_f32_16x16x32_bf16 a[64:67], v[240:243], v[64:67], a[64:67]
 ds_read_b64_tr_b16 v[90:91], v21 offset:41984
 s_add_u32 s22, s22, s24
 v_mfma_f32_16x16x32_bf16 a[68:71], v[244:247], v[64:67], a[68:71]
 v_mfma_f32_16x16x32_bf16 a[68:71], v[212:215], v[60:63], a[68:71]
 v_mfma_f32_16x16x32_bf16 a[80:83], v[216:219], v[60:63], a[80:83]
 v_mfma_f32_16x16x32_bf16 a[80:83], v[248:251], v[64:67], a[80:83]
 s_add_u32 s26, s26, 128
 v_min_u32 v41, 11, v41
 v_mfma_f32_16x16x32_bf16 a[84:87], v[252:255], v[64:67], a[84:87]
 v_mfma_f32_16x16x32_bf16 a[84:87], v[220:223], v[60:63], a[84:87]
 s_waitcnt lgkmcnt(8)
 v_mfma_f32_16x16x32_bf16 a[136:139], v[192:195], v[68:71], a[136:139]
 v_lshl_add_u32 v53, v41, 10, s22
 v_mfma_f32_16x16x32_bf16 a[136:139], v[224:227], v[72:75], a[136:139]
 v_mfma_f32_16x16x32_bf16 a[140:143], v[228:231], v[72:75], a[140:143]
 v_mfma_f32_16x16x32_bf16 a[140:143], v[196:199], v[68:71], a[140:143]
 v_mfma_f32_16x16x32_bf16 a[152:155], v[200:203], v[68:71], a[152:155]
 v_mfma_f32_16x16x32_bf16 a[152:155], v[232:235], v[72:75], a[152:155]
 v_mfma_f32_16x16x32_bf16 a[156:159], v[236:239], v[72:75], a[156:159]
 v_mfma_f32_16x16x32_bf16 a[156:159], v[204:207], v[68:71], a[156:159]
 s_waitcnt vmcnt(9) lgkmcnt(0)
 s_barrier
 v_mfma_f32_16x16x32_bf16 a[72:75], v[208:211], v[68:71], a[72:75]
 ds_read_b64_tr_b16 v[60:61], v14 offset:0
 s_add_u32 m0, s30, 131072
 v_mfma_f32_16x16x32_bf16 a[72:75], v[240:243], v[72:75], a[72:75]
 ds_read_b64_tr_b16 v[62:63], v14 offset:1024
 s_nop 0
 v_mfma_f32_16x16x32_bf16 a[76:79], v[244:247], v[72:75], a[76:79]
 ds_read_b64_tr_b16 v[64:65], v14 offset:8192
 v_lshrrev_b32 v39, 1, v35
 v_mfma_f32_16x16x32_bf16 a[76:79], v[212:215], v[68:71], a[76:79]
 ds_read_b64_tr_b16 v[66:67], v14 offset:9216
 v_mfma_f32_16x16x32_bf16 a[88:91], v[216:219], v[68:71], a[88:91]
 ds_read_b128 v[128:131], v12 offset:0
 v_mfma_f32_16x16x32_bf16 a[88:91], v[248:251], v[72:75], a[88:91]
 ds_read_b128 v[160:163], v13 offset:0
 v_mfma_f32_16x16x32_bf16 a[92:95], v[252:255], v[72:75], a[92:95]
 ds_read_b128 v[132:135], v12 offset:2048
 v_lshlrev_b32 v39, 2, v39
 v_mfma_f32_16x16x32_bf16 a[92:95], v[220:223], v[68:71], a[92:95]
 ds_read_b128 v[164:167], v13 offset:2048
 v_mfma_f32_16x16x32_bf16 a[160:163], v[192:195], v[76:79], a[160:163]
 ds_read_b128 v[136:139], v12 offset:4096
 v_mfma_f32_16x16x32_bf16 a[160:163], v[224:227], v[80:83], a[160:163]
 ds_read_b64_tr_b16 v[68:69], v15 offset:0
 v_mfma_f32_16x16x32_bf16 a[164:167], v[228:231], v[80:83], a[164:167]
 ds_read_b64_tr_b16 v[70:71], v15 offset:1024
 v_mfma_f32_16x16x32_bf16 a[164:167], v[196:199], v[76:79], a[164:167]
 ds_read_b128 v[168:171], v13 offset:4096
 v_xor_b32 v39, v39, v37
 v_mfma_f32_16x16x32_bf16 a[176:179], v[200:203], v[76:79], a[176:179]
 ds_read_b128 v[140:143], v12 offset:6144
 v_mfma_f32_16x16x32_bf16 a[176:179], v[232:235], v[80:83], a[176:179]
 ds_read_b128 v[172:175], v13 offset:6144
 buffer_load_dwordx4 v6, s[8:11], s27 offen offset:0  lds
 v_mfma_f32_16x16x32_bf16 a[180:183], v[236:239], v[80:83], a[180:183]
 ds_read_b128 v[144:147], v12 offset:8192
 v_mfma_f32_16x16x32_bf16 a[180:183], v[204:207], v[76:79], a[180:183]
 ds_read_b128 v[176:179], v13 offset:8192
 v_mfma_f32_16x16x32_bf16 a[96:99], v[208:211], v[76:79], a[96:99]
 ds_read_b64_tr_b16 v[72:73], v15 offset:8192
 v_mfma_f32_16x16x32_bf16 a[96:99], v[240:243], v[80:83], a[96:99]
 ds_read_b64_tr_b16 v[74:75], v15 offset:9216
 buffer_load_dwordx4 v7, s[8:11], s27 offen offset:1024  lds
 v_mfma_f32_16x16x32_bf16 a[100:103], v[244:247], v[80:83], a[100:103]
 ds_read_b128 v[148:151], v12 offset:10240
 v_lshlrev_b32 v39, 4, v39
 v_mfma_f32_16x16x32_bf16 a[100:103], v[212:215], v[76:79], a[100:103]
 ds_read_b128 v[180:183], v13 offset:10240
 v_mfma_f32_16x16x32_bf16 a[112:115], v[216:219], v[76:79], a[112:115]
 ds_read_b128 v[152:155], v12 offset:12288
 v_mfma_f32_16x16x32_bf16 a[112:115], v[248:251], v[80:83], a[112:115]
 ds_read_b128 v[184:187], v13 offset:12288
 v_mfma_f32_16x16x32_bf16 a[116:119], v[252:255], v[80:83], a[116:119]
 buffer_load_dwordx4 v8, s[8:11], s27 offen offset:2048  lds
 v_mfma_f32_16x16x32_bf16 a[116:119], v[220:223], v[76:79], a[116:119]
 ds_read_b128 v[156:159], v12 offset:14336
 v_mfma_f32_16x16x32_bf16 a[168:171], v[192:195], v[84:87], a[168:171]
 ds_read_b128 v[188:191], v13 offset:14336
 v_lshl_add_u32 v39, v36, 7, v39
 v_mfma_f32_16x16x32_bf16 a[168:171], v[224:227], v[88:91], a[168:171]
 ds_read_b64_tr_b16 v[76:77], v16 offset:0
 v_mfma_f32_16x16x32_bf16 a[172:175], v[228:231], v[88:91], a[172:175]
 ds_read_b64_tr_b16 v[78:79], v16 offset:1024
 v_add_u32 v12, 0x8000, v12
 v_mfma_f32_16x16x32_bf16 a[172:175], v[196:199], v[84:87], a[172:175]
 buffer_load_dwordx4 v9, s[8:11], s27 offen offset:3072  lds
 v_add_u32 v13, 0x8000, v13
 v_mfma_f32_16x16x32_bf16 a[184:187], v[200:203], v[84:87], a[184:187]
 s_add_u32 m0, s30, 135168
 s_add_u32 s27, s27, 524288
 v_mfma_f32_16x16x32_bf16 a[184:187], v[232:235], v[88:91], a[184:187]
 buffer_load_dwordx4 v6, s[8:11], s62 offen offset:0  lds
 v_mfma_f32_16x16x32_bf16 a[188:191], v[236:239], v[88:91], a[188:191]
 buffer_load_dwordx4 v7, s[8:11], s62 offen offset:1024  lds
 v_mfma_f32_16x16x32_bf16 a[188:191], v[204:207], v[84:87], a[188:191]
 buffer_load_dwordx4 v8, s[8:11], s62 offen offset:2048  lds
 v_mfma_f32_16x16x32_bf16 a[104:107], v[208:211], v[84:87], a[104:107]
 ds_read_b64_tr_b16 v[80:81], v16 offset:8192
 v_mfma_f32_16x16x32_bf16 a[104:107], v[240:243], v[88:91], a[104:107]
 ds_read_b64_tr_b16 v[82:83], v16 offset:9216
 v_mfma_f32_16x16x32_bf16 a[108:111], v[244:247], v[88:91], a[108:111]
 buffer_load_dwordx4 v9, s[8:11], s62 offen offset:3072  lds
 v_mfma_f32_16x16x32_bf16 a[108:111], v[212:215], v[84:87], a[108:111]
 v_add_u32 v39, v39, v38
 v_mfma_f32_16x16x32_bf16 a[120:123], v[216:219], v[84:87], a[120:123]
 v_mfma_f32_16x16x32_bf16 a[120:123], v[248:251], v[88:91], a[120:123]
 s_add_u32 s62, s62, 524288
 s_mov_b32 s35, 0x300000
 v_add_u32 v39, 114688, v39
 v_mfma_f32_16x16x32_bf16 a[124:127], v[252:255], v[88:91], a[124:127]
 buffer_load_dword v122, v55, s[8:11], s35 offen
 v_mfma_f32_16x16x32_bf16 a[124:127], v[220:223], v[84:87], a[124:127]
 s_waitcnt lgkmcnt(4)
 v_mfma_f32_16x16x32_bf16 a[192:195], v[128:131], v[60:63], a[192:195]
 ds_read_b64_tr_b16 v[84:85], v17 offset:0
 v_mfma_f32_16x16x32_bf16 a[192:195], v[160:163], v[64:67], a[192:195]
 ds_read_b64_tr_b16 v[86:87], v17 offset:1024
 v_xor_b32 v22, 0, v39
 v_mfma_f32_16x16x32_bf16 a[196:199], v[164:167], v[64:67], a[196:199]
 buffer_atomic_add v125, v120, s[40:43], s32 offen sc1
 v_mfma_f32_16x16x32_bf16 a[196:199], v[132:135], v[60:63], a[196:199]
 v_mfma_f32_16x16x32_bf16 a[208:211], v[136:139], v[60:63], a[208:211]
 s_add_u32 m0, s29, 0
 v_mfma_f32_16x16x32_bf16 a[208:211], v[168:171], v[64:67], a[208:211]
 v_xor_b32 v23, 32, v39
 v_mfma_f32_16x16x32_bf16 a[212:215], v[172:175], v[64:67], a[212:215]
 s_nop 0
 v_mfma_f32_16x16x32_bf16 a[212:215], v[140:143], v[60:63], a[212:215]
 v_xor_b32 v24, 64, v39
 v_mfma_f32_16x16x32_bf16 a[0:3], v[144:147], v[60:63], a[0:3]
 ds_read_b64_tr_b16 v[88:89], v17 offset:8192
 v_mfma_f32_16x16x32_bf16 a[0:3], v[176:179], v[64:67], a[0:3]
 ds_read_b64_tr_b16 v[90:91], v17 offset:9216
 v_mfma_f32_16x16x32_bf16 a[4:7], v[180:183], v[64:67], a[4:7]
 buffer_load_dwordx4 v2, s[4:7], s25 offen offset:0  lds
 v_mfma_f32_16x16x32_bf16 a[4:7], v[148:151], v[60:63], a[4:7]
 s_and_b32 s22, s20, 3
 v_mfma_f32_16x16x32_bf16 a[16:19], v[152:155], v[60:63], a[16:19]
 v_mfma_f32_16x16x32_bf16 a[16:19], v[184:187], v[64:67], a[16:19]
 s_and_b32 s23, s2, 7
 v_mfma_f32_16x16x32_bf16 a[20:23], v[188:191], v[64:67], a[20:23]
 v_mfma_f32_16x16x32_bf16 a[20:23], v[156:159], v[60:63], a[20:23]
 v_mfma_f32_16x16x32_bf16 a[200:203], v[128:131], v[68:71], a[200:203]
 ds_read_b64_tr_b16 v[60:61], v18 offset:0
 s_lshl_b32 s23, s23, 7
 v_mfma_f32_16x16x32_bf16 a[200:203], v[160:163], v[72:75], a[200:203]
 ds_read_b64_tr_b16 v[62:63], v18 offset:1024
 v_mfma_f32_16x16x32_bf16 a[204:207], v[164:167], v[72:75], a[204:207]
 buffer_load_dwordx4 v3, s[4:7], s25 offen offset:1024  lds
 v_mfma_f32_16x16x32_bf16 a[204:207], v[132:135], v[68:71], a[204:207]
 v_mfma_f32_16x16x32_bf16 a[216:219], v[136:139], v[68:71], a[216:219]
 s_lshl_b32 s24, s22, 5
 v_mfma_f32_16x16x32_bf16 a[216:219], v[168:171], v[72:75], a[216:219]
 v_mfma_f32_16x16x32_bf16 a[220:223], v[172:175], v[72:75], a[220:223]
 s_add_u32 s24, s24, s23
 v_mfma_f32_16x16x32_bf16 a[220:223], v[140:143], v[68:71], a[220:223]
 v_mfma_f32_16x16x32_bf16 a[8:11], v[144:147], v[68:71], a[8:11]
 ds_read_b64_tr_b16 v[64:65], v18 offset:8192
 v_mfma_f32_16x16x32_bf16 a[8:11], v[176:179], v[72:75], a[8:11]
 ds_read_b64_tr_b16 v[66:67], v18 offset:9216
 s_add_u32 s24, s24, 1984
 v_mfma_f32_16x16x32_bf16 a[12:15], v[180:183], v[72:75], a[12:15]
 buffer_load_dwordx4 v4, s[4:7], s25 offen offset:2048  lds
 v_mfma_f32_16x16x32_bf16 a[12:15], v[148:151], v[68:71], a[12:15]
 v_mfma_f32_16x16x32_bf16 a[24:27], v[152:155], v[68:71], a[24:27]
 s_lshr_b32 s34, s22, 1
 v_mfma_f32_16x16x32_bf16 a[24:27], v[184:187], v[72:75], a[24:27]
 v_mfma_f32_16x16x32_bf16 a[28:31], v[188:191], v[72:75], a[28:31]
 v_mfma_f32_16x16x32_bf16 a[28:31], v[156:159], v[68:71], a[28:31]
 s_waitcnt lgkmcnt(8)
 s_lshl_b32 s34, s34, 10
 v_mfma_f32_16x16x32_bf16 a[224:227], v[128:131], v[76:79], a[224:227]
 ds_read_b64_tr_b16 v[68:69], v19 offset:0
 v_mfma_f32_16x16x32_bf16 a[224:227], v[160:163], v[80:83], a[224:227]
 ds_read_b64_tr_b16 v[70:71], v19 offset:1024
 v_mfma_f32_16x16x32_bf16 a[228:231], v[164:167], v[80:83], a[228:231]
 buffer_load_dwordx4 v5, s[4:7], s25 offen offset:3072  lds
 v_mfma_f32_16x16x32_bf16 a[228:231], v[132:135], v[76:79], a[228:231]
 s_add_u32 s23, s23, s34
 v_mfma_f32_16x16x32_bf16 a[240:243], v[136:139], v[76:79], a[240:243]
 v_mfma_f32_16x16x32_bf16 a[240:243], v[168:171], v[80:83], a[240:243]
 s_and_b32 s34, s22, 1
 v_mfma_f32_16x16x32_bf16 a[244:247], v[172:175], v[80:83], a[244:247]
 v_mfma_f32_16x16x32_bf16 a[244:247], v[140:143], v[76:79], a[244:247]
 s_lshl_b32 s34, s34, 6
 v_mfma_f32_16x16x32_bf16 a[32:35], v[144:147], v[76:79], a[32:35]
 ds_read_b64_tr_b16 v[72:73], v19 offset:8192
 s_add_u32 m0, s29, 4096
 v_mfma_f32_16x16x32_bf16 a[32:35], v[176:179], v[80:83], a[32:35]
 ds_read_b64_tr_b16 v[74:75], v19 offset:9216
 v_mfma_f32_16x16x32_bf16 a[36:39], v[180:183], v[80:83], a[36:39]
 v_mfma_f32_16x16x32_bf16 a[36:39], v[148:151], v[76:79], a[36:39]
 s_add_u32 s25, s25, 128
 s_add_u32 s23, s23, s34
 v_mfma_f32_16x16x32_bf16 a[48:51], v[152:155], v[76:79], a[48:51]
 v_mfma_f32_16x16x32_bf16 a[48:51], v[184:187], v[80:83], a[48:51]
 buffer_load_dwordx4 v2, s[4:7], s26 offen offset:0  lds
 v_mfma_f32_16x16x32_bf16 a[52:55], v[188:191], v[80:83], a[52:55]
 v_and_b32 v33, 1, v31
 v_mfma_f32_16x16x32_bf16 a[52:55], v[156:159], v[76:79], a[52:55]
 s_waitcnt lgkmcnt(8)
 v_mfma_f32_16x16x32_bf16 a[232:235], v[128:131], v[84:87], a[232:235]
 ds_read_b64_tr_b16 v[76:77], v20 offset:0
 v_mfma_f32_16x16x32_bf16 a[232:235], v[160:163], v[88:91], a[232:235]
 ds_read_b64_tr_b16 v[78:79], v20 offset:1024
 v_lshlrev_b32 v33, 2, v33
 v_mfma_f32_16x16x32_bf16 a[236:239], v[164:167], v[88:91], a[236:239]
 v_mfma_f32_16x16x32_bf16 a[236:239], v[132:135], v[84:87], a[236:239]
 v_mfma_f32_16x16x32_bf16 a[248:251], v[136:139], v[84:87], a[248:251]
 v_xor_b32 v33, v33, v32
 v_mfma_f32_16x16x32_bf16 a[248:251], v[168:171], v[88:91], a[248:251]
 buffer_load_dwordx4 v3, s[4:7], s26 offen offset:1024  lds
 v_mfma_f32_16x16x32_bf16 a[252:255], v[172:175], v[88:91], a[252:255]
 v_mfma_f32_16x16x32_bf16 a[252:255], v[140:143], v[84:87], a[252:255]
 v_mul_u32_u24 v34, 3072, v30
 v_mfma_f32_16x16x32_bf16 a[40:43], v[144:147], v[84:87], a[40:43]
 ds_read_b64_tr_b16 v[80:81], v20 offset:8192
 v_mfma_f32_16x16x32_bf16 a[40:43], v[176:179], v[88:91], a[40:43]
 ds_read_b64_tr_b16 v[82:83], v20 offset:9216
 v_mfma_f32_16x16x32_bf16 a[44:47], v[180:183], v[88:91], a[44:47]
 v_mov_b32 v36, s23
 v_mfma_f32_16x16x32_bf16 a[44:47], v[148:151], v[84:87], a[44:47]
 v_mfma_f32_16x16x32_bf16 a[56:59], v[152:155], v[84:87], a[56:59]
 v_mov_b32 v37, s24
 v_mfma_f32_16x16x32_bf16 a[56:59], v[184:187], v[88:91], a[56:59]
 buffer_load_dwordx4 v4, s[4:7], s26 offen offset:2048  lds
 v_mfma_f32_16x16x32_bf16 a[60:63], v[188:191], v[88:91], a[60:63]
 v_mfma_f32_16x16x32_bf16 a[60:63], v[156:159], v[84:87], a[60:63]
 s_waitcnt lgkmcnt(8)
 v_mov_b32 v38, 0x1000000
 v_mfma_f32_16x16x32_bf16 a[128:131], v[128:131], v[60:63], a[128:131]
 ds_read_b64_tr_b16 v[84:85], v21 offset:0
 v_mfma_f32_16x16x32_bf16 a[128:131], v[160:163], v[64:67], a[128:131]
 ds_read_b64_tr_b16 v[86:87], v21 offset:1024
 v_mfma_f32_16x16x32_bf16 a[132:135], v[164:167], v[64:67], a[132:135]
 v_mfma_f32_16x16x32_bf16 a[132:135], v[132:135], v[60:63], a[132:135]
 v_cmp_gt_u32 vcc, 4, v33
 v_mfma_f32_16x16x32_bf16 a[144:147], v[136:139], v[60:63], a[144:147]
 v_mfma_f32_16x16x32_bf16 a[144:147], v[168:171], v[64:67], a[144:147]
 buffer_load_dwordx4 v5, s[4:7], s26 offen offset:3072  lds
 v_mfma_f32_16x16x32_bf16 a[148:151], v[172:175], v[64:67], a[148:151]
 v_cmp_gt_u32 s[66:67], 6, v33
 v_mfma_f32_16x16x32_bf16 a[148:151], v[140:143], v[60:63], a[148:151]
 v_mfma_f32_16x16x32_bf16 a[64:67], v[144:147], v[60:63], a[64:67]
 ds_read_b64_tr_b16 v[88:89], v21 offset:8192
 v_mfma_f32_16x16x32_bf16 a[64:67], v[176:179], v[64:67], a[64:67]
 ds_read_b64_tr_b16 v[90:91], v21 offset:9216
 v_lshl_add_u32 v35, v33, 4, v34
 v_mfma_f32_16x16x32_bf16 a[68:71], v[180:183], v[64:67], a[68:71]
 v_mfma_f32_16x16x32_bf16 a[68:71], v[148:151], v[60:63], a[68:71]
 v_cndmask_b32 v39, v37, v36, vcc
 v_mfma_f32_16x16x32_bf16 a[80:83], v[152:155], v[60:63], a[80:83]
 v_mfma_f32_16x16x32_bf16 a[80:83], v[184:187], v[64:67], a[80:83]
 s_add_u32 s26, s26, 128
 v_mfma_f32_16x16x32_bf16 a[84:87], v[188:191], v[64:67], a[84:87]
 v_cndmask_b32 v39, v38, v39, s[66:67]
 v_mfma_f32_16x16x32_bf16 a[84:87], v[156:159], v[60:63], a[84:87]
 s_waitcnt lgkmcnt(8)
 v_mfma_f32_16x16x32_bf16 a[136:139], v[128:131], v[68:71], a[136:139]
 v_add_u32 v10, v35, v39
 v_mfma_f32_16x16x32_bf16 a[136:139], v[160:163], v[72:75], a[136:139]
 v_mfma_f32_16x16x32_bf16 a[140:143], v[164:167], v[72:75], a[140:143]
 v_xor_b32 v33, 2, v33
 v_mfma_f32_16x16x32_bf16 a[140:143], v[132:135], v[68:71], a[140:143]
 v_mfma_f32_16x16x32_bf16 a[152:155], v[136:139], v[68:71], a[152:155]
 v_add_u32 v34, 23552, v34
 v_mfma_f32_16x16x32_bf16 a[152:155], v[168:171], v[72:75], a[152:155]
 v_mfma_f32_16x16x32_bf16 a[156:159], v[172:175], v[72:75], a[156:159]
 v_cmp_gt_u32 vcc, 4, v33
 v_mfma_f32_16x16x32_bf16 a[156:159], v[140:143], v[68:71], a[156:159]
 s_waitcnt vmcnt(10) lgkmcnt(0)
 s_barrier
 v_mfma_f32_16x16x32_bf16 a[72:75], v[144:147], v[68:71], a[72:75]
 ds_read_b64_tr_b16 v[60:61], v14 offset:32768
 s_add_u32 m0, s30, 98304
 v_mfma_f32_16x16x32_bf16 a[72:75], v[176:179], v[72:75], a[72:75]
 ds_read_b64_tr_b16 v[62:63], v14 offset:33792
 s_nop 0
 v_mfma_f32_16x16x32_bf16 a[76:79], v[180:183], v[72:75], a[76:79]
 ds_read_b64_tr_b16 v[64:65], v14 offset:40960
 v_mfma_f32_16x16x32_bf16 a[76:79], v[148:151], v[68:71], a[76:79]
 ds_read_b64_tr_b16 v[66:67], v14 offset:41984
 v_mfma_f32_16x16x32_bf16 a[88:91], v[152:155], v[68:71], a[88:91]
 ds_read_b128 v[192:195], v12 offset:0
 v_mfma_f32_16x16x32_bf16 a[88:91], v[184:187], v[72:75], a[88:91]
 ds_read_b128 v[224:227], v13 offset:0
 v_cmp_gt_u32 s[66:67], 6, v33
 v_mfma_f32_16x16x32_bf16 a[92:95], v[188:191], v[72:75], a[92:95]
 ds_read_b128 v[196:199], v12 offset:2048
 v_mfma_f32_16x16x32_bf16 a[92:95], v[156:159], v[68:71], a[92:95]
 ds_read_b128 v[228:231], v13 offset:2048
 v_mfma_f32_16x16x32_bf16 a[160:163], v[128:131], v[76:79], a[160:163]
 ds_read_b128 v[200:203], v12 offset:4096
 v_mfma_f32_16x16x32_bf16 a[160:163], v[160:163], v[80:83], a[160:163]
 ds_read_b64_tr_b16 v[68:69], v15 offset:32768
 v_mfma_f32_16x16x32_bf16 a[164:167], v[164:167], v[80:83], a[164:167]
 ds_read_b64_tr_b16 v[70:71], v15 offset:33792
 v_lshl_add_u32 v35, v33, 4, v34
 v_mfma_f32_16x16x32_bf16 a[164:167], v[132:135], v[76:79], a[164:167]
 ds_read_b128 v[232:235], v13 offset:4096
 v_mfma_f32_16x16x32_bf16 a[176:179], v[136:139], v[76:79], a[176:179]
 ds_read_b128 v[204:207], v12 offset:6144
 v_mfma_f32_16x16x32_bf16 a[176:179], v[168:171], v[80:83], a[176:179]
 ds_read_b128 v[236:239], v13 offset:6144
 buffer_load_dwordx4 v6, s[8:11], s27 offen offset:0  lds
 v_mfma_f32_16x16x32_bf16 a[180:183], v[172:175], v[80:83], a[180:183]
 ds_read_b128 v[208:211], v12 offset:8192
 v_mfma_f32_16x16x32_bf16 a[180:183], v[140:143], v[76:79], a[180:183]
 ds_read_b128 v[240:243], v13 offset:8192
 v_cndmask_b32 v39, v37, v36, vcc
 v_mfma_f32_16x16x32_bf16 a[96:99], v[144:147], v[76:79], a[96:99]
 ds_read_b64_tr_b16 v[72:73], v15 offset:40960
 v_mfma_f32_16x16x32_bf16 a[96:99], v[176:179], v[80:83], a[96:99]
 ds_read_b64_tr_b16 v[74:75], v15 offset:41984
 buffer_load_dwordx4 v7, s[8:11], s27 offen offset:1024  lds
 v_mfma_f32_16x16x32_bf16 a[100:103], v[180:183], v[80:83], a[100:103]
 ds_read_b128 v[212:215], v12 offset:10240
 v_mfma_f32_16x16x32_bf16 a[100:103], v[148:151], v[76:79], a[100:103]
 ds_read_b128 v[244:247], v13 offset:10240
 v_mfma_f32_16x16x32_bf16 a[112:115], v[152:155], v[76:79], a[112:115]
 ds_read_b128 v[216:219], v12 offset:12288
 v_mfma_f32_16x16x32_bf16 a[112:115], v[184:187], v[80:83], a[112:115]
 ds_read_b128 v[248:251], v13 offset:12288
 v_cndmask_b32 v39, v38, v39, s[66:67]
 v_mfma_f32_16x16x32_bf16 a[116:119], v[188:191], v[80:83], a[116:119]
 buffer_load_dwordx4 v8, s[8:11], s27 offen offset:2048  lds
 v_mfma_f32_16x16x32_bf16 a[116:119], v[156:159], v[76:79], a[116:119]
 ds_read_b128 v[220:223], v12 offset:14336
 v_mfma_f32_16x16x32_bf16 a[168:171], v[128:131], v[84:87], a[168:171]
 ds_read_b128 v[252:255], v13 offset:14336
 v_mfma_f32_16x16x32_bf16 a[168:171], v[160:163], v[88:91], a[168:171]
 ds_read_b64_tr_b16 v[76:77], v16 offset:32768
 v_mfma_f32_16x16x32_bf16 a[172:175], v[164:167], v[88:91], a[172:175]
 ds_read_b64_tr_b16 v[78:79], v16 offset:33792
 v_subrev_u32 v12, 0x10000, v12
 v_mfma_f32_16x16x32_bf16 a[172:175], v[132:135], v[84:87], a[172:175]
 v_subrev_u32 v13, 0x10000, v13
 v_mfma_f32_16x16x32_bf16 a[184:187], v[136:139], v[84:87], a[184:187]
 buffer_load_dwordx4 v9, s[8:11], s27 offen offset:3072  lds
 v_mfma_f32_16x16x32_bf16 a[184:187], v[168:171], v[88:91], a[184:187]
 s_add_u32 m0, s30, 102400
 s_add_u32 s27, s27, 524288
 v_add_u32 v11, v35, v39
 v_mfma_f32_16x16x32_bf16 a[188:191], v[172:175], v[88:91], a[188:191]
 buffer_load_dwordx4 v6, s[8:11], s62 offen offset:0  lds
 v_mfma_f32_16x16x32_bf16 a[188:191], v[140:143], v[84:87], a[188:191]
 buffer_load_dwordx4 v7, s[8:11], s62 offen offset:1024  lds
 v_mfma_f32_16x16x32_bf16 a[104:107], v[144:147], v[84:87], a[104:107]
 ds_read_b64_tr_b16 v[80:81], v16 offset:40960
 v_mfma_f32_16x16x32_bf16 a[104:107], v[176:179], v[88:91], a[104:107]
 ds_read_b64_tr_b16 v[82:83], v16 offset:41984
 v_mfma_f32_16x16x32_bf16 a[108:111], v[180:183], v[88:91], a[108:111]
 buffer_load_dwordx4 v8, s[8:11], s62 offen offset:2048  lds
 v_mfma_f32_16x16x32_bf16 a[108:111], v[148:151], v[84:87], a[108:111]
 buffer_load_dwordx4 v9, s[8:11], s62 offen offset:3072  lds
 v_mfma_f32_16x16x32_bf16 a[120:123], v[152:155], v[84:87], a[120:123]
 v_mfma_f32_16x16x32_bf16 a[120:123], v[184:187], v[88:91], a[120:123]
 s_add_u32 s62, s62, 524288
 s_lshl_b32 s22, s22, 11
 v_mfma_f32_16x16x32_bf16 a[124:127], v[188:191], v[88:91], a[124:127]
 global_load_dword v122, v50, s[36:37]
 v_mfma_f32_16x16x32_bf16 a[124:127], v[156:159], v[84:87], a[124:127]
 s_waitcnt lgkmcnt(4)
 v_mfma_f32_16x16x32_bf16 a[192:195], v[192:195], v[60:63], a[192:195]
 ds_read_b64_tr_b16 v[84:85], v17 offset:32768
 s_lshl_b32 s23, s3, 13
 v_mfma_f32_16x16x32_bf16 a[192:195], v[224:227], v[64:67], a[192:195]
 ds_read_b64_tr_b16 v[86:87], v17 offset:33792
 v_mfma_f32_16x16x32_bf16 a[196:199], v[228:231], v[64:67], a[196:199]
 global_load_dword v122, v127, s[0:1]
 v_mfma_f32_16x16x32_bf16 a[196:199], v[196:199], v[60:63], a[196:199]
 v_mfma_f32_16x16x32_bf16 a[208:211], v[200:203], v[60:63], a[208:211]
 s_add_u32 m0, s29, 32768
 s_add_u32 s22, s22, s23
 v_mfma_f32_16x16x32_bf16 a[208:211], v[232:235], v[64:67], a[208:211]
 v_mfma_f32_16x16x32_bf16 a[212:215], v[236:239], v[64:67], a[212:215]
 s_nop 0
 s_add_u32 s22, s22, 32768
 v_mfma_f32_16x16x32_bf16 a[212:215], v[204:207], v[60:63], a[212:215]
 v_mfma_f32_16x16x32_bf16 a[0:3], v[208:211], v[60:63], a[0:3]
 ds_read_b64_tr_b16 v[88:89], v17 offset:40960
 v_mfma_f32_16x16x32_bf16 a[0:3], v[240:243], v[64:67], a[0:3]
 ds_read_b64_tr_b16 v[90:91], v17 offset:41984
 v_add_u32 v26, s22, v40
 v_mfma_f32_16x16x32_bf16 a[4:7], v[244:247], v[64:67], a[4:7]
 buffer_load_dwordx4 v2, s[4:7], s25 offen offset:0  lds
 v_mfma_f32_16x16x32_bf16 a[4:7], v[212:215], v[60:63], a[4:7]
 v_mfma_f32_16x16x32_bf16 a[16:19], v[216:219], v[60:63], a[16:19]
 v_mfma_f32_16x16x32_bf16 a[16:19], v[248:251], v[64:67], a[16:19]
 v_xor_b32 v27, 64, v26
 v_mfma_f32_16x16x32_bf16 a[20:23], v[252:255], v[64:67], a[20:23]
 v_mfma_f32_16x16x32_bf16 a[20:23], v[220:223], v[60:63], a[20:23]
 v_lshlrev_b32 v25, 4, v31
 v_mfma_f32_16x16x32_bf16 a[200:203], v[192:195], v[68:71], a[200:203]
 ds_read_b64_tr_b16 v[60:61], v18 offset:32768
 v_mfma_f32_16x16x32_bf16 a[200:203], v[224:227], v[72:75], a[200:203]
 ds_read_b64_tr_b16 v[62:63], v18 offset:33792
 v_mfma_f32_16x16x32_bf16 a[204:207], v[228:231], v[72:75], a[204:207]
 buffer_load_dwordx4 v3, s[4:7], s25 offen offset:1024  lds
 v_mfma_f32_16x16x32_bf16 a[204:207], v[196:199], v[68:71], a[204:207]
 v_add_u32 v25, 122880, v25
 v_mfma_f32_16x16x32_bf16 a[216:219], v[200:203], v[68:71], a[216:219]
 v_mfma_f32_16x16x32_bf16 a[216:219], v[232:235], v[72:75], a[216:219]
 s_lshl_b32 s23, s21, 2
 v_mfma_f32_16x16x32_bf16 a[220:223], v[236:239], v[72:75], a[220:223]
 v_mfma_f32_16x16x32_bf16 a[220:223], v[204:207], v[68:71], a[220:223]
 v_mfma_f32_16x16x32_bf16 a[8:11], v[208:211], v[68:71], a[8:11]
 ds_read_b64_tr_b16 v[64:65], v18 offset:40960
 s_add_u32 s93, s23, s3
 v_mfma_f32_16x16x32_bf16 a[8:11], v[240:243], v[72:75], a[8:11]
 ds_read_b64_tr_b16 v[66:67], v18 offset:41984
 v_mfma_f32_16x16x32_bf16 a[12:15], v[244:247], v[72:75], a[12:15]
 buffer_load_dwordx4 v4, s[4:7], s25 offen offset:2048  lds
 v_mfma_f32_16x16x32_bf16 a[12:15], v[212:215], v[68:71], a[12:15]
 v_mfma_f32_16x16x32_bf16 a[24:27], v[216:219], v[68:71], a[24:27]
 s_sub_u32 s92, 60, s23
 v_mfma_f32_16x16x32_bf16 a[24:27], v[248:251], v[72:75], a[24:27]
 v_mfma_f32_16x16x32_bf16 a[28:31], v[252:255], v[72:75], a[28:31]
 s_add_u32 s92, s92, s3
 v_mfma_f32_16x16x32_bf16 a[28:31], v[220:223], v[68:71], a[28:31]
 s_waitcnt lgkmcnt(8)
 v_mfma_f32_16x16x32_bf16 a[224:227], v[192:195], v[76:79], a[224:227]
 ds_read_b64_tr_b16 v[68:69], v19 offset:32768
 v_mfma_f32_16x16x32_bf16 a[224:227], v[224:227], v[80:83], a[224:227]
 ds_read_b64_tr_b16 v[70:71], v19 offset:33792
 s_lshr_b32 s22, s3, 1
 v_mfma_f32_16x16x32_bf16 a[228:231], v[228:231], v[80:83], a[228:231]
 buffer_load_dwordx4 v5, s[4:7], s25 offen offset:3072  lds
 v_mfma_f32_16x16x32_bf16 a[228:231], v[196:199], v[76:79], a[228:231]
 v_mfma_f32_16x16x32_bf16 a[240:243], v[200:203], v[76:79], a[240:243]
 s_lshl_b32 s22, s22, 5
 v_mfma_f32_16x16x32_bf16 a[240:243], v[232:235], v[80:83], a[240:243]
 v_mfma_f32_16x16x32_bf16 a[244:247], v[236:239], v[80:83], a[244:247]
 v_mfma_f32_16x16x32_bf16 a[244:247], v[204:207], v[76:79], a[244:247]
 s_add_u32 s22, s22, s20
 v_mfma_f32_16x16x32_bf16 a[32:35], v[208:211], v[76:79], a[32:35]
 ds_read_b64_tr_b16 v[72:73], v19 offset:40960
 s_add_u32 m0, s29, 36864
 v_mfma_f32_16x16x32_bf16 a[32:35], v[240:243], v[80:83], a[32:35]
 ds_read_b64_tr_b16 v[74:75], v19 offset:41984
 v_mfma_f32_16x16x32_bf16 a[36:39], v[244:247], v[80:83], a[36:39]
 s_add_u32 s22, s22, 44
 v_mfma_f32_16x16x32_bf16 a[36:39], v[212:215], v[76:79], a[36:39]
 s_add_u32 s25, s25, 128
 v_mfma_f32_16x16x32_bf16 a[48:51], v[216:219], v[76:79], a[48:51]
 v_mfma_f32_16x16x32_bf16 a[48:51], v[248:251], v[80:83], a[48:51]
 buffer_load_dwordx4 v2, s[4:7], s26 offen offset:0  lds
 v_mfma_f32_16x16x32_bf16 a[52:55], v[252:255], v[80:83], a[52:55]
 s_lshl_b32 s33, s22, 19
 v_mfma_f32_16x16x32_bf16 a[52:55], v[220:223], v[76:79], a[52:55]
 s_waitcnt lgkmcnt(8)
 v_mfma_f32_16x16x32_bf16 a[232:235], v[192:195], v[84:87], a[232:235]
 ds_read_b64_tr_b16 v[76:77], v20 offset:32768
 s_and_b32 s22, s3, 1
 v_mfma_f32_16x16x32_bf16 a[232:235], v[224:227], v[88:91], a[232:235]
 ds_read_b64_tr_b16 v[78:79], v20 offset:33792
 v_mfma_f32_16x16x32_bf16 a[236:239], v[228:231], v[88:91], a[236:239]
 v_mfma_f32_16x16x32_bf16 a[236:239], v[196:199], v[84:87], a[236:239]
 s_lshl_b32 s23, s21, 1
 v_mfma_f32_16x16x32_bf16 a[248:251], v[200:203], v[84:87], a[248:251]
 v_mfma_f32_16x16x32_bf16 a[248:251], v[232:235], v[88:91], a[248:251]
 buffer_load_dwordx4 v3, s[4:7], s26 offen offset:1024  lds
 v_mfma_f32_16x16x32_bf16 a[252:255], v[236:239], v[88:91], a[252:255]
 s_add_u32 s22, s22, s23
 v_mfma_f32_16x16x32_bf16 a[252:255], v[204:207], v[84:87], a[252:255]
 v_mfma_f32_16x16x32_bf16 a[40:43], v[208:211], v[84:87], a[40:43]
 ds_read_b64_tr_b16 v[80:81], v20 offset:40960
 v_mfma_f32_16x16x32_bf16 a[40:43], v[240:243], v[88:91], a[40:43]
 ds_read_b64_tr_b16 v[82:83], v20 offset:41984
 s_lshl_b32 s22, s22, 14
 v_mfma_f32_16x16x32_bf16 a[44:47], v[244:247], v[88:91], a[44:47]
 v_mfma_f32_16x16x32_bf16 a[44:47], v[212:215], v[84:87], a[44:47]
 v_mfma_f32_16x16x32_bf16 a[56:59], v[216:219], v[84:87], a[56:59]
 s_add_u32 s33, s33, s22
 v_mfma_f32_16x16x32_bf16 a[56:59], v[248:251], v[88:91], a[56:59]
 buffer_load_dwordx4 v4, s[4:7], s26 offen offset:2048  lds
 v_mfma_f32_16x16x32_bf16 a[60:63], v[252:255], v[88:91], a[60:63]
 v_mfma_f32_16x16x32_bf16 a[60:63], v[220:223], v[84:87], a[60:63]
 s_waitcnt lgkmcnt(8)
 s_lshl_b32 s22, s21, 16
 v_mfma_f32_16x16x32_bf16 a[128:131], v[192:195], v[60:63], a[128:131]
 ds_read_b64_tr_b16 v[84:85], v21 offset:32768
 v_mfma_f32_16x16x32_bf16 a[128:131], v[224:227], v[64:67], a[128:131]
 ds_read_b64_tr_b16 v[86:87], v21 offset:33792
 v_mfma_f32_16x16x32_bf16 a[132:135], v[228:231], v[64:67], a[132:135]
 s_sub_u32 s56, 487424, s22
 v_mfma_f32_16x16x32_bf16 a[132:135], v[196:199], v[60:63], a[132:135]
 v_mfma_f32_16x16x32_bf16 a[144:147], v[200:203], v[60:63], a[144:147]
 s_add_u32 s98, s33, 8192
 v_mfma_f32_16x16x32_bf16 a[144:147], v[232:235], v[64:67], a[144:147]
 buffer_load_dwordx4 v5, s[4:7], s26 offen offset:3072  lds
 v_mfma_f32_16x16x32_bf16 a[148:151], v[236:239], v[64:67], a[148:151]
 v_mfma_f32_16x16x32_bf16 a[148:151], v[204:207], v[60:63], a[148:151]
 s_lshl_b32 s22, s3, 13
 v_mfma_f32_16x16x32_bf16 a[64:67], v[208:211], v[60:63], a[64:67]
 ds_read_b64_tr_b16 v[88:89], v21 offset:40960
 v_mfma_f32_16x16x32_bf16 a[64:67], v[240:243], v[64:67], a[64:67]
 ds_read_b64_tr_b16 v[90:91], v21 offset:41984
 v_mfma_f32_16x16x32_bf16 a[68:71], v[244:247], v[64:67], a[68:71]
 v_mfma_f32_16x16x32_bf16 a[68:71], v[212:215], v[60:63], a[68:71]
 s_and_b32 s23, s3, 1
 v_mfma_f32_16x16x32_bf16 a[80:83], v[216:219], v[60:63], a[80:83]
 v_mfma_f32_16x16x32_bf16 a[80:83], v[248:251], v[64:67], a[80:83]
 s_add_u32 s26, s26, 128
 s_lshl_b32 s23, s23, 14
 v_mfma_f32_16x16x32_bf16 a[84:87], v[252:255], v[64:67], a[84:87]
 v_mfma_f32_16x16x32_bf16 a[84:87], v[220:223], v[60:63], a[84:87]
 s_waitcnt lgkmcnt(8)
 s_sub_u32 s96, s22, s23
 v_mfma_f32_16x16x32_bf16 a[136:139], v[192:195], v[68:71], a[136:139]
 v_mfma_f32_16x16x32_bf16 a[136:139], v[224:227], v[72:75], a[136:139]
 s_add_u32 s96, s96, 32768
 v_mfma_f32_16x16x32_bf16 a[140:143], v[228:231], v[72:75], a[140:143]
 v_mfma_f32_16x16x32_bf16 a[140:143], v[196:199], v[68:71], a[140:143]
 v_mfma_f32_16x16x32_bf16 a[152:155], v[200:203], v[68:71], a[152:155]
 v_mfma_f32_16x16x32_bf16 a[152:155], v[232:235], v[72:75], a[152:155]
 v_mfma_f32_16x16x32_bf16 a[156:159], v[236:239], v[72:75], a[156:159]
 v_mfma_f32_16x16x32_bf16 a[156:159], v[204:207], v[68:71], a[156:159]
 s_waitcnt vmcnt(10) lgkmcnt(0)
 s_barrier
 v_mfma_f32_16x16x32_bf16 a[72:75], v[208:211], v[68:71], a[72:75]
 ds_read_b64_tr_b16 v[60:61], v14 offset:0
 s_add_u32 m0, s30, 131072
 v_mfma_f32_16x16x32_bf16 a[72:75], v[240:243], v[72:75], a[72:75]
 ds_read_b64_tr_b16 v[62:63], v14 offset:1024
 s_nop 0
 v_mfma_f32_16x16x32_bf16 a[76:79], v[244:247], v[72:75], a[76:79]
 ds_read_b64_tr_b16 v[64:65], v14 offset:8192
 v_mfma_f32_16x16x32_bf16 a[76:79], v[212:215], v[68:71], a[76:79]
 ds_read_b64_tr_b16 v[66:67], v14 offset:9216
 v_mfma_f32_16x16x32_bf16 a[88:91], v[216:219], v[68:71], a[88:91]
 ds_read_b128 v[128:131], v12 offset:0
 v_mfma_f32_16x16x32_bf16 a[88:91], v[248:251], v[72:75], a[88:91]
 ds_read_b128 v[160:163], v13 offset:0
 v_mfma_f32_16x16x32_bf16 a[92:95], v[252:255], v[72:75], a[92:95]
 ds_read_b128 v[132:135], v12 offset:2048
 v_mfma_f32_16x16x32_bf16 a[92:95], v[220:223], v[68:71], a[92:95]
 ds_read_b128 v[164:167], v13 offset:2048
 v_mfma_f32_16x16x32_bf16 a[160:163], v[192:195], v[76:79], a[160:163]
 ds_read_b128 v[136:139], v12 offset:4096
 v_mfma_f32_16x16x32_bf16 a[160:163], v[224:227], v[80:83], a[160:163]
 ds_read_b64_tr_b16 v[68:69], v15 offset:0
 v_mfma_f32_16x16x32_bf16 a[164:167], v[228:231], v[80:83], a[164:167]
 ds_read_b64_tr_b16 v[70:71], v15 offset:1024
 v_mfma_f32_16x16x32_bf16 a[164:167], v[196:199], v[76:79], a[164:167]
 ds_read_b128 v[168:171], v13 offset:4096
 v_mfma_f32_16x16x32_bf16 a[176:179], v[200:203], v[76:79], a[176:179]
 ds_read_b128 v[140:143], v12 offset:6144
 v_mfma_f32_16x16x32_bf16 a[176:179], v[232:235], v[80:83], a[176:179]
 ds_read_b128 v[172:175], v13 offset:6144
 v_mfma_f32_16x16x32_bf16 a[180:183], v[236:239], v[80:83], a[180:183]
 ds_read_b128 v[144:147], v12 offset:8192
 buffer_load_dwordx4 v6, s[8:11], s27 offen offset:0  lds
 v_mfma_f32_16x16x32_bf16 a[180:183], v[204:207], v[76:79], a[180:183]
 ds_read_b128 v[176:179], v13 offset:8192
 v_mfma_f32_16x16x32_bf16 a[96:99], v[208:211], v[76:79], a[96:99]
 ds_read_b64_tr_b16 v[72:73], v15 offset:8192
 v_mfma_f32_16x16x32_bf16 a[96:99], v[240:243], v[80:83], a[96:99]
 ds_read_b64_tr_b16 v[74:75], v15 offset:9216
 v_mfma_f32_16x16x32_bf16 a[100:103], v[244:247], v[80:83], a[100:103]
 ds_read_b128 v[148:151], v12 offset:10240
 v_mfma_f32_16x16x32_bf16 a[100:103], v[212:215], v[76:79], a[100:103]
 ds_read_b128 v[180:183], v13 offset:10240
 buffer_load_dwordx4 v7, s[8:11], s27 offen offset:1024  lds
 v_mfma_f32_16x16x32_bf16 a[112:115], v[216:219], v[76:79], a[112:115]
 ds_read_b128 v[152:155], v12 offset:12288
 v_mfma_f32_16x16x32_bf16 a[112:115], v[248:251], v[80:83], a[112:115]
 ds_read_b128 v[184:187], v13 offset:12288
 v_mfma_f32_16x16x32_bf16 a[116:119], v[252:255], v[80:83], a[116:119]
 buffer_load_dwordx4 v8, s[8:11], s27 offen offset:2048  lds
 v_mfma_f32_16x16x32_bf16 a[116:119], v[220:223], v[76:79], a[116:119]
 ds_read_b128 v[156:159], v12 offset:14336
 v_mfma_f32_16x16x32_bf16 a[168:171], v[192:195], v[84:87], a[168:171]
 ds_read_b128 v[188:191], v13 offset:14336
 v_mfma_f32_16x16x32_bf16 a[168:171], v[224:227], v[88:91], a[168:171]
 ds_read_b64_tr_b16 v[76:77], v16 offset:0
 v_mfma_f32_16x16x32_bf16 a[172:175], v[228:231], v[88:91], a[172:175]
 ds_read_b64_tr_b16 v[78:79], v16 offset:1024
 v_add_u32 v12, 0x8000, v12
 v_mfma_f32_16x16x32_bf16 a[172:175], v[196:199], v[84:87], a[172:175]
 v_add_u32 v13, 0x8000, v13
 v_mfma_f32_16x16x32_bf16 a[184:187], v[200:203], v[84:87], a[184:187]
 buffer_load_dwordx4 v9, s[8:11], s27 offen offset:3072  lds
 v_mfma_f32_16x16x32_bf16 a[184:187], v[232:235], v[88:91], a[184:187]
 s_add_u32 m0, s30, 135168
 s_add_u32 s27, s27, 524288
 v_mfma_f32_16x16x32_bf16 a[188:191], v[236:239], v[88:91], a[188:191]
 buffer_load_dwordx4 v6, s[8:11], s62 offen offset:0  lds
 v_mfma_f32_16x16x32_bf16 a[188:191], v[204:207], v[84:87], a[188:191]
 buffer_load_dwordx4 v7, s[8:11], s62 offen offset:1024  lds
 v_mfma_f32_16x16x32_bf16 a[104:107], v[208:211], v[84:87], a[104:107]
 ds_read_b64_tr_b16 v[80:81], v16 offset:8192
 v_mfma_f32_16x16x32_bf16 a[104:107], v[240:243], v[88:91], a[104:107]
 ds_read_b64_tr_b16 v[82:83], v16 offset:9216
 v_mfma_f32_16x16x32_bf16 a[108:111], v[244:247], v[88:91], a[108:111]
 buffer_load_dwordx4 v8, s[8:11], s62 offen offset:2048  lds
 v_mfma_f32_16x16x32_bf16 a[108:111], v[212:215], v[84:87], a[108:111]
 v_mfma_f32_16x16x32_bf16 a[120:123], v[216:219], v[84:87], a[120:123]
 v_mfma_f32_16x16x32_bf16 a[120:123], v[248:251], v[88:91], a[120:123]
 buffer_load_dwordx4 v9, s[8:11], s62 offen offset:3072  lds
 v_mfma_f32_16x16x32_bf16 a[124:127], v[252:255], v[88:91], a[124:127]
 v_mfma_f32_16x16x32_bf16 a[124:127], v[220:223], v[84:87], a[124:127]
 s_waitcnt lgkmcnt(4)
 s_add_u32 s62, s62, 524288
 v_mfma_f32_16x16x32_bf16 a[192:195], v[128:131], v[60:63], a[192:195]
 ds_read_b64_tr_b16 v[84:85], v17 offset:0
 v_mfma_f32_16x16x32_bf16 a[192:195], v[160:163], v[64:67], a[192:195]
 ds_read_b64_tr_b16 v[86:87], v17 offset:1024
 v_mfma_f32_16x16x32_bf16 a[196:199], v[164:167], v[64:67], a[196:199]
 global_load_dword v122, v51, s[46:47]
 v_mfma_f32_16x16x32_bf16 a[196:199], v[132:135], v[60:63], a[196:199]
 v_mfma_f32_16x16x32_bf16 a[208:211], v[136:139], v[60:63], a[208:211]
 s_add_u32 m0, s29, 65536
 v_mfma_f32_16x16x32_bf16 a[208:211], v[168:171], v[64:67], a[208:211]
 v_mfma_f32_16x16x32_bf16 a[212:215], v[172:175], v[64:67], a[212:215]
 s_nop 0
 v_mfma_f32_16x16x32_bf16 a[212:215], v[140:143], v[60:63], a[212:215]
 v_mfma_f32_16x16x32_bf16 a[0:3], v[144:147], v[60:63], a[0:3]
 ds_read_b64_tr_b16 v[88:89], v17 offset:8192
 v_mfma_f32_16x16x32_bf16 a[0:3], v[176:179], v[64:67], a[0:3]
 ds_read_b64_tr_b16 v[90:91], v17 offset:9216
 v_mfma_f32_16x16x32_bf16 a[4:7], v[180:183], v[64:67], a[4:7]
 buffer_load_dwordx4 v2, s[4:7], s25 offen offset:0  lds
 v_mfma_f32_16x16x32_bf16 a[4:7], v[148:151], v[60:63], a[4:7]
 v_mfma_f32_16x16x32_bf16 a[16:19], v[152:155], v[60:63], a[16:19]
 v_mfma_f32_16x16x32_bf16 a[16:19], v[184:187], v[64:67], a[16:19]
 v_mfma_f32_16x16x32_bf16 a[20:23], v[188:191], v[64:67], a[20:23]
 v_mfma_f32_16x16x32_bf16 a[20:23], v[156:159], v[60:63], a[20:23]
 v_mfma_f32_16x16x32_bf16 a[200:203], v[128:131], v[68:71], a[200:203]
 ds_read_b64_tr_b16 v[60:61], v18 offset:0
 v_mfma_f32_16x16x32_bf16 a[200:203], v[160:163], v[72:75], a[200:203]
 ds_read_b64_tr_b16 v[62:63], v18 offset:1024
 v_mfma_f32_16x16x32_bf16 a[204:207], v[164:167], v[72:75], a[204:207]
 buffer_load_dwordx4 v3, s[4:7], s25 offen offset:1024  lds
 v_mfma_f32_16x16x32_bf16 a[204:207], v[132:135], v[68:71], a[204:207]
 v_mfma_f32_16x16x32_bf16 a[216:219], v[136:139], v[68:71], a[216:219]
 v_mfma_f32_16x16x32_bf16 a[216:219], v[168:171], v[72:75], a[216:219]
 v_mfma_f32_16x16x32_bf16 a[220:223], v[172:175], v[72:75], a[220:223]
 v_mfma_f32_16x16x32_bf16 a[220:223], v[140:143], v[68:71], a[220:223]
 v_mfma_f32_16x16x32_bf16 a[8:11], v[144:147], v[68:71], a[8:11]
 ds_read_b64_tr_b16 v[64:65], v18 offset:8192
 v_mfma_f32_16x16x32_bf16 a[8:11], v[176:179], v[72:75], a[8:11]
 ds_read_b64_tr_b16 v[66:67], v18 offset:9216
 v_mfma_f32_16x16x32_bf16 a[12:15], v[180:183], v[72:75], a[12:15]
 buffer_load_dwordx4 v4, s[4:7], s25 offen offset:2048  lds
 v_mfma_f32_16x16x32_bf16 a[12:15], v[148:151], v[68:71], a[12:15]
 v_mfma_f32_16x16x32_bf16 a[24:27], v[152:155], v[68:71], a[24:27]
 v_mfma_f32_16x16x32_bf16 a[24:27], v[184:187], v[72:75], a[24:27]
 v_mfma_f32_16x16x32_bf16 a[28:31], v[188:191], v[72:75], a[28:31]
 v_mfma_f32_16x16x32_bf16 a[28:31], v[156:159], v[68:71], a[28:31]
 s_waitcnt lgkmcnt(8)
 v_mfma_f32_16x16x32_bf16 a[224:227], v[128:131], v[76:79], a[224:227]
 ds_read_b64_tr_b16 v[68:69], v19 offset:0
 v_mfma_f32_16x16x32_bf16 a[224:227], v[160:163], v[80:83], a[224:227]
 ds_read_b64_tr_b16 v[70:71], v19 offset:1024
 v_mfma_f32_16x16x32_bf16 a[228:231], v[164:167], v[80:83], a[228:231]
 buffer_load_dwordx4 v5, s[4:7], s25 offen offset:3072  lds
 v_mfma_f32_16x16x32_bf16 a[228:231], v[132:135], v[76:79], a[228:231]
 v_mfma_f32_16x16x32_bf16 a[240:243], v[136:139], v[76:79], a[240:243]
 v_mfma_f32_16x16x32_bf16 a[240:243], v[168:171], v[80:83], a[240:243]
 v_mfma_f32_16x16x32_bf16 a[244:247], v[172:175], v[80:83], a[244:247]
 v_mfma_f32_16x16x32_bf16 a[244:247], v[140:143], v[76:79], a[244:247]
 v_mfma_f32_16x16x32_bf16 a[32:35], v[144:147], v[76:79], a[32:35]
 ds_read_b64_tr_b16 v[72:73], v19 offset:8192
 s_add_u32 m0, s29, 69632
 v_mfma_f32_16x16x32_bf16 a[32:35], v[176:179], v[80:83], a[32:35]
 ds_read_b64_tr_b16 v[74:75], v19 offset:9216
 v_mfma_f32_16x16x32_bf16 a[36:39], v[180:183], v[80:83], a[36:39]
 v_mfma_f32_16x16x32_bf16 a[36:39], v[148:151], v[76:79], a[36:39]
 s_add_u32 s25, s25, 128
 v_mfma_f32_16x16x32_bf16 a[48:51], v[152:155], v[76:79], a[48:51]
 v_mfma_f32_16x16x32_bf16 a[48:51], v[184:187], v[80:83], a[48:51]
 buffer_load_dwordx4 v2, s[4:7], s26 offen offset:0  lds
 v_mfma_f32_16x16x32_bf16 a[52:55], v[188:191], v[80:83], a[52:55]
 v_mfma_f32_16x16x32_bf16 a[52:55], v[156:159], v[76:79], a[52:55]
 s_waitcnt lgkmcnt(8)
 v_mfma_f32_16x16x32_bf16 a[232:235], v[128:131], v[84:87], a[232:235]
 ds_read_b64_tr_b16 v[76:77], v20 offset:0
 v_mfma_f32_16x16x32_bf16 a[232:235], v[160:163], v[88:91], a[232:235]
 ds_read_b64_tr_b16 v[78:79], v20 offset:1024
 v_mfma_f32_16x16x32_bf16 a[236:239], v[164:167], v[88:91], a[236:239]
 v_mfma_f32_16x16x32_bf16 a[236:239], v[132:135], v[84:87], a[236:239]
 v_mfma_f32_16x16x32_bf16 a[248:251], v[136:139], v[84:87], a[248:251]
 v_mfma_f32_16x16x32_bf16 a[248:251], v[168:171], v[88:91], a[248:251]
 buffer_load_dwordx4 v3, s[4:7], s26 offen offset:1024  lds
 v_mfma_f32_16x16x32_bf16 a[252:255], v[172:175], v[88:91], a[252:255]
 v_mfma_f32_16x16x32_bf16 a[252:255], v[140:143], v[84:87], a[252:255]
 v_mfma_f32_16x16x32_bf16 a[40:43], v[144:147], v[84:87], a[40:43]
 ds_read_b64_tr_b16 v[80:81], v20 offset:8192
 v_mfma_f32_16x16x32_bf16 a[40:43], v[176:179], v[88:91], a[40:43]
 ds_read_b64_tr_b16 v[82:83], v20 offset:9216
 v_mfma_f32_16x16x32_bf16 a[44:47], v[180:183], v[88:91], a[44:47]
 v_mfma_f32_16x16x32_bf16 a[44:47], v[148:151], v[84:87], a[44:47]
 v_mfma_f32_16x16x32_bf16 a[56:59], v[152:155], v[84:87], a[56:59]
 v_mfma_f32_16x16x32_bf16 a[56:59], v[184:187], v[88:91], a[56:59]
 buffer_load_dwordx4 v4, s[4:7], s26 offen offset:2048  lds
 v_mfma_f32_16x16x32_bf16 a[60:63], v[188:191], v[88:91], a[60:63]
 v_mfma_f32_16x16x32_bf16 a[60:63], v[156:159], v[84:87], a[60:63]
 s_waitcnt lgkmcnt(8)
 v_mfma_f32_16x16x32_bf16 a[128:131], v[128:131], v[60:63], a[128:131]
 ds_read_b64_tr_b16 v[84:85], v21 offset:0
 v_mfma_f32_16x16x32_bf16 a[128:131], v[160:163], v[64:67], a[128:131]
 ds_read_b64_tr_b16 v[86:87], v21 offset:1024
 v_mfma_f32_16x16x32_bf16 a[132:135], v[164:167], v[64:67], a[132:135]
 v_mfma_f32_16x16x32_bf16 a[132:135], v[132:135], v[60:63], a[132:135]
 v_mfma_f32_16x16x32_bf16 a[144:147], v[136:139], v[60:63], a[144:147]
 v_mfma_f32_16x16x32_bf16 a[144:147], v[168:171], v[64:67], a[144:147]
 buffer_load_dwordx4 v5, s[4:7], s26 offen offset:3072  lds
 v_mfma_f32_16x16x32_bf16 a[148:151], v[172:175], v[64:67], a[148:151]
 v_mfma_f32_16x16x32_bf16 a[148:151], v[140:143], v[60:63], a[148:151]
 v_mfma_f32_16x16x32_bf16 a[64:67], v[144:147], v[60:63], a[64:67]
 ds_read_b64_tr_b16 v[88:89], v21 offset:8192
 v_mfma_f32_16x16x32_bf16 a[64:67], v[176:179], v[64:67], a[64:67]
 ds_read_b64_tr_b16 v[90:91], v21 offset:9216
 v_mfma_f32_16x16x32_bf16 a[68:71], v[180:183], v[64:67], a[68:71]
 v_mfma_f32_16x16x32_bf16 a[68:71], v[148:151], v[60:63], a[68:71]
 v_mfma_f32_16x16x32_bf16 a[80:83], v[152:155], v[60:63], a[80:83]
 v_mfma_f32_16x16x32_bf16 a[80:83], v[184:187], v[64:67], a[80:83]
 s_add_u32 s26, s26, 128
 v_mfma_f32_16x16x32_bf16 a[84:87], v[188:191], v[64:67], a[84:87]
 v_mfma_f32_16x16x32_bf16 a[84:87], v[156:159], v[60:63], a[84:87]
 s_waitcnt lgkmcnt(8)
 v_mfma_f32_16x16x32_bf16 a[136:139], v[128:131], v[68:71], a[136:139]
 v_mfma_f32_16x16x32_bf16 a[136:139], v[160:163], v[72:75], a[136:139]
 v_mfma_f32_16x16x32_bf16 a[140:143], v[164:167], v[72:75], a[140:143]
 v_mfma_f32_16x16x32_bf16 a[140:143], v[132:135], v[68:71], a[140:143]
 v_mfma_f32_16x16x32_bf16 a[152:155], v[136:139], v[68:71], a[152:155]
 v_mfma_f32_16x16x32_bf16 a[152:155], v[168:171], v[72:75], a[152:155]
 v_mfma_f32_16x16x32_bf16 a[156:159], v[172:175], v[72:75], a[156:159]
 v_mfma_f32_16x16x32_bf16 a[156:159], v[140:143], v[68:71], a[156:159]
 s_waitcnt vmcnt(9) lgkmcnt(0)
 s_barrier
 v_mfma_f32_16x16x32_bf16 a[72:75], v[144:147], v[68:71], a[72:75]
 ds_read_b64_tr_b16 v[60:61], v14 offset:32768
 s_add_u32 m0, s30, 98304
 v_mfma_f32_16x16x32_bf16 a[72:75], v[176:179], v[72:75], a[72:75]
 ds_read_b64_tr_b16 v[62:63], v14 offset:33792
 s_nop 0
 v_mfma_f32_16x16x32_bf16 a[76:79], v[180:183], v[72:75], a[76:79]
 ds_read_b64_tr_b16 v[64:65], v14 offset:40960
 v_mfma_f32_16x16x32_bf16 a[76:79], v[148:151], v[68:71], a[76:79]
 ds_read_b64_tr_b16 v[66:67], v14 offset:41984
 v_mfma_f32_16x16x32_bf16 a[88:91], v[152:155], v[68:71], a[88:91]
 ds_read_b128 v[192:195], v12 offset:0
 v_mfma_f32_16x16x32_bf16 a[88:91], v[184:187], v[72:75], a[88:91]
 ds_read_b128 v[224:227], v13 offset:0
 v_mfma_f32_16x16x32_bf16 a[92:95], v[188:191], v[72:75], a[92:95]
 ds_read_b128 v[196:199], v12 offset:2048
 v_mfma_f32_16x16x32_bf16 a[92:95], v[156:159], v[68:71], a[92:95]
 ds_read_b128 v[228:231], v13 offset:2048
 v_mfma_f32_16x16x32_bf16 a[160:163], v[128:131], v[76:79], a[160:163]
 ds_read_b128 v[200:203], v12 offset:4096
 v_mfma_f32_16x16x32_bf16 a[160:163], v[160:163], v[80:83], a[160:163]
 ds_read_b64_tr_b16 v[68:69], v15 offset:32768
 v_mfma_f32_16x16x32_bf16 a[164:167], v[164:167], v[80:83], a[164:167]
 ds_read_b64_tr_b16 v[70:71], v15 offset:33792
 v_mfma_f32_16x16x32_bf16 a[164:167], v[132:135], v[76:79], a[164:167]
 ds_read_b128 v[232:235], v13 offset:4096
 v_mfma_f32_16x16x32_bf16 a[176:179], v[136:139], v[76:79], a[176:179]
 ds_read_b128 v[204:207], v12 offset:6144
 v_mfma_f32_16x16x32_bf16 a[176:179], v[168:171], v[80:83], a[176:179]
 ds_read_b128 v[236:239], v13 offset:6144
 buffer_load_dwordx4 v6, s[8:11], s27 offen offset:0  lds
 v_mfma_f32_16x16x32_bf16 a[180:183], v[172:175], v[80:83], a[180:183]
 ds_read_b128 v[208:211], v12 offset:8192
 v_mfma_f32_16x16x32_bf16 a[180:183], v[140:143], v[76:79], a[180:183]
 ds_read_b128 v[240:243], v13 offset:8192
 v_mfma_f32_16x16x32_bf16 a[96:99], v[144:147], v[76:79], a[96:99]
 ds_read_b64_tr_b16 v[72:73], v15 offset:40960
 v_mfma_f32_16x16x32_bf16 a[96:99], v[176:179], v[80:83], a[96:99]
 ds_read_b64_tr_b16 v[74:75], v15 offset:41984
 buffer_load_dwordx4 v7, s[8:11], s27 offen offset:1024  lds
 v_mfma_f32_16x16x32_bf16 a[100:103], v[180:183], v[80:83], a[100:103]
 ds_read_b128 v[212:215], v12 offset:10240
 v_mfma_f32_16x16x32_bf16 a[100:103], v[148:151], v[76:79], a[100:103]
 ds_read_b128 v[244:247], v13 offset:10240
 v_mfma_f32_16x16x32_bf16 a[112:115], v[152:155], v[76:79], a[112:115]
 ds_read_b128 v[216:219], v12 offset:12288
 v_mfma_f32_16x16x32_bf16 a[112:115], v[184:187], v[80:83], a[112:115]
 ds_read_b128 v[248:251], v13 offset:12288
 v_mfma_f32_16x16x32_bf16 a[116:119], v[188:191], v[80:83], a[116:119]
 buffer_load_dwordx4 v8, s[8:11], s27 offen offset:2048  lds
 v_mfma_f32_16x16x32_bf16 a[116:119], v[156:159], v[76:79], a[116:119]
 ds_read_b128 v[220:223], v12 offset:14336
 v_mfma_f32_16x16x32_bf16 a[168:171], v[128:131], v[84:87], a[168:171]
 ds_read_b128 v[252:255], v13 offset:14336
 v_mfma_f32_16x16x32_bf16 a[168:171], v[160:163], v[88:91], a[168:171]
 ds_read_b64_tr_b16 v[76:77], v16 offset:32768
 v_mfma_f32_16x16x32_bf16 a[172:175], v[164:167], v[88:91], a[172:175]
 ds_read_b64_tr_b16 v[78:79], v16 offset:33792
 v_add_u32 v12, 0x8000, v12
 v_mfma_f32_16x16x32_bf16 a[172:175], v[132:135], v[84:87], a[172:175]
 v_add_u32 v13, 0x8000, v13
 v_mfma_f32_16x16x32_bf16 a[184:187], v[136:139], v[84:87], a[184:187]
 buffer_load_dwordx4 v9, s[8:11], s27 offen offset:3072  lds
 v_mfma_f32_16x16x32_bf16 a[184:187], v[168:171], v[88:91], a[184:187]
 s_add_u32 m0, s30, 102400
 s_add_u32 s27, s27, 524288
 v_mfma_f32_16x16x32_bf16 a[188:191], v[172:175], v[88:91], a[188:191]
 buffer_load_dwordx4 v6, s[8:11], s62 offen offset:0  lds
 v_mfma_f32_16x16x32_bf16 a[188:191], v[140:143], v[84:87], a[188:191]
 buffer_load_dwordx4 v7, s[8:11], s62 offen offset:1024  lds
 v_mfma_f32_16x16x32_bf16 a[104:107], v[144:147], v[84:87], a[104:107]
 ds_read_b64_tr_b16 v[80:81], v16 offset:40960
 v_mfma_f32_16x16x32_bf16 a[104:107], v[176:179], v[88:91], a[104:107]
 ds_read_b64_tr_b16 v[82:83], v16 offset:41984
 v_mfma_f32_16x16x32_bf16 a[108:111], v[180:183], v[88:91], a[108:111]
 buffer_load_dwordx4 v8, s[8:11], s62 offen offset:2048  lds
 v_mfma_f32_16x16x32_bf16 a[108:111], v[148:151], v[84:87], a[108:111]
 buffer_load_dwordx4 v9, s[8:11], s62 offen offset:3072  lds
 v_mfma_f32_16x16x32_bf16 a[120:123], v[152:155], v[84:87], a[120:123]
 v_mfma_f32_16x16x32_bf16 a[120:123], v[184:187], v[88:91], a[120:123]
 s_add_u32 s62, s62, 524288
 v_mfma_f32_16x16x32_bf16 a[124:127], v[188:191], v[88:91], a[124:127]
 global_load_dword v122, v53, s[38:39]
 v_mfma_f32_16x16x32_bf16 a[124:127], v[156:159], v[84:87], a[124:127]
 s_waitcnt lgkmcnt(4)
 v_mfma_f32_16x16x32_bf16 a[192:195], v[192:195], v[60:63], a[192:195]
 ds_read_b64_tr_b16 v[84:85], v17 offset:32768
 v_mfma_f32_16x16x32_bf16 a[192:195], v[224:227], v[64:67], a[192:195]
 ds_read_b64_tr_b16 v[86:87], v17 offset:33792
 v_mfma_f32_16x16x32_bf16 a[196:199], v[228:231], v[64:67], a[196:199]
 global_load_dword v122, v127, s[0:1]
 v_mfma_f32_16x16x32_bf16 a[196:199], v[196:199], v[60:63], a[196:199]
 v_mfma_f32_16x16x32_bf16 a[208:211], v[200:203], v[60:63], a[208:211]
 s_add_u32 m0, s29, 0
 v_mfma_f32_16x16x32_bf16 a[208:211], v[232:235], v[64:67], a[208:211]
 v_mfma_f32_16x16x32_bf16 a[212:215], v[236:239], v[64:67], a[212:215]
 s_nop 0
 v_mfma_f32_16x16x32_bf16 a[212:215], v[204:207], v[60:63], a[212:215]
 v_mfma_f32_16x16x32_bf16 a[0:3], v[208:211], v[60:63], a[0:3]
 ds_read_b64_tr_b16 v[88:89], v17 offset:40960
 v_mfma_f32_16x16x32_bf16 a[0:3], v[240:243], v[64:67], a[0:3]
 ds_read_b64_tr_b16 v[90:91], v17 offset:41984
 v_mfma_f32_16x16x32_bf16 a[4:7], v[244:247], v[64:67], a[4:7]
 buffer_load_dwordx4 v2, s[4:7], s25 offen offset:0  lds
 v_mfma_f32_16x16x32_bf16 a[4:7], v[212:215], v[60:63], a[4:7]
 v_mfma_f32_16x16x32_bf16 a[16:19], v[216:219], v[60:63], a[16:19]
 v_mfma_f32_16x16x32_bf16 a[16:19], v[248:251], v[64:67], a[16:19]
 v_mfma_f32_16x16x32_bf16 a[20:23], v[252:255], v[64:67], a[20:23]
 v_mfma_f32_16x16x32_bf16 a[20:23], v[220:223], v[60:63], a[20:23]
 v_mfma_f32_16x16x32_bf16 a[200:203], v[192:195], v[68:71], a[200:203]
 ds_read_b64_tr_b16 v[60:61], v18 offset:32768
 v_mfma_f32_16x16x32_bf16 a[200:203], v[224:227], v[72:75], a[200:203]
 ds_read_b64_tr_b16 v[62:63], v18 offset:33792
 v_mfma_f32_16x16x32_bf16 a[204:207], v[228:231], v[72:75], a[204:207]
 buffer_load_dwordx4 v3, s[4:7], s25 offen offset:1024  lds
 v_mfma_f32_16x16x32_bf16 a[204:207], v[196:199], v[68:71], a[204:207]
 v_mfma_f32_16x16x32_bf16 a[216:219], v[200:203], v[68:71], a[216:219]
 v_mfma_f32_16x16x32_bf16 a[216:219], v[232:235], v[72:75], a[216:219]
 v_mfma_f32_16x16x32_bf16 a[220:223], v[236:239], v[72:75], a[220:223]
 v_mfma_f32_16x16x32_bf16 a[220:223], v[204:207], v[68:71], a[220:223]
 v_mfma_f32_16x16x32_bf16 a[8:11], v[208:211], v[68:71], a[8:11]
 ds_read_b64_tr_b16 v[64:65], v18 offset:40960
 v_mfma_f32_16x16x32_bf16 a[8:11], v[240:243], v[72:75], a[8:11]
 ds_read_b64_tr_b16 v[66:67], v18 offset:41984
 v_mfma_f32_16x16x32_bf16 a[12:15], v[244:247], v[72:75], a[12:15]
 buffer_load_dwordx4 v4, s[4:7], s25 offen offset:2048  lds
 v_mfma_f32_16x16x32_bf16 a[12:15], v[212:215], v[68:71], a[12:15]
 v_mfma_f32_16x16x32_bf16 a[24:27], v[216:219], v[68:71], a[24:27]
 v_mfma_f32_16x16x32_bf16 a[24:27], v[248:251], v[72:75], a[24:27]
 v_mfma_f32_16x16x32_bf16 a[28:31], v[252:255], v[72:75], a[28:31]
 v_mfma_f32_16x16x32_bf16 a[28:31], v[220:223], v[68:71], a[28:31]
 s_waitcnt lgkmcnt(8)
 v_mfma_f32_16x16x32_bf16 a[224:227], v[192:195], v[76:79], a[224:227]
 ds_read_b64_tr_b16 v[68:69], v19 offset:32768
 v_mfma_f32_16x16x32_bf16 a[224:227], v[224:227], v[80:83], a[224:227]
 ds_read_b64_tr_b16 v[70:71], v19 offset:33792
 v_mfma_f32_16x16x32_bf16 a[228:231], v[228:231], v[80:83], a[228:231]
 buffer_load_dwordx4 v5, s[4:7], s25 offen offset:3072  lds
 v_mfma_f32_16x16x32_bf16 a[228:231], v[196:199], v[76:79], a[228:231]
 v_mfma_f32_16x16x32_bf16 a[240:243], v[200:203], v[76:79], a[240:243]
 v_mfma_f32_16x16x32_bf16 a[240:243], v[232:235], v[80:83], a[240:243]
 v_mfma_f32_16x16x32_bf16 a[244:247], v[236:239], v[80:83], a[244:247]
 v_mfma_f32_16x16x32_bf16 a[244:247], v[204:207], v[76:79], a[244:247]
 v_mfma_f32_16x16x32_bf16 a[32:35], v[208:211], v[76:79], a[32:35]
 ds_read_b64_tr_b16 v[72:73], v19 offset:40960
 s_add_u32 m0, s29, 4096
 v_mfma_f32_16x16x32_bf16 a[32:35], v[240:243], v[80:83], a[32:35]
 ds_read_b64_tr_b16 v[74:75], v19 offset:41984
 v_mfma_f32_16x16x32_bf16 a[36:39], v[244:247], v[80:83], a[36:39]
 v_mfma_f32_16x16x32_bf16 a[36:39], v[212:215], v[76:79], a[36:39]
 s_add_u32 s25, s25, 128
 v_mfma_f32_16x16x32_bf16 a[48:51], v[216:219], v[76:79], a[48:51]
 v_mfma_f32_16x16x32_bf16 a[48:51], v[248:251], v[80:83], a[48:51]
 buffer_load_dwordx4 v2, s[4:7], s26 offen offset:0  lds
 v_mfma_f32_16x16x32_bf16 a[52:55], v[252:255], v[80:83], a[52:55]
 v_mfma_f32_16x16x32_bf16 a[52:55], v[220:223], v[76:79], a[52:55]
 s_waitcnt lgkmcnt(8)
 v_mfma_f32_16x16x32_bf16 a[232:235], v[192:195], v[84:87], a[232:235]
 ds_read_b64_tr_b16 v[76:77], v20 offset:32768
 v_mfma_f32_16x16x32_bf16 a[232:235], v[224:227], v[88:91], a[232:235]
 ds_read_b64_tr_b16 v[78:79], v20 offset:33792
 v_mfma_f32_16x16x32_bf16 a[236:239], v[228:231], v[88:91], a[236:239]
 v_mfma_f32_16x16x32_bf16 a[236:239], v[196:199], v[84:87], a[236:239]
 v_mfma_f32_16x16x32_bf16 a[248:251], v[200:203], v[84:87], a[248:251]
 v_mfma_f32_16x16x32_bf16 a[248:251], v[232:235], v[88:91], a[248:251]
 buffer_load_dwordx4 v3, s[4:7], s26 offen offset:1024  lds
 v_mfma_f32_16x16x32_bf16 a[252:255], v[236:239], v[88:91], a[252:255]
 v_mfma_f32_16x16x32_bf16 a[252:255], v[204:207], v[84:87], a[252:255]
 v_mfma_f32_16x16x32_bf16 a[40:43], v[208:211], v[84:87], a[40:43]
 ds_read_b64_tr_b16 v[80:81], v20 offset:40960
 v_mfma_f32_16x16x32_bf16 a[40:43], v[240:243], v[88:91], a[40:43]
 ds_read_b64_tr_b16 v[82:83], v20 offset:41984
 v_mfma_f32_16x16x32_bf16 a[44:47], v[244:247], v[88:91], a[44:47]
 v_mfma_f32_16x16x32_bf16 a[44:47], v[212:215], v[84:87], a[44:47]
 v_mfma_f32_16x16x32_bf16 a[56:59], v[216:219], v[84:87], a[56:59]
 v_mfma_f32_16x16x32_bf16 a[56:59], v[248:251], v[88:91], a[56:59]
 buffer_load_dwordx4 v4, s[4:7], s26 offen offset:2048  lds
 v_mfma_f32_16x16x32_bf16 a[60:63], v[252:255], v[88:91], a[60:63]
 v_mfma_f32_16x16x32_bf16 a[60:63], v[220:223], v[84:87], a[60:63]
 s_waitcnt lgkmcnt(8)
 v_mfma_f32_16x16x32_bf16 a[128:131], v[192:195], v[60:63], a[128:131]
 ds_read_b64_tr_b16 v[84:85], v21 offset:32768
 v_mfma_f32_16x16x32_bf16 a[128:131], v[224:227], v[64:67], a[128:131]
 ds_read_b64_tr_b16 v[86:87], v21 offset:33792
 v_mfma_f32_16x16x32_bf16 a[132:135], v[228:231], v[64:67], a[132:135]
 v_mfma_f32_16x16x32_bf16 a[132:135], v[196:199], v[60:63], a[132:135]
 v_mfma_f32_16x16x32_bf16 a[144:147], v[200:203], v[60:63], a[144:147]
 v_mfma_f32_16x16x32_bf16 a[144:147], v[232:235], v[64:67], a[144:147]
 buffer_load_dwordx4 v5, s[4:7], s26 offen offset:3072  lds
 v_mfma_f32_16x16x32_bf16 a[148:151], v[236:239], v[64:67], a[148:151]
 v_mfma_f32_16x16x32_bf16 a[148:151], v[204:207], v[60:63], a[148:151]
 v_mfma_f32_16x16x32_bf16 a[64:67], v[208:211], v[60:63], a[64:67]
 ds_read_b64_tr_b16 v[88:89], v21 offset:40960
 v_mfma_f32_16x16x32_bf16 a[64:67], v[240:243], v[64:67], a[64:67]
 ds_read_b64_tr_b16 v[90:91], v21 offset:41984
 v_mfma_f32_16x16x32_bf16 a[68:71], v[244:247], v[64:67], a[68:71]
 v_mfma_f32_16x16x32_bf16 a[68:71], v[212:215], v[60:63], a[68:71]
 v_mfma_f32_16x16x32_bf16 a[80:83], v[216:219], v[60:63], a[80:83]
 v_mfma_f32_16x16x32_bf16 a[80:83], v[248:251], v[64:67], a[80:83]
 s_add_u32 s26, s26, 128
 v_mfma_f32_16x16x32_bf16 a[84:87], v[252:255], v[64:67], a[84:87]
 v_mfma_f32_16x16x32_bf16 a[84:87], v[220:223], v[60:63], a[84:87]
 s_waitcnt lgkmcnt(8)
 v_mfma_f32_16x16x32_bf16 a[136:139], v[192:195], v[68:71], a[136:139]
 v_mfma_f32_16x16x32_bf16 a[136:139], v[224:227], v[72:75], a[136:139]
 v_mfma_f32_16x16x32_bf16 a[140:143], v[228:231], v[72:75], a[140:143]
 v_mfma_f32_16x16x32_bf16 a[140:143], v[196:199], v[68:71], a[140:143]
 v_mfma_f32_16x16x32_bf16 a[152:155], v[200:203], v[68:71], a[152:155]
 v_mfma_f32_16x16x32_bf16 a[152:155], v[232:235], v[72:75], a[152:155]
 v_mfma_f32_16x16x32_bf16 a[156:159], v[236:239], v[72:75], a[156:159]
 v_mfma_f32_16x16x32_bf16 a[156:159], v[204:207], v[68:71], a[156:159]
 s_waitcnt vmcnt(10) lgkmcnt(0)
 s_barrier
 v_mfma_f32_16x16x32_bf16 a[72:75], v[208:211], v[68:71], a[72:75]
 ds_read_b64_tr_b16 v[60:61], v14 offset:0
 s_add_u32 m0, s30, 131072
 v_mfma_f32_16x16x32_bf16 a[72:75], v[240:243], v[72:75], a[72:75]
 ds_read_b64_tr_b16 v[62:63], v14 offset:1024
 s_nop 0
 v_mfma_f32_16x16x32_bf16 a[76:79], v[244:247], v[72:75], a[76:79]
 ds_read_b64_tr_b16 v[64:65], v14 offset:8192
 v_mfma_f32_16x16x32_bf16 a[76:79], v[212:215], v[68:71], a[76:79]
 ds_read_b64_tr_b16 v[66:67], v14 offset:9216
 v_mfma_f32_16x16x32_bf16 a[88:91], v[216:219], v[68:71], a[88:91]
 ds_read_b128 v[128:131], v12 offset:0
 v_mfma_f32_16x16x32_bf16 a[88:91], v[248:251], v[72:75], a[88:91]
 ds_read_b128 v[160:163], v13 offset:0
 v_mfma_f32_16x16x32_bf16 a[92:95], v[252:255], v[72:75], a[92:95]
 ds_read_b128 v[132:135], v12 offset:2048
 v_mfma_f32_16x16x32_bf16 a[92:95], v[220:223], v[68:71], a[92:95]
 ds_read_b128 v[164:167], v13 offset:2048
 v_mfma_f32_16x16x32_bf16 a[160:163], v[192:195], v[76:79], a[160:163]
 ds_read_b128 v[136:139], v12 offset:4096
 v_mfma_f32_16x16x32_bf16 a[160:163], v[224:227], v[80:83], a[160:163]
 ds_read_b64_tr_b16 v[68:69], v15 offset:0
 v_mfma_f32_16x16x32_bf16 a[164:167], v[228:231], v[80:83], a[164:167]
 ds_read_b64_tr_b16 v[70:71], v15 offset:1024
 v_mfma_f32_16x16x32_bf16 a[164:167], v[196:199], v[76:79], a[164:167]
 ds_read_b128 v[168:171], v13 offset:4096
 v_mfma_f32_16x16x32_bf16 a[176:179], v[200:203], v[76:79], a[176:179]
 ds_read_b128 v[140:143], v12 offset:6144
 buffer_load_dwordx4 v6, s[8:11], s27 offen offset:0  lds
 v_mfma_f32_16x16x32_bf16 a[176:179], v[232:235], v[80:83], a[176:179]
 ds_read_b128 v[172:175], v13 offset:6144
 v_mfma_f32_16x16x32_bf16 a[180:183], v[236:239], v[80:83], a[180:183]
 ds_read_b128 v[144:147], v12 offset:8192
 v_mfma_f32_16x16x32_bf16 a[180:183], v[204:207], v[76:79], a[180:183]
 ds_read_b128 v[176:179], v13 offset:8192
 v_mfma_f32_16x16x32_bf16 a[96:99], v[208:211], v[76:79], a[96:99]
 ds_read_b64_tr_b16 v[72:73], v15 offset:8192
 v_mfma_f32_16x16x32_bf16 a[96:99], v[240:243], v[80:83], a[96:99]
 ds_read_b64_tr_b16 v[74:75], v15 offset:9216
 buffer_load_dwordx4 v7, s[8:11], s27 offen offset:1024  lds
 v_mfma_f32_16x16x32_bf16 a[100:103], v[244:247], v[80:83], a[100:103]
 ds_read_b128 v[148:151], v12 offset:10240
 v_mfma_f32_16x16x32_bf16 a[100:103], v[212:215], v[76:79], a[100:103]
 ds_read_b128 v[180:183], v13 offset:10240
 v_mfma_f32_16x16x32_bf16 a[112:115], v[216:219], v[76:79], a[112:115]
 ds_read_b128 v[152:155], v12 offset:12288
 v_mfma_f32_16x16x32_bf16 a[112:115], v[248:251], v[80:83], a[112:115]
 ds_read_b128 v[184:187], v13 offset:12288
 buffer_load_dwordx4 v8, s[8:11], s27 offen offset:2048  lds
 v_mfma_f32_16x16x32_bf16 a[116:119], v[252:255], v[80:83], a[116:119]
 buffer_load_dwordx4 v9, s[8:11], s27 offen offset:3072  lds
 v_mfma_f32_16x16x32_bf16 a[116:119], v[220:223], v[76:79], a[116:119]
 ds_read_b128 v[156:159], v12 offset:14336
 v_mfma_f32_16x16x32_bf16 a[168:171], v[192:195], v[84:87], a[168:171]
 ds_read_b128 v[188:191], v13 offset:14336
 s_add_u32 m0, s30, 135168
 v_mfma_f32_16x16x32_bf16 a[168:171], v[224:227], v[88:91], a[168:171]
 ds_read_b64_tr_b16 v[76:77], v16 offset:0
 s_add_u32 s27, s27, 524288
 v_mfma_f32_16x16x32_bf16 a[172:175], v[228:231], v[88:91], a[172:175]
 ds_read_b64_tr_b16 v[78:79], v16 offset:1024
 v_subrev_u32 v12, 0x10000, v12
 v_mfma_f32_16x16x32_bf16 a[172:175], v[196:199], v[84:87], a[172:175]
 v_subrev_u32 v13, 0x10000, v13
 v_mfma_f32_16x16x32_bf16 a[184:187], v[200:203], v[84:87], a[184:187]
 buffer_load_dwordx4 v6, s[8:11], s62 offen offset:0  lds
 v_mfma_f32_16x16x32_bf16 a[184:187], v[232:235], v[88:91], a[184:187]
 buffer_load_dwordx4 v7, s[8:11], s62 offen offset:1024  lds
 v_mfma_f32_16x16x32_bf16 a[188:191], v[236:239], v[88:91], a[188:191]
 v_mfma_f32_16x16x32_bf16 a[188:191], v[204:207], v[84:87], a[188:191]
 buffer_load_dwordx4 v8, s[8:11], s62 offen offset:2048  lds
 v_mfma_f32_16x16x32_bf16 a[104:107], v[208:211], v[84:87], a[104:107]
 ds_read_b64_tr_b16 v[80:81], v16 offset:8192
 v_mfma_f32_16x16x32_bf16 a[104:107], v[240:243], v[88:91], a[104:107]
 ds_read_b64_tr_b16 v[82:83], v16 offset:9216
 v_mfma_f32_16x16x32_bf16 a[108:111], v[244:247], v[88:91], a[108:111]
 buffer_load_dwordx4 v9, s[8:11], s62 offen offset:3072  lds
 v_mfma_f32_16x16x32_bf16 a[108:111], v[212:215], v[84:87], a[108:111]
 v_mfma_f32_16x16x32_bf16 a[120:123], v[216:219], v[84:87], a[120:123]
 s_add_u32 s62, s62, 524288
 v_mfma_f32_16x16x32_bf16 a[120:123], v[248:251], v[88:91], a[120:123]
 global_load_dword v122, v52, s[46:47]
 v_mfma_f32_16x16x32_bf16 a[124:127], v[252:255], v[88:91], a[124:127]
 v_mfma_f32_16x16x32_bf16 a[124:127], v[220:223], v[84:87], a[124:127]
 s_waitcnt lgkmcnt(4)
 v_mfma_f32_16x16x32_bf16 a[192:195], v[128:131], v[60:63], a[192:195]
 ds_read_b64_tr_b16 v[84:85], v17 offset:0
 v_mfma_f32_16x16x32_bf16 a[192:195], v[160:163], v[64:67], a[192:195]
 ds_read_b64_tr_b16 v[86:87], v17 offset:1024
 v_mfma_f32_16x16x32_bf16 a[196:199], v[164:167], v[64:67], a[196:199]
 buffer_load_dword v125, v126, s[40:43], 0 offen sc1
 v_mfma_f32_16x16x32_bf16 a[196:199], v[132:135], v[60:63], a[196:199]
 s_cmp_eq_u32 s3, 0
 s_cselect_b32 s45, 8, 0
 v_mfma_f32_16x16x32_bf16 a[208:211], v[136:139], v[60:63], a[208:211]
 s_mov_b32 s4, s36
 v_mfma_f32_16x16x32_bf16 a[208:211], v[168:171], v[64:67], a[208:211]
 s_mov_b32 s5, s37
 v_mfma_f32_16x16x32_bf16 a[212:215], v[172:175], v[64:67], a[212:215]
 v_mfma_f32_16x16x32_bf16 a[212:215], v[140:143], v[60:63], a[212:215]
 s_lshl_b32 s22, s3, 14
 v_mfma_f32_16x16x32_bf16 a[0:3], v[144:147], v[60:63], a[0:3]
 ds_read_b64_tr_b16 v[88:89], v17 offset:8192
 v_mfma_f32_16x16x32_bf16 a[0:3], v[176:179], v[64:67], a[0:3]
 ds_read_b64_tr_b16 v[90:91], v17 offset:9216
 v_mfma_f32_16x16x32_bf16 a[4:7], v[180:183], v[64:67], a[4:7]
 s_lshl_b32 s25, s92, 15
 v_mfma_f32_16x16x32_bf16 a[4:7], v[148:151], v[60:63], a[4:7]
 s_lshl_b32 s26, s93, 15
 v_mfma_f32_16x16x32_bf16 a[16:19], v[152:155], v[60:63], a[16:19]
 v_mfma_f32_16x16x32_bf16 a[16:19], v[184:187], v[64:67], a[16:19]
 s_sub_u32 s25, s25, s22
 v_mfma_f32_16x16x32_bf16 a[20:23], v[188:191], v[64:67], a[20:23]
 v_mfma_f32_16x16x32_bf16 a[20:23], v[156:159], v[60:63], a[20:23]
 s_sub_u32 s26, s26, s22
 v_mfma_f32_16x16x32_bf16 a[200:203], v[128:131], v[68:71], a[200:203]
 ds_read_b64_tr_b16 v[60:61], v18 offset:0
 v_mfma_f32_16x16x32_bf16 a[200:203], v[160:163], v[72:75], a[200:203]
 ds_read_b64_tr_b16 v[62:63], v18 offset:1024
 s_lshl_b32 s22, s22, 1
 v_mfma_f32_16x16x32_bf16 a[204:207], v[164:167], v[72:75], a[204:207]
 v_mfma_f32_16x16x32_bf16 a[204:207], v[132:135], v[68:71], a[204:207]
 s_sub_u32 s22, 98304, s22
 v_mfma_f32_16x16x32_bf16 a[216:219], v[136:139], v[68:71], a[216:219]
 v_mfma_f32_16x16x32_bf16 a[216:219], v[168:171], v[72:75], a[216:219]
 v_add_u32 v4, s22, v4
 v_mfma_f32_16x16x32_bf16 a[220:223], v[172:175], v[72:75], a[220:223]
 v_add_u32 v5, s22, v5
 v_mfma_f32_16x16x32_bf16 a[220:223], v[140:143], v[68:71], a[220:223]
 v_mfma_f32_16x16x32_bf16 a[8:11], v[144:147], v[68:71], a[8:11]
 ds_read_b64_tr_b16 v[64:65], v18 offset:8192
 s_add_u32 m0, s29, 32768
 v_mfma_f32_16x16x32_bf16 a[8:11], v[176:179], v[72:75], a[8:11]
 ds_read_b64_tr_b16 v[66:67], v18 offset:9216
 v_mfma_f32_16x16x32_bf16 a[12:15], v[180:183], v[72:75], a[12:15]
 v_mfma_f32_16x16x32_bf16 a[12:15], v[148:151], v[68:71], a[12:15]
 s_nop 0
 v_mfma_f32_16x16x32_bf16 a[24:27], v[152:155], v[68:71], a[24:27]
 buffer_load_dwordx4 v2, s[4:7], s25 offen offset:0  lds
 v_mfma_f32_16x16x32_bf16 a[24:27], v[184:187], v[72:75], a[24:27]
 v_mfma_f32_16x16x32_bf16 a[28:31], v[188:191], v[72:75], a[28:31]
 v_mfma_f32_16x16x32_bf16 a[28:31], v[156:159], v[68:71], a[28:31]
 s_waitcnt lgkmcnt(8)
 v_mfma_f32_16x16x32_bf16 a[224:227], v[128:131], v[76:79], a[224:227]
 ds_read_b64_tr_b16 v[68:69], v19 offset:0
 v_mfma_f32_16x16x32_bf16 a[224:227], v[160:163], v[80:83], a[224:227]
 ds_read_b64_tr_b16 v[70:71], v19 offset:1024
 v_mfma_f32_16x16x32_bf16 a[228:231], v[164:167], v[80:83], a[228:231]
 buffer_load_dwordx4 v3, s[4:7], s25 offen offset:1024  lds
 v_mfma_f32_16x16x32_bf16 a[228:231], v[132:135], v[76:79], a[228:231]
 v_mfma_f32_16x16x32_bf16 a[240:243], v[136:139], v[76:79], a[240:243]
 v_mfma_f32_16x16x32_bf16 a[240:243], v[168:171], v[80:83], a[240:243]
 v_mfma_f32_16x16x32_bf16 a[244:247], v[172:175], v[80:83], a[244:247]
 v_mfma_f32_16x16x32_bf16 a[244:247], v[140:143], v[76:79], a[244:247]
 buffer_load_dwordx4 v4, s[4:7], s25 offen offset:2048  lds
 v_mfma_f32_16x16x32_bf16 a[32:35], v[144:147], v[76:79], a[32:35]
 ds_read_b64_tr_b16 v[72:73], v19 offset:8192
 v_mfma_f32_16x16x32_bf16 a[32:35], v[176:179], v[80:83], a[32:35]
 ds_read_b64_tr_b16 v[74:75], v19 offset:9216
 v_mfma_f32_16x16x32_bf16 a[36:39], v[180:183], v[80:83], a[36:39]
 v_mfma_f32_16x16x32_bf16 a[36:39], v[148:151], v[76:79], a[36:39]
 v_mfma_f32_16x16x32_bf16 a[48:51], v[152:155], v[76:79], a[48:51]
 v_mfma_f32_16x16x32_bf16 a[48:51], v[184:187], v[80:83], a[48:51]
 buffer_load_dwordx4 v5, s[4:7], s25 offen offset:3072  lds
 v_mfma_f32_16x16x32_bf16 a[52:55], v[188:191], v[80:83], a[52:55]
 v_mfma_f32_16x16x32_bf16 a[52:55], v[156:159], v[76:79], a[52:55]
 s_waitcnt lgkmcnt(8)
 v_mfma_f32_16x16x32_bf16 a[232:235], v[128:131], v[84:87], a[232:235]
 ds_read_b64_tr_b16 v[76:77], v20 offset:0
 v_mfma_f32_16x16x32_bf16 a[232:235], v[160:163], v[88:91], a[232:235]
 ds_read_b64_tr_b16 v[78:79], v20 offset:1024
 v_mfma_f32_16x16x32_bf16 a[236:239], v[164:167], v[88:91], a[236:239]
 v_mfma_f32_16x16x32_bf16 a[236:239], v[132:135], v[84:87], a[236:239]
 s_add_u32 m0, s29, 36864
 v_mfma_f32_16x16x32_bf16 a[248:251], v[136:139], v[84:87], a[248:251]
 v_mfma_f32_16x16x32_bf16 a[248:251], v[168:171], v[88:91], a[248:251]
 s_add_u32 s25, s25, 128
 v_mfma_f32_16x16x32_bf16 a[252:255], v[172:175], v[88:91], a[252:255]
 v_mfma_f32_16x16x32_bf16 a[252:255], v[140:143], v[84:87], a[252:255]
 buffer_load_dwordx4 v2, s[4:7], s26 offen offset:0  lds
 v_mfma_f32_16x16x32_bf16 a[40:43], v[144:147], v[84:87], a[40:43]
 ds_read_b64_tr_b16 v[80:81], v20 offset:8192
 v_mfma_f32_16x16x32_bf16 a[40:43], v[176:179], v[88:91], a[40:43]
 ds_read_b64_tr_b16 v[82:83], v20 offset:9216
 v_mfma_f32_16x16x32_bf16 a[44:47], v[180:183], v[88:91], a[44:47]
 v_mfma_f32_16x16x32_bf16 a[44:47], v[148:151], v[84:87], a[44:47]
 v_mfma_f32_16x16x32_bf16 a[56:59], v[152:155], v[84:87], a[56:59]
 v_mfma_f32_16x16x32_bf16 a[56:59], v[184:187], v[88:91], a[56:59]
 buffer_load_dwordx4 v3, s[4:7], s26 offen offset:1024  lds
 v_mfma_f32_16x16x32_bf16 a[60:63], v[188:191], v[88:91], a[60:63]
 v_mfma_f32_16x16x32_bf16 a[60:63], v[156:159], v[84:87], a[60:63]
 s_waitcnt lgkmcnt(8)
 v_mfma_f32_16x16x32_bf16 a[128:131], v[128:131], v[60:63], a[128:131]
 ds_read_b64_tr_b16 v[84:85], v21 offset:0
 v_mfma_f32_16x16x32_bf16 a[128:131], v[160:163], v[64:67], a[128:131]
 ds_read_b64_tr_b16 v[86:87], v21 offset:1024
 v_mfma_f32_16x16x32_bf16 a[132:135], v[164:167], v[64:67], a[132:135]
 v_mfma_f32_16x16x32_bf16 a[132:135], v[132:135], v[60:63], a[132:135]
 buffer_load_dwordx4 v4, s[4:7], s26 offen offset:2048  lds
 v_mfma_f32_16x16x32_bf16 a[144:147], v[136:139], v[60:63], a[144:147]
 v_mfma_f32_16x16x32_bf16 a[144:147], v[168:171], v[64:67], a[144:147]
 v_mfma_f32_16x16x32_bf16 a[148:151], v[172:175], v[64:67], a[148:151]
 v_mfma_f32_16x16x32_bf16 a[148:151], v[140:143], v[60:63], a[148:151]
 v_mfma_f32_16x16x32_bf16 a[64:67], v[144:147], v[60:63], a[64:67]
 ds_read_b64_tr_b16 v[88:89], v21 offset:8192
 v_mfma_f32_16x16x32_bf16 a[64:67], v[176:179], v[64:67], a[64:67]
 ds_read_b64_tr_b16 v[90:91], v21 offset:9216
 v_mfma_f32_16x16x32_bf16 a[68:71], v[180:183], v[64:67], a[68:71]
 buffer_load_dwordx4 v5, s[4:7], s26 offen offset:3072  lds
 v_mfma_f32_16x16x32_bf16 a[68:71], v[148:151], v[60:63], a[68:71]
 v_mfma_f32_16x16x32_bf16 a[80:83], v[152:155], v[60:63], a[80:83]
 v_mfma_f32_16x16x32_bf16 a[80:83], v[184:187], v[64:67], a[80:83]
 v_mfma_f32_16x16x32_bf16 a[84:87], v[188:191], v[64:67], a[84:87]
 s_add_u32 s26, s26, 128
 v_mfma_f32_16x16x32_bf16 a[84:87], v[156:159], v[60:63], a[84:87]
 s_waitcnt lgkmcnt(8)
 v_mfma_f32_16x16x32_bf16 a[136:139], v[128:131], v[68:71], a[136:139]
 v_mfma_f32_16x16x32_bf16 a[136:139], v[160:163], v[72:75], a[136:139]
 v_mfma_f32_16x16x32_bf16 a[140:143], v[164:167], v[72:75], a[140:143]
 v_mfma_f32_16x16x32_bf16 a[140:143], v[132:135], v[68:71], a[140:143]
 v_mfma_f32_16x16x32_bf16 a[152:155], v[136:139], v[68:71], a[152:155]
 v_mfma_f32_16x16x32_bf16 a[152:155], v[168:171], v[72:75], a[152:155]
 v_mfma_f32_16x16x32_bf16 a[156:159], v[172:175], v[72:75], a[156:159]
 v_mfma_f32_16x16x32_bf16 a[156:159], v[140:143], v[68:71], a[156:159]
 s_waitcnt vmcnt(8) lgkmcnt(0)
 s_barrier
 v_and_b32 v120, 0xff, v125
 v_cmp_gt_u32 vcc, s45, v120
 s_cbranch_vccnz L_spin_9
L_spun_10:
 v_mfma_f32_16x16x32_bf16 a[72:75], v[144:147], v[68:71], a[72:75]
 ds_read_b64_tr_b16 v[60:61], v14 offset:32768
 s_mov_b32 m0, 122880
 v_mfma_f32_16x16x32_bf16 a[72:75], v[176:179], v[72:75], a[72:75]
 ds_read_b64_tr_b16 v[62:63], v14 offset:33792
 s_mov_b32 s8, s46
 v_mfma_f32_16x16x32_bf16 a[76:79], v[180:183], v[72:75], a[76:79]
 ds_read_b64_tr_b16 v[64:65], v14 offset:40960
 v_mfma_f32_16x16x32_bf16 a[76:79], v[148:151], v[68:71], a[76:79]
 ds_read_b64_tr_b16 v[66:67], v14 offset:41984
 v_mfma_f32_16x16x32_bf16 a[88:91], v[152:155], v[68:71], a[88:91]
 ds_read_b128 v[192:195], v12 offset:0
 v_mfma_f32_16x16x32_bf16 a[88:91], v[184:187], v[72:75], a[88:91]
 ds_read_b128 v[224:227], v13 offset:0
 v_mfma_f32_16x16x32_bf16 a[92:95], v[188:191], v[72:75], a[92:95]
 ds_read_b128 v[196:199], v12 offset:2048
 v_mfma_f32_16x16x32_bf16 a[92:95], v[156:159], v[68:71], a[92:95]
 ds_read_b128 v[228:231], v13 offset:2048
 v_mfma_f32_16x16x32_bf16 a[160:163], v[128:131], v[76:79], a[160:163]
 ds_read_b128 v[200:203], v12 offset:4096
 v_mfma_f32_16x16x32_bf16 a[160:163], v[160:163], v[80:83], a[160:163]
 ds_read_b64_tr_b16 v[68:69], v15 offset:32768
 v_mfma_f32_16x16x32_bf16 a[164:167], v[164:167], v[80:83], a[164:167]
 ds_read_b64_tr_b16 v[70:71], v15 offset:33792
 v_mfma_f32_16x16x32_bf16 a[164:167], v[132:135], v[76:79], a[164:167]
 ds_read_b128 v[232:235], v13 offset:4096
 buffer_load_dwordx4 v1, s[12:15], 0 offen lds
 v_mfma_f32_16x16x32_bf16 a[176:179], v[136:139], v[76:79], a[176:179]
 ds_read_b128 v[204:207], v12 offset:6144
 s_mov_b32 s9, s47
 v_mfma_f32_16x16x32_bf16 a[176:179], v[168:171], v[80:83], a[176:179]
 ds_read_b128 v[236:239], v13 offset:6144
 s_lshl_b32 s22, s3, 17
 v_mfma_f32_16x16x32_bf16 a[180:183], v[172:175], v[80:83], a[180:183]
 ds_read_b128 v[208:211], v12 offset:8192
 s_lshl_b32 s27, s20, 8
 v_mfma_f32_16x16x32_bf16 a[180:183], v[140:143], v[76:79], a[180:183]
 ds_read_b128 v[240:243], v13 offset:8192
 s_add_u32 s27, s27, s22
 v_mfma_f32_16x16x32_bf16 a[96:99], v[144:147], v[76:79], a[96:99]
 ds_read_b64_tr_b16 v[72:73], v15 offset:40960
 s_lshl_b32 s30, s3, 12
 v_mfma_f32_16x16x32_bf16 a[96:99], v[176:179], v[80:83], a[96:99]
 ds_read_b64_tr_b16 v[74:75], v15 offset:41984
 s_mov_b32 s12, s38
 v_mfma_f32_16x16x32_bf16 a[100:103], v[180:183], v[80:83], a[100:103]
 ds_read_b128 v[212:215], v12 offset:10240
 s_mov_b32 s13, s39
 v_mfma_f32_16x16x32_bf16 a[100:103], v[148:151], v[76:79], a[100:103]
 ds_read_b128 v[244:247], v13 offset:10240
 s_lshl_b32 s31, s3, 11
 v_mfma_f32_16x16x32_bf16 a[112:115], v[152:155], v[76:79], a[112:115]
 ds_read_b128 v[216:219], v12 offset:12288
 s_mul_i32 s28, s3, 49152
 v_mfma_f32_16x16x32_bf16 a[112:115], v[184:187], v[80:83], a[112:115]
 ds_read_b128 v[248:251], v13 offset:12288
 s_mov_b32 s14, 0x180000
 v_mfma_f32_16x16x32_bf16 a[116:119], v[188:191], v[80:83], a[116:119]
 s_add_u32 m0, s30, 98304
 s_nop 0
 v_mfma_f32_16x16x32_bf16 a[116:119], v[156:159], v[76:79], a[116:119]
 ds_read_b128 v[220:223], v12 offset:14336
 v_mfma_f32_16x16x32_bf16 a[168:171], v[128:131], v[84:87], a[168:171]
 ds_read_b128 v[252:255], v13 offset:14336
 v_mfma_f32_16x16x32_bf16 a[168:171], v[160:163], v[88:91], a[168:171]
 ds_read_b64_tr_b16 v[76:77], v16 offset:32768
 v_mfma_f32_16x16x32_bf16 a[172:175], v[164:167], v[88:91], a[172:175]
 ds_read_b64_tr_b16 v[78:79], v16 offset:33792
 v_add_u32 v12, s96, v12
 v_mfma_f32_16x16x32_bf16 a[172:175], v[132:135], v[84:87], a[172:175]
 v_add_u32 v13, s96, v13
 v_mfma_f32_16x16x32_bf16 a[184:187], v[136:139], v[84:87], a[184:187]
 buffer_load_dwordx4 v6, s[8:11], s27 offen offset:0  lds
 v_mfma_f32_16x16x32_bf16 a[184:187], v[168:171], v[88:91], a[184:187]
 buffer_load_dwordx4 v7, s[8:11], s27 offen offset:1024  lds
 v_mfma_f32_16x16x32_bf16 a[188:191], v[172:175], v[88:91], a[188:191]
 buffer_load_dwordx4 v8, s[8:11], s27 offen offset:2048  lds
 v_mfma_f32_16x16x32_bf16 a[188:191], v[140:143], v[84:87], a[188:191]
 v_mfma_f32_16x16x32_bf16 a[104:107], v[144:147], v[84:87], a[104:107]
 ds_read_b64_tr_b16 v[80:81], v16 offset:40960
 v_mfma_f32_16x16x32_bf16 a[104:107], v[176:179], v[88:91], a[104:107]
 ds_read_b64_tr_b16 v[82:83], v16 offset:41984
 v_mfma_f32_16x16x32_bf16 a[108:111], v[180:183], v[88:91], a[108:111]
 buffer_load_dwordx4 v9, s[8:11], s27 offen offset:3072  lds
 v_mfma_f32_16x16x32_bf16 a[108:111], v[148:151], v[84:87], a[108:111]
 s_add_u32 m0, s31, 114688
 s_add_u32 s27, s27, 524288
 v_mfma_f32_16x16x32_bf16 a[120:123], v[152:155], v[84:87], a[120:123]
 buffer_load_dwordx4 v10, s[12:15], s28 offen offset:0  lds
 v_mfma_f32_16x16x32_bf16 a[120:123], v[184:187], v[88:91], a[120:123]
 v_mfma_f32_16x16x32_bf16 a[124:127], v[188:191], v[88:91], a[124:127]
 buffer_load_dwordx4 v11, s[12:15], s28 offen offset:1024  lds
 v_mfma_f32_16x16x32_bf16 a[124:127], v[156:159], v[84:87], a[124:127]
 s_waitcnt lgkmcnt(4)
 v_mfma_f32_16x16x32_bf16 a[192:195], v[192:195], v[60:63], a[192:195]
 ds_read_b64_tr_b16 v[84:85], v17 offset:32768
 s_add_u32 s28, s28, 196608
 v_mfma_f32_16x16x32_bf16 a[192:195], v[224:227], v[64:67], a[192:195]
 ds_read_b64_tr_b16 v[86:87], v17 offset:33792
 v_mfma_f32_16x16x32_bf16 a[196:199], v[228:231], v[64:67], a[196:199]
 global_load_dword v122, v127, s[0:1]
 v_mfma_f32_16x16x32_bf16 a[196:199], v[196:199], v[60:63], a[196:199]
 v_mfma_f32_16x16x32_bf16 a[208:211], v[200:203], v[60:63], a[208:211]
 s_add_u32 m0, s29, 65536
 v_mfma_f32_16x16x32_bf16 a[208:211], v[232:235], v[64:67], a[208:211]
 s_nop 0
 v_mfma_f32_16x16x32_bf16 a[212:215], v[236:239], v[64:67], a[212:215]
 buffer_load_dwordx4 v2, s[4:7], s25 offen offset:0  lds
 v_mfma_f32_16x16x32_bf16 a[212:215], v[204:207], v[60:63], a[212:215]
 v_mfma_f32_16x16x32_bf16 a[0:3], v[208:211], v[60:63], a[0:3]
 ds_read_b64_tr_b16 v[88:89], v17 offset:40960
 v_mfma_f32_16x16x32_bf16 a[0:3], v[240:243], v[64:67], a[0:3]
 ds_read_b64_tr_b16 v[90:91], v17 offset:41984
 v_mfma_f32_16x16x32_bf16 a[4:7], v[244:247], v[64:67], a[4:7]
 v_mfma_f32_16x16x32_bf16 a[4:7], v[212:215], v[60:63], a[4:7]
 v_mfma_f32_16x16x32_bf16 a[16:19], v[216:219], v[60:63], a[16:19]
 buffer_load_dwordx4 v3, s[4:7], s25 offen offset:1024  lds
 v_mfma_f32_16x16x32_bf16 a[16:19], v[248:251], v[64:67], a[16:19]
 v_mfma_f32_16x16x32_bf16 a[20:23], v[252:255], v[64:67], a[20:23]
 v_mfma_f32_16x16x32_bf16 a[20:23], v[220:223], v[60:63], a[20:23]
 v_mfma_f32_16x16x32_bf16 a[200:203], v[192:195], v[68:71], a[200:203]
 ds_read_b64_tr_b16 v[60:61], v18 offset:32768
 v_mfma_f32_16x16x32_bf16 a[200:203], v[224:227], v[72:75], a[200:203]
 ds_read_b64_tr_b16 v[62:63], v18 offset:33792
 v_mfma_f32_16x16x32_bf16 a[204:207], v[228:231], v[72:75], a[204:207]
 buffer_load_dwordx4 v4, s[4:7], s25 offen offset:2048  lds
 v_mfma_f32_16x16x32_bf16 a[204:207], v[196:199], v[68:71], a[204:207]
 v_mfma_f32_16x16x32_bf16 a[216:219], v[200:203], v[68:71], a[216:219]
 v_mfma_f32_16x16x32_bf16 a[216:219], v[232:235], v[72:75], a[216:219]
 buffer_load_dwordx4 v5, s[4:7], s25 offen offset:3072  lds
 v_mfma_f32_16x16x32_bf16 a[220:223], v[236:239], v[72:75], a[220:223]
 v_mfma_f32_16x16x32_bf16 a[220:223], v[204:207], v[68:71], a[220:223]
 v_mfma_f32_16x16x32_bf16 a[8:11], v[208:211], v[68:71], a[8:11]
 ds_read_b64_tr_b16 v[64:65], v18 offset:40960
 v_mfma_f32_16x16x32_bf16 a[8:11], v[240:243], v[72:75], a[8:11]
 ds_read_b64_tr_b16 v[66:67], v18 offset:41984
 v_mfma_f32_16x16x32_bf16 a[12:15], v[244:247], v[72:75], a[12:15]
 s_add_u32 m0, s29, 69632
 v_mfma_f32_16x16x32_bf16 a[12:15], v[212:215], v[68:71], a[12:15]
 v_mfma_f32_16x16x32_bf16 a[24:27], v[216:219], v[68:71], a[24:27]
 s_add_u32 s25, s25, 128
 v_mfma_f32_16x16x32_bf16 a[24:27], v[248:251], v[72:75], a[24:27]
 buffer_load_dwordx4 v2, s[4:7], s26 offen offset:0  lds
 v_mfma_f32_16x16x32_bf16 a[28:31], v[252:255], v[72:75], a[28:31]
 v_mfma_f32_16x16x32_bf16 a[28:31], v[220:223], v[68:71], a[28:31]
 s_waitcnt lgkmcnt(8)
 v_mfma_f32_16x16x32_bf16 a[224:227], v[192:195], v[76:79], a[224:227]
 ds_read_b64_tr_b16 v[68:69], v19 offset:32768
 v_mfma_f32_16x16x32_bf16 a[224:227], v[224:227], v[80:83], a[224:227]
 ds_read_b64_tr_b16 v[70:71], v19 offset:33792
 v_mfma_f32_16x16x32_bf16 a[228:231], v[228:231], v[80:83], a[228:231]
 v_mfma_f32_16x16x32_bf16 a[228:231], v[196:199], v[76:79], a[228:231]
 buffer_load_dwordx4 v3, s[4:7], s26 offen offset:1024  lds
 v_mfma_f32_16x16x32_bf16 a[240:243], v[200:203], v[76:79], a[240:243]
 v_mfma_f32_16x16x32_bf16 a[240:243], v[232:235], v[80:83], a[240:243]
 v_mfma_f32_16x16x32_bf16 a[244:247], v[236:239], v[80:83], a[244:247]
 v_accvgpr_read_b32 v96, a192
 v_accvgpr_read_b32 v97, a193
 v_mfma_f32_16x16x32_bf16 a[244:247], v[204:207], v[76:79], a[244:247]
 buffer_load_dwordx4 v4, s[4:7], s26 offen offset:2048  lds
 v_mfma_f32_16x16x32_bf16 a[32:35], v[208:211], v[76:79], a[32:35]
 ds_read_b64_tr_b16 v[72:73], v19 offset:40960
 v_accvgpr_read_b32 v98, a194
 v_mfma_f32_16x16x32_bf16 a[32:35], v[240:243], v[80:83], a[32:35]
 ds_read_b64_tr_b16 v[74:75], v19 offset:41984
 v_accvgpr_read_b32 v99, a195
 v_mfma_f32_16x16x32_bf16 a[36:39], v[244:247], v[80:83], a[36:39]
 v_accvgpr_read_b32 v100, a196
 v_accvgpr_read_b32 v101, a197
 v_mfma_f32_16x16x32_bf16 a[36:39], v[212:215], v[76:79], a[36:39]
 v_accvgpr_read_b32 v102, a198
 v_accvgpr_read_b32 v103, a199
 v_mfma_f32_16x16x32_bf16 a[48:51], v[216:219], v[76:79], a[48:51]
 buffer_load_dwordx4 v5, s[4:7], s26 offen offset:3072  lds
 v_mfma_f32_16x16x32_bf16 a[48:51], v[248:251], v[80:83], a[48:51]
 v_cvt_pk_bf16_f32 v104, v96, v97
 v_cvt_pk_bf16_f32 v105, v98, v99
 v_mfma_f32_16x16x32_bf16 a[52:55], v[252:255], v[80:83], a[52:55]
 v_cvt_pk_bf16_f32 v106, v100, v101
 v_cvt_pk_bf16_f32 v107, v102, v103
 v_mfma_f32_16x16x32_bf16 a[52:55], v[220:223], v[76:79], a[52:55]
 s_waitcnt lgkmcnt(8)
 v_mfma_f32_16x16x32_bf16 a[232:235], v[192:195], v[84:87], a[232:235]
 ds_read_b64_tr_b16 v[76:77], v20 offset:32768
 v_mfma_f32_16x16x32_bf16 a[232:235], v[224:227], v[88:91], a[232:235]
 ds_read_b64_tr_b16 v[78:79], v20 offset:33792
 s_add_u32 s26, s26, 128
 v_mfma_f32_16x16x32_bf16 a[236:239], v[228:231], v[88:91], a[236:239]
 buffer_store_dwordx4 v[104:107], v1, s[16:19], s33 offen offset:0
 v_mfma_f32_16x16x32_bf16 a[236:239], v[196:199], v[84:87], a[236:239]
 v_cmp_ne_u32 vcc, s63, v125
 v_accvgpr_read_b32 v96, a200
 v_mfma_f32_16x16x32_bf16 a[248:251], v[200:203], v[84:87], a[248:251]
 v_mov_b32 v120, 1
 v_accvgpr_read_b32 v97, a201
 v_mfma_f32_16x16x32_bf16 a[248:251], v[232:235], v[88:91], a[248:251]
 v_accvgpr_read_b32 v98, a202
 v_accvgpr_read_b32 v99, a203
 v_mfma_f32_16x16x32_bf16 a[252:255], v[236:239], v[88:91], a[252:255]
 s_nop 0
 v_accvgpr_read_b32 v100, a204
 v_accvgpr_read_b32 v101, a205
 v_mfma_f32_16x16x32_bf16 a[252:255], v[204:207], v[84:87], a[252:255]
 s_lshr_b32 s22, vcc_lo, s99
 v_accvgpr_read_b32 v102, a206
 v_accvgpr_read_b32 v103, a207
 v_mfma_f32_16x16x32_bf16 a[40:43], v[208:211], v[84:87], a[40:43]
 ds_read_b64_tr_b16 v[80:81], v20 offset:40960
 v_cvt_pk_bf16_f32 v108, v96, v97
 v_mfma_f32_16x16x32_bf16 a[40:43], v[240:243], v[88:91], a[40:43]
 ds_read_b64_tr_b16 v[82:83], v20 offset:41984
 v_cvt_pk_bf16_f32 v109, v98, v99
 v_mfma_f32_16x16x32_bf16 a[44:47], v[244:247], v[88:91], a[44:47]
 s_and_b32 s22, s22, 15
 v_cvt_pk_bf16_f32 v110, v100, v101
 v_cvt_pk_bf16_f32 v111, v102, v103
 v_mfma_f32_16x16x32_bf16 a[44:47], v[212:215], v[84:87], a[44:47]
 s_cmp_eq_u32 s22, 0
 s_cselect_b32 s63, 1, s3
 v_mfma_f32_16x16x32_bf16 a[56:59], v[216:219], v[84:87], a[56:59]
 buffer_store_dwordx4 v[108:111], v1, s[16:19], s33 offen offset:1024
 v_mfma_f32_16x16x32_bf16 a[56:59], v[248:251], v[88:91], a[56:59]
 v_mfma_f32_16x16x32_bf16 a[60:63], v[252:255], v[88:91], a[60:63]
 s_cmp_eq_u32 s3, 0
 s_cselect_b32 s46, 1, 0
 s_cselect_b32 s47, 2, 0
 v_mfma_f32_16x16x32_bf16 a[60:63], v[220:223], v[84:87], a[60:63]
 s_waitcnt lgkmcnt(8)
 v_accvgpr_read_b32 v96, a208
 v_accvgpr_read_b32 v97, a209
 v_mfma_f32_16x16x32_bf16 a[128:131], v[192:195], v[60:63], a[128:131]
 ds_read_b64_tr_b16 v[84:85], v21 offset:32768
 v_accvgpr_read_b32 v98, a210
 v_mfma_f32_16x16x32_bf16 a[128:131], v[224:227], v[64:67], a[128:131]
 ds_read_b64_tr_b16 v[86:87], v21 offset:33792
 v_accvgpr_read_b32 v99, a211
 v_mfma_f32_16x16x32_bf16 a[132:135], v[228:231], v[64:67], a[132:135]
 v_accvgpr_read_b32 v100, a212
 v_accvgpr_read_b32 v101, a213
 v_mfma_f32_16x16x32_bf16 a[132:135], v[196:199], v[60:63], a[132:135]
 s_lshl_b32 s50, s3, 12
 v_accvgpr_read_b32 v102, a214
 v_accvgpr_read_b32 v103, a215
 v_mfma_f32_16x16x32_bf16 a[144:147], v[200:203], v[60:63], a[144:147]
 v_cvt_pk_bf16_f32 v112, v96, v97
 v_cvt_pk_bf16_f32 v113, v98, v99
 v_mfma_f32_16x16x32_bf16 a[144:147], v[232:235], v[64:67], a[144:147]
 s_lshl_b32 s51, s3, 13
 v_cvt_pk_bf16_f32 v114, v100, v101
 v_cvt_pk_bf16_f32 v115, v102, v103
 v_mfma_f32_16x16x32_bf16 a[148:151], v[236:239], v[64:67], a[148:151]
 s_lshl_b32 s22, s20, 19
 v_mfma_f32_16x16x32_bf16 a[148:151], v[204:207], v[60:63], a[148:151]
 s_lshl_b32 s57, s21, 15
 v_mfma_f32_16x16x32_bf16 a[64:67], v[208:211], v[60:63], a[64:67]
 ds_read_b64_tr_b16 v[88:89], v21 offset:40960
 v_mfma_f32_16x16x32_bf16 a[64:67], v[240:243], v[64:67], a[64:67]
 ds_read_b64_tr_b16 v[90:91], v21 offset:41984
 v_mfma_f32_16x16x32_bf16 a[68:71], v[244:247], v[64:67], a[68:71]
 buffer_store_dwordx4 v[112:115], v1, s[16:19], s98 offen offset:0
 s_add_u32 s22, s22, s57
 v_mfma_f32_16x16x32_bf16 a[68:71], v[212:215], v[60:63], a[68:71]
 s_add_u32 s48, s22, 0x1600000
 v_accvgpr_read_b32 v96, a216
 v_accvgpr_read_b32 v97, a217
 v_mfma_f32_16x16x32_bf16 a[80:83], v[216:219], v[60:63], a[80:83]
 v_accvgpr_read_b32 v98, a218
 v_accvgpr_read_b32 v99, a219
 v_mfma_f32_16x16x32_bf16 a[80:83], v[248:251], v[64:67], a[80:83]
 s_add_u32 s49, s22, 0x2600000
 v_accvgpr_read_b32 v100, a220
 v_accvgpr_read_b32 v101, a221
 v_mfma_f32_16x16x32_bf16 a[84:87], v[252:255], v[64:67], a[84:87]
 s_mov_b32 s54, 0x57800000
 v_accvgpr_read_b32 v102, a222
 v_accvgpr_read_b32 v103, a223
 v_mfma_f32_16x16x32_bf16 a[84:87], v[220:223], v[60:63], a[84:87]
 s_waitcnt lgkmcnt(8)
 v_cvt_pk_bf16_f32 v116, v96, v97
 v_cvt_pk_bf16_f32 v117, v98, v99
 v_mfma_f32_16x16x32_bf16 a[136:139], v[192:195], v[68:71], a[136:139]
 v_cvt_pk_bf16_f32 v118, v100, v101
 v_cvt_pk_bf16_f32 v119, v102, v103
 v_mfma_f32_16x16x32_bf16 a[136:139], v[224:227], v[72:75], a[136:139]
 buffer_store_dwordx4 v[116:119], v1, s[16:19], s98 offen offset:1024
 v_mfma_f32_16x16x32_bf16 a[140:143], v[228:231], v[72:75], a[140:143]
 v_mfma_f32_16x16x32_bf16 a[140:143], v[196:199], v[68:71], a[140:143]
 v_accvgpr_read_b32 v96, a224
 v_accvgpr_read_b32 v97, a225
 v_mfma_f32_16x16x32_bf16 a[152:155], v[200:203], v[68:71], a[152:155]
 v_accvgpr_read_b32 v98, a226
 v_accvgpr_read_b32 v99, a227
 v_mfma_f32_16x16x32_bf16 a[152:155], v[232:235], v[72:75], a[152:155]
 v_accvgpr_read_b32 v100, a228
 v_accvgpr_read_b32 v101, a229
 v_mfma_f32_16x16x32_bf16 a[156:159], v[236:239], v[72:75], a[156:159]
 v_accvgpr_read_b32 v102, a230
 v_accvgpr_read_b32 v103, a231
 v_mfma_f32_16x16x32_bf16 a[156:159], v[204:207], v[68:71], a[156:159]
 v_cvt_pk_bf16_f32 v104, v96, v97
 v_cvt_pk_bf16_f32 v105, v98, v99
 s_waitcnt vmcnt(13) lgkmcnt(0)
 s_barrier
 v_mfma_f32_16x16x32_bf16 a[72:75], v[208:211], v[68:71], a[72:75]
 v_subrev_u32 v14, s97, v14
 v_subrev_u32 v15, s97, v15
 v_mfma_f32_16x16x32_bf16 a[72:75], v[240:243], v[72:75], a[72:75]
 v_subrev_u32 v16, s97, v16
 v_subrev_u32 v17, s97, v17
 v_mfma_f32_16x16x32_bf16 a[76:79], v[244:247], v[72:75], a[76:79]
 v_subrev_u32 v18, s97, v18
 v_subrev_u32 v19, s97, v19
 v_mfma_f32_16x16x32_bf16 a[76:79], v[212:215], v[68:71], a[76:79]
 v_subrev_u32 v20, s97, v20
 v_subrev_u32 v21, s97, v21
 v_mfma_f32_16x16x32_bf16 a[88:91], v[216:219], v[68:71], a[88:91]
 ds_read_b64_tr_b16 v[60:61], v14 offset:0
 s_add_u32 m0, s30, 131072
 v_mfma_f32_16x16x32_bf16 a[88:91], v[248:251], v[72:75], a[88:91]
 ds_read_b64_tr_b16 v[62:63], v14 offset:1024
 s_nop 0
 v_mfma_f32_16x16x32_bf16 a[92:95], v[252:255], v[72:75], a[92:95]
 ds_read_b64_tr_b16 v[64:65], v14 offset:8192
 v_cvt_pk_bf16_f32 v106, v100, v101
 v_cvt_pk_bf16_f32 v107, v102, v103
 v_mfma_f32_16x16x32_bf16 a[92:95], v[220:223], v[68:71], a[92:95]
 ds_read_b64_tr_b16 v[66:67], v14 offset:9216
 v_mfma_f32_16x16x32_bf16 a[160:163], v[192:195], v[76:79], a[160:163]
 ds_read_b64_tr_b16 v[68:69], v15 offset:0
 buffer_store_dwordx4 v[104:107], v1, s[16:19], s33 offen offset:2048
 v_mfma_f32_16x16x32_bf16 a[160:163], v[224:227], v[80:83], a[160:163]
 ds_read_b64_tr_b16 v[70:71], v15 offset:1024
 v_accvgpr_read_b32 v96, a232
 v_mfma_f32_16x16x32_bf16 a[164:167], v[228:231], v[80:83], a[164:167]
 ds_read_b128 v[28:31], v12 offset:0
 v_accvgpr_read_b32 v97, a233
 v_mfma_f32_16x16x32_bf16 a[164:167], v[196:199], v[76:79], a[164:167]
 ds_read_b128 v[44:47], v13 offset:0
 v_accvgpr_read_b32 v98, a234
 v_mfma_f32_16x16x32_bf16 a[176:179], v[200:203], v[76:79], a[176:179]
 buffer_load_dwordx4 v6, s[8:11], s27 offen offset:0  lds
 v_mfma_f32_16x16x32_bf16 a[176:179], v[232:235], v[80:83], a[176:179]
 ds_read_b128 v[32:35], v12 offset:2048
 v_accvgpr_read_b32 v99, a235
 v_mfma_f32_16x16x32_bf16 a[180:183], v[236:239], v[80:83], a[180:183]
 ds_read_b128 v[48:51], v13 offset:2048
 v_accvgpr_read_b32 v100, a236
 v_mfma_f32_16x16x32_bf16 a[180:183], v[204:207], v[76:79], a[180:183]
 buffer_load_dwordx4 v7, s[8:11], s27 offen offset:1024  lds
 v_mfma_f32_16x16x32_bf16 a[96:99], v[208:211], v[76:79], a[96:99]
 ds_read_b128 v[36:39], v12 offset:4096
 v_accvgpr_read_b32 v101, a237
 v_mfma_f32_16x16x32_bf16 a[96:99], v[240:243], v[80:83], a[96:99]
 ds_read_b64_tr_b16 v[72:73], v15 offset:8192
 v_accvgpr_read_b32 v102, a238
 v_mfma_f32_16x16x32_bf16 a[100:103], v[244:247], v[80:83], a[100:103]
 ds_read_b64_tr_b16 v[74:75], v15 offset:9216
 v_accvgpr_read_b32 v103, a239
 v_cvt_pk_bf16_f32 v108, v96, v97
 v_mfma_f32_16x16x32_bf16 a[100:103], v[212:215], v[76:79], a[100:103]
 ds_read_b128 v[52:55], v13 offset:4096
 v_cvt_pk_bf16_f32 v109, v98, v99
 v_cvt_pk_bf16_f32 v110, v100, v101
 v_mfma_f32_16x16x32_bf16 a[112:115], v[216:219], v[76:79], a[112:115]
 ds_read_b128 v[40:43], v12 offset:6144
 v_cvt_pk_bf16_f32 v111, v102, v103
 buffer_store_dwordx4 v[108:111], v1, s[16:19], s33 offen offset:3072
 v_mfma_f32_16x16x32_bf16 a[112:115], v[248:251], v[80:83], a[112:115]
 ds_read_b128 v[56:59], v13 offset:6144
 v_accvgpr_read_b32 v96, a240
 v_mfma_f32_16x16x32_bf16 a[116:119], v[252:255], v[80:83], a[116:119]
 buffer_load_dwordx4 v8, s[8:11], s27 offen offset:2048  lds
 v_add_u32 v12, 0x8000, v12
 v_mfma_f32_16x16x32_bf16 a[116:119], v[220:223], v[76:79], a[116:119]
 v_add_u32 v13, 0x8000, v13
 v_mfma_f32_16x16x32_bf16 a[168:171], v[192:195], v[84:87], a[168:171]
 ds_read_b64_tr_b16 v[76:77], v16 offset:0
 v_accvgpr_read_b32 v97, a241
 v_mfma_f32_16x16x32_bf16 a[168:171], v[224:227], v[88:91], a[168:171]
 ds_read_b64_tr_b16 v[78:79], v16 offset:1024
 v_accvgpr_read_b32 v98, a242
 v_mfma_f32_16x16x32_bf16 a[172:175], v[228:231], v[88:91], a[172:175]
 buffer_load_dwordx4 v9, s[8:11], s27 offen offset:3072  lds
 v_mfma_f32_16x16x32_bf16 a[172:175], v[196:199], v[84:87], a[172:175]
 s_add_u32 m0, s31, 147456
 s_add_u32 s27, s27, 524288
 v_accvgpr_read_b32 v99, a243
 v_mfma_f32_16x16x32_bf16 a[184:187], v[200:203], v[84:87], a[184:187]
 buffer_load_dwordx4 v10, s[12:15], s28 offen offset:0  lds
 v_mfma_f32_16x16x32_bf16 a[184:187], v[232:235], v[88:91], a[184:187]
 buffer_load_dwordx4 v11, s[12:15], s28 offen offset:1024  lds
 v_mfma_f32_16x16x32_bf16 a[188:191], v[236:239], v[88:91], a[188:191]
 s_add_u32 s28, s28, 196608
 v_accvgpr_read_b32 v100, a244
 v_accvgpr_read_b32 v101, a245
 v_mfma_f32_16x16x32_bf16 a[188:191], v[204:207], v[84:87], a[188:191]
 v_accvgpr_read_b32 v102, a246
 v_accvgpr_read_b32 v103, a247
 v_mfma_f32_16x16x32_bf16 a[104:107], v[208:211], v[84:87], a[104:107]
 ds_read_b64_tr_b16 v[80:81], v16 offset:8192
 v_cvt_pk_bf16_f32 v112, v96, v97
 v_cvt_pk_bf16_f32 v113, v98, v99
 v_mfma_f32_16x16x32_bf16 a[104:107], v[240:243], v[88:91], a[104:107]
 ds_read_b64_tr_b16 v[82:83], v16 offset:9216
 v_cvt_pk_bf16_f32 v114, v100, v101
 v_cvt_pk_bf16_f32 v115, v102, v103
 v_mfma_f32_16x16x32_bf16 a[108:111], v[244:247], v[88:91], a[108:111]
 buffer_store_dwordx4 v[112:115], v1, s[16:19], s98 offen offset:2048
 v_mfma_f32_16x16x32_bf16 a[108:111], v[212:215], v[84:87], a[108:111]
 v_accvgpr_read_b32 v96, a248
 v_accvgpr_read_b32 v97, a249
 v_mfma_f32_16x16x32_bf16 a[120:123], v[216:219], v[84:87], a[120:123]
 v_accvgpr_read_b32 v98, a250
 v_accvgpr_read_b32 v99, a251
 v_mfma_f32_16x16x32_bf16 a[120:123], v[248:251], v[88:91], a[120:123]
 v_accvgpr_read_b32 v100, a252
 v_accvgpr_read_b32 v101, a253
 v_accvgpr_read_b32 v102, a254
 v_accvgpr_read_b32 v103, a255
 v_mfma_f32_16x16x32_bf16 a[124:127], v[252:255], v[88:91], a[124:127]
 v_cvt_pk_bf16_f32 v116, v96, v97
 v_cvt_pk_bf16_f32 v117, v98, v99
 v_cvt_pk_bf16_f32 v118, v100, v101
 v_mfma_f32_16x16x32_bf16 a[124:127], v[220:223], v[84:87], a[124:127]
 v_cvt_pk_bf16_f32 v119, v102, v103
 buffer_store_dwordx4 v[116:119], v1, s[16:19], s98 offen offset:3072
 s_add_u32 s33, s33, 4096
 s_add_u32 s98, s98, 4096
L_qphase_6:
 s_waitcnt lgkmcnt(4)
 v_mfma_f32_16x16x32_bf16 v[128:131], v[60:63], v[28:31], 0
 ds_read_b64_tr_b16 v[84:85], v17 offset:0
 s_add_u32 m0, s29, 0
 v_mfma_f32_16x16x32_bf16 v[128:131], v[64:67], v[44:47], v[128:131]
 ds_read_b64_tr_b16 v[86:87], v17 offset:1024
 v_mfma_f32_16x16x32_bf16 v[136:139], v[60:63], v[32:35], 0
 s_nop 0
 v_mfma_f32_16x16x32_bf16 v[136:139], v[64:67], v[48:51], v[136:139]
 v_mfma_f32_16x16x32_bf16 v[192:195], v[60:63], v[36:39], 0
 ds_read_b64_tr_b16 v[88:89], v17 offset:8192
 v_accvgpr_read_b32 v96, a128
 v_mfma_f32_16x16x32_bf16 v[192:195], v[64:67], v[52:55], v[192:195]
 ds_read_b64_tr_b16 v[90:91], v17 offset:9216
 v_accvgpr_read_b32 v97, a129
 v_mfma_f32_16x16x32_bf16 v[200:203], v[60:63], v[40:43], 0
 buffer_load_dwordx4 v2, s[4:7], s25 offen offset:0  lds
 v_mfma_f32_16x16x32_bf16 v[200:203], v[64:67], v[56:59], v[200:203]
 v_accvgpr_read_b32 v98, a130
 v_accvgpr_read_b32 v99, a131
 v_mfma_f32_16x16x32_bf16 v[132:135], v[68:71], v[28:31], 0
 ds_read_b64_tr_b16 v[60:61], v18 offset:0
 v_accvgpr_read_b32 v100, a132
 v_mfma_f32_16x16x32_bf16 v[132:135], v[72:75], v[44:47], v[132:135]
 ds_read_b64_tr_b16 v[62:63], v18 offset:1024
 v_accvgpr_read_b32 v101, a133
 v_mfma_f32_16x16x32_bf16 v[140:143], v[68:71], v[32:35], 0
 buffer_load_dwordx4 v3, s[4:7], s25 offen offset:1024  lds
 v_mfma_f32_16x16x32_bf16 v[140:143], v[72:75], v[48:51], v[140:143]
 v_accvgpr_read_b32 v102, a134
 v_accvgpr_read_b32 v103, a135
 v_mfma_f32_16x16x32_bf16 v[196:199], v[68:71], v[36:39], 0
 ds_read_b64_tr_b16 v[64:65], v18 offset:8192
 v_cvt_pk_bf16_f32 v104, v96, v97
 v_mfma_f32_16x16x32_bf16 v[196:199], v[72:75], v[52:55], v[196:199]
 ds_read_b64_tr_b16 v[66:67], v18 offset:9216
 v_cvt_pk_bf16_f32 v105, v98, v99
 v_mfma_f32_16x16x32_bf16 v[204:207], v[68:71], v[40:43], 0
 v_cvt_pk_bf16_f32 v106, v100, v101
 v_cvt_pk_bf16_f32 v107, v102, v103
 v_mfma_f32_16x16x32_bf16 v[204:207], v[72:75], v[56:59], v[204:207]
 s_waitcnt lgkmcnt(8)
 v_mfma_f32_16x16x32_bf16 v[144:147], v[76:79], v[28:31], 0
 ds_read_b64_tr_b16 v[68:69], v19 offset:0
 v_mfma_f32_16x16x32_bf16 v[144:147], v[80:83], v[44:47], v[144:147]
 ds_read_b64_tr_b16 v[70:71], v19 offset:1024
 v_mfma_f32_16x16x32_bf16 v[152:155], v[76:79], v[32:35], 0
 buffer_load_dwordx4 v4, s[4:7], s25 offen offset:2048  lds
 v_mfma_f32_16x16x32_bf16 v[152:155], v[80:83], v[48:51], v[152:155]
 buffer_store_dwordx4 v[104:107], v1, s[16:19], s33 offen offset:0
 v_mfma_f32_16x16x32_bf16 v[208:211], v[76:79], v[36:39], 0
 ds_read_b64_tr_b16 v[72:73], v19 offset:8192
 v_mfma_f32_16x16x32_bf16 v[208:211], v[80:83], v[52:55], v[208:211]
 ds_read_b64_tr_b16 v[74:75], v19 offset:9216
 v_accvgpr_read_b32 v96, a136
 v_mfma_f32_16x16x32_bf16 v[216:219], v[76:79], v[40:43], 0
 buffer_load_dwordx4 v5, s[4:7], s25 offen offset:3072  lds
 v_mfma_f32_16x16x32_bf16 v[216:219], v[80:83], v[56:59], v[216:219]
 s_waitcnt lgkmcnt(8)
 v_accvgpr_read_b32 v97, a137
 v_accvgpr_read_b32 v98, a138
 v_mfma_f32_16x16x32_bf16 v[148:151], v[84:87], v[28:31], 0
 ds_read_b128 v[76:79], v25 offset:0
 v_accvgpr_read_b32 v99, a139
 v_mfma_f32_16x16x32_bf16 v[148:151], v[88:91], v[44:47], v[148:151]
 ds_read_b128 v[92:95], v26
 v_add_u32 v26, 0x8000, v26
 v_mfma_f32_16x16x32_bf16 v[156:159], v[84:87], v[32:35], 0
 v_accvgpr_read_b32 v100, a140
 v_accvgpr_read_b32 v101, a141
 v_mfma_f32_16x16x32_bf16 v[156:159], v[88:91], v[48:51], v[156:159]
 v_accvgpr_read_b32 v102, a142
 v_accvgpr_read_b32 v103, a143
 v_mfma_f32_16x16x32_bf16 v[212:215], v[84:87], v[36:39], 0
 ds_read_b128 v[80:83], v25 offset:64
 v_cvt_pk_bf16_f32 v108, v96, v97
 v_mfma_f32_16x16x32_bf16 v[212:215], v[88:91], v[52:55], v[212:215]
 ds_read_b128 a[244:247], v27
 v_add_u32 v27, 0x8000, v27
 v_mfma_f32_16x16x32_bf16 v[220:223], v[84:87], v[40:43], 0
 s_add_u32 m0, s29, 4096
 v_cvt_pk_bf16_f32 v109, v98, v99
 v_cvt_pk_bf16_f32 v110, v100, v101
 v_mfma_f32_16x16x32_bf16 v[220:223], v[88:91], v[56:59], v[220:223]
 s_waitcnt lgkmcnt(8)
 v_cvt_pk_bf16_f32 v111, v102, v103
 v_mfma_f32_16x16x32_bf16 v[160:163], v[60:63], v[28:31], 0
 ds_read_b64_tr_b16 v[84:85], v20 offset:0
 s_add_u32 s25, s25, 128
 v_mfma_f32_16x16x32_bf16 v[160:163], v[64:67], v[44:47], v[160:163]
 ds_read_b64_tr_b16 v[86:87], v20 offset:1024
 v_mfma_f32_16x16x32_bf16 v[168:171], v[60:63], v[32:35], 0
 buffer_load_dwordx4 v2, s[4:7], s26 offen offset:0  lds
 v_mfma_f32_16x16x32_bf16 v[168:171], v[64:67], v[48:51], v[168:171]
 buffer_store_dwordx4 v[108:111], v1, s[16:19], s33 offen offset:1024
 v_mfma_f32_16x16x32_bf16 v[224:227], v[60:63], v[36:39], 0
 ds_read_b64_tr_b16 v[88:89], v20 offset:8192
 v_mfma_f32_16x16x32_bf16 v[224:227], v[64:67], v[52:55], v[224:227]
 ds_read_b64_tr_b16 v[90:91], v20 offset:9216
 v_mfma_f32_16x16x32_bf16 v[232:235], v[60:63], v[40:43], 0
 v_accvgpr_read_b32 v96, a144
 v_mfma_f32_16x16x32_bf16 v[232:235], v[64:67], v[56:59], v[232:235]
 s_waitcnt lgkmcnt(8)
 v_accvgpr_read_b32 v97, a145
 v_accvgpr_read_b32 v98, a146
 v_mfma_f32_16x16x32_bf16 v[164:167], v[68:71], v[28:31], 0
 ds_read_b64_tr_b16 v[60:61], v21 offset:0
 v_accvgpr_read_b32 v99, a147
 v_mfma_f32_16x16x32_bf16 v[164:167], v[72:75], v[44:47], v[164:167]
 ds_read_b64_tr_b16 v[62:63], v21 offset:1024
 v_accvgpr_read_b32 v100, a148
 v_mfma_f32_16x16x32_bf16 v[172:175], v[68:71], v[32:35], 0
 buffer_load_dwordx4 v3, s[4:7], s26 offen offset:1024  lds
 v_mfma_f32_16x16x32_bf16 v[172:175], v[72:75], v[48:51], v[172:175]
 v_accvgpr_read_b32 v101, a149
 v_accvgpr_read_b32 v102, a150
 v_mfma_f32_16x16x32_bf16 v[228:231], v[68:71], v[36:39], 0
 ds_read_b64_tr_b16 v[64:65], v21 offset:8192
 v_accvgpr_read_b32 v103, a151
 v_mfma_f32_16x16x32_bf16 v[228:231], v[72:75], v[52:55], v[228:231]
 ds_read_b64_tr_b16 v[66:67], v21 offset:9216
 v_cvt_pk_bf16_f32 v112, v96, v97
 v_mfma_f32_16x16x32_bf16 v[236:239], v[68:71], v[40:43], 0
 buffer_load_dwordx4 v4, s[4:7], s26 offen offset:2048  lds
 v_mfma_f32_16x16x32_bf16 v[236:239], v[72:75], v[56:59], v[236:239]
 s_waitcnt lgkmcnt(8)
 v_cvt_pk_bf16_f32 v113, v98, v99
 v_cvt_pk_bf16_f32 v114, v100, v101
 v_mfma_f32_16x16x32_bf16 a[240:243], v[76:79], v[92:95], 0
 ds_read_b64_tr_b16 v[68:69], v22 offset:0
 v_cvt_pk_bf16_f32 v115, v102, v103
 v_mfma_f32_16x16x32_bf16 a[240:243], v[80:83], a[244:247], a[240:243]
 ds_read_b64_tr_b16 v[70:71], v22 offset:512
 s_waitcnt lgkmcnt(6)
 v_mfma_f32_16x16x32_bf16 v[176:179], v[84:87], v[28:31], 0
 ds_read_b64_tr_b16 v[72:73], v22 offset:4096
 v_mfma_f32_16x16x32_bf16 v[176:179], v[88:91], v[44:47], v[176:179]
 ds_read_b64_tr_b16 v[74:75], v22 offset:4608
 v_mfma_f32_16x16x32_bf16 v[184:187], v[84:87], v[32:35], 0
 ds_read_b64_tr_b16 v[76:77], v23 offset:0
 v_mfma_f32_16x16x32_bf16 v[184:187], v[88:91], v[48:51], v[184:187]
 ds_read_b64_tr_b16 v[78:79], v23 offset:512
 v_mfma_f32_16x16x32_bf16 v[240:243], v[84:87], v[36:39], 0
 ds_read_b64_tr_b16 v[80:81], v23 offset:4096
 v_mfma_f32_16x16x32_bf16 v[240:243], v[88:91], v[52:55], v[240:243]
 ds_read_b64_tr_b16 v[82:83], v23 offset:4608
 v_mfma_f32_16x16x32_bf16 v[248:251], v[84:87], v[40:43], 0
 buffer_load_dwordx4 v5, s[4:7], s26 offen offset:3072  lds
 v_mfma_f32_16x16x32_bf16 v[248:251], v[88:91], v[56:59], v[248:251]
 buffer_store_dwordx4 v[112:115], v1, s[16:19], s98 offen offset:0
 s_waitcnt lgkmcnt(8)
 v_mfma_f32_16x16x32_bf16 v[180:183], v[60:63], v[28:31], 0
 ds_read_b64_tr_b16 v[84:85], v24 offset:0
 v_accvgpr_read_b32 v96, a152
 v_mfma_f32_16x16x32_bf16 v[180:183], v[64:67], v[44:47], v[180:183]
 ds_read_b64_tr_b16 v[86:87], v24 offset:512
 v_accvgpr_read_b32 v97, a153
 v_mfma_f32_16x16x32_bf16 v[188:191], v[60:63], v[32:35], 0
 v_accvgpr_read_b32 v98, a154
 v_accvgpr_read_b32 v99, a155
 v_mfma_f32_16x16x32_bf16 v[188:191], v[64:67], v[48:51], v[188:191]
 s_add_u32 s26, s26, 128
 v_accvgpr_read_b32 v100, a156
 v_accvgpr_read_b32 v101, a157
 v_mfma_f32_16x16x32_bf16 v[244:247], v[60:63], v[36:39], 0
 ds_read_b64_tr_b16 v[88:89], v24 offset:4096
 v_accvgpr_read_b32 v102, a158
 v_mfma_f32_16x16x32_bf16 v[244:247], v[64:67], v[52:55], v[244:247]
 ds_read_b64_tr_b16 v[90:91], v24 offset:4608
 v_accvgpr_read_b32 v103, a159
 v_mfma_f32_16x16x32_bf16 v[252:255], v[60:63], v[40:43], 0
 v_cvt_pk_bf16_f32 v116, v96, v97
 v_cvt_pk_bf16_f32 v117, v98, v99
 v_mfma_f32_16x16x32_bf16 v[252:255], v[64:67], v[56:59], v[252:255]
 s_waitcnt lgkmcnt(8)
 v_cvt_pk_bf16_f32 v118, v100, v101
 v_cvt_pk_bf16_f32 v119, v102, v103
 v_mfma_f32_16x16x32_bf16 a[192:195], v[68:71], v[28:31], 0
 buffer_store_dwordx4 v[116:119], v1, s[16:19], s98 offen offset:1024
 v_mfma_f32_16x16x32_bf16 a[192:195], v[72:75], v[44:47], a[192:195]
 v_mfma_f32_16x16x32_bf16 a[200:203], v[68:71], v[32:35], 0
 v_mfma_f32_16x16x32_bf16 a[200:203], v[72:75], v[48:51], a[200:203]
 s_waitcnt vmcnt(14) lgkmcnt(0)
 s_barrier
 v_mfma_f32_16x16x32_bf16 a[208:211], v[68:71], v[36:39], 0
 ds_read_b64_tr_b16 v[60:61], v14 offset:32768
 s_add_u32 m0, s30, 98304
 v_mfma_f32_16x16x32_bf16 a[208:211], v[72:75], v[52:55], a[208:211]
 ds_read_b64_tr_b16 v[62:63], v14 offset:33792
 s_nop 0
 v_mfma_f32_16x16x32_bf16 a[216:219], v[68:71], v[40:43], 0
 ds_read_b64_tr_b16 v[64:65], v14 offset:40960
 v_accvgpr_read_b32 v96, a160
 v_mfma_f32_16x16x32_bf16 a[216:219], v[72:75], v[56:59], a[216:219]
 ds_read_b64_tr_b16 v[66:67], v14 offset:41984
 v_mfma_f32_16x16x32_bf16 a[196:199], v[76:79], v[28:31], 0
 ds_read_b128 a[128:131], v12 offset:0
 v_accvgpr_read_b32 v97, a161
 v_mfma_f32_16x16x32_bf16 a[196:199], v[80:83], v[44:47], a[196:199]
 ds_read_b128 a[144:147], v13 offset:0
 v_mfma_f32_16x16x32_bf16 a[204:207], v[76:79], v[32:35], 0
 ds_read_b128 a[132:135], v12 offset:2048
 v_accvgpr_read_b32 v98, a162
 v_mfma_f32_16x16x32_bf16 a[204:207], v[80:83], v[48:51], a[204:207]
 ds_read_b64_tr_b16 v[68:69], v15 offset:32768
 v_accvgpr_read_b32 v99, a163
 v_mfma_f32_16x16x32_bf16 a[212:215], v[76:79], v[36:39], 0
 ds_read_b64_tr_b16 v[70:71], v15 offset:33792
 ds_read_b128 a[148:151], v13 offset:2048
 v_mfma_f32_16x16x32_bf16 a[212:215], v[80:83], v[52:55], a[212:215]
 ds_read_b128 a[136:139], v12 offset:4096
 ds_read_b128 a[152:155], v13 offset:4096
 v_mfma_f32_16x16x32_bf16 a[220:223], v[76:79], v[40:43], 0
 ds_read_b128 a[140:143], v12 offset:6144
 v_mfma_f32_16x16x32_bf16 a[220:223], v[80:83], v[56:59], a[220:223]
 ds_read_b64_tr_b16 v[72:73], v15 offset:40960
 v_mfma_f32_16x16x32_bf16 a[224:227], v[28:31], v[84:87], 0
 ds_read_b64_tr_b16 v[74:75], v15 offset:41984
 ds_read_b128 a[156:159], v13 offset:6144
 v_mfma_f32_16x16x32_bf16 a[224:227], v[44:47], v[88:91], a[224:227]
 v_subrev_u32 v12, 0x10000, v12
 v_subrev_u32 v13, 0x10000, v13
 v_mfma_f32_16x16x32_bf16 a[228:231], v[32:35], v[84:87], 0
 ds_read_b64_tr_b16 v[76:77], v16 offset:32768
 v_accvgpr_read_b32 v100, a164
 v_mfma_f32_16x16x32_bf16 a[228:231], v[48:51], v[88:91], a[228:231]
 ds_read_b64_tr_b16 v[78:79], v16 offset:33792
 v_accvgpr_read_b32 v101, a165
 v_mfma_f32_16x16x32_bf16 a[232:235], v[36:39], v[84:87], 0
 ds_read_b64_tr_b16 v[80:81], v16 offset:40960
 v_mfma_f32_16x16x32_bf16 a[232:235], v[52:55], v[88:91], a[232:235]
 ds_read_b64_tr_b16 v[82:83], v16 offset:41984
 buffer_load_dwordx4 v6, s[8:11], s27 offen offset:0  lds
 v_mfma_f32_16x16x32_bf16 a[236:239], v[40:43], v[84:87], 0
 buffer_load_dwordx4 v7, s[8:11], s27 offen offset:1024  lds
 v_mfma_f32_16x16x32_bf16 a[236:239], v[56:59], v[88:91], a[236:239]
 s_waitcnt lgkmcnt(4)
 v_accvgpr_read_b32 v102, a166
 v_accvgpr_read_b32 v103, a167
 v_mfma_f32_16x16x32_bf16 v[128:131], v[60:63], a[128:131], v[128:131]
 ds_read_b64_tr_b16 v[84:85], v17 offset:32768
 v_mfma_f32_16x16x32_bf16 v[128:131], v[64:67], a[144:147], v[128:131]
 ds_read_b64_tr_b16 v[86:87], v17 offset:33792
 v_cvt_pk_bf16_f32 v104, v96, v97
 v_mfma_f32_16x16x32_bf16 v[136:139], v[64:67], a[148:151], v[136:139]
 buffer_load_dwordx4 v8, s[8:11], s27 offen offset:2048  lds
 v_mfma_f32_16x16x32_bf16 v[136:139], v[60:63], a[132:135], v[136:139]
 buffer_load_dwordx4 v9, s[8:11], s27 offen offset:3072  lds
 v_mfma_f32_16x16x32_bf16 v[192:195], v[60:63], a[136:139], v[192:195]
 ds_read_b64_tr_b16 v[88:89], v17 offset:40960
 s_add_u32 m0, s31, 114688
 v_mfma_f32_16x16x32_bf16 v[192:195], v[64:67], a[152:155], v[192:195]
 ds_read_b64_tr_b16 v[90:91], v17 offset:41984
 s_add_u32 s27, s27, 524288
 v_mfma_f32_16x16x32_bf16 v[200:203], v[64:67], a[156:159], v[200:203]
 buffer_load_dwordx4 v10, s[12:15], s28 offen offset:0  lds
 v_mfma_f32_16x16x32_bf16 v[200:203], v[60:63], a[140:143], v[200:203]
 v_cvt_pk_bf16_f32 v105, v98, v99
 v_mfma_f32_16x16x32_bf16 v[132:135], v[68:71], a[128:131], v[132:135]
 ds_read_b64_tr_b16 v[60:61], v18 offset:32768
 v_cvt_pk_bf16_f32 v106, v100, v101
 v_mfma_f32_16x16x32_bf16 v[132:135], v[72:75], a[144:147], v[132:135]
 ds_read_b64_tr_b16 v[62:63], v18 offset:33792
 v_mfma_f32_16x16x32_bf16 v[140:143], v[72:75], a[148:151], v[140:143]
 buffer_load_dwordx4 v11, s[12:15], s28 offen offset:1024  lds
 v_mfma_f32_16x16x32_bf16 v[140:143], v[68:71], a[132:135], v[140:143]
 s_add_u32 s28, s28, 196608
 v_cvt_pk_bf16_f32 v107, v102, v103
 v_mfma_f32_16x16x32_bf16 v[196:199], v[68:71], a[136:139], v[196:199]
 ds_read_b64_tr_b16 v[64:65], v18 offset:40960
 v_mfma_f32_16x16x32_bf16 v[196:199], v[72:75], a[152:155], v[196:199]
 ds_read_b64_tr_b16 v[66:67], v18 offset:41984
 global_load_dword v122, v127, s[0:1]
 v_mfma_f32_16x16x32_bf16 v[204:207], v[72:75], a[156:159], v[204:207]
 s_add_u32 m0, s29, 32768
 v_mfma_f32_16x16x32_bf16 v[204:207], v[68:71], a[140:143], v[204:207]
 s_waitcnt lgkmcnt(8)
 s_nop 0
 v_mfma_f32_16x16x32_bf16 v[144:147], v[76:79], a[128:131], v[144:147]
 ds_read_b64_tr_b16 v[68:69], v19 offset:32768
 v_mfma_f32_16x16x32_bf16 v[144:147], v[80:83], a[144:147], v[144:147]
 ds_read_b64_tr_b16 v[70:71], v19 offset:33792
 v_mfma_f32_16x16x32_bf16 v[152:155], v[80:83], a[148:151], v[152:155]
 buffer_load_dwordx4 v2, s[4:7], s25 offen offset:0  lds
 v_mfma_f32_16x16x32_bf16 v[152:155], v[76:79], a[132:135], v[152:155]
 buffer_store_dwordx4 v[104:107], v1, s[16:19], s33 offen offset:2048
 v_mfma_f32_16x16x32_bf16 v[208:211], v[76:79], a[136:139], v[208:211]
 ds_read_b64_tr_b16 v[72:73], v19 offset:40960
 v_mfma_f32_16x16x32_bf16 v[208:211], v[80:83], a[152:155], v[208:211]
 ds_read_b64_tr_b16 v[74:75], v19 offset:41984
 v_accvgpr_read_b32 v96, a168
 v_mfma_f32_16x16x32_bf16 v[216:219], v[80:83], a[156:159], v[216:219]
 buffer_load_dwordx4 v3, s[4:7], s25 offen offset:1024  lds
 v_mfma_f32_16x16x32_bf16 v[216:219], v[76:79], a[140:143], v[216:219]
 s_waitcnt lgkmcnt(8)
 v_accvgpr_read_b32 v97, a169
 v_mfma_f32_16x16x32_bf16 v[148:151], v[84:87], a[128:131], v[148:151]
 ds_read_b128 v[76:79], v25 offset:128
 v_accvgpr_read_b32 v98, a170
 v_mfma_f32_16x16x32_bf16 v[148:151], v[88:91], a[144:147], v[148:151]
 ds_read_b128 v[92:95], v26
 v_subrev_u32 v26, 0x10000, v26
 v_mfma_f32_16x16x32_bf16 v[156:159], v[88:91], a[148:151], v[156:159]
 v_accvgpr_read_b32 v99, a171
 v_mfma_f32_16x16x32_bf16 v[156:159], v[84:87], a[132:135], v[156:159]
 buffer_load_dwordx4 v4, s[4:7], s25 offen offset:2048  lds
 v_mfma_f32_16x16x32_bf16 v[212:215], v[84:87], a[136:139], v[212:215]
 ds_read_b128 v[80:83], v25 offset:192
 v_accvgpr_read_b32 v100, a172
 v_mfma_f32_16x16x32_bf16 v[212:215], v[88:91], a[152:155], v[212:215]
 ds_read_b128 a[244:247], v27
 v_subrev_u32 v27, 0x10000, v27
 v_mfma_f32_16x16x32_bf16 v[220:223], v[88:91], a[156:159], v[220:223]
 v_accvgpr_read_b32 v101, a173
 v_mfma_f32_16x16x32_bf16 v[220:223], v[84:87], a[140:143], v[220:223]
 s_waitcnt lgkmcnt(8)
 v_accvgpr_read_b32 v102, a174
 v_mfma_f32_16x16x32_bf16 v[160:163], v[60:63], a[128:131], v[160:163]
 ds_read_b64_tr_b16 v[84:85], v20 offset:32768
 v_accvgpr_read_b32 v103, a175
 v_mfma_f32_16x16x32_bf16 v[160:163], v[64:67], a[144:147], v[160:163]
 ds_read_b64_tr_b16 v[86:87], v20 offset:33792
 v_cvt_pk_bf16_f32 v108, v96, v97
 v_mfma_f32_16x16x32_bf16 v[168:171], v[64:67], a[148:151], v[168:171]
 buffer_load_dwordx4 v5, s[4:7], s25 offen offset:3072  lds
 v_mfma_f32_16x16x32_bf16 v[168:171], v[60:63], a[132:135], v[168:171]
 v_cvt_pk_bf16_f32 v109, v98, v99
 v_mfma_f32_16x16x32_bf16 v[224:227], v[60:63], a[136:139], v[224:227]
 ds_read_b64_tr_b16 v[88:89], v20 offset:40960
 v_cvt_pk_bf16_f32 v110, v100, v101
 v_mfma_f32_16x16x32_bf16 v[224:227], v[64:67], a[152:155], v[224:227]
 ds_read_b64_tr_b16 v[90:91], v20 offset:41984
 s_add_u32 m0, s29, 36864
 v_mfma_f32_16x16x32_bf16 v[232:235], v[64:67], a[156:159], v[232:235]
 s_add_u32 s25, s25, 128
 v_cvt_pk_bf16_f32 v111, v102, v103
 v_mfma_f32_16x16x32_bf16 v[232:235], v[60:63], a[140:143], v[232:235]
 s_waitcnt lgkmcnt(8)
 v_mfma_f32_16x16x32_bf16 v[164:167], v[68:71], a[128:131], v[164:167]
 ds_read_b64_tr_b16 v[60:61], v21 offset:32768
 v_mfma_f32_16x16x32_bf16 v[164:167], v[72:75], a[144:147], v[164:167]
 ds_read_b64_tr_b16 v[62:63], v21 offset:33792
 v_mfma_f32_16x16x32_bf16 v[172:175], v[72:75], a[148:151], v[172:175]
 buffer_load_dwordx4 v2, s[4:7], s26 offen offset:0  lds
 v_mfma_f32_16x16x32_bf16 v[172:175], v[68:71], a[132:135], v[172:175]
 buffer_store_dwordx4 v[108:111], v1, s[16:19], s33 offen offset:3072
 v_mfma_f32_16x16x32_bf16 v[228:231], v[68:71], a[136:139], v[228:231]
 ds_read_b64_tr_b16 v[64:65], v21 offset:40960
 v_mfma_f32_16x16x32_bf16 v[228:231], v[72:75], a[152:155], v[228:231]
 ds_read_b64_tr_b16 v[66:67], v21 offset:41984
 v_mfma_f32_16x16x32_bf16 v[236:239], v[72:75], a[156:159], v[236:239]
 buffer_load_dwordx4 v3, s[4:7], s26 offen offset:1024  lds
 v_mfma_f32_16x16x32_bf16 v[236:239], v[68:71], a[140:143], v[236:239]
 s_waitcnt lgkmcnt(8)
 v_mfma_f32_16x16x32_bf16 a[240:243], v[76:79], v[92:95], a[240:243]
 ds_read_b64_tr_b16 v[68:69], v22 offset:32768
 v_accvgpr_read_b32 v96, a176
 v_mfma_f32_16x16x32_bf16 a[240:243], v[80:83], a[244:247], a[240:243]
 ds_read_b64_tr_b16 v[70:71], v22 offset:33280
 s_waitcnt lgkmcnt(6)
 v_mfma_f32_16x16x32_bf16 v[176:179], v[84:87], a[128:131], v[176:179]
 ds_read_b64_tr_b16 v[72:73], v22 offset:36864
 v_mfma_f32_16x16x32_bf16 v[176:179], v[88:91], a[144:147], v[176:179]
 ds_read_b64_tr_b16 v[74:75], v22 offset:37376
 v_accvgpr_read_b32 v97, a177
 v_mfma_f32_16x16x32_bf16 v[184:187], v[88:91], a[148:151], v[184:187]
 ds_read_b64_tr_b16 v[76:77], v23 offset:32768
 v_accvgpr_read_b32 v98, a178
 v_mfma_f32_16x16x32_bf16 v[184:187], v[84:87], a[132:135], v[184:187]
 ds_read_b64_tr_b16 v[78:79], v23 offset:33280
 v_mfma_f32_16x16x32_bf16 v[240:243], v[84:87], a[136:139], v[240:243]
 ds_read_b64_tr_b16 v[80:81], v23 offset:36864
 v_accvgpr_read_b32 v99, a179
 v_mfma_f32_16x16x32_bf16 v[240:243], v[88:91], a[152:155], v[240:243]
 ds_read_b64_tr_b16 v[82:83], v23 offset:37376
 v_accvgpr_read_b32 v100, a180
 v_mfma_f32_16x16x32_bf16 v[248:251], v[88:91], a[156:159], v[248:251]
 buffer_load_dwordx4 v4, s[4:7], s26 offen offset:2048  lds
 v_mfma_f32_16x16x32_bf16 v[248:251], v[84:87], a[140:143], v[248:251]
 s_waitcnt lgkmcnt(8)
 v_accvgpr_read_b32 v101, a181
 v_mfma_f32_16x16x32_bf16 v[180:183], v[60:63], a[128:131], v[180:183]
 ds_read_b64_tr_b16 v[84:85], v24 offset:32768
 v_accvgpr_read_b32 v102, a182
 v_mfma_f32_16x16x32_bf16 v[180:183], v[64:67], a[144:147], v[180:183]
 ds_read_b64_tr_b16 v[86:87], v24 offset:33280
 v_mfma_f32_16x16x32_bf16 v[188:191], v[64:67], a[148:151], v[188:191]
 buffer_load_dwordx4 v5, s[4:7], s26 offen offset:3072  lds
 v_mfma_f32_16x16x32_bf16 v[188:191], v[60:63], a[132:135], v[188:191]
 s_add_u32 s26, s26, 128
 v_accvgpr_read_b32 v103, a183
 v_cvt_pk_bf16_f32 v112, v96, v97
 v_mfma_f32_16x16x32_bf16 v[244:247], v[60:63], a[136:139], v[244:247]
 ds_read_b64_tr_b16 v[88:89], v24 offset:36864
 v_mfma_f32_16x16x32_bf16 v[244:247], v[64:67], a[152:155], v[244:247]
 ds_read_b64_tr_b16 v[90:91], v24 offset:37376
 v_cvt_pk_bf16_f32 v113, v98, v99
 v_mfma_f32_16x16x32_bf16 v[252:255], v[64:67], a[156:159], v[252:255]
 v_cvt_pk_bf16_f32 v114, v100, v101
 v_mfma_f32_16x16x32_bf16 v[252:255], v[60:63], a[140:143], v[252:255]
 s_waitcnt lgkmcnt(8)
 v_cvt_pk_bf16_f32 v115, v102, v103
 v_mfma_f32_16x16x32_bf16 a[192:195], v[68:71], a[128:131], a[192:195]
 buffer_store_dwordx4 v[112:115], v1, s[16:19], s98 offen offset:2048
 v_mfma_f32_16x16x32_bf16 a[192:195], v[72:75], a[144:147], a[192:195]
 v_mfma_f32_16x16x32_bf16 a[200:203], v[72:75], a[148:151], a[200:203]
 v_mfma_f32_16x16x32_bf16 a[200:203], v[68:71], a[132:135], a[200:203]
 s_waitcnt vmcnt(12) lgkmcnt(0)
 s_barrier
 v_mfma_f32_16x16x32_bf16 a[208:211], v[68:71], a[136:139], a[208:211]
 ds_read_b64_tr_b16 v[60:61], v14 offset:0
 s_add_u32 m0, s30, 131072
 v_mfma_f32_16x16x32_bf16 a[208:211], v[72:75], a[152:155], a[208:211]
 ds_read_b64_tr_b16 v[62:63], v14 offset:1024
 s_nop 0
 v_mfma_f32_16x16x32_bf16 a[216:219], v[72:75], a[156:159], a[216:219]
 ds_read_b64_tr_b16 v[64:65], v14 offset:8192
 v_mfma_f32_16x16x32_bf16 a[216:219], v[68:71], a[140:143], a[216:219]
 ds_read_b64_tr_b16 v[66:67], v14 offset:9216
 v_mfma_f32_16x16x32_bf16 a[196:199], v[76:79], a[128:131], a[196:199]
 ds_read_b128 v[28:31], v12 offset:0
 v_mfma_f32_16x16x32_bf16 a[196:199], v[80:83], a[144:147], a[196:199]
 ds_read_b128 v[44:47], v13 offset:0
 v_accvgpr_read_b32 v96, a184
 v_mfma_f32_16x16x32_bf16 a[204:207], v[80:83], a[148:151], a[204:207]
 ds_read_b128 v[32:35], v12 offset:2048
 v_mfma_f32_16x16x32_bf16 a[204:207], v[76:79], a[132:135], a[204:207]
 ds_read_b64_tr_b16 v[68:69], v15 offset:0
 v_accvgpr_read_b32 v97, a185
 v_mfma_f32_16x16x32_bf16 a[212:215], v[76:79], a[136:139], a[212:215]
 ds_read_b64_tr_b16 v[70:71], v15 offset:1024
 ds_read_b128 v[48:51], v13 offset:2048
 v_mfma_f32_16x16x32_bf16 a[212:215], v[80:83], a[152:155], a[212:215]
 ds_read_b128 v[36:39], v12 offset:4096
 ds_read_b128 v[52:55], v13 offset:4096
 v_mfma_f32_16x16x32_bf16 a[220:223], v[80:83], a[156:159], a[220:223]
 ds_read_b128 v[40:43], v12 offset:6144
 v_accvgpr_read_b32 v98, a186
 v_mfma_f32_16x16x32_bf16 a[220:223], v[76:79], a[140:143], a[220:223]
 ds_read_b64_tr_b16 v[72:73], v15 offset:8192
 v_mfma_f32_16x16x32_bf16 a[224:227], a[128:131], v[84:87], a[224:227]
 ds_read_b64_tr_b16 v[74:75], v15 offset:9216
 ds_read_b128 v[56:59], v13 offset:6144
 v_mfma_f32_16x16x32_bf16 a[224:227], a[144:147], v[88:91], a[224:227]
 v_add_u32 v12, 0x8000, v12
 v_add_u32 v13, 0x8000, v13
 v_mfma_f32_16x16x32_bf16 a[228:231], a[148:151], v[88:91], a[228:231]
 ds_read_b64_tr_b16 v[76:77], v16 offset:0
 v_mfma_f32_16x16x32_bf16 a[228:231], a[132:135], v[84:87], a[228:231]
 ds_read_b64_tr_b16 v[78:79], v16 offset:1024
 v_accvgpr_read_b32 v99, a187
 v_mfma_f32_16x16x32_bf16 a[232:235], a[136:139], v[84:87], a[232:235]
 ds_read_b64_tr_b16 v[80:81], v16 offset:8192
 v_accvgpr_read_b32 v100, a188
 v_mfma_f32_16x16x32_bf16 a[232:235], a[152:155], v[88:91], a[232:235]
 ds_read_b64_tr_b16 v[82:83], v16 offset:9216
 v_mfma_f32_16x16x32_bf16 a[236:239], a[156:159], v[88:91], a[236:239]
 buffer_load_dwordx4 v6, s[8:11], s27 offen offset:0  lds
 v_mfma_f32_16x16x32_bf16 a[236:239], a[140:143], v[84:87], a[236:239]
 s_waitcnt lgkmcnt(4)
 v_accvgpr_read_b32 v101, a189
 v_mfma_f32_16x16x32_bf16 v[128:131], v[60:63], v[28:31], v[128:131]
 ds_read_b64_tr_b16 v[84:85], v17 offset:0
 s_lshr_b32 s71, s20, 3
 v_mfma_f32_16x16x32_bf16 v[128:131], v[64:67], v[44:47], v[128:131]
 ds_read_b64_tr_b16 v[86:87], v17 offset:1024
 buffer_load_dwordx4 v7, s[8:11], s27 offen offset:1024  lds
 v_mfma_f32_16x16x32_bf16 v[136:139], v[64:67], v[48:51], v[136:139]
 buffer_load_dwordx4 v8, s[8:11], s27 offen offset:2048  lds
 v_mfma_f32_16x16x32_bf16 v[136:139], v[60:63], v[32:35], v[136:139]
 buffer_load_dwordx4 v9, s[8:11], s27 offen offset:3072  lds
 v_mfma_f32_16x16x32_bf16 v[192:195], v[60:63], v[36:39], v[192:195]
 ds_read_b64_tr_b16 v[88:89], v17 offset:8192
 s_add_u32 m0, s31, 147456
 v_mfma_f32_16x16x32_bf16 v[192:195], v[64:67], v[52:55], v[192:195]
 ds_read_b64_tr_b16 v[90:91], v17 offset:9216
 s_add_u32 s27, s27, 524288
 v_mfma_f32_16x16x32_bf16 v[200:203], v[64:67], v[56:59], v[200:203]
 buffer_load_dwordx4 v10, s[12:15], s28 offen offset:0  lds
 v_mfma_f32_16x16x32_bf16 v[200:203], v[60:63], v[40:43], v[200:203]
 s_lshl_b32 s96, s71, 3
 s_add_u32 s96, s96, s21
 v_mfma_f32_16x16x32_bf16 v[132:135], v[68:71], v[28:31], v[132:135]
 ds_read_b64_tr_b16 v[60:61], v18 offset:0
 s_lshl_b32 s96, s96, 5
 v_mfma_f32_16x16x32_bf16 v[132:135], v[72:75], v[44:47], v[132:135]
 ds_read_b64_tr_b16 v[62:63], v18 offset:1024
 s_and_b32 s70, s20, 7
 v_mfma_f32_16x16x32_bf16 v[140:143], v[72:75], v[48:51], v[140:143]
 buffer_load_dwordx4 v11, s[12:15], s28 offen offset:1024  lds
 v_mfma_f32_16x16x32_bf16 v[140:143], v[68:71], v[32:35], v[140:143]
 s_add_u32 s96, s96, s70
 v_accvgpr_read_b32 v102, a190
 v_accvgpr_read_b32 v103, a191
 v_mfma_f32_16x16x32_bf16 v[196:199], v[68:71], v[36:39], v[196:199]
 ds_read_b64_tr_b16 v[64:65], v18 offset:8192
 s_add_u32 s28, s28, 196608
 v_mfma_f32_16x16x32_bf16 v[196:199], v[72:75], v[52:55], v[196:199]
 ds_read_b64_tr_b16 v[66:67], v18 offset:9216
 v_mfma_f32_16x16x32_bf16 v[204:207], v[72:75], v[56:59], v[204:207]
 s_add_u32 m0, s29, 65536
 v_cvt_pk_bf16_f32 v116, v96, v97
 v_cvt_pk_bf16_f32 v117, v98, v99
 v_mfma_f32_16x16x32_bf16 v[204:207], v[68:71], v[40:43], v[204:207]
 s_waitcnt lgkmcnt(8)
 s_nop 0
 v_mfma_f32_16x16x32_bf16 v[144:147], v[76:79], v[28:31], v[144:147]
 ds_read_b64_tr_b16 v[68:69], v19 offset:0
 s_lshl_b32 s96, s96, 2
 v_mfma_f32_16x16x32_bf16 v[144:147], v[80:83], v[44:47], v[144:147]
 ds_read_b64_tr_b16 v[70:71], v19 offset:1024
 v_cvt_pk_bf16_f32 v118, v100, v101
 v_mfma_f32_16x16x32_bf16 v[152:155], v[80:83], v[48:51], v[152:155]
 buffer_load_dwordx4 v2, s[4:7], s25 offen offset:0  lds
 v_mfma_f32_16x16x32_bf16 v[152:155], v[76:79], v[32:35], v[152:155]
 v_cvt_pk_bf16_f32 v119, v102, v103
 v_mfma_f32_16x16x32_bf16 v[208:211], v[76:79], v[36:39], v[208:211]
 ds_read_b64_tr_b16 v[72:73], v19 offset:8192
 v_mfma_f32_16x16x32_bf16 v[208:211], v[80:83], v[52:55], v[208:211]
 ds_read_b64_tr_b16 v[74:75], v19 offset:9216
 v_mfma_f32_16x16x32_bf16 v[216:219], v[80:83], v[56:59], v[216:219]
 buffer_load_dwordx4 v3, s[4:7], s25 offen offset:1024  lds
 v_mfma_f32_16x16x32_bf16 v[216:219], v[76:79], v[40:43], v[216:219]
 s_waitcnt lgkmcnt(8)
 s_add_u32 s96, s96, 0x6300000
 v_mfma_f32_16x16x32_bf16 v[148:151], v[84:87], v[28:31], v[148:151]
 ds_read_b128 v[76:79], v25 offset:256
 v_mfma_f32_16x16x32_bf16 v[148:151], v[88:91], v[44:47], v[148:151]
 ds_read_b128 v[92:95], v26
 v_add_u32 v26, 0x8000, v26
 v_mfma_f32_16x16x32_bf16 v[156:159], v[88:91], v[48:51], v[156:159]
 buffer_store_dwordx4 v[116:119], v1, s[16:19], s98 offen offset:3072
 v_mfma_f32_16x16x32_bf16 v[156:159], v[84:87], v[32:35], v[156:159]
 buffer_load_dwordx4 v4, s[4:7], s25 offen offset:2048  lds
 v_mfma_f32_16x16x32_bf16 v[212:215], v[84:87], v[36:39], v[212:215]
 ds_read_b128 v[80:83], v25 offset:320
 s_sub_u32 s70, 15, s21
 v_mfma_f32_16x16x32_bf16 v[212:215], v[88:91], v[52:55], v[212:215]
 ds_read_b128 a[244:247], v27
 v_add_u32 v27, 0x8000, v27
 v_mfma_f32_16x16x32_bf16 v[220:223], v[88:91], v[56:59], v[220:223]
 v_mfma_f32_16x16x32_bf16 v[220:223], v[84:87], v[40:43], v[220:223]
 s_waitcnt lgkmcnt(8)
 s_add_u32 s33, s33, s56
 v_mfma_f32_16x16x32_bf16 v[160:163], v[60:63], v[28:31], v[160:163]
 ds_read_b64_tr_b16 v[84:85], v20 offset:0
 v_mfma_f32_16x16x32_bf16 v[160:163], v[64:67], v[44:47], v[160:163]
 ds_read_b64_tr_b16 v[86:87], v20 offset:1024
 s_add_u32 s98, s98, s56
 v_mfma_f32_16x16x32_bf16 v[168:171], v[64:67], v[48:51], v[168:171]
 buffer_load_dwordx4 v5, s[4:7], s25 offen offset:3072  lds
 v_mfma_f32_16x16x32_bf16 v[168:171], v[60:63], v[32:35], v[168:171]
 s_bitcmp1_b32 s2, 0
 s_cselect_b32 s60, s70, s21
 v_mfma_f32_16x16x32_bf16 v[224:227], v[60:63], v[36:39], v[224:227]
 ds_read_b64_tr_b16 v[88:89], v20 offset:8192
 v_accvgpr_read_b32 v96, a0
 v_mfma_f32_16x16x32_bf16 v[224:227], v[64:67], v[52:55], v[224:227]
 ds_read_b64_tr_b16 v[90:91], v20 offset:9216
 s_add_u32 m0, s29, 69632
 v_mfma_f32_16x16x32_bf16 v[232:235], v[64:67], v[56:59], v[232:235]
 s_add_u32 s25, s25, 128
 s_lshl_b32 s97, s60, 2
 v_accvgpr_read_b32 v97, a1
 v_mfma_f32_16x16x32_bf16 v[232:235], v[60:63], v[40:43], v[232:235]
 s_waitcnt lgkmcnt(8)
 v_accvgpr_read_b32 v98, a2
 v_accvgpr_read_b32 v99, a3
 v_mfma_f32_16x16x32_bf16 v[164:167], v[68:71], v[28:31], v[164:167]
 ds_read_b64_tr_b16 v[60:61], v21 offset:0
 v_accvgpr_read_b32 v100, a4
 v_mfma_f32_16x16x32_bf16 v[164:167], v[72:75], v[44:47], v[164:167]
 ds_read_b64_tr_b16 v[62:63], v21 offset:1024
 v_accvgpr_read_b32 v101, a5
 v_mfma_f32_16x16x32_bf16 v[172:175], v[72:75], v[48:51], v[172:175]
 buffer_load_dwordx4 v2, s[4:7], s26 offen offset:0  lds
 v_mfma_f32_16x16x32_bf16 v[172:175], v[68:71], v[32:35], v[172:175]
 v_accvgpr_read_b32 v102, a6
 v_accvgpr_read_b32 v103, a7
 v_mfma_f32_16x16x32_bf16 v[228:231], v[68:71], v[36:39], v[228:231]
 ds_read_b64_tr_b16 v[64:65], v21 offset:8192
 s_and_b32 s70, s20, 3
 v_mfma_f32_16x16x32_bf16 v[228:231], v[72:75], v[52:55], v[228:231]
 ds_read_b64_tr_b16 v[66:67], v21 offset:9216
 v_cvt_pk_bf16_f32 v104, v96, v97
 v_mfma_f32_16x16x32_bf16 v[236:239], v[72:75], v[56:59], v[236:239]
 buffer_load_dwordx4 v3, s[4:7], s26 offen offset:1024  lds
 v_mfma_f32_16x16x32_bf16 v[236:239], v[68:71], v[40:43], v[236:239]
 s_waitcnt lgkmcnt(8)
 v_cvt_pk_bf16_f32 v105, v98, v99
 v_cvt_pk_bf16_f32 v106, v100, v101
 v_mfma_f32_16x16x32_bf16 a[240:243], v[76:79], v[92:95], a[240:243]
 ds_read_b64_tr_b16 v[68:69], v22 offset:0
 v_cvt_pk_bf16_f32 v107, v102, v103
 v_mfma_f32_16x16x32_bf16 a[240:243], v[80:83], a[244:247], a[240:243]
 ds_read_b64_tr_b16 v[70:71], v22 offset:512
 s_waitcnt lgkmcnt(6)
 v_mfma_f32_16x16x32_bf16 v[176:179], v[84:87], v[28:31], v[176:179]
 ds_read_b64_tr_b16 v[72:73], v22 offset:4096
 s_add_u32 s61, s97, s70
 v_mfma_f32_16x16x32_bf16 v[176:179], v[88:91], v[44:47], v[176:179]
 ds_read_b64_tr_b16 v[74:75], v22 offset:4608
 v_mfma_f32_16x16x32_bf16 v[184:187], v[88:91], v[48:51], v[184:187]
 ds_read_b64_tr_b16 v[76:77], v23 offset:0
 v_mfma_f32_16x16x32_bf16 v[184:187], v[84:87], v[32:35], v[184:187]
 ds_read_b64_tr_b16 v[78:79], v23 offset:512
 v_mfma_f32_16x16x32_bf16 v[240:243], v[84:87], v[36:39], v[240:243]
 ds_read_b64_tr_b16 v[80:81], v23 offset:4096
 buffer_store_dwordx4 v[104:107], v1, s[16:19], s33 offen offset:0
 v_mfma_f32_16x16x32_bf16 v[240:243], v[88:91], v[52:55], v[240:243]
 ds_read_b64_tr_b16 v[82:83], v23 offset:4608
 s_lshl_b32 s97, s61, 5
 v_mfma_f32_16x16x32_bf16 v[248:251], v[88:91], v[56:59], v[248:251]
 buffer_load_dwordx4 v4, s[4:7], s26 offen offset:2048  lds
 v_mfma_f32_16x16x32_bf16 v[248:251], v[84:87], v[40:43], v[248:251]
 s_waitcnt lgkmcnt(8)
 v_accvgpr_write_b32 a0, 0
 v_accvgpr_write_b32 a1, 0
 v_mfma_f32_16x16x32_bf16 v[180:183], v[60:63], v[28:31], v[180:183]
 ds_read_b64_tr_b16 v[84:85], v24 offset:0
 v_accvgpr_write_b32 a2, 0
 v_mfma_f32_16x16x32_bf16 v[180:183], v[64:67], v[44:47], v[180:183]
 ds_read_b64_tr_b16 v[86:87], v24 offset:512
 v_accvgpr_write_b32 a3, 0
 v_mfma_f32_16x16x32_bf16 v[188:191], v[64:67], v[48:51], v[188:191]
 buffer_load_dwordx4 v5, s[4:7], s26 offen offset:3072  lds
 v_mfma_f32_16x16x32_bf16 v[188:191], v[60:63], v[32:35], v[188:191]
 s_add_u32 s26, s26, 128
 s_add_u32 s97, s97, s71
 v_accvgpr_write_b32 a4, 0
 v_mfma_f32_16x16x32_bf16 v[244:247], v[60:63], v[36:39], v[244:247]
 ds_read_b64_tr_b16 v[88:89], v24 offset:4096
 v_accvgpr_write_b32 a5, 0
 v_mfma_f32_16x16x32_bf16 v[244:247], v[64:67], v[52:55], v[244:247]
 ds_read_b64_tr_b16 v[90:91], v24 offset:4608
 v_accvgpr_write_b32 a6, 0
 v_mfma_f32_16x16x32_bf16 v[252:255], v[64:67], v[56:59], v[252:255]
 v_accvgpr_write_b32 a7, 0
 v_accvgpr_read_b32 v96, a8
 v_mfma_f32_16x16x32_bf16 v[252:255], v[60:63], v[40:43], v[252:255]
 s_waitcnt lgkmcnt(8)
 v_accvgpr_read_b32 v97, a9
 v_accvgpr_read_b32 v98, a10
 v_mfma_f32_16x16x32_bf16 a[192:195], v[68:71], v[28:31], a[192:195]
 s_lshl_b32 s97, s97, 2
 v_accvgpr_read_b32 v99, a11
 v_accvgpr_read_b32 v100, a12
 v_mfma_f32_16x16x32_bf16 a[192:195], v[72:75], v[44:47], a[192:195]
 v_accvgpr_read_b32 v101, a13
 v_accvgpr_read_b32 v102, a14
 v_mfma_f32_16x16x32_bf16 a[200:203], v[72:75], v[48:51], a[200:203]
 v_accvgpr_read_b32 v103, a15
 v_cvt_pk_bf16_f32 v108, v96, v97
 v_mfma_f32_16x16x32_bf16 a[200:203], v[68:71], v[32:35], a[200:203]
 v_cvt_pk_bf16_f32 v109, v98, v99
 s_waitcnt vmcnt(10) lgkmcnt(0)
 s_barrier
 v_mfma_f32_16x16x32_bf16 a[208:211], v[68:71], v[36:39], a[208:211]
 ds_read_b64_tr_b16 v[60:61], v14 offset:32768
 s_add_u32 m0, s30, 98304
 v_mfma_f32_16x16x32_bf16 a[208:211], v[72:75], v[52:55], a[208:211]
 ds_read_b64_tr_b16 v[62:63], v14 offset:33792
 s_nop 0
 v_mfma_f32_16x16x32_bf16 a[216:219], v[72:75], v[56:59], a[216:219]
 ds_read_b64_tr_b16 v[64:65], v14 offset:40960
 s_add_u32 s97, s97, 0x6301000
 v_mfma_f32_16x16x32_bf16 a[216:219], v[68:71], v[40:43], a[216:219]
 ds_read_b64_tr_b16 v[66:67], v14 offset:41984
 v_mfma_f32_16x16x32_bf16 a[196:199], v[76:79], v[28:31], a[196:199]
 ds_read_b128 a[128:131], v12 offset:0
 v_cvt_pk_bf16_f32 v110, v100, v101
 v_mfma_f32_16x16x32_bf16 a[196:199], v[80:83], v[44:47], a[196:199]
 ds_read_b128 a[144:147], v13 offset:0
 v_cvt_pk_bf16_f32 v111, v102, v103
 v_mfma_f32_16x16x32_bf16 a[204:207], v[80:83], v[48:51], a[204:207]
 ds_read_b128 a[132:135], v12 offset:2048
 v_mfma_f32_16x16x32_bf16 a[204:207], v[76:79], v[32:35], a[204:207]
 ds_read_b64_tr_b16 v[68:69], v15 offset:32768
 buffer_store_dwordx4 v[108:111], v1, s[16:19], s33 offen offset:1024
 v_mfma_f32_16x16x32_bf16 a[212:215], v[76:79], v[36:39], a[212:215]
 ds_read_b64_tr_b16 v[70:71], v15 offset:33792
 ds_read_b128 a[148:151], v13 offset:2048
 v_mfma_f32_16x16x32_bf16 a[212:215], v[80:83], v[52:55], a[212:215]
 ds_read_b128 a[136:139], v12 offset:4096
 ds_read_b128 a[152:155], v13 offset:4096
 v_mfma_f32_16x16x32_bf16 a[220:223], v[80:83], v[56:59], a[220:223]
 ds_read_b128 a[140:143], v12 offset:6144
 v_accvgpr_write_b32 a8, 0
 v_mfma_f32_16x16x32_bf16 a[220:223], v[76:79], v[40:43], a[220:223]
 ds_read_b64_tr_b16 v[72:73], v15 offset:40960
 v_mfma_f32_16x16x32_bf16 a[224:227], v[28:31], v[84:87], a[224:227]
 ds_read_b64_tr_b16 v[74:75], v15 offset:41984
 ds_read_b128 a[156:159], v13 offset:6144
 v_mfma_f32_16x16x32_bf16 a[224:227], v[44:47], v[88:91], a[224:227]
 v_add_u32 v12, 0x8000, v12
 v_add_u32 v13, 0x8000, v13
 v_mfma_f32_16x16x32_bf16 a[228:231], v[48:51], v[88:91], a[228:231]
 ds_read_b64_tr_b16 v[76:77], v16 offset:32768
 v_accvgpr_write_b32 a9, 0
 v_mfma_f32_16x16x32_bf16 a[228:231], v[32:35], v[84:87], a[228:231]
 ds_read_b64_tr_b16 v[78:79], v16 offset:33792
 v_accvgpr_write_b32 a10, 0
 v_mfma_f32_16x16x32_bf16 a[232:235], v[36:39], v[84:87], a[232:235]
 ds_read_b64_tr_b16 v[80:81], v16 offset:40960
 v_accvgpr_write_b32 a11, 0
 v_mfma_f32_16x16x32_bf16 a[232:235], v[52:55], v[88:91], a[232:235]
 ds_read_b64_tr_b16 v[82:83], v16 offset:41984
 buffer_load_dwordx4 v6, s[8:11], s27 offen offset:0  lds
 v_mfma_f32_16x16x32_bf16 a[236:239], v[56:59], v[88:91], a[236:239]
 buffer_load_dwordx4 v7, s[8:11], s27 offen offset:1024  lds
 v_mfma_f32_16x16x32_bf16 a[236:239], v[40:43], v[84:87], a[236:239]
 s_waitcnt lgkmcnt(4)
 s_bitcmp1_b32 s20, 1
 s_cselect_b32 s36, s92, s93
 v_mfma_f32_16x16x32_bf16 v[128:131], v[60:63], a[128:131], v[128:131]
 ds_read_b64_tr_b16 v[84:85], v17 offset:32768
 s_and_b32 s37, s20, 1
 v_mfma_f32_16x16x32_bf16 v[128:131], v[64:67], a[144:147], v[128:131]
 ds_read_b64_tr_b16 v[86:87], v17 offset:33792
 s_lshr_b32 s70, s99, 1
 v_mfma_f32_16x16x32_bf16 v[136:139], v[64:67], a[148:151], v[136:139]
 buffer_load_dwordx4 v8, s[8:11], s27 offen offset:2048  lds
 v_mfma_f32_16x16x32_bf16 v[136:139], v[60:63], a[132:135], v[136:139]
 buffer_load_dwordx4 v9, s[8:11], s27 offen offset:3072  lds
 v_mfma_f32_16x16x32_bf16 v[192:195], v[60:63], a[136:139], v[192:195]
 ds_read_b64_tr_b16 v[88:89], v17 offset:40960
 s_add_u32 m0, s31, 114688
 v_mfma_f32_16x16x32_bf16 v[192:195], v[64:67], a[152:155], v[192:195]
 ds_read_b64_tr_b16 v[90:91], v17 offset:41984
 s_add_u32 s27, s27, 524288
 v_mfma_f32_16x16x32_bf16 v[200:203], v[64:67], a[156:159], v[200:203]
 buffer_load_dwordx4 v10, s[12:15], s28 offen offset:0  lds
 v_mfma_f32_16x16x32_bf16 v[200:203], v[60:63], a[140:143], v[200:203]
 s_add_u32 s37, s37, s70
 v_accvgpr_write_b32 a12, 0
 v_mfma_f32_16x16x32_bf16 v[132:135], v[68:71], a[128:131], v[132:135]
 ds_read_b64_tr_b16 v[60:61], v18 offset:32768
 v_accvgpr_write_b32 a13, 0
 v_mfma_f32_16x16x32_bf16 v[132:135], v[72:75], a[144:147], v[132:135]
 ds_read_b64_tr_b16 v[62:63], v18 offset:33792
 v_accvgpr_write_b32 a14, 0
 v_mfma_f32_16x16x32_bf16 v[140:143], v[72:75], a[148:151], v[140:143]
 buffer_load_dwordx4 v11, s[12:15], s28 offen offset:1024  lds
 v_mfma_f32_16x16x32_bf16 v[140:143], v[68:71], a[132:135], v[140:143]
 s_add_u32 s28, s28, 196608
 s_lshl_b32 s64, s99, 11
 v_accvgpr_write_b32 a15, 0
 v_mfma_f32_16x16x32_bf16 v[196:199], v[68:71], a[136:139], v[196:199]
 ds_read_b64_tr_b16 v[64:65], v18 offset:40960
 v_accvgpr_read_b32 v96, a16
 v_mfma_f32_16x16x32_bf16 v[196:199], v[72:75], a[152:155], v[196:199]
 ds_read_b64_tr_b16 v[66:67], v18 offset:41984
 global_load_dword v122, v127, s[0:1]
 v_mfma_f32_16x16x32_bf16 v[204:207], v[72:75], a[156:159], v[204:207]
 s_add_u32 m0, s29, 0
 v_accvgpr_read_b32 v97, a17
 v_accvgpr_read_b32 v98, a18
 v_mfma_f32_16x16x32_bf16 v[204:207], v[68:71], a[140:143], v[204:207]
 s_waitcnt lgkmcnt(8)
 s_nop 0
 s_add_u32 s64, s64, 0x3600000
 v_mfma_f32_16x16x32_bf16 v[144:147], v[76:79], a[128:131], v[144:147]
 ds_read_b64_tr_b16 v[68:69], v19 offset:32768
 v_accvgpr_read_b32 v99, a19
 v_mfma_f32_16x16x32_bf16 v[144:147], v[80:83], a[144:147], v[144:147]
 ds_read_b64_tr_b16 v[70:71], v19 offset:33792
 v_accvgpr_read_b32 v100, a20
 v_mfma_f32_16x16x32_bf16 v[152:155], v[80:83], a[148:151], v[152:155]
 buffer_load_dwordx4 v2, s[4:7], s25 offen offset:0  lds
 v_mfma_f32_16x16x32_bf16 v[152:155], v[76:79], a[132:135], v[152:155]
 v_accvgpr_read_b32 v101, a21
 v_accvgpr_read_b32 v102, a22
 v_mfma_f32_16x16x32_bf16 v[208:211], v[76:79], a[136:139], v[208:211]
 ds_read_b64_tr_b16 v[72:73], v19 offset:40960
 v_accvgpr_read_b32 v103, a23
 v_mfma_f32_16x16x32_bf16 v[208:211], v[80:83], a[152:155], v[208:211]
 ds_read_b64_tr_b16 v[74:75], v19 offset:41984
 s_lshl_b32 s65, s36, 7
 v_mfma_f32_16x16x32_bf16 v[216:219], v[80:83], a[156:159], v[216:219]
 buffer_load_dwordx4 v3, s[4:7], s25 offen offset:1024  lds
 v_mfma_f32_16x16x32_bf16 v[216:219], v[76:79], a[140:143], v[216:219]
 s_waitcnt lgkmcnt(8)
 v_cvt_pk_bf16_f32 v112, v96, v97
 v_cvt_pk_bf16_f32 v113, v98, v99
 v_mfma_f32_16x16x32_bf16 v[148:151], v[84:87], a[128:131], v[148:151]
 ds_read_b128 v[76:79], v25 offset:384
 v_cvt_pk_bf16_f32 v114, v100, v101
 v_mfma_f32_16x16x32_bf16 v[148:151], v[88:91], a[144:147], v[148:151]
 ds_read_b128 v[92:95], v26
 v_add_u32 v26, 0x8000, v26
 v_mfma_f32_16x16x32_bf16 v[156:159], v[88:91], a[148:151], v[156:159]
 s_add_u32 s65, s65, s64
 v_cvt_pk_bf16_f32 v115, v102, v103
 v_mfma_f32_16x16x32_bf16 v[156:159], v[84:87], a[132:135], v[156:159]
 buffer_load_dwordx4 v4, s[4:7], s25 offen offset:2048  lds
 v_mfma_f32_16x16x32_bf16 v[212:215], v[84:87], a[136:139], v[212:215]
 ds_read_b128 v[80:83], v25 offset:448
 buffer_store_dwordx4 v[112:115], v1, s[16:19], s98 offen offset:0
 v_mfma_f32_16x16x32_bf16 v[212:215], v[88:91], a[152:155], v[212:215]
 ds_read_b128 a[244:247], v27
 v_add_u32 v27, 0x8000, v27
 v_mfma_f32_16x16x32_bf16 v[220:223], v[88:91], a[156:159], v[220:223]
 v_accvgpr_write_b32 a16, 0
 v_accvgpr_write_b32 a17, 0
 v_mfma_f32_16x16x32_bf16 v[220:223], v[84:87], a[140:143], v[220:223]
 s_waitcnt lgkmcnt(8)
 v_accvgpr_write_b32 a18, 0
 v_accvgpr_write_b32 a19, 0
 v_mfma_f32_16x16x32_bf16 v[160:163], v[60:63], a[128:131], v[160:163]
 ds_read_b64_tr_b16 v[84:85], v20 offset:32768
 s_mov_b32 s66, s64
 v_mfma_f32_16x16x32_bf16 v[160:163], v[64:67], a[144:147], v[160:163]
 ds_read_b64_tr_b16 v[86:87], v20 offset:33792
 v_accvgpr_write_b32 a20, 0
 v_mfma_f32_16x16x32_bf16 v[168:171], v[64:67], a[148:151], v[168:171]
 buffer_load_dwordx4 v5, s[4:7], s25 offen offset:3072  lds
 v_mfma_f32_16x16x32_bf16 v[168:171], v[60:63], a[132:135], v[168:171]
 v_accvgpr_write_b32 a21, 0
 v_accvgpr_write_b32 a22, 0
 v_mfma_f32_16x16x32_bf16 v[224:227], v[60:63], a[136:139], v[224:227]
 ds_read_b64_tr_b16 v[88:89], v20 offset:40960
 v_accvgpr_write_b32 a23, 0
 v_mfma_f32_16x16x32_bf16 v[224:227], v[64:67], a[152:155], v[224:227]
 ds_read_b64_tr_b16 v[90:91], v20 offset:41984
 s_add_u32 m0, s29, 4096
 v_mfma_f32_16x16x32_bf16 v[232:235], v[64:67], a[156:159], v[232:235]
 s_add_u32 s25, s25, 128
 s_lshl_b32 s92, s92, 1
 v_accvgpr_read_b32 v96, a24
 v_mfma_f32_16x16x32_bf16 v[232:235], v[60:63], a[140:143], v[232:235]
 s_waitcnt lgkmcnt(8)
 v_accvgpr_read_b32 v97, a25
 v_accvgpr_read_b32 v98, a26
 v_mfma_f32_16x16x32_bf16 v[164:167], v[68:71], a[128:131], v[164:167]
 ds_read_b64_tr_b16 v[60:61], v21 offset:32768
 v_accvgpr_read_b32 v99, a27
 v_mfma_f32_16x16x32_bf16 v[164:167], v[72:75], a[144:147], v[164:167]
 ds_read_b64_tr_b16 v[62:63], v21 offset:33792
 v_accvgpr_read_b32 v100, a28
 v_mfma_f32_16x16x32_bf16 v[172:175], v[72:75], a[148:151], v[172:175]
 buffer_load_dwordx4 v2, s[4:7], s26 offen offset:0  lds
 v_mfma_f32_16x16x32_bf16 v[172:175], v[68:71], a[132:135], v[172:175]
 s_sub_u32 s92, s92, s3
 v_accvgpr_read_b32 v101, a29
 v_accvgpr_read_b32 v102, a30
 v_mfma_f32_16x16x32_bf16 v[228:231], v[68:71], a[136:139], v[228:231]
 ds_read_b64_tr_b16 v[64:65], v21 offset:40960
 v_accvgpr_read_b32 v103, a31
 v_mfma_f32_16x16x32_bf16 v[228:231], v[72:75], a[152:155], v[228:231]
 ds_read_b64_tr_b16 v[66:67], v21 offset:41984
 v_cvt_pk_bf16_f32 v116, v96, v97
 v_mfma_f32_16x16x32_bf16 v[236:239], v[72:75], a[156:159], v[236:239]
 buffer_load_dwordx4 v3, s[4:7], s26 offen offset:1024  lds
 v_mfma_f32_16x16x32_bf16 v[236:239], v[68:71], a[140:143], v[236:239]
 s_waitcnt lgkmcnt(8)
 v_cvt_pk_bf16_f32 v117, v98, v99
 v_cvt_pk_bf16_f32 v118, v100, v101
 v_mfma_f32_16x16x32_bf16 a[240:243], v[76:79], v[92:95], a[240:243]
 ds_read_b64_tr_b16 v[68:69], v22 offset:32768
 v_cvt_pk_bf16_f32 v119, v102, v103
 v_mfma_f32_16x16x32_bf16 a[240:243], v[80:83], a[244:247], a[240:243]
 ds_read_b64_tr_b16 v[70:71], v22 offset:33280
 s_waitcnt lgkmcnt(6)
 v_mfma_f32_16x16x32_bf16 v[176:179], v[84:87], a[128:131], v[176:179]
 ds_read_b64_tr_b16 v[72:73], v22 offset:36864
 s_xor_b32 s67, s92, 7
 v_mfma_f32_16x16x32_bf16 v[176:179], v[88:91], a[144:147], v[176:179]
 ds_read_b64_tr_b16 v[74:75], v22 offset:37376
 v_mfma_f32_16x16x32_bf16 v[184:187], v[88:91], a[148:151], v[184:187]
 ds_read_b64_tr_b16 v[76:77], v23 offset:32768
 buffer_store_dwordx4 v[116:119], v1, s[16:19], s98 offen offset:1024
 v_mfma_f32_16x16x32_bf16 v[184:187], v[84:87], a[132:135], v[184:187]
 ds_read_b64_tr_b16 v[78:79], v23 offset:33280
 v_accvgpr_write_b32 a24, 0
 v_mfma_f32_16x16x32_bf16 v[240:243], v[84:87], a[136:139], v[240:243]
 ds_read_b64_tr_b16 v[80:81], v23 offset:36864
 s_lshl_b32 s93, s93, 1
 v_mfma_f32_16x16x32_bf16 v[240:243], v[88:91], a[152:155], v[240:243]
 ds_read_b64_tr_b16 v[82:83], v23 offset:37376
 v_accvgpr_write_b32 a25, 0
 v_mfma_f32_16x16x32_bf16 v[248:251], v[88:91], a[156:159], v[248:251]
 buffer_load_dwordx4 v4, s[4:7], s26 offen offset:2048  lds
 v_mfma_f32_16x16x32_bf16 v[248:251], v[84:87], a[140:143], v[248:251]
 s_waitcnt lgkmcnt(8)
 v_accvgpr_write_b32 a26, 0
 v_accvgpr_write_b32 a27, 0
 v_mfma_f32_16x16x32_bf16 v[180:183], v[60:63], a[128:131], v[180:183]
 ds_read_b64_tr_b16 v[84:85], v24 offset:32768
 v_accvgpr_write_b32 a28, 0
 v_mfma_f32_16x16x32_bf16 v[180:183], v[64:67], a[144:147], v[180:183]
 ds_read_b64_tr_b16 v[86:87], v24 offset:33280
 v_accvgpr_write_b32 a29, 0
 v_mfma_f32_16x16x32_bf16 v[188:191], v[64:67], a[148:151], v[188:191]
 buffer_load_dwordx4 v5, s[4:7], s26 offen offset:3072  lds
 v_mfma_f32_16x16x32_bf16 v[188:191], v[60:63], a[132:135], v[188:191]
 s_add_u32 s26, s26, 128
 s_sub_u32 s93, s93, s3
 v_accvgpr_write_b32 a30, 0
 v_mfma_f32_16x16x32_bf16 v[244:247], v[60:63], a[136:139], v[244:247]
 ds_read_b64_tr_b16 v[88:89], v24 offset:36864
 v_accvgpr_write_b32 a31, 0
 v_mfma_f32_16x16x32_bf16 v[244:247], v[64:67], a[152:155], v[244:247]
 ds_read_b64_tr_b16 v[90:91], v24 offset:37376
 v_accvgpr_read_b32 v96, a32
 v_mfma_f32_16x16x32_bf16 v[252:255], v[64:67], a[156:159], v[252:255]
 v_accvgpr_read_b32 v97, a33
 v_accvgpr_read_b32 v98, a34
 v_mfma_f32_16x16x32_bf16 v[252:255], v[60:63], a[140:143], v[252:255]
 s_waitcnt lgkmcnt(8)
 s_xor_b32 s45, s93, 7
 v_accvgpr_read_b32 v99, a35
 v_mfma_f32_16x16x32_bf16 a[192:195], v[68:71], a[128:131], a[192:195]
 v_accvgpr_read_b32 v100, a36
 v_accvgpr_read_b32 v101, a37
 v_mfma_f32_16x16x32_bf16 a[192:195], v[72:75], a[144:147], a[192:195]
 v_accvgpr_read_b32 v102, a38
 v_accvgpr_read_b32 v103, a39
 v_mfma_f32_16x16x32_bf16 a[200:203], v[72:75], a[148:151], a[200:203]
 v_cvt_pk_bf16_f32 v104, v96, v97
 v_cvt_pk_bf16_f32 v105, v98, v99
 v_mfma_f32_16x16x32_bf16 a[200:203], v[68:71], a[132:135], a[200:203]
 v_cvt_pk_bf16_f32 v106, v100, v101
 s_waitcnt vmcnt(11) lgkmcnt(0)
 s_barrier
 s_cmp_eq_u32 s63, 0
 s_cbranch_scc1 L_rel_11
L_reld_12:
 v_mfma_f32_16x16x32_bf16 a[208:211], v[68:71], a[136:139], a[208:211]
 ds_read_b64_tr_b16 v[60:61], v14 offset:0
 s_add_u32 m0, s30, 131072
 v_mfma_f32_16x16x32_bf16 a[208:211], v[72:75], a[152:155], a[208:211]
 ds_read_b64_tr_b16 v[62:63], v14 offset:1024
 s_nop 0
 v_mfma_f32_16x16x32_bf16 a[216:219], v[72:75], a[156:159], a[216:219]
 ds_read_b64_tr_b16 v[64:65], v14 offset:8192
 s_lshr_b32 s70, s37, 2
 v_mfma_f32_16x16x32_bf16 a[216:219], v[68:71], a[140:143], a[216:219]
 ds_read_b64_tr_b16 v[66:67], v14 offset:9216
 v_mfma_f32_16x16x32_bf16 a[196:199], v[76:79], a[128:131], a[196:199]
 ds_read_b128 v[28:31], v12 offset:0
 v_cvt_pk_bf16_f32 v107, v102, v103
 v_mfma_f32_16x16x32_bf16 a[196:199], v[80:83], a[144:147], a[196:199]
 ds_read_b128 v[44:47], v13 offset:0
 v_mfma_f32_16x16x32_bf16 a[204:207], v[80:83], a[148:151], a[204:207]
 ds_read_b128 v[32:35], v12 offset:2048
 s_lshl_b32 s70, s70, 19
 v_mfma_f32_16x16x32_bf16 a[204:207], v[76:79], a[132:135], a[204:207]
 ds_read_b64_tr_b16 v[68:69], v15 offset:0
 buffer_store_dwordx4 v[104:107], v1, s[16:19], s33 offen offset:2048
 v_mfma_f32_16x16x32_bf16 a[212:215], v[76:79], a[136:139], a[212:215]
 ds_read_b64_tr_b16 v[70:71], v15 offset:1024
 ds_read_b128 v[48:51], v13 offset:2048
 v_mfma_f32_16x16x32_bf16 a[212:215], v[80:83], a[152:155], a[212:215]
 ds_read_b128 v[36:39], v12 offset:4096
 ds_read_b128 v[52:55], v13 offset:4096
 v_mfma_f32_16x16x32_bf16 a[220:223], v[80:83], a[156:159], a[220:223]
 ds_read_b128 v[40:43], v12 offset:6144
 v_accvgpr_write_b32 a32, 0
 v_mfma_f32_16x16x32_bf16 a[220:223], v[76:79], a[140:143], a[220:223]
 ds_read_b64_tr_b16 v[72:73], v15 offset:8192
 v_mfma_f32_16x16x32_bf16 a[224:227], a[128:131], v[84:87], a[224:227]
 ds_read_b64_tr_b16 v[74:75], v15 offset:9216
 ds_read_b128 v[56:59], v13 offset:6144
 v_mfma_f32_16x16x32_bf16 a[224:227], a[144:147], v[88:91], a[224:227]
 s_and_b32 s71, s37, 3
 v_subrev_u32 v12, 0x10000, v12
 v_subrev_u32 v13, 0x10000, v13
 v_mfma_f32_16x16x32_bf16 a[228:231], a[148:151], v[88:91], a[228:231]
 ds_read_b64_tr_b16 v[76:77], v16 offset:0
 v_accvgpr_write_b32 a33, 0
 v_mfma_f32_16x16x32_bf16 a[228:231], a[132:135], v[84:87], a[228:231]
 ds_read_b64_tr_b16 v[78:79], v16 offset:1024
 buffer_load_dwordx4 v6, s[8:11], s27 offen offset:0  lds
 v_mfma_f32_16x16x32_bf16 a[232:235], a[136:139], v[84:87], a[232:235]
 ds_read_b64_tr_b16 v[80:81], v16 offset:8192
 v_accvgpr_write_b32 a34, 0
 v_mfma_f32_16x16x32_bf16 a[232:235], a[152:155], v[88:91], a[232:235]
 ds_read_b64_tr_b16 v[82:83], v16 offset:9216
 v_accvgpr_write_b32 a35, 0
 v_mfma_f32_16x16x32_bf16 a[236:239], a[156:159], v[88:91], a[236:239]
 buffer_load_dwordx4 v7, s[8:11], s27 offen offset:1024  lds
 v_mfma_f32_16x16x32_bf16 a[236:239], a[140:143], v[84:87], a[236:239]
 s_waitcnt lgkmcnt(4)
 s_lshl_b32 s71, s71, 11
 v_accvgpr_write_b32 a36, 0
 v_mfma_f32_16x16x32_bf16 v[128:131], v[60:63], v[28:31], v[128:131]
 ds_read_b64_tr_b16 v[84:85], v17 offset:0
 v_accvgpr_write_b32 a37, 0
 v_mfma_f32_16x16x32_bf16 v[128:131], v[64:67], v[44:47], v[128:131]
 ds_read_b64_tr_b16 v[86:87], v17 offset:1024
 buffer_load_dwordx4 v8, s[8:11], s27 offen offset:2048  lds
 v_mfma_f32_16x16x32_bf16 v[136:139], v[64:67], v[48:51], v[136:139]
 buffer_load_dwordx4 v9, s[8:11], s27 offen offset:3072  lds
 v_mfma_f32_16x16x32_bf16 v[136:139], v[60:63], v[32:35], v[136:139]
 s_add_u32 m0, s31, 147456
 s_add_u32 s27, s27, 524288
 s_add_u32 s70, s70, s71
 v_mfma_f32_16x16x32_bf16 v[192:195], v[60:63], v[36:39], v[192:195]
 ds_read_b64_tr_b16 v[88:89], v17 offset:8192
 v_accvgpr_write_b32 a38, 0
 v_mfma_f32_16x16x32_bf16 v[192:195], v[64:67], v[52:55], v[192:195]
 ds_read_b64_tr_b16 v[90:91], v17 offset:9216
 v_accvgpr_write_b32 a39, 0
 v_mfma_f32_16x16x32_bf16 v[200:203], v[64:67], v[56:59], v[200:203]
 buffer_load_dwordx4 v10, s[12:15], s28 offen offset:0  lds
 v_mfma_f32_16x16x32_bf16 v[200:203], v[60:63], v[40:43], v[200:203]
 v_accvgpr_read_b32 v96, a40
 v_accvgpr_read_b32 v97, a41
 v_mfma_f32_16x16x32_bf16 v[132:135], v[68:71], v[28:31], v[132:135]
 ds_read_b64_tr_b16 v[60:61], v18 offset:0
 v_accvgpr_read_b32 v98, a42
 v_mfma_f32_16x16x32_bf16 v[132:135], v[72:75], v[44:47], v[132:135]
 ds_read_b64_tr_b16 v[62:63], v18 offset:1024
 s_lshl_b32 s71, s36, 13
 v_mfma_f32_16x16x32_bf16 v[140:143], v[72:75], v[48:51], v[140:143]
 buffer_load_dwordx4 v11, s[12:15], s28 offen offset:1024  lds
 v_mfma_f32_16x16x32_bf16 v[140:143], v[68:71], v[32:35], v[140:143]
 s_add_u32 s28, s28, 196608
 v_accvgpr_read_b32 v99, a43
 v_accvgpr_read_b32 v100, a44
 v_mfma_f32_16x16x32_bf16 v[196:199], v[68:71], v[36:39], v[196:199]
 ds_read_b64_tr_b16 v[64:65], v18 offset:8192
 v_accvgpr_read_b32 v101, a45
 v_mfma_f32_16x16x32_bf16 v[196:199], v[72:75], v[52:55], v[196:199]
 ds_read_b64_tr_b16 v[66:67], v18 offset:9216
 buffer_store_dword v120, v121, s[16:19], s94 offen sc1
 v_mfma_f32_16x16x32_bf16 v[204:207], v[72:75], v[56:59], v[204:207]
 s_add_u32 m0, s29, 32768
 s_add_u32 s38, s70, s71
 v_accvgpr_read_b32 v102, a46
 v_mfma_f32_16x16x32_bf16 v[204:207], v[68:71], v[40:43], v[204:207]
 s_waitcnt lgkmcnt(8)
 s_nop 0
 v_accvgpr_read_b32 v103, a47
 v_mfma_f32_16x16x32_bf16 v[144:147], v[76:79], v[28:31], v[144:147]
 ds_read_b64_tr_b16 v[68:69], v19 offset:0
 v_cvt_pk_bf16_f32 v108, v96, v97
 v_mfma_f32_16x16x32_bf16 v[144:147], v[80:83], v[44:47], v[144:147]
 ds_read_b64_tr_b16 v[70:71], v19 offset:1024
 v_cvt_pk_bf16_f32 v109, v98, v99
 v_mfma_f32_16x16x32_bf16 v[152:155], v[80:83], v[48:51], v[152:155]
 buffer_load_dwordx4 v2, s[4:7], s25 offen offset:0  lds
 v_mfma_f32_16x16x32_bf16 v[152:155], v[76:79], v[32:35], v[152:155]
 v_cvt_pk_bf16_f32 v110, v100, v101
 v_cvt_pk_bf16_f32 v111, v102, v103
 v_mfma_f32_16x16x32_bf16 v[208:211], v[76:79], v[36:39], v[208:211]
 ds_read_b64_tr_b16 v[72:73], v19 offset:8192
 s_max_u32 s71, s36, 1
 v_mfma_f32_16x16x32_bf16 v[208:211], v[80:83], v[52:55], v[208:211]
 ds_read_b64_tr_b16 v[74:75], v19 offset:9216
 v_mfma_f32_16x16x32_bf16 v[216:219], v[80:83], v[56:59], v[216:219]
 buffer_load_dwordx4 v3, s[4:7], s25 offen offset:1024  lds
 v_mfma_f32_16x16x32_bf16 v[216:219], v[76:79], v[40:43], v[216:219]
 buffer_store_dwordx4 v[108:111], v1, s[16:19], s33 offen offset:3072
 s_waitcnt lgkmcnt(8)
 v_mfma_f32_16x16x32_bf16 v[148:151], v[84:87], v[28:31], v[148:151]
 ds_read_b128 v[76:79], v25 offset:512
 v_accvgpr_write_b32 a40, 0
 v_mfma_f32_16x16x32_bf16 v[148:151], v[88:91], v[44:47], v[148:151]
 ds_read_b128 v[92:95], v26
 v_subrev_u32 v26, 0x10000, v26
 v_mfma_f32_16x16x32_bf16 v[156:159], v[88:91], v[48:51], v[156:159]
 s_sub_u32 s71, s71, 1
 v_accvgpr_write_b32 a41, 0
 v_accvgpr_write_b32 a42, 0
 v_mfma_f32_16x16x32_bf16 v[156:159], v[84:87], v[32:35], v[156:159]
 buffer_load_dwordx4 v4, s[4:7], s25 offen offset:2048  lds
 v_mfma_f32_16x16x32_bf16 v[212:215], v[84:87], v[36:39], v[212:215]
 ds_read_b128 v[80:83], v25 offset:576
 v_accvgpr_write_b32 a43, 0
 v_mfma_f32_16x16x32_bf16 v[212:215], v[88:91], v[52:55], v[212:215]
 ds_read_b128 a[244:247], v27
 v_subrev_u32 v27, 0x10000, v27
 v_mfma_f32_16x16x32_bf16 v[220:223], v[88:91], v[56:59], v[220:223]
 v_accvgpr_write_b32 a44, 0
 v_accvgpr_write_b32 a45, 0
 v_mfma_f32_16x16x32_bf16 v[220:223], v[84:87], v[40:43], v[220:223]
 s_waitcnt lgkmcnt(8)
 s_lshl_b32 s71, s71, 13
 v_accvgpr_write_b32 a46, 0
 v_mfma_f32_16x16x32_bf16 v[160:163], v[60:63], v[28:31], v[160:163]
 ds_read_b64_tr_b16 v[84:85], v20 offset:0
 v_accvgpr_write_b32 a47, 0
 v_mfma_f32_16x16x32_bf16 v[160:163], v[64:67], v[44:47], v[160:163]
 ds_read_b64_tr_b16 v[86:87], v20 offset:1024
 v_accvgpr_read_b32 v96, a48
 v_mfma_f32_16x16x32_bf16 v[168:171], v[64:67], v[48:51], v[168:171]
 buffer_load_dwordx4 v5, s[4:7], s25 offen offset:3072  lds
 v_mfma_f32_16x16x32_bf16 v[168:171], v[60:63], v[32:35], v[168:171]
 v_accvgpr_read_b32 v97, a49
 v_accvgpr_read_b32 v98, a50
 v_mfma_f32_16x16x32_bf16 v[224:227], v[60:63], v[36:39], v[224:227]
 ds_read_b64_tr_b16 v[88:89], v20 offset:8192
 s_add_u32 s39, s70, s71
 v_mfma_f32_16x16x32_bf16 v[224:227], v[64:67], v[52:55], v[224:227]
 ds_read_b64_tr_b16 v[90:91], v20 offset:9216
 s_add_u32 m0, s29, 36864
 v_mfma_f32_16x16x32_bf16 v[232:235], v[64:67], v[56:59], v[232:235]
 s_add_u32 s25, s25, 128
 v_accvgpr_read_b32 v99, a51
 v_accvgpr_read_b32 v100, a52
 v_mfma_f32_16x16x32_bf16 v[232:235], v[60:63], v[40:43], v[232:235]
 s_waitcnt lgkmcnt(8)
 v_accvgpr_read_b32 v101, a53
 v_accvgpr_read_b32 v102, a54
 v_mfma_f32_16x16x32_bf16 v[164:167], v[68:71], v[28:31], v[164:167]
 ds_read_b64_tr_b16 v[60:61], v21 offset:0
 v_accvgpr_read_b32 v103, a55
 v_mfma_f32_16x16x32_bf16 v[164:167], v[72:75], v[44:47], v[164:167]
 ds_read_b64_tr_b16 v[62:63], v21 offset:1024
 v_cvt_pk_bf16_f32 v112, v96, v97
 v_mfma_f32_16x16x32_bf16 v[172:175], v[72:75], v[48:51], v[172:175]
 buffer_load_dwordx4 v2, s[4:7], s26 offen offset:0  lds
 v_mfma_f32_16x16x32_bf16 v[172:175], v[68:71], v[32:35], v[172:175]
 s_add_u32 s39, s39, 2097152
 v_cvt_pk_bf16_f32 v113, v98, v99
 v_cvt_pk_bf16_f32 v114, v100, v101
 v_mfma_f32_16x16x32_bf16 v[228:231], v[68:71], v[36:39], v[228:231]
 ds_read_b64_tr_b16 v[64:65], v21 offset:8192
 v_cvt_pk_bf16_f32 v115, v102, v103
 v_mfma_f32_16x16x32_bf16 v[228:231], v[72:75], v[52:55], v[228:231]
 ds_read_b64_tr_b16 v[66:67], v21 offset:9216
 v_mfma_f32_16x16x32_bf16 v[236:239], v[72:75], v[56:59], v[236:239]
 buffer_load_dwordx4 v3, s[4:7], s26 offen offset:1024  lds
 v_mfma_f32_16x16x32_bf16 v[236:239], v[68:71], v[40:43], v[236:239]
 buffer_store_dwordx4 v[112:115], v1, s[16:19], s98 offen offset:2048
 s_waitcnt lgkmcnt(8)
 v_mfma_f32_16x16x32_bf16 a[240:243], v[76:79], v[92:95], a[240:243]
 ds_read_b64_tr_b16 v[68:69], v22 offset:0
 s_lshr_b32 s70, s2, 3
 v_mfma_f32_16x16x32_bf16 a[240:243], v[80:83], a[244:247], a[240:243]
 ds_read_b64_tr_b16 v[70:71], v22 offset:512
 s_waitcnt lgkmcnt(6)
 v_mfma_f32_16x16x32_bf16 v[176:179], v[84:87], v[28:31], v[176:179]
 ds_read_b64_tr_b16 v[72:73], v22 offset:4096
 v_accvgpr_write_b32 a48, 0
 v_mfma_f32_16x16x32_bf16 v[176:179], v[88:91], v[44:47], v[176:179]
 ds_read_b64_tr_b16 v[74:75], v22 offset:4608
 v_accvgpr_write_b32 a49, 0
 v_mfma_f32_16x16x32_bf16 v[184:187], v[88:91], v[48:51], v[184:187]
 ds_read_b64_tr_b16 v[76:77], v23 offset:0
 v_accvgpr_write_b32 a50, 0
 v_mfma_f32_16x16x32_bf16 v[184:187], v[84:87], v[32:35], v[184:187]
 ds_read_b64_tr_b16 v[78:79], v23 offset:512
 s_lshl_b32 s70, s70, 2
 v_mfma_f32_16x16x32_bf16 v[240:243], v[84:87], v[36:39], v[240:243]
 ds_read_b64_tr_b16 v[80:81], v23 offset:4096
 v_accvgpr_write_b32 a51, 0
 v_mfma_f32_16x16x32_bf16 v[240:243], v[88:91], v[52:55], v[240:243]
 ds_read_b64_tr_b16 v[82:83], v23 offset:4608
 v_accvgpr_write_b32 a52, 0
 v_mfma_f32_16x16x32_bf16 v[248:251], v[88:91], v[56:59], v[248:251]
 buffer_load_dwordx4 v4, s[4:7], s26 offen offset:2048  lds
 v_mfma_f32_16x16x32_bf16 v[248:251], v[84:87], v[40:43], v[248:251]
 s_waitcnt lgkmcnt(8)
 v_accvgpr_write_b32 a53, 0
 v_accvgpr_write_b32 a54, 0
 v_mfma_f32_16x16x32_bf16 v[180:183], v[60:63], v[28:31], v[180:183]
 ds_read_b64_tr_b16 v[84:85], v24 offset:0
 v_accvgpr_write_b32 a55, 0
 v_mfma_f32_16x16x32_bf16 v[180:183], v[64:67], v[44:47], v[180:183]
 ds_read_b64_tr_b16 v[86:87], v24 offset:512
 s_add_u32 s70, s70, s3
 v_mfma_f32_16x16x32_bf16 v[188:191], v[64:67], v[48:51], v[188:191]
 buffer_load_dwordx4 v5, s[4:7], s26 offen offset:3072  lds
 v_mfma_f32_16x16x32_bf16 v[188:191], v[60:63], v[32:35], v[188:191]
 s_add_u32 s26, s26, 128
 v_accvgpr_read_b32 v96, a56
 v_accvgpr_read_b32 v97, a57
 v_mfma_f32_16x16x32_bf16 v[244:247], v[60:63], v[36:39], v[244:247]
 ds_read_b64_tr_b16 v[88:89], v24 offset:4096
 v_accvgpr_read_b32 v98, a58
 v_mfma_f32_16x16x32_bf16 v[244:247], v[64:67], v[52:55], v[244:247]
 ds_read_b64_tr_b16 v[90:91], v24 offset:4608
 v_accvgpr_read_b32 v99, a59
 v_mfma_f32_16x16x32_bf16 v[252:255], v[64:67], v[56:59], v[252:255]
 s_and_b32 s71, s2, 1
 v_accvgpr_read_b32 v100, a60
 v_accvgpr_read_b32 v101, a61
 v_mfma_f32_16x16x32_bf16 v[252:255], v[60:63], v[40:43], v[252:255]
 s_waitcnt lgkmcnt(8)
 v_accvgpr_read_b32 v102, a62
 v_accvgpr_read_b32 v103, a63
 v_mfma_f32_16x16x32_bf16 a[192:195], v[68:71], v[28:31], a[192:195]
 v_cvt_pk_bf16_f32 v116, v96, v97
 v_cvt_pk_bf16_f32 v117, v98, v99
 v_mfma_f32_16x16x32_bf16 a[192:195], v[72:75], v[44:47], a[192:195]
 v_cvt_pk_bf16_f32 v118, v100, v101
 v_cvt_pk_bf16_f32 v119, v102, v103
 v_mfma_f32_16x16x32_bf16 a[200:203], v[72:75], v[48:51], a[200:203]
 buffer_store_dwordx4 v[116:119], v1, s[16:19], s98 offen offset:3072
 v_mfma_f32_16x16x32_bf16 a[200:203], v[68:71], v[32:35], a[200:203]
 s_add_u32 s33, s33, 4096
 s_waitcnt vmcnt(12) lgkmcnt(0)
 s_barrier
 v_mfma_f32_16x16x32_bf16 a[208:211], v[68:71], v[36:39], a[208:211]
 ds_read_b64_tr_b16 v[60:61], v14 offset:32768
 s_add_u32 m0, s30, 98304
 v_mfma_f32_16x16x32_bf16 a[208:211], v[72:75], v[52:55], a[208:211]
 ds_read_b64_tr_b16 v[62:63], v14 offset:33792
 s_nop 0
 v_mfma_f32_16x16x32_bf16 a[216:219], v[72:75], v[56:59], a[216:219]
 ds_read_b64_tr_b16 v[64:65], v14 offset:40960
 s_lshl_b32 s71, s71, 6
 v_mfma_f32_16x16x32_bf16 a[216:219], v[68:71], v[40:43], a[216:219]
 ds_read_b64_tr_b16 v[66:67], v14 offset:41984
 v_mfma_f32_16x16x32_bf16 a[196:199], v[76:79], v[28:31], a[196:199]
 ds_read_b128 a[128:131], v12 offset:0
 s_add_u32 s98, s98, 4096
 v_mfma_f32_16x16x32_bf16 a[196:199], v[80:83], v[44:47], a[196:199]
 ds_read_b128 a[144:147], v13 offset:0
 s_xor_b32 s70, s70, s71
 v_mfma_f32_16x16x32_bf16 a[204:207], v[80:83], v[48:51], a[204:207]
 ds_read_b128 a[132:135], v12 offset:2048
 v_accvgpr_write_b32 a56, 0
 v_mfma_f32_16x16x32_bf16 a[204:207], v[76:79], v[32:35], a[204:207]
 ds_read_b64_tr_b16 v[68:69], v15 offset:32768
 v_accvgpr_write_b32 a57, 0
 v_mfma_f32_16x16x32_bf16 a[212:215], v[76:79], v[36:39], a[212:215]
 ds_read_b64_tr_b16 v[70:71], v15 offset:33792
 ds_read_b128 a[148:151], v13 offset:2048
 v_mfma_f32_16x16x32_bf16 a[212:215], v[80:83], v[52:55], a[212:215]
 ds_read_b128 a[136:139], v12 offset:4096
 ds_read_b128 a[152:155], v13 offset:4096
 v_mfma_f32_16x16x32_bf16 a[220:223], v[80:83], v[56:59], a[220:223]
 ds_read_b128 a[140:143], v12 offset:6144
 v_accvgpr_write_b32 a58, 0
 v_mfma_f32_16x16x32_bf16 a[220:223], v[76:79], v[40:43], a[220:223]
 ds_read_b64_tr_b16 v[72:73], v15 offset:40960
 v_mfma_f32_16x16x32_bf16 a[224:227], v[28:31], v[84:87], a[224:227]
 ds_read_b64_tr_b16 v[74:75], v15 offset:41984
 ds_read_b128 a[156:159], v13 offset:6144
 v_mfma_f32_16x16x32_bf16 a[224:227], v[44:47], v[88:91], a[224:227]
 s_and_b32 s71, s2, 6
 v_add_u32 v12, 0x8000, v12
 v_add_u32 v13, 0x8000, v13
 v_mfma_f32_16x16x32_bf16 a[228:231], v[48:51], v[88:91], a[228:231]
 ds_read_b64_tr_b16 v[76:77], v16 offset:32768
 v_accvgpr_write_b32 a59, 0
 v_mfma_f32_16x16x32_bf16 a[228:231], v[32:35], v[84:87], a[228:231]
 ds_read_b64_tr_b16 v[78:79], v16 offset:33792
 v_accvgpr_write_b32 a60, 0
 v_mfma_f32_16x16x32_bf16 a[232:235], v[36:39], v[84:87], a[232:235]
 ds_read_b64_tr_b16 v[80:81], v16 offset:40960
 v_accvgpr_write_b32 a61, 0
 v_mfma_f32_16x16x32_bf16 a[232:235], v[52:55], v[88:91], a[232:235]
 ds_read_b64_tr_b16 v[82:83], v16 offset:41984
 buffer_load_dwordx4 v6, s[8:11], s27 offen offset:0  lds
 v_mfma_f32_16x16x32_bf16 a[236:239], v[56:59], v[88:91], a[236:239]
 buffer_load_dwordx4 v7, s[8:11], s27 offen offset:1024  lds
 v_mfma_f32_16x16x32_bf16 a[236:239], v[40:43], v[84:87], a[236:239]
 s_waitcnt lgkmcnt(4)
 s_lshl_b32 s71, s71, 6
 v_accvgpr_write_b32 a62, 0
 v_mfma_f32_16x16x32_bf16 v[128:131], v[60:63], a[128:131], v[128:131]
 ds_read_b64_tr_b16 v[84:85], v17 offset:32768
 v_accvgpr_write_b32 a63, 0
 v_mfma_f32_16x16x32_bf16 v[128:131], v[64:67], a[144:147], v[128:131]
 ds_read_b64_tr_b16 v[86:87], v17 offset:33792
 v_accvgpr_read_b32 v96, a64
 v_mfma_f32_16x16x32_bf16 v[136:139], v[64:67], a[148:151], v[136:139]
 buffer_load_dwordx4 v8, s[8:11], s27 offen offset:2048  lds
 v_mfma_f32_16x16x32_bf16 v[136:139], v[60:63], a[132:135], v[136:139]
 buffer_load_dwordx4 v9, s[8:11], s27 offen offset:3072  lds
 v_mfma_f32_16x16x32_bf16 v[192:195], v[60:63], a[136:139], v[192:195]
 ds_read_b64_tr_b16 v[88:89], v17 offset:40960
 s_add_u32 m0, s31, 114688
 v_mfma_f32_16x16x32_bf16 v[192:195], v[64:67], a[152:155], v[192:195]
 ds_read_b64_tr_b16 v[90:91], v17 offset:41984
 s_add_u32 s27, s27, 524288
 v_mfma_f32_16x16x32_bf16 v[200:203], v[64:67], a[156:159], v[200:203]
 buffer_load_dwordx4 v10, s[12:15], s28 offen offset:0  lds
 v_mfma_f32_16x16x32_bf16 v[200:203], v[60:63], a[140:143], v[200:203]
 s_add_u32 s70, s70, s71
 v_accvgpr_read_b32 v97, a65
 v_mfma_f32_16x16x32_bf16 v[132:135], v[68:71], a[128:131], v[132:135]
 ds_read_b64_tr_b16 v[60:61], v18 offset:32768
 s_lshl_b32 s68, s70, 6
 v_mfma_f32_16x16x32_bf16 v[132:135], v[72:75], a[144:147], v[132:135]
 ds_read_b64_tr_b16 v[62:63], v18 offset:33792
 v_accvgpr_read_b32 v98, a66
 v_mfma_f32_16x16x32_bf16 v[140:143], v[72:75], a[148:151], v[140:143]
 buffer_load_dwordx4 v11, s[12:15], s28 offen offset:1024  lds
 v_mfma_f32_16x16x32_bf16 v[140:143], v[68:71], a[132:135], v[140:143]
 s_add_u32 s28, s28, 196608
 v_accvgpr_read_b32 v99, a67
 v_accvgpr_read_b32 v100, a68
 v_mfma_f32_16x16x32_bf16 v[196:199], v[68:71], a[136:139], v[196:199]
 ds_read_b64_tr_b16 v[64:65], v18 offset:40960
 v_accvgpr_read_b32 v101, a69
 v_mfma_f32_16x16x32_bf16 v[196:199], v[72:75], a[152:155], v[196:199]
 ds_read_b64_tr_b16 v[66:67], v18 offset:41984
 global_load_dword v122, v127, s[0:1]
 v_mfma_f32_16x16x32_bf16 v[204:207], v[72:75], a[156:159], v[204:207]
 s_add_u32 m0, s29, 65536
 s_lshl_b32 s69, s70, 3
 v_accvgpr_read_b32 v102, a70
 v_mfma_f32_16x16x32_bf16 v[204:207], v[68:71], a[140:143], v[204:207]
 s_waitcnt lgkmcnt(8)
 s_nop 0
 v_accvgpr_read_b32 v103, a71
 v_mfma_f32_16x16x32_bf16 v[144:147], v[76:79], a[128:131], v[144:147]
 ds_read_b64_tr_b16 v[68:69], v19 offset:32768
 v_cvt_pk_bf16_f32 v104, v96, v97
 v_mfma_f32_16x16x32_bf16 v[144:147], v[80:83], a[144:147], v[144:147]
 ds_read_b64_tr_b16 v[70:71], v19 offset:33792
 v_cvt_pk_bf16_f32 v105, v98, v99
 v_mfma_f32_16x16x32_bf16 v[152:155], v[80:83], a[148:151], v[152:155]
 buffer_load_dwordx4 v2, s[4:7], s25 offen offset:0  lds
 v_mfma_f32_16x16x32_bf16 v[152:155], v[76:79], a[132:135], v[152:155]
 s_mul_i32 s62, s61, 196608
 v_cvt_pk_bf16_f32 v106, v100, v101
 v_cvt_pk_bf16_f32 v107, v102, v103
 v_mfma_f32_16x16x32_bf16 v[208:211], v[76:79], a[136:139], v[208:211]
 ds_read_b64_tr_b16 v[72:73], v19 offset:40960
 buffer_store_dwordx4 v[104:107], v1, s[16:19], s33 offen offset:0
 v_mfma_f32_16x16x32_bf16 v[208:211], v[80:83], a[152:155], v[208:211]
 ds_read_b64_tr_b16 v[74:75], v19 offset:41984
 v_accvgpr_write_b32 a64, 0
 v_mfma_f32_16x16x32_bf16 v[216:219], v[80:83], a[156:159], v[216:219]
 buffer_load_dwordx4 v3, s[4:7], s25 offen offset:1024  lds
 v_mfma_f32_16x16x32_bf16 v[216:219], v[76:79], a[140:143], v[216:219]
 s_waitcnt lgkmcnt(8)
 v_accvgpr_write_b32 a65, 0
 v_accvgpr_write_b32 a66, 0
 v_mfma_f32_16x16x32_bf16 v[148:151], v[84:87], a[128:131], v[148:151]
 ds_read_b128 v[76:79], v25 offset:640
 s_add_u32 s62, s62, s50
 v_mfma_f32_16x16x32_bf16 v[148:151], v[88:91], a[144:147], v[148:151]
 ds_read_b128 v[92:95], v26
 v_add_u32 v26, 0x8000, v26
 v_mfma_f32_16x16x32_bf16 v[156:159], v[88:91], a[148:151], v[156:159]
 v_accvgpr_write_b32 a67, 0
 v_accvgpr_write_b32 a68, 0
 v_mfma_f32_16x16x32_bf16 v[156:159], v[84:87], a[132:135], v[156:159]
 buffer_load_dwordx4 v4, s[4:7], s25 offen offset:2048  lds
 v_mfma_f32_16x16x32_bf16 v[212:215], v[84:87], a[136:139], v[212:215]
 ds_read_b128 v[80:83], v25 offset:704
 v_accvgpr_write_b32 a69, 0
 v_mfma_f32_16x16x32_bf16 v[212:215], v[88:91], a[152:155], v[212:215]
 ds_read_b128 a[244:247], v27
 v_add_u32 v27, 0x8000, v27
 v_mfma_f32_16x16x32_bf16 v[220:223], v[88:91], a[156:159], v[220:223]
 s_add_u32 s62, s62, 0x5500000
 v_accvgpr_write_b32 a70, 0
 v_accvgpr_write_b32 a71, 0
 v_mfma_f32_16x16x32_bf16 v[220:223], v[84:87], a[140:143], v[220:223]
 s_waitcnt lgkmcnt(8)
 v_accvgpr_read_b32 v96, a72
 v_accvgpr_read_b32 v97, a73
 v_mfma_f32_16x16x32_bf16 v[160:163], v[60:63], a[128:131], v[160:163]
 ds_read_b64_tr_b16 v[84:85], v20 offset:32768
 v_accvgpr_read_b32 v98, a74
 v_mfma_f32_16x16x32_bf16 v[160:163], v[64:67], a[144:147], v[160:163]
 ds_read_b64_tr_b16 v[86:87], v20 offset:33792
 v_accvgpr_read_b32 v99, a75
 v_mfma_f32_16x16x32_bf16 v[168:171], v[64:67], a[148:151], v[168:171]
 buffer_load_dwordx4 v5, s[4:7], s25 offen offset:3072  lds
 v_mfma_f32_16x16x32_bf16 v[168:171], v[60:63], a[132:135], v[168:171]
 s_lshr_b32 s95, s20, 3
 v_accvgpr_read_b32 v100, a76
 v_accvgpr_read_b32 v101, a77
 v_mfma_f32_16x16x32_bf16 v[224:227], v[60:63], a[136:139], v[224:227]
 ds_read_b64_tr_b16 v[88:89], v20 offset:40960
 v_accvgpr_read_b32 v102, a78
 v_mfma_f32_16x16x32_bf16 v[224:227], v[64:67], a[152:155], v[224:227]
 ds_read_b64_tr_b16 v[90:91], v20 offset:41984
 s_add_u32 m0, s29, 69632
 v_mfma_f32_16x16x32_bf16 v[232:235], v[64:67], a[156:159], v[232:235]
 s_add_u32 s25, s25, 128
 v_accvgpr_read_b32 v103, a79
 v_cvt_pk_bf16_f32 v108, v96, v97
 v_mfma_f32_16x16x32_bf16 v[232:235], v[60:63], a[140:143], v[232:235]
 s_waitcnt lgkmcnt(8)
 v_cvt_pk_bf16_f32 v109, v98, v99
 v_cvt_pk_bf16_f32 v110, v100, v101
 v_mfma_f32_16x16x32_bf16 v[164:167], v[68:71], a[128:131], v[164:167]
 ds_read_b64_tr_b16 v[60:61], v21 offset:32768
 v_cvt_pk_bf16_f32 v111, v102, v103
 v_mfma_f32_16x16x32_bf16 v[164:167], v[72:75], a[144:147], v[164:167]
 ds_read_b64_tr_b16 v[62:63], v21 offset:33792
 s_mul_i32 s95, s95, 49152
 v_mfma_f32_16x16x32_bf16 v[172:175], v[72:75], a[148:151], v[172:175]
 buffer_load_dwordx4 v2, s[4:7], s26 offen offset:0  lds
 v_mfma_f32_16x16x32_bf16 v[172:175], v[68:71], a[132:135], v[172:175]
 buffer_store_dwordx4 v[108:111], v1, s[16:19], s33 offen offset:1024
 v_mfma_f32_16x16x32_bf16 v[228:231], v[68:71], a[136:139], v[228:231]
 ds_read_b64_tr_b16 v[64:65], v21 offset:40960
 v_accvgpr_write_b32 a72, 0
 v_mfma_f32_16x16x32_bf16 v[228:231], v[72:75], a[152:155], v[228:231]
 ds_read_b64_tr_b16 v[66:67], v21 offset:41984
 v_accvgpr_write_b32 a73, 0
 v_mfma_f32_16x16x32_bf16 v[236:239], v[72:75], a[156:159], v[236:239]
 buffer_load_dwordx4 v3, s[4:7], s26 offen offset:1024  lds
 v_mfma_f32_16x16x32_bf16 v[236:239], v[68:71], a[140:143], v[236:239]
 s_waitcnt lgkmcnt(8)
 s_add_u32 s95, s95, s62
 v_accvgpr_write_b32 a74, 0
 v_mfma_f32_16x16x32_bf16 a[240:243], v[76:79], v[92:95], a[240:243]
 ds_read_b64_tr_b16 v[68:69], v22 offset:32768
 v_accvgpr_write_b32 a75, 0
 v_mfma_f32_16x16x32_bf16 a[240:243], v[80:83], a[244:247], a[240:243]
 ds_read_b64_tr_b16 v[70:71], v22 offset:33280
 s_waitcnt lgkmcnt(6)
 v_mfma_f32_16x16x32_bf16 v[176:179], v[84:87], a[128:131], v[176:179]
 ds_read_b64_tr_b16 v[72:73], v22 offset:36864
 v_accvgpr_write_b32 a76, 0
 v_mfma_f32_16x16x32_bf16 v[176:179], v[88:91], a[144:147], v[176:179]
 ds_read_b64_tr_b16 v[74:75], v22 offset:37376
 v_accvgpr_write_b32 a77, 0
 v_mfma_f32_16x16x32_bf16 v[184:187], v[88:91], a[148:151], v[184:187]
 ds_read_b64_tr_b16 v[76:77], v23 offset:32768
 s_add_u32 s70, s38, 2097152
 v_mfma_f32_16x16x32_bf16 v[184:187], v[84:87], a[132:135], v[184:187]
 ds_read_b64_tr_b16 v[78:79], v23 offset:33280
 v_accvgpr_write_b32 a78, 0
 v_mfma_f32_16x16x32_bf16 v[240:243], v[84:87], a[136:139], v[240:243]
 ds_read_b64_tr_b16 v[80:81], v23 offset:36864
 v_accvgpr_write_b32 a79, 0
 v_mfma_f32_16x16x32_bf16 v[240:243], v[88:91], a[152:155], v[240:243]
 ds_read_b64_tr_b16 v[82:83], v23 offset:37376
 v_accvgpr_read_b32 v96, a80
 v_mfma_f32_16x16x32_bf16 v[248:251], v[88:91], a[156:159], v[248:251]
 buffer_load_dwordx4 v4, s[4:7], s26 offen offset:2048  lds
 v_mfma_f32_16x16x32_bf16 v[248:251], v[84:87], a[140:143], v[248:251]
 s_waitcnt lgkmcnt(8)
 v_accvgpr_read_b32 v97, a81
 v_accvgpr_read_b32 v98, a82
 v_mfma_f32_16x16x32_bf16 v[180:183], v[60:63], a[128:131], v[180:183]
 ds_read_b64_tr_b16 v[84:85], v24 offset:32768
 s_add_u32 s71, s38, 4194304
 v_mfma_f32_16x16x32_bf16 v[180:183], v[64:67], a[144:147], v[180:183]
 ds_read_b64_tr_b16 v[86:87], v24 offset:33280
 v_accvgpr_read_b32 v99, a83
 v_mfma_f32_16x16x32_bf16 v[188:191], v[64:67], a[148:151], v[188:191]
 buffer_load_dwordx4 v5, s[4:7], s26 offen offset:3072  lds
 v_mfma_f32_16x16x32_bf16 v[188:191], v[60:63], a[132:135], v[188:191]
 s_add_u32 s26, s26, 128
 v_accvgpr_read_b32 v100, a84
 v_accvgpr_read_b32 v101, a85
 v_mfma_f32_16x16x32_bf16 v[244:247], v[60:63], a[136:139], v[244:247]
 ds_read_b64_tr_b16 v[88:89], v24 offset:36864
 v_accvgpr_read_b32 v102, a86
 v_mfma_f32_16x16x32_bf16 v[244:247], v[64:67], a[152:155], v[244:247]
 ds_read_b64_tr_b16 v[90:91], v24 offset:37376
 s_add_u32 s64, s39, 2097152
 v_mfma_f32_16x16x32_bf16 v[252:255], v[64:67], a[156:159], v[252:255]
 v_accvgpr_read_b32 v103, a87
 v_cvt_pk_bf16_f32 v112, v96, v97
 v_mfma_f32_16x16x32_bf16 v[252:255], v[60:63], a[140:143], v[252:255]
 s_waitcnt lgkmcnt(8)
 v_cvt_pk_bf16_f32 v113, v98, v99
 v_cvt_pk_bf16_f32 v114, v100, v101
 v_mfma_f32_16x16x32_bf16 a[192:195], v[68:71], a[128:131], a[192:195]
 v_cvt_pk_bf16_f32 v115, v102, v103
 v_mfma_f32_16x16x32_bf16 a[192:195], v[72:75], a[144:147], a[192:195]
 buffer_store_dwordx4 v[112:115], v1, s[16:19], s98 offen offset:0
 v_mfma_f32_16x16x32_bf16 a[200:203], v[72:75], a[148:151], a[200:203]
 v_accvgpr_write_b32 a80, 0
 v_accvgpr_write_b32 a81, 0
 v_mfma_f32_16x16x32_bf16 a[200:203], v[68:71], a[132:135], a[200:203]
 v_accvgpr_write_b32 a82, 0
 s_waitcnt vmcnt(12) lgkmcnt(0)
 s_barrier
 v_mfma_f32_16x16x32_bf16 a[208:211], v[68:71], a[136:139], a[208:211]
 ds_read_b64_tr_b16 v[60:61], v14 offset:0
 s_add_u32 m0, s30, 131072
 v_mfma_f32_16x16x32_bf16 a[208:211], v[72:75], a[152:155], a[208:211]
 ds_read_b64_tr_b16 v[62:63], v14 offset:1024
 s_nop 0
 v_mfma_f32_16x16x32_bf16 a[216:219], v[72:75], a[156:159], a[216:219]
 ds_read_b64_tr_b16 v[64:65], v14 offset:8192
 v_accvgpr_write_b32 a83, 0
 v_mfma_f32_16x16x32_bf16 a[216:219], v[68:71], a[140:143], a[216:219]
 ds_read_b64_tr_b16 v[66:67], v14 offset:9216
 v_mfma_f32_16x16x32_bf16 a[196:199], v[76:79], a[128:131], a[196:199]
 ds_read_b128 v[28:31], v12 offset:0
 v_accvgpr_write_b32 a84, 0
 v_mfma_f32_16x16x32_bf16 a[196:199], v[80:83], a[144:147], a[196:199]
 ds_read_b128 v[44:47], v13 offset:0
 v_accvgpr_write_b32 a85, 0
 v_mfma_f32_16x16x32_bf16 a[204:207], v[80:83], a[148:151], a[204:207]
 ds_read_b128 v[32:35], v12 offset:2048
 v_accvgpr_write_b32 a86, 0
 v_mfma_f32_16x16x32_bf16 a[204:207], v[76:79], a[132:135], a[204:207]
 ds_read_b64_tr_b16 v[68:69], v15 offset:0
 v_accvgpr_write_b32 a87, 0
 v_mfma_f32_16x16x32_bf16 a[212:215], v[76:79], a[136:139], a[212:215]
 ds_read_b64_tr_b16 v[70:71], v15 offset:1024
 ds_read_b128 v[48:51], v13 offset:2048
 v_mfma_f32_16x16x32_bf16 a[212:215], v[80:83], a[152:155], a[212:215]
 ds_read_b128 v[36:39], v12 offset:4096
 ds_read_b128 v[52:55], v13 offset:4096
 v_mfma_f32_16x16x32_bf16 a[220:223], v[80:83], a[156:159], a[220:223]
 ds_read_b128 v[40:43], v12 offset:6144
 v_accvgpr_read_b32 v96, a88
 v_mfma_f32_16x16x32_bf16 a[220:223], v[76:79], a[140:143], a[220:223]
 ds_read_b64_tr_b16 v[72:73], v15 offset:8192
 v_mfma_f32_16x16x32_bf16 a[224:227], a[128:131], v[84:87], a[224:227]
 ds_read_b64_tr_b16 v[74:75], v15 offset:9216
 ds_read_b128 v[56:59], v13 offset:6144
 v_mfma_f32_16x16x32_bf16 a[224:227], a[144:147], v[88:91], a[224:227]
 v_add_u32 v12, 0x8000, v12
 v_add_u32 v13, 0x8000, v13
 v_mfma_f32_16x16x32_bf16 a[228:231], a[148:151], v[88:91], a[228:231]
 ds_read_b64_tr_b16 v[76:77], v16 offset:0
 v_accvgpr_read_b32 v97, a89
 v_mfma_f32_16x16x32_bf16 a[228:231], a[132:135], v[84:87], a[228:231]
 ds_read_b64_tr_b16 v[78:79], v16 offset:1024
 v_accvgpr_read_b32 v98, a90
 v_mfma_f32_16x16x32_bf16 a[232:235], a[136:139], v[84:87], a[232:235]
 ds_read_b64_tr_b16 v[80:81], v16 offset:8192
 v_accvgpr_read_b32 v99, a91
 v_mfma_f32_16x16x32_bf16 a[232:235], a[152:155], v[88:91], a[232:235]
 ds_read_b64_tr_b16 v[82:83], v16 offset:9216
 v_accvgpr_read_b32 v100, a92
 v_mfma_f32_16x16x32_bf16 a[236:239], a[156:159], v[88:91], a[236:239]
 buffer_load_dwordx4 v6, s[8:11], s27 offen offset:0  lds
 v_mfma_f32_16x16x32_bf16 a[236:239], a[140:143], v[84:87], a[236:239]
 s_waitcnt lgkmcnt(4)
 v_accvgpr_read_b32 v101, a93
 v_accvgpr_read_b32 v102, a94
 v_mfma_f32_16x16x32_bf16 v[128:131], v[60:63], v[28:31], v[128:131]
 ds_read_b64_tr_b16 v[84:85], v17 offset:0
 v_accvgpr_read_b32 v103, a95
 v_mfma_f32_16x16x32_bf16 v[128:131], v[64:67], v[44:47], v[128:131]
 ds_read_b64_tr_b16 v[86:87], v17 offset:1024
 buffer_load_dwordx4 v7, s[8:11], s27 offen offset:1024  lds
 v_mfma_f32_16x16x32_bf16 v[136:139], v[64:67], v[48:51], v[136:139]
 buffer_load_dwordx4 v8, s[8:11], s27 offen offset:2048  lds
 v_mfma_f32_16x16x32_bf16 v[136:139], v[60:63], v[32:35], v[136:139]
 buffer_load_dwordx4 v9, s[8:11], s27 offen offset:3072  lds
 v_mfma_f32_16x16x32_bf16 v[192:195], v[60:63], v[36:39], v[192:195]
 ds_read_b64_tr_b16 v[88:89], v17 offset:8192
 s_add_u32 m0, s31, 147456
 v_mfma_f32_16x16x32_bf16 v[192:195], v[64:67], v[52:55], v[192:195]
 ds_read_b64_tr_b16 v[90:91], v17 offset:9216
 s_add_u32 s27, s27, 524288
 v_mfma_f32_16x16x32_bf16 v[200:203], v[64:67], v[56:59], v[200:203]
 buffer_load_dwordx4 v10, s[12:15], s28 offen offset:0  lds
 v_mfma_f32_16x16x32_bf16 v[200:203], v[60:63], v[40:43], v[200:203]
 v_cvt_pk_bf16_f32 v116, v96, v97
 v_cvt_pk_bf16_f32 v117, v98, v99
 v_mfma_f32_16x16x32_bf16 v[132:135], v[68:71], v[28:31], v[132:135]
 ds_read_b64_tr_b16 v[60:61], v18 offset:0
 v_cvt_pk_bf16_f32 v118, v100, v101
 v_mfma_f32_16x16x32_bf16 v[132:135], v[72:75], v[44:47], v[132:135]
 ds_read_b64_tr_b16 v[62:63], v18 offset:1024
 v_cvt_pk_bf16_f32 v119, v102, v103
 v_mfma_f32_16x16x32_bf16 v[140:143], v[72:75], v[48:51], v[140:143]
 buffer_load_dwordx4 v11, s[12:15], s28 offen offset:1024  lds
 v_mfma_f32_16x16x32_bf16 v[140:143], v[68:71], v[32:35], v[140:143]
 buffer_store_dwordx4 v[116:119], v1, s[16:19], s98 offen offset:1024
 v_mfma_f32_16x16x32_bf16 v[196:199], v[68:71], v[36:39], v[196:199]
 ds_read_b64_tr_b16 v[64:65], v18 offset:8192
 s_add_u32 s28, s28, 196608
 v_mfma_f32_16x16x32_bf16 v[196:199], v[72:75], v[52:55], v[196:199]
 ds_read_b64_tr_b16 v[66:67], v18 offset:9216
 v_accvgpr_write_b32 a88, 0
 v_mfma_f32_16x16x32_bf16 v[204:207], v[72:75], v[56:59], v[204:207]
 buffer_load_dword v122, v124, s[16:19], s55 offen sc1
 v_mfma_f32_16x16x32_bf16 v[204:207], v[68:71], v[40:43], v[204:207]
 s_waitcnt lgkmcnt(8)
 v_accvgpr_write_b32 a89, 0
 v_accvgpr_write_b32 a90, 0
 v_mfma_f32_16x16x32_bf16 v[144:147], v[76:79], v[28:31], v[144:147]
 ds_read_b64_tr_b16 v[68:69], v19 offset:0
 v_accvgpr_write_b32 a91, 0
 v_mfma_f32_16x16x32_bf16 v[144:147], v[80:83], v[44:47], v[144:147]
 ds_read_b64_tr_b16 v[70:71], v19 offset:1024
 v_accvgpr_write_b32 a92, 0
 v_mfma_f32_16x16x32_bf16 v[152:155], v[80:83], v[48:51], v[152:155]
 v_accvgpr_write_b32 a93, 0
 v_accvgpr_write_b32 a94, 0
 v_mfma_f32_16x16x32_bf16 v[152:155], v[76:79], v[32:35], v[152:155]
 s_add_u32 m0, s50, 0
 v_accvgpr_write_b32 a95, 0
 v_accvgpr_read_b32 v96, a96
 v_mfma_f32_16x16x32_bf16 v[208:211], v[76:79], v[36:39], v[208:211]
 ds_read_b64_tr_b16 v[72:73], v19 offset:8192
 v_accvgpr_read_b32 v97, a97
 v_mfma_f32_16x16x32_bf16 v[208:211], v[80:83], v[52:55], v[208:211]
 ds_read_b64_tr_b16 v[74:75], v19 offset:9216
 v_accvgpr_read_b32 v98, a98
 v_mfma_f32_16x16x32_bf16 v[216:219], v[80:83], v[56:59], v[216:219]
 s_add_u32 s34, s48, s50
 v_accvgpr_read_b32 v99, a99
 v_accvgpr_read_b32 v100, a100
 v_mfma_f32_16x16x32_bf16 v[216:219], v[76:79], v[40:43], v[216:219]
 s_waitcnt lgkmcnt(8)
 v_accvgpr_read_b32 v101, a101
 v_accvgpr_read_b32 v102, a102
 v_mfma_f32_16x16x32_bf16 v[148:151], v[84:87], v[28:31], v[148:151]
 ds_read_b128 v[76:79], v25 offset:768
 v_accvgpr_read_b32 v103, a103
 v_mfma_f32_16x16x32_bf16 v[148:151], v[88:91], v[44:47], v[148:151]
 ds_read_b128 v[92:95], v26
 v_add_u32 v26, 0x8000, v26
 v_mfma_f32_16x16x32_bf16 v[156:159], v[88:91], v[48:51], v[156:159]
 buffer_load_dwordx4 v1, s[16:19], s34 offen offset:0 sc1 lds
 v_mfma_f32_16x16x32_bf16 v[156:159], v[84:87], v[32:35], v[156:159]
 s_and_b32 s22, s20, 1
 v_cvt_pk_bf16_f32 v104, v96, v97
 v_cvt_pk_bf16_f32 v105, v98, v99
 v_mfma_f32_16x16x32_bf16 v[212:215], v[84:87], v[36:39], v[212:215]
 ds_read_b128 v[80:83], v25 offset:832
 v_cvt_pk_bf16_f32 v106, v100, v101
 v_mfma_f32_16x16x32_bf16 v[212:215], v[88:91], v[52:55], v[212:215]
 ds_read_b128 a[244:247], v27
 v_add_u32 v27, 0x8000, v27
 v_mfma_f32_16x16x32_bf16 v[220:223], v[88:91], v[56:59], v[220:223]
 s_lshr_b32 s23, s99, 1
 v_cvt_pk_bf16_f32 v107, v102, v103
 buffer_store_dwordx4 v[104:107], v1, s[16:19], s33 offen offset:2048
 v_mfma_f32_16x16x32_bf16 v[220:223], v[84:87], v[40:43], v[220:223]
 s_waitcnt lgkmcnt(8)
 v_accvgpr_write_b32 a96, 0
 v_accvgpr_write_b32 a97, 0
 v_mfma_f32_16x16x32_bf16 v[160:163], v[60:63], v[28:31], v[160:163]
 ds_read_b64_tr_b16 v[84:85], v20 offset:0
 v_accvgpr_write_b32 a98, 0
 s_add_u32 s22, s22, s23
 v_mfma_f32_16x16x32_bf16 v[160:163], v[64:67], v[44:47], v[160:163]
 ds_read_b64_tr_b16 v[86:87], v20 offset:1024
 v_accvgpr_write_b32 a99, 0
 v_mfma_f32_16x16x32_bf16 v[168:171], v[64:67], v[48:51], v[168:171]
 buffer_load_dwordx4 v1, s[16:19], s34 offen offset:1024 sc1 lds
 s_and_b32 s24, s20, 2
 v_mfma_f32_16x16x32_bf16 v[168:171], v[60:63], v[32:35], v[168:171]
 s_lshl_b32 s25, s24, 20
 v_accvgpr_write_b32 a100, 0
 v_accvgpr_write_b32 a101, 0
 v_mfma_f32_16x16x32_bf16 v[224:227], v[60:63], v[36:39], v[224:227]
 ds_read_b64_tr_b16 v[88:89], v20 offset:8192
 v_accvgpr_write_b32 a102, 0
 v_mfma_f32_16x16x32_bf16 v[224:227], v[64:67], v[52:55], v[224:227]
 ds_read_b64_tr_b16 v[90:91], v20 offset:9216
 v_accvgpr_write_b32 a103, 0
 s_lshr_b32 s24, s24, 1
 v_mfma_f32_16x16x32_bf16 v[232:235], v[64:67], v[56:59], v[232:235]
 s_add_u32 s23, s23, s24
 v_accvgpr_read_b32 v96, a104
 v_accvgpr_read_b32 v97, a105
 v_mfma_f32_16x16x32_bf16 v[232:235], v[60:63], v[40:43], v[232:235]
 s_waitcnt lgkmcnt(8)
 v_accvgpr_read_b32 v98, a106
 v_accvgpr_read_b32 v99, a107
 v_mfma_f32_16x16x32_bf16 v[164:167], v[68:71], v[28:31], v[164:167]
 ds_read_b64_tr_b16 v[60:61], v21 offset:0
 v_accvgpr_read_b32 v100, a108
 s_lshr_b32 s24, s22, 2
 v_mfma_f32_16x16x32_bf16 v[164:167], v[72:75], v[44:47], v[164:167]
 ds_read_b64_tr_b16 v[62:63], v21 offset:1024
 v_accvgpr_read_b32 v101, a109
 s_lshl_b32 s24, s24, 19
 v_mfma_f32_16x16x32_bf16 v[172:175], v[72:75], v[48:51], v[172:175]
 buffer_load_dwordx4 v1, s[16:19], s34 offen offset:2048 sc1 lds
 v_mfma_f32_16x16x32_bf16 v[172:175], v[68:71], v[32:35], v[172:175]
 s_add_u32 s25, s25, s24
 v_accvgpr_read_b32 v102, a110
 v_accvgpr_read_b32 v103, a111
 v_mfma_f32_16x16x32_bf16 v[228:231], v[68:71], v[36:39], v[228:231]
 ds_read_b64_tr_b16 v[64:65], v21 offset:8192
 v_cvt_pk_bf16_f32 v108, v96, v97
 s_and_b32 s22, s22, 3
 v_mfma_f32_16x16x32_bf16 v[228:231], v[72:75], v[52:55], v[228:231]
 ds_read_b64_tr_b16 v[66:67], v21 offset:9216
 v_cvt_pk_bf16_f32 v109, v98, v99
 v_mfma_f32_16x16x32_bf16 v[236:239], v[72:75], v[56:59], v[236:239]
 buffer_load_dwordx4 v1, s[16:19], s34 offen offset:3072 sc1 lds
 s_lshl_b32 s22, s22, 11
 v_mfma_f32_16x16x32_bf16 v[236:239], v[68:71], v[40:43], v[236:239]
 s_waitcnt lgkmcnt(8)
 v_cvt_pk_bf16_f32 v110, v100, v101
 v_cvt_pk_bf16_f32 v111, v102, v103
 v_mfma_f32_16x16x32_bf16 a[240:243], v[76:79], v[92:95], a[240:243]
 ds_read_b64_tr_b16 v[68:69], v22 offset:0
 s_add_u32 s25, s25, s22
 v_mfma_f32_16x16x32_bf16 a[240:243], v[80:83], a[244:247], a[240:243]
 ds_read_b64_tr_b16 v[70:71], v22 offset:512
 s_waitcnt lgkmcnt(6)
 s_lshr_b32 s24, s23, 2
 v_mfma_f32_16x16x32_bf16 v[176:179], v[84:87], v[28:31], v[176:179]
 ds_read_b64_tr_b16 v[72:73], v22 offset:4096
 buffer_store_dwordx4 v[108:111], v1, s[16:19], s33 offen offset:3072
 v_mfma_f32_16x16x32_bf16 v[176:179], v[88:91], v[44:47], v[176:179]
 ds_read_b64_tr_b16 v[74:75], v22 offset:4608
 v_accvgpr_write_b32 a104, 0
 s_add_u32 s24, s24, 8
 v_mfma_f32_16x16x32_bf16 v[184:187], v[88:91], v[48:51], v[184:187]
 ds_read_b64_tr_b16 v[76:77], v23 offset:0
 v_accvgpr_write_b32 a105, 0
 s_lshl_b32 s26, s24, 19
 v_mfma_f32_16x16x32_bf16 v[184:187], v[84:87], v[32:35], v[184:187]
 ds_read_b64_tr_b16 v[78:79], v23 offset:512
 v_accvgpr_write_b32 a106, 0
 v_mfma_f32_16x16x32_bf16 v[240:243], v[84:87], v[36:39], v[240:243]
 ds_read_b64_tr_b16 v[80:81], v23 offset:4096
 s_sub_u32 s48, s48, s57
 s_and_b32 s23, s23, 3
 v_mfma_f32_16x16x32_bf16 v[240:243], v[88:91], v[52:55], v[240:243]
 ds_read_b64_tr_b16 v[82:83], v23 offset:4608
 v_accvgpr_write_b32 a107, 0
 s_lshl_b32 s23, s23, 11
 v_mfma_f32_16x16x32_bf16 v[248:251], v[88:91], v[56:59], v[248:251]
 s_add_u32 s26, s26, s23
 v_accvgpr_write_b32 a108, 0
 v_accvgpr_write_b32 a109, 0
 v_mfma_f32_16x16x32_bf16 v[248:251], v[84:87], v[40:43], v[248:251]
 s_waitcnt lgkmcnt(8)
 s_cmp_eq_u32 s21, 0
 s_cselect_b32 s34, 0x4000, 0
 v_mfma_f32_16x16x32_bf16 v[180:183], v[60:63], v[28:31], v[180:183]
 ds_read_b64_tr_b16 v[84:85], v24 offset:0
 v_accvgpr_write_b32 a110, 0
 s_and_b32 s22, s20, 1
 v_mfma_f32_16x16x32_bf16 v[180:183], v[64:67], v[44:47], v[180:183]
 ds_read_b64_tr_b16 v[86:87], v24 offset:512
 v_accvgpr_write_b32 a111, 0
 v_mfma_f32_16x16x32_bf16 v[188:191], v[64:67], v[48:51], v[188:191]
 s_lshl_b32 s22, s22, 10
 v_accvgpr_read_b32 v96, a112
 v_accvgpr_read_b32 v97, a113
 v_mfma_f32_16x16x32_bf16 v[188:191], v[60:63], v[32:35], v[188:191]
 s_add_u32 s48, s48, s34
 v_accvgpr_read_b32 v98, a114
 v_accvgpr_read_b32 v99, a115
 v_mfma_f32_16x16x32_bf16 v[244:247], v[60:63], v[36:39], v[244:247]
 ds_read_b64_tr_b16 v[88:89], v24 offset:4096
 v_accvgpr_read_b32 v100, a116
 s_add_u32 s26, s26, s22
 v_mfma_f32_16x16x32_bf16 v[244:247], v[64:67], v[52:55], v[244:247]
 ds_read_b64_tr_b16 v[90:91], v24 offset:4608
 v_accvgpr_read_b32 v101, a117
 s_bitcmp1_b32 s20, 1
 s_cselect_b32 s35, 1.0, 0x3eb8aa3b
 s_cselect_b32 s31, s93, s92
 v_mfma_f32_16x16x32_bf16 v[252:255], v[64:67], v[56:59], v[252:255]
 s_xor_b32 s22, s31, 7
 v_accvgpr_read_b32 v102, a118
 v_accvgpr_read_b32 v103, a119
 v_mfma_f32_16x16x32_bf16 v[252:255], v[60:63], v[40:43], v[252:255]
 s_waitcnt lgkmcnt(8)
 v_cvt_pk_bf16_f32 v112, v96, v97
 v_cvt_pk_bf16_f32 v113, v98, v99
 v_mfma_f32_16x16x32_bf16 a[192:195], v[68:71], v[28:31], a[192:195]
 s_bitcmp1_b32 s20, 0
 v_cvt_pk_bf16_f32 v114, v100, v101
 v_cvt_pk_bf16_f32 v115, v102, v103
 s_cselect_b32 s31, s22, s31
 v_mfma_f32_16x16x32_bf16 a[192:195], v[72:75], v[44:47], a[192:195]
 buffer_store_dwordx4 v[112:115], v1, s[16:19], s98 offen offset:2048
 v_mfma_f32_16x16x32_bf16 a[200:203], v[72:75], v[48:51], a[200:203]
 s_lshl_b32 s31, s31, 6
 v_accvgpr_write_b32 a112, 0
 v_accvgpr_write_b32 a113, 0
 v_mfma_f32_16x16x32_bf16 a[200:203], v[68:71], v[32:35], a[200:203]
 v_accvgpr_write_b32 a114, 0
 s_add_u32 s31, s31, s66
 s_waitcnt vmcnt(7) lgkmcnt(0)
 v_cmp_gt_u32 vcc, s46, v122
 s_cbranch_vccnz L_spin_13
L_spun_14:
 s_nop 0
 s_barrier
 v_mfma_f32_16x16x32_bf16 a[208:211], v[68:71], v[36:39], a[208:211]
 ds_read_b64_tr_b16 v[60:61], v22 offset:32768
 s_add_u32 m0, s50, 32768
 v_mfma_f32_16x16x32_bf16 a[208:211], v[72:75], v[52:55], a[208:211]
 ds_read_b64_tr_b16 v[62:63], v22 offset:33280
 v_accvgpr_write_b32 a115, 0
 s_lshr_b32 s22, s92, 1
 v_mfma_f32_16x16x32_bf16 a[216:219], v[72:75], v[56:59], a[216:219]
 ds_read_b64_tr_b16 v[64:65], v22 offset:36864
 s_add_u32 s34, s48, s50
 s_lshl_b32 s22, s22, 13
 v_mfma_f32_16x16x32_bf16 a[216:219], v[68:71], v[40:43], a[216:219]
 ds_read_b64_tr_b16 v[66:67], v22 offset:37376
 v_mfma_f32_16x16x32_bf16 a[196:199], v[76:79], v[28:31], a[196:199]
 ds_read_b128 a[128:131], v12 offset:0
 v_accvgpr_write_b32 a116, 0
 s_and_b32 s23, s92, 1
 v_mfma_f32_16x16x32_bf16 a[196:199], v[80:83], v[44:47], a[196:199]
 ds_read_b128 a[144:147], v13 offset:0
 v_accvgpr_write_b32 a117, 0
 v_mfma_f32_16x16x32_bf16 a[204:207], v[80:83], v[48:51], a[204:207]
 ds_read_b128 a[132:135], v12 offset:2048
 v_accvgpr_write_b32 a118, 0
 s_lshl_b32 s24, s23, 10
 v_mfma_f32_16x16x32_bf16 a[204:207], v[76:79], v[32:35], a[204:207]
 ds_read_b64_tr_b16 v[68:69], v23 offset:32768
 v_accvgpr_write_b32 a119, 0
 s_lshl_b32 s23, s23, 3
 v_mfma_f32_16x16x32_bf16 a[212:215], v[76:79], v[36:39], a[212:215]
 ds_read_b64_tr_b16 v[70:71], v23 offset:33280
 ds_read_b128 a[148:151], v13 offset:2048
 v_mfma_f32_16x16x32_bf16 a[212:215], v[80:83], v[52:55], a[212:215]
 ds_read_b128 a[136:139], v12 offset:4096
 ds_read_b128 a[152:155], v13 offset:4096
 s_add_u32 s24, s24, s22
 v_mfma_f32_16x16x32_bf16 a[220:223], v[80:83], v[56:59], a[220:223]
 ds_read_b128 a[140:143], v12 offset:6144
 v_accvgpr_read_b32 v96, a120
 s_add_u32 s23, s23, s22
 v_mfma_f32_16x16x32_bf16 a[220:223], v[76:79], v[40:43], a[220:223]
 ds_read_b64_tr_b16 v[72:73], v23 offset:36864
 v_mfma_f32_16x16x32_bf16 a[224:227], v[28:31], v[84:87], a[224:227]
 ds_read_b64_tr_b16 v[74:75], v23 offset:37376
 v_accvgpr_read_b32 v97, a121
 s_add_u32 s27, s25, s24
 v_mfma_f32_16x16x32_bf16 a[224:227], v[44:47], v[88:91], a[224:227]
 ds_read_b128 a[156:159], v13 offset:6144
 v_accvgpr_read_b32 v98, a122
 s_add_u32 s8, s26, s23
 v_mfma_f32_16x16x32_bf16 a[228:231], v[48:51], v[88:91], a[228:231]
 ds_read_b64_tr_b16 v[76:77], v24 offset:32768
 v_accvgpr_read_b32 v99, a123
 v_mfma_f32_16x16x32_bf16 a[228:231], v[32:35], v[84:87], a[228:231]
 ds_read_b64_tr_b16 v[78:79], v24 offset:33280
 v_accvgpr_read_b32 v100, a124
 s_lshr_b32 s22, s67, 1
 v_mfma_f32_16x16x32_bf16 a[232:235], v[36:39], v[84:87], a[232:235]
 ds_read_b64_tr_b16 v[80:81], v24 offset:36864
 v_accvgpr_read_b32 v101, a125
 s_lshl_b32 s22, s22, 13
 v_mfma_f32_16x16x32_bf16 a[232:235], v[52:55], v[88:91], a[232:235]
 ds_read_b64_tr_b16 v[82:83], v24 offset:37376
 v_accvgpr_read_b32 v102, a126
 v_mfma_f32_16x16x32_bf16 a[236:239], v[56:59], v[88:91], a[236:239]
 buffer_load_dwordx4 v1, s[16:19], s34 offen offset:0 sc1 lds
 s_and_b32 s23, s67, 1
 v_mfma_f32_16x16x32_bf16 a[236:239], v[40:43], v[84:87], a[236:239]
 s_waitcnt lgkmcnt(4)
 v_accvgpr_read_b32 v103, a127
 v_cvt_pk_bf16_f32 v116, v96, v97
 v_mfma_f32_16x16x32_bf16 a[192:195], v[60:63], a[128:131], a[192:195]
 ds_read_b64_tr_b16 v[84:85], v14 offset:32768
 v_cvt_pk_bf16_f32 v117, v98, v99
 s_lshl_b32 s24, s23, 10
 v_mfma_f32_16x16x32_bf16 a[192:195], v[64:67], a[144:147], a[192:195]
 ds_read_b64_tr_b16 v[86:87], v14 offset:33792
 v_cvt_pk_bf16_f32 v118, v100, v101
 s_lshl_b32 s23, s23, 3
 v_mfma_f32_16x16x32_bf16 a[200:203], v[64:67], a[148:151], a[200:203]
 buffer_load_dwordx4 v1, s[16:19], s34 offen offset:1024 sc1 lds
 v_mfma_f32_16x16x32_bf16 a[200:203], v[60:63], a[132:135], a[200:203]
 buffer_load_dwordx4 v1, s[16:19], s34 offen offset:2048 sc1 lds
 s_add_u32 s24, s24, s22
 v_mfma_f32_16x16x32_bf16 a[208:211], v[60:63], a[136:139], a[208:211]
 ds_read_b64_tr_b16 v[88:89], v14 offset:40960
 v_cvt_pk_bf16_f32 v119, v102, v103
 s_add_u32 s23, s23, s22
 v_mfma_f32_16x16x32_bf16 a[208:211], v[64:67], a[152:155], a[208:211]
 ds_read_b64_tr_b16 v[90:91], v14 offset:41984
 s_add_u32 s28, s25, s24
 v_mfma_f32_16x16x32_bf16 a[216:219], v[64:67], a[156:159], a[216:219]
 buffer_load_dwordx4 v1, s[16:19], s34 offen offset:3072 sc1 lds
 v_mfma_f32_16x16x32_bf16 a[216:219], v[60:63], a[140:143], a[216:219]
 buffer_store_dwordx4 v[116:119], v1, s[16:19], s98 offen offset:3072
 s_add_u32 s9, s26, s23
 v_mfma_f32_16x16x32_bf16 a[196:199], v[68:71], a[128:131], a[196:199]
 ds_read_b128 v[60:63], v25 offset:896
 v_accvgpr_write_b32 a120, 0
 v_mfma_f32_16x16x32_bf16 a[196:199], v[72:75], a[144:147], a[196:199]
 ds_read_b128 v[92:95], v26
 v_accvgpr_write_b32 a121, 0
 s_lshr_b32 s22, s93, 1
 v_mfma_f32_16x16x32_bf16 a[204:207], v[72:75], a[148:151], a[204:207]
 s_lshl_b32 s22, s22, 13
 v_accvgpr_write_b32 a122, 0
 v_accvgpr_write_b32 a123, 0
 v_mfma_f32_16x16x32_bf16 a[204:207], v[68:71], a[132:135], a[204:207]
 s_add_u32 s48, s48, 16384
 v_accvgpr_write_b32 a124, 0
 v_accvgpr_write_b32 a125, 0
 v_accvgpr_write_b32 a126, 0
 v_accvgpr_write_b32 a127, 0
 v_mfma_f32_16x16x32_bf16 a[212:215], v[68:71], a[136:139], a[212:215]
 ds_read_b128 v[64:67], v25 offset:960
 s_and_b32 s23, s93, 1
 v_mfma_f32_16x16x32_bf16 a[212:215], v[72:75], a[152:155], a[212:215]
 ds_read_b128 a[244:247], v27
 s_lshl_b32 s24, s23, 10
 v_mfma_f32_16x16x32_bf16 a[220:223], v[72:75], a[156:159], a[220:223]
 s_lshl_b32 s23, s23, 3
 s_add_u32 s24, s24, s22
 s_add_u32 s23, s23, s22
 v_mfma_f32_16x16x32_bf16 a[220:223], v[68:71], a[140:143], a[220:223]
 s_waitcnt lgkmcnt(8)
 s_add_u32 s29, s25, s24
 s_add_u32 s10, s26, s23
 v_mfma_f32_16x16x32_bf16 a[224:227], a[128:131], v[76:79], a[224:227]
 ds_read_b64_tr_b16 v[68:69], v15 offset:32768
 s_lshr_b32 s22, s45, 1
 v_mfma_f32_16x16x32_bf16 a[224:227], a[144:147], v[80:83], a[224:227]
 ds_read_b64_tr_b16 v[70:71], v15 offset:33792
 s_lshl_b32 s22, s22, 13
 v_mfma_f32_16x16x32_bf16 a[228:231], a[148:151], v[80:83], a[228:231]
 s_and_b32 s23, s45, 1
 s_lshl_b32 s24, s23, 10
 s_lshl_b32 s23, s23, 3
 v_mfma_f32_16x16x32_bf16 a[228:231], a[132:135], v[76:79], a[228:231]
 s_add_u32 s24, s24, s22
 s_add_u32 s23, s23, s22
 v_mfma_f32_16x16x32_bf16 a[232:235], a[136:139], v[76:79], a[232:235]
 ds_read_b64_tr_b16 v[72:73], v15 offset:40960
 s_add_u32 s30, s25, s24
 v_mfma_f32_16x16x32_bf16 a[232:235], a[152:155], v[80:83], a[232:235]
 ds_read_b64_tr_b16 v[74:75], v15 offset:41984
 s_add_u32 s12, s26, s23
 v_mfma_f32_16x16x32_bf16 a[236:239], a[156:159], v[80:83], a[236:239]
 v_mfma_f32_16x16x32_bf16 a[236:239], a[140:143], v[76:79], a[236:239]
 s_waitcnt lgkmcnt(8)
 v_mfma_f32_16x16x32_bf16 v[128:131], v[84:87], a[128:131], v[128:131]
 ds_read_b64_tr_b16 v[76:77], v16 offset:32768
 v_mfma_f32_16x16x32_bf16 v[128:131], v[88:91], a[144:147], v[128:131]
 ds_read_b64_tr_b16 v[78:79], v16 offset:33792
 v_mfma_f32_16x16x32_bf16 v[136:139], v[88:91], a[148:151], v[136:139]
 v_mfma_f32_16x16x32_bf16 v[136:139], v[84:87], a[132:135], v[136:139]
 v_mfma_f32_16x16x32_bf16 v[192:195], v[84:87], a[136:139], v[192:195]
 ds_read_b64_tr_b16 v[80:81], v16 offset:40960
 v_mfma_f32_16x16x32_bf16 v[192:195], v[88:91], a[152:155], v[192:195]
 ds_read_b64_tr_b16 v[82:83], v16 offset:41984
 v_mfma_f32_16x16x32_bf16 v[200:203], v[88:91], a[156:159], v[200:203]
 v_accvgpr_read_b32 v96, a192
 v_accvgpr_read_b32 v97, a193
 v_mfma_f32_16x16x32_bf16 v[200:203], v[84:87], a[140:143], v[200:203]
 s_waitcnt lgkmcnt(8)
 v_accvgpr_read_b32 v98, a194
 v_accvgpr_read_b32 v99, a195
 v_mfma_f32_16x16x32_bf16 a[240:243], v[60:63], v[92:95], a[240:243]
 ds_read_b64_tr_b16 v[84:85], v17 offset:32768
 v_accvgpr_read_b32 v100, a196
 v_mfma_f32_16x16x32_bf16 a[240:243], v[64:67], a[244:247], a[240:243]
 ds_read_b64_tr_b16 v[86:87], v17 offset:33792
 s_waitcnt lgkmcnt(6)
 v_mfma_f32_16x16x32_bf16 v[132:135], v[68:71], a[128:131], v[132:135]
 ds_read_b64_tr_b16 v[88:89], v17 offset:40960
 v_accvgpr_read_b32 v101, a197
 v_mfma_f32_16x16x32_bf16 v[132:135], v[72:75], a[144:147], v[132:135]
 ds_read_b64_tr_b16 v[90:91], v17 offset:41984
 v_accvgpr_read_b32 v102, a198
 v_mfma_f32_16x16x32_bf16 v[140:143], v[72:75], a[148:151], v[140:143]
 ds_read_b64_tr_b16 v[60:61], v18 offset:32768
 v_accvgpr_read_b32 v103, a199
 v_mfma_f32_16x16x32_bf16 v[140:143], v[68:71], a[132:135], v[140:143]
 ds_read_b64_tr_b16 v[62:63], v18 offset:33792
 v_mul_f32 v96, s35, v96
 v_mfma_f32_16x16x32_bf16 v[196:199], v[68:71], a[136:139], v[196:199]
 ds_read_b64_tr_b16 v[64:65], v18 offset:40960
 v_mul_f32 v97, s35, v97
 v_mfma_f32_16x16x32_bf16 v[196:199], v[72:75], a[152:155], v[196:199]
 ds_read_b64_tr_b16 v[66:67], v18 offset:41984
 v_mul_f32 v98, s35, v98
 v_mfma_f32_16x16x32_bf16 v[204:207], v[72:75], a[156:159], v[204:207]
 v_mul_f32 v99, s35, v99
 v_mul_f32 v100, s35, v100
 v_mfma_f32_16x16x32_bf16 v[204:207], v[68:71], a[140:143], v[204:207]
 s_waitcnt lgkmcnt(8)
 v_mul_f32 v101, s35, v101
 v_mul_f32 v102, s35, v102
 v_mfma_f32_16x16x32_bf16 v[144:147], v[76:79], a[128:131], v[144:147]
 ds_read_b64_tr_b16 v[68:69], v19 offset:32768
 v_mul_f32 v103, s35, v103
 v_mfma_f32_16x16x32_bf16 v[144:147], v[80:83], a[144:147], v[144:147]
 ds_read_b64_tr_b16 v[70:71], v19 offset:33792
 v_cvt_pk_bf16_f32 v104, v96, v97
 v_mfma_f32_16x16x32_bf16 v[152:155], v[80:83], a[148:151], v[152:155]
 v_cvt_pk_bf16_f32 v105, v98, v99
 v_cvt_pk_bf16_f32 v106, v100, v101
 v_mfma_f32_16x16x32_bf16 v[152:155], v[76:79], a[132:135], v[152:155]
 v_cvt_pk_bf16_f32 v107, v102, v103
 v_mfma_f32_16x16x32_bf16 v[208:211], v[76:79], a[136:139], v[208:211]
 ds_read_b64_tr_b16 v[72:73], v19 offset:40960
 v_mfma_f32_16x16x32_bf16 v[208:211], v[80:83], a[152:155], v[208:211]
 ds_read_b64_tr_b16 v[74:75], v19 offset:41984
 v_mfma_f32_16x16x32_bf16 v[216:219], v[80:83], a[156:159], v[216:219]
 buffer_store_dwordx4 v[104:107], v1, s[16:19], s27 offen
 v_mfma_f32_16x16x32_bf16 v[216:219], v[76:79], a[140:143], v[216:219]
 s_waitcnt lgkmcnt(8)
 v_accvgpr_read_b32 v96, a200
 v_accvgpr_read_b32 v97, a201
 v_mfma_f32_16x16x32_bf16 v[148:151], v[84:87], a[128:131], v[148:151]
 ds_read_b64_tr_b16 v[76:77], v20 offset:32768
 v_accvgpr_read_b32 v98, a202
 v_mfma_f32_16x16x32_bf16 v[148:151], v[88:91], a[144:147], v[148:151]
 ds_read_b64_tr_b16 v[78:79], v20 offset:33792
 v_accvgpr_read_b32 v99, a203
 v_mfma_f32_16x16x32_bf16 v[156:159], v[88:91], a[148:151], v[156:159]
 v_accvgpr_read_b32 v100, a204
 v_accvgpr_read_b32 v101, a205
 v_mfma_f32_16x16x32_bf16 v[156:159], v[84:87], a[132:135], v[156:159]
 v_accvgpr_read_b32 v102, a206
 v_accvgpr_read_b32 v103, a207
 v_mfma_f32_16x16x32_bf16 v[212:215], v[84:87], a[136:139], v[212:215]
 ds_read_b64_tr_b16 v[80:81], v20 offset:40960
 v_mul_f32 v96, s35, v96
 v_mfma_f32_16x16x32_bf16 v[212:215], v[88:91], a[152:155], v[212:215]
 ds_read_b64_tr_b16 v[82:83], v20 offset:41984
 v_mul_f32 v97, s35, v97
 v_mfma_f32_16x16x32_bf16 v[220:223], v[88:91], a[156:159], v[220:223]
 v_mul_f32 v98, s35, v98
 v_mul_f32 v99, s35, v99
 v_mfma_f32_16x16x32_bf16 v[220:223], v[84:87], a[140:143], v[220:223]
 s_waitcnt lgkmcnt(8)
 v_mul_f32 v100, s35, v100
 v_mul_f32 v101, s35, v101
 v_mfma_f32_16x16x32_bf16 v[160:163], v[60:63], a[128:131], v[160:163]
 ds_read_b64_tr_b16 v[84:85], v21 offset:32768
 v_mul_f32 v102, s35, v102
 v_mfma_f32_16x16x32_bf16 v[160:163], v[64:67], a[144:147], v[160:163]
 ds_read_b64_tr_b16 v[86:87], v21 offset:33792
 v_mul_f32 v103, s35, v103
 v_mfma_f32_16x16x32_bf16 v[168:171], v[64:67], a[148:151], v[168:171]
 v_cvt_pk_bf16_f32 v108, v96, v97
 v_cvt_pk_bf16_f32 v109, v98, v99
 v_mfma_f32_16x16x32_bf16 v[168:171], v[60:63], a[132:135], v[168:171]
 v_cvt_pk_bf16_f32 v110, v100, v101
 v_cvt_pk_bf16_f32 v111, v102, v103
 v_mfma_f32_16x16x32_bf16 v[224:227], v[60:63], a[136:139], v[224:227]
 ds_read_b64_tr_b16 v[88:89], v21 offset:40960
 v_mfma_f32_16x16x32_bf16 v[224:227], v[64:67], a[152:155], v[224:227]
 ds_read_b64_tr_b16 v[90:91], v21 offset:41984
 buffer_store_dwordx4 v[108:111], v1, s[16:19], s28 offen
 v_mfma_f32_16x16x32_bf16 v[232:235], v[64:67], a[156:159], v[232:235]
 v_accvgpr_read_b32 v96, a208
 v_accvgpr_read_b32 v97, a209
 v_mfma_f32_16x16x32_bf16 v[232:235], v[60:63], a[140:143], v[232:235]
 s_waitcnt lgkmcnt(8)
 v_accvgpr_read_b32 v98, a210
 v_accvgpr_read_b32 v99, a211
 v_mfma_f32_16x16x32_bf16 v[164:167], v[68:71], a[128:131], v[164:167]
 v_accvgpr_read_b32 v100, a212
 v_accvgpr_read_b32 v101, a213
 v_mfma_f32_16x16x32_bf16 v[164:167], v[72:75], a[144:147], v[164:167]
 v_accvgpr_read_b32 v102, a214
 v_accvgpr_read_b32 v103, a215
 v_mfma_f32_16x16x32_bf16 v[172:175], v[72:75], a[148:151], v[172:175]
 v_mul_f32 v96, s35, v96
 v_mul_f32 v97, s35, v97
 v_mfma_f32_16x16x32_bf16 v[172:175], v[68:71], a[132:135], v[172:175]
 v_mul_f32 v98, s35, v98
 v_mul_f32 v99, s35, v99
 v_mfma_f32_16x16x32_bf16 v[228:231], v[68:71], a[136:139], v[228:231]
 v_mul_f32 v100, s35, v100
 v_mul_f32 v101, s35, v101
 v_mfma_f32_16x16x32_bf16 v[228:231], v[72:75], a[152:155], v[228:231]
 v_mul_f32 v102, s35, v102
 v_mul_f32 v103, s35, v103
 v_mfma_f32_16x16x32_bf16 v[236:239], v[72:75], a[156:159], v[236:239]
 v_cvt_pk_bf16_f32 v112, v96, v97
 v_cvt_pk_bf16_f32 v113, v98, v99
 v_mfma_f32_16x16x32_bf16 v[236:239], v[68:71], a[140:143], v[236:239]
 s_waitcnt lgkmcnt(4)
 v_cvt_pk_bf16_f32 v114, v100, v101
 v_cvt_pk_bf16_f32 v115, v102, v103
 v_mfma_f32_16x16x32_bf16 v[176:179], v[76:79], a[128:131], v[176:179]
 buffer_store_dwordx4 v[112:115], v1, s[16:19], s29 offen
 v_mfma_f32_16x16x32_bf16 v[176:179], v[80:83], a[144:147], v[176:179]
 v_accvgpr_read_b32 v96, a216
 v_accvgpr_read_b32 v97, a217
 v_mfma_f32_16x16x32_bf16 v[184:187], v[80:83], a[148:151], v[184:187]
 v_accvgpr_read_b32 v98, a218
 v_accvgpr_read_b32 v99, a219
 v_mfma_f32_16x16x32_bf16 v[184:187], v[76:79], a[132:135], v[184:187]
 v_accvgpr_read_b32 v100, a220
 v_accvgpr_read_b32 v101, a221
 v_mfma_f32_16x16x32_bf16 v[240:243], v[76:79], a[136:139], v[240:243]
 v_accvgpr_read_b32 v102, a222
 v_accvgpr_read_b32 v103, a223
 v_mfma_f32_16x16x32_bf16 v[240:243], v[80:83], a[152:155], v[240:243]
 v_mul_f32 v96, s35, v96
 v_mul_f32 v97, s35, v97
 v_mfma_f32_16x16x32_bf16 v[248:251], v[80:83], a[156:159], v[248:251]
 v_mul_f32 v98, s35, v98
 v_mul_f32 v99, s35, v99
 v_mfma_f32_16x16x32_bf16 v[248:251], v[76:79], a[140:143], v[248:251]
 s_waitcnt lgkmcnt(0)
 v_mul_f32 v100, s35, v100
 v_mul_f32 v101, s35, v101
 v_mfma_f32_16x16x32_bf16 v[180:183], v[84:87], a[128:131], v[180:183]
 v_mul_f32 v102, s35, v102
 v_mul_f32 v103, s35, v103
 v_mfma_f32_16x16x32_bf16 v[180:183], v[88:91], a[144:147], v[180:183]
 v_cvt_pk_bf16_f32 v116, v96, v97
 v_cvt_pk_bf16_f32 v117, v98, v99
 v_mfma_f32_16x16x32_bf16 v[188:191], v[88:91], a[148:151], v[188:191]
 v_cvt_pk_bf16_f32 v118, v100, v101
 v_cvt_pk_bf16_f32 v119, v102, v103
 v_mfma_f32_16x16x32_bf16 v[188:191], v[84:87], a[132:135], v[188:191]
 buffer_store_dwordx4 v[116:119], v1, s[16:19], s30 offen
 v_mfma_f32_16x16x32_bf16 v[244:247], v[84:87], a[136:139], v[244:247]
 v_accvgpr_read_b32 v96, a224
 v_mfma_f32_16x16x32_bf16 v[244:247], v[88:91], a[152:155], v[244:247]
 v_accvgpr_read_b32 v97, a225
 v_accvgpr_read_b32 v98, a226
 v_mfma_f32_16x16x32_bf16 v[252:255], v[88:91], a[156:159], v[252:255]
 v_accvgpr_read_b32 v99, a227
 v_accvgpr_read_b32 v100, a228
 v_mfma_f32_16x16x32_bf16 v[252:255], v[84:87], a[140:143], v[252:255]
 v_accvgpr_read_b32 v101, a229
 v_accvgpr_read_b32 v102, a230
 v_accvgpr_read_b32 v103, a231
 v_cvt_pk_bf16_f32 v104, v96, v97
 v_cvt_pk_bf16_f32 v105, v98, v99
 v_cvt_pk_bf16_f32 v106, v100, v101
 v_cvt_pk_bf16_f32 v107, v102, v103
 buffer_store_dwordx2 v[104:105], v1, s[16:19], s8 offen
 buffer_store_dwordx2 v[106:107], v1, s[16:19], s9 offen
 v_accvgpr_read_b32 v96, a232
 v_accvgpr_read_b32 v97, a233
 v_accvgpr_read_b32 v98, a234
 v_accvgpr_read_b32 v99, a235
 v_accvgpr_read_b32 v100, a236
 v_accvgpr_read_b32 v101, a237
 v_accvgpr_read_b32 v102, a238
 v_accvgpr_read_b32 v103, a239
 v_cvt_pk_bf16_f32 v108, v96, v97
 v_cvt_pk_bf16_f32 v109, v98, v99
 v_cvt_pk_bf16_f32 v110, v100, v101
 v_cvt_pk_bf16_f32 v111, v102, v103
 buffer_store_dwordx2 v[108:109], v1, s[16:19], s10 offen
 buffer_store_dwordx2 v[110:111], v1, s[16:19], s12 offen
 v_accvgpr_read_b32 v96, a240
 v_and_b32 v97, 15, v0
 v_mul_f32 v96, 0xbfb8aa3b, v96
 v_exp_f32 v96, v96
 v_lshlrev_b32 v97, 2, v97
 v_add_f32 v96, 1.0, v96
 v_rcp_f32 v96, v96
 s_nop 0
 buffer_store_dword v96, v97, s[16:19], s31 offen
 s_waitcnt vmcnt(10)
L_attn_2:
 s_nop 0
 s_barrier
 s_mov_b32 s35, 0x3e0293ee
 ds_read_b128 a[192:195], v1 offset:0
 ds_read_b128 a[196:199], v1 offset:1024
 ds_read_b128 a[200:203], v1 offset:8192
 ds_read_b128 a[204:207], v1 offset:9216
 ds_read_b128 a[208:211], v1 offset:2048
 ds_read_b128 a[212:215], v1 offset:3072
 ds_read_b128 a[216:219], v1 offset:10240
 ds_read_b128 a[220:223], v1 offset:11264
 ds_read_b128 a[224:227], v1 offset:4096
 ds_read_b128 a[228:231], v1 offset:5120
 ds_read_b128 a[232:235], v1 offset:12288
 ds_read_b128 a[236:239], v1 offset:13312
 s_add_u32 m0, s50, 65536
 s_add_u32 s34, s49, s50
 buffer_load_dwordx4 v1, s[16:19], s34 offen offset:0 sc1 lds
 buffer_load_dwordx4 v1, s[16:19], s34 offen offset:1024 sc1 lds
 buffer_load_dwordx4 v1, s[16:19], s34 offen offset:2048 sc1 lds
 buffer_load_dwordx4 v1, s[16:19], s34 offen offset:3072 sc1 lds
 s_sub_u32 s49, s49, s57
 s_sub_u32 s56, 3, s3
 s_mov_b32 s26, s35
 s_mov_b32 s27, s35
 v_pk_mul_f32 v[128:129], v[128:129], s[26:27]
 v_pk_mul_f32 v[130:131], v[130:131], s[26:27]
 v_pk_mul_f32 v[132:133], v[132:133], s[26:27]
 v_pk_mul_f32 v[134:135], v[134:135], s[26:27]
 v_pk_mul_f32 v[136:137], v[136:137], s[26:27]
 v_pk_mul_f32 v[138:139], v[138:139], s[26:27]
 v_pk_mul_f32 v[140:141], v[140:141], s[26:27]
 v_pk_mul_f32 v[142:143], v[142:143], s[26:27]
 v_pk_mul_f32 v[144:145], v[144:145], s[26:27]
 v_pk_mul_f32 v[146:147], v[146:147], s[26:27]
 v_pk_mul_f32 v[148:149], v[148:149], s[26:27]
 v_pk_mul_f32 v[150:151], v[150:151], s[26:27]
 v_pk_mul_f32 v[152:153], v[152:153], s[26:27]
 v_pk_mul_f32 v[154:155], v[154:155], s[26:27]
 v_pk_mul_f32 v[156:157], v[156:157], s[26:27]
 v_pk_mul_f32 v[158:159], v[158:159], s[26:27]
 v_pk_mul_f32 v[160:161], v[160:161], s[26:27]
 v_pk_mul_f32 v[162:163], v[162:163], s[26:27]
 v_pk_mul_f32 v[164:165], v[164:165], s[26:27]
 v_pk_mul_f32 v[166:167], v[166:167], s[26:27]
 v_pk_mul_f32 v[168:169], v[168:169], s[26:27]
 v_pk_mul_f32 v[170:171], v[170:171], s[26:27]
 v_pk_mul_f32 v[172:173], v[172:173], s[26:27]
 v_pk_mul_f32 v[174:175], v[174:175], s[26:27]
 v_pk_mul_f32 v[176:177], v[176:177], s[26:27]
 v_pk_mul_f32 v[178:179], v[178:179], s[26:27]
 v_pk_mul_f32 v[180:181], v[180:181], s[26:27]
 v_pk_mul_f32 v[182:183], v[182:183], s[26:27]
 v_pk_mul_f32 v[184:185], v[184:185], s[26:27]
 v_pk_mul_f32 v[186:187], v[186:187], s[26:27]
 v_pk_mul_f32 v[188:189], v[188:189], s[26:27]
 v_pk_mul_f32 v[190:191], v[190:191], s[26:27]
 v_pk_mul_f32 v[192:193], v[192:193], s[26:27]
 v_pk_mul_f32 v[194:195], v[194:195], s[26:27]
 v_pk_mul_f32 v[196:197], v[196:197], s[26:27]
 v_pk_mul_f32 v[198:199], v[198:199], s[26:27]
 v_pk_mul_f32 v[200:201], v[200:201], s[26:27]
 v_pk_mul_f32 v[202:203], v[202:203], s[26:27]
 v_pk_mul_f32 v[204:205], v[204:205], s[26:27]
 v_pk_mul_f32 v[206:207], v[206:207], s[26:27]
 v_pk_mul_f32 v[208:209], v[208:209], s[26:27]
 v_pk_mul_f32 v[210:211], v[210:211], s[26:27]
 v_pk_mul_f32 v[212:213], v[212:213], s[26:27]
 v_pk_mul_f32 v[214:215], v[214:215], s[26:27]
 v_pk_mul_f32 v[216:217], v[216:217], s[26:27]
 v_pk_mul_f32 v[218:219], v[218:219], s[26:27]
 v_pk_mul_f32 v[220:221], v[220:221], s[26:27]
 v_pk_mul_f32 v[222:223], v[222:223], s[26:27]
 v_pk_mul_f32 v[224:225], v[224:225], s[26:27]
 v_pk_mul_f32 v[226:227], v[226:227], s[26:27]
 v_pk_mul_f32 v[228:229], v[228:229], s[26:27]
 v_pk_mul_f32 v[230:231], v[230:231], s[26:27]
 v_pk_mul_f32 v[232:233], v[232:233], s[26:27]
 v_pk_mul_f32 v[234:235], v[234:235], s[26:27]
 v_pk_mul_f32 v[236:237], v[236:237], s[26:27]
 v_pk_mul_f32 v[238:239], v[238:239], s[26:27]
 v_pk_mul_f32 v[240:241], v[240:241], s[26:27]
 v_pk_mul_f32 v[242:243], v[242:243], s[26:27]
 v_pk_mul_f32 v[244:245], v[244:245], s[26:27]
 v_pk_mul_f32 v[246:247], v[246:247], s[26:27]
 v_pk_mul_f32 v[248:249], v[248:249], s[26:27]
 v_pk_mul_f32 v[250:251], v[250:251], s[26:27]
 v_pk_mul_f32 v[252:253], v[252:253], s[26:27]
 v_pk_mul_f32 v[254:255], v[254:255], s[26:27]
 v_cvt_pk_bf16_f32 v128, v128, v129
 v_cvt_pk_bf16_f32 v129, v130, v131
 v_cvt_pk_bf16_f32 v130, v132, v133
 v_cvt_pk_bf16_f32 v131, v134, v135
 v_accvgpr_write_b32 a128, v128
 v_accvgpr_write_b32 a129, v129
 v_accvgpr_write_b32 a130, v130
 v_accvgpr_write_b32 a131, v131
 v_cvt_pk_bf16_f32 v136, v136, v137
 v_cvt_pk_bf16_f32 v137, v138, v139
 v_cvt_pk_bf16_f32 v138, v140, v141
 v_cvt_pk_bf16_f32 v139, v142, v143
 v_accvgpr_write_b32 a144, v136
 v_accvgpr_write_b32 a145, v137
 v_accvgpr_write_b32 a146, v138
 v_accvgpr_write_b32 a147, v139
 v_cvt_pk_bf16_f32 v192, v192, v193
 v_cvt_pk_bf16_f32 v193, v194, v195
 v_cvt_pk_bf16_f32 v194, v196, v197
 v_cvt_pk_bf16_f32 v195, v198, v199
 v_accvgpr_write_b32 a160, v192
 v_accvgpr_write_b32 a161, v193
 v_accvgpr_write_b32 a162, v194
 v_accvgpr_write_b32 a163, v195
 v_cvt_pk_bf16_f32 v200, v200, v201
 v_cvt_pk_bf16_f32 v201, v202, v203
 v_cvt_pk_bf16_f32 v202, v204, v205
 v_cvt_pk_bf16_f32 v203, v206, v207
 v_accvgpr_write_b32 a176, v200
 v_accvgpr_write_b32 a177, v201
 v_accvgpr_write_b32 a178, v202
 v_accvgpr_write_b32 a179, v203
 ds_read_b128 a[240:243], v1 offset:6144
 ds_read_b128 a[244:247], v1 offset:7168
 ds_read_b128 a[248:251], v1 offset:14336
 ds_read_b128 a[252:255], v1 offset:15360
 s_waitcnt lgkmcnt(0)
 s_barrier
 v_mfma_f32_16x16x32_bf16 v[16:19], a[192:195], a[128:131], 0
 s_add_u32 m0, s51, 0
 v_cvt_pk_bf16_f32 v144, v144, v145
 v_cvt_pk_bf16_f32 v145, v146, v147
 v_mfma_f32_16x16x32_bf16 v[20:23], a[196:199], a[128:131], 0
 s_add_u32 s34, s48, s51
 v_cvt_pk_bf16_f32 v146, v148, v149
 v_cvt_pk_bf16_f32 v147, v150, v151
 v_accvgpr_write_b32 a132, v144
 v_mfma_f32_16x16x32_bf16 v[48:51], a[200:203], a[128:131], 0
 buffer_load_dwordx4 v1, s[16:19], s34 offen offset:0 sc1 lds
 v_mfma_f32_16x16x32_bf16 v[52:55], a[204:207], a[128:131], 0
 v_accvgpr_write_b32 a133, v145
 v_accvgpr_write_b32 a134, v146
 v_mfma_f32_16x16x32_bf16 v[24:27], a[192:195], a[144:147], 0
 v_accvgpr_write_b32 a135, v147
 v_cvt_pk_bf16_f32 v152, v152, v153
 v_cvt_pk_bf16_f32 v153, v154, v155
 v_mfma_f32_16x16x32_bf16 v[28:31], a[196:199], a[144:147], 0
 v_cvt_pk_bf16_f32 v154, v156, v157
 v_cvt_pk_bf16_f32 v155, v158, v159
 v_accvgpr_write_b32 a148, v152
 v_mfma_f32_16x16x32_bf16 v[56:59], a[200:203], a[144:147], 0
 buffer_load_dwordx4 v1, s[16:19], s34 offen offset:1024 sc1 lds
 v_mfma_f32_16x16x32_bf16 v[60:63], a[204:207], a[144:147], 0
 v_accvgpr_write_b32 a149, v153
 v_accvgpr_write_b32 a150, v154
 v_mfma_f32_16x16x32_bf16 v[32:35], a[192:195], a[160:163], 0
 v_accvgpr_write_b32 a151, v155
 v_cvt_pk_bf16_f32 v208, v208, v209
 v_cvt_pk_bf16_f32 v209, v210, v211
 v_mfma_f32_16x16x32_bf16 v[36:39], a[196:199], a[160:163], 0
 v_cvt_pk_bf16_f32 v210, v212, v213
 v_cvt_pk_bf16_f32 v211, v214, v215
 v_accvgpr_write_b32 a164, v208
 v_mfma_f32_16x16x32_bf16 v[64:67], a[200:203], a[160:163], 0
 buffer_load_dwordx4 v1, s[16:19], s34 offen offset:2048 sc1 lds
 v_mfma_f32_16x16x32_bf16 v[68:71], a[204:207], a[160:163], 0
 v_accvgpr_write_b32 a165, v209
 v_accvgpr_write_b32 a166, v210
 v_mfma_f32_16x16x32_bf16 v[40:43], a[192:195], a[176:179], 0
 v_accvgpr_write_b32 a167, v211
 v_cvt_pk_bf16_f32 v216, v216, v217
 v_cvt_pk_bf16_f32 v217, v218, v219
 v_mfma_f32_16x16x32_bf16 v[44:47], a[196:199], a[176:179], 0
 buffer_load_dwordx4 v1, s[16:19], s34 offen offset:3072 sc1 lds
 v_mfma_f32_16x16x32_bf16 v[72:75], a[200:203], a[176:179], 0
 v_cvt_pk_bf16_f32 v218, v220, v221
 v_cvt_pk_bf16_f32 v219, v222, v223
 v_accvgpr_write_b32 a180, v216
 v_mfma_f32_16x16x32_bf16 v[76:79], a[204:207], a[176:179], 0
 v_accvgpr_write_b32 a181, v217
 v_accvgpr_write_b32 a182, v218
 v_accvgpr_write_b32 a183, v219
 v_mfma_f32_16x16x32_bf16 v[16:19], a[208:211], a[132:135], v[16:19]
 v_cvt_pk_bf16_f32 v160, v160, v161
 v_cvt_pk_bf16_f32 v161, v162, v163
 v_mfma_f32_16x16x32_bf16 v[20:23], a[212:215], a[132:135], v[20:23]
 s_add_u32 m0, s51, 4096
 v_cvt_pk_bf16_f32 v162, v164, v165
 v_cvt_pk_bf16_f32 v163, v166, v167
 v_accvgpr_write_b32 a136, v160
 v_mfma_f32_16x16x32_bf16 v[48:51], a[216:219], a[132:135], v[48:51]
 s_add_u32 s34, s34, 4096
 v_accvgpr_write_b32 a137, v161
 v_accvgpr_write_b32 a138, v162
 v_mfma_f32_16x16x32_bf16 v[52:55], a[220:223], a[132:135], v[52:55]
 v_accvgpr_write_b32 a139, v163
 v_cvt_pk_bf16_f32 v168, v168, v169
 v_cvt_pk_bf16_f32 v169, v170, v171
 v_mfma_f32_16x16x32_bf16 v[24:27], a[208:211], a[148:151], v[24:27]
 buffer_load_dwordx4 v1, s[16:19], s34 offen offset:0 sc1 lds
 v_mfma_f32_16x16x32_bf16 v[28:31], a[212:215], a[148:151], v[28:31]
 v_cvt_pk_bf16_f32 v170, v172, v173
 v_cvt_pk_bf16_f32 v171, v174, v175
 v_accvgpr_write_b32 a152, v168
 v_mfma_f32_16x16x32_bf16 v[56:59], a[216:219], a[148:151], v[56:59]
 v_accvgpr_write_b32 a153, v169
 v_accvgpr_write_b32 a154, v170
 v_mfma_f32_16x16x32_bf16 v[60:63], a[220:223], a[148:151], v[60:63]
 buffer_load_dwordx4 v1, s[16:19], s34 offen offset:1024 sc1 lds
 v_mfma_f32_16x16x32_bf16 v[32:35], a[208:211], a[164:167], v[32:35]
 v_accvgpr_write_b32 a155, v171
 v_cvt_pk_bf16_f32 v224, v224, v225
 v_cvt_pk_bf16_f32 v225, v226, v227
 v_mfma_f32_16x16x32_bf16 v[36:39], a[212:215], a[164:167], v[36:39]
 v_cvt_pk_bf16_f32 v226, v228, v229
 v_cvt_pk_bf16_f32 v227, v230, v231
 v_accvgpr_write_b32 a168, v224
 v_mfma_f32_16x16x32_bf16 v[64:67], a[216:219], a[164:167], v[64:67]
 v_accvgpr_write_b32 a169, v225
 v_accvgpr_write_b32 a170, v226
 v_mfma_f32_16x16x32_bf16 v[68:71], a[220:223], a[164:167], v[68:71]
 buffer_load_dwordx4 v1, s[16:19], s34 offen offset:2048 sc1 lds
 v_mfma_f32_16x16x32_bf16 v[40:43], a[208:211], a[180:183], v[40:43]
 v_accvgpr_write_b32 a171, v227
 v_cvt_pk_bf16_f32 v232, v232, v233
 v_cvt_pk_bf16_f32 v233, v234, v235
 v_mfma_f32_16x16x32_bf16 v[44:47], a[212:215], a[180:183], v[44:47]
 v_cvt_pk_bf16_f32 v234, v236, v237
 v_cvt_pk_bf16_f32 v235, v238, v239
 v_accvgpr_write_b32 a184, v232
 v_mfma_f32_16x16x32_bf16 v[72:75], a[216:219], a[180:183], v[72:75]
 v_accvgpr_write_b32 a185, v233
 v_accvgpr_write_b32 a186, v234
 v_mfma_f32_16x16x32_bf16 v[76:79], a[220:223], a[180:183], v[76:79]
 buffer_load_dwordx4 v1, s[16:19], s34 offen offset:3072 sc1 lds
 v_accvgpr_write_b32 a187, v235
 v_mfma_f32_16x16x32_bf16 v[16:19], a[224:227], a[136:139], v[16:19]
 v_cvt_pk_bf16_f32 v176, v176, v177
 v_cvt_pk_bf16_f32 v177, v178, v179
 v_mfma_f32_16x16x32_bf16 v[20:23], a[228:231], a[136:139], v[20:23]
 v_cvt_pk_bf16_f32 v178, v180, v181
 v_cvt_pk_bf16_f32 v179, v182, v183
 v_mfma_f32_16x16x32_bf16 v[48:51], a[232:235], a[136:139], v[48:51]
 v_accvgpr_write_b32 a140, v176
 v_accvgpr_write_b32 a141, v177
 v_mfma_f32_16x16x32_bf16 v[52:55], a[236:239], a[136:139], v[52:55]
 s_cmp_eq_u32 s21, 0
 s_cselect_b32 s22, 2, 1
 v_accvgpr_write_b32 a142, v178
 v_mfma_f32_16x16x32_bf16 v[24:27], a[224:227], a[152:155], v[24:27]
 v_accvgpr_write_b32 a143, v179
 v_cvt_pk_bf16_f32 v184, v184, v185
 v_mfma_f32_16x16x32_bf16 v[28:31], a[228:231], a[152:155], v[28:31]
 s_lshl_b32 s22, s22, 14
 v_cvt_pk_bf16_f32 v185, v186, v187
 v_cvt_pk_bf16_f32 v186, v188, v189
 v_mfma_f32_16x16x32_bf16 v[56:59], a[232:235], a[152:155], v[56:59]
 s_add_u32 s48, s48, s22
 v_cvt_pk_bf16_f32 v187, v190, v191
 v_accvgpr_write_b32 a156, v184
 v_mfma_f32_16x16x32_bf16 v[60:63], a[236:239], a[152:155], v[60:63]
 v_accvgpr_write_b32 a157, v185
 v_accvgpr_write_b32 a158, v186
 v_mfma_f32_16x16x32_bf16 v[32:35], a[224:227], a[168:171], v[32:35]
 v_accvgpr_write_b32 a159, v187
 v_cvt_pk_bf16_f32 v240, v240, v241
 v_mfma_f32_16x16x32_bf16 v[36:39], a[228:231], a[168:171], v[36:39]
 v_cvt_pk_bf16_f32 v241, v242, v243
 v_cvt_pk_bf16_f32 v242, v244, v245
 v_mfma_f32_16x16x32_bf16 v[64:67], a[232:235], a[168:171], v[64:67]
 v_cvt_pk_bf16_f32 v243, v246, v247
 v_accvgpr_write_b32 a172, v240
 v_mfma_f32_16x16x32_bf16 v[68:71], a[236:239], a[168:171], v[68:71]
 v_accvgpr_write_b32 a173, v241
 v_accvgpr_write_b32 a174, v242
 v_mfma_f32_16x16x32_bf16 v[40:43], a[224:227], a[184:187], v[40:43]
 v_accvgpr_write_b32 a175, v243
 v_cvt_pk_bf16_f32 v248, v248, v249
 v_mfma_f32_16x16x32_bf16 v[44:47], a[228:231], a[184:187], v[44:47]
 v_cvt_pk_bf16_f32 v249, v250, v251
 v_cvt_pk_bf16_f32 v250, v252, v253
 v_mfma_f32_16x16x32_bf16 v[72:75], a[232:235], a[184:187], v[72:75]
 v_cvt_pk_bf16_f32 v251, v254, v255
 v_accvgpr_write_b32 a188, v248
 v_mfma_f32_16x16x32_bf16 v[76:79], a[236:239], a[184:187], v[76:79]
 v_accvgpr_write_b32 a189, v249
 v_accvgpr_write_b32 a190, v250
 v_accvgpr_write_b32 a191, v251
 v_mfma_f32_16x16x32_bf16 v[16:19], a[240:243], a[140:143], v[16:19]
 v_add_u32 v2, 0x10000, v1
 v_and_b32 v10, 15, v0
 v_mfma_f32_16x16x32_bf16 v[20:23], a[244:247], a[140:143], v[20:23]
 v_lshrrev_b32 v11, 4, v0
 v_mfma_f32_16x16x32_bf16 v[48:51], a[248:251], a[140:143], v[48:51]
 v_lshlrev_b32 v11, 2, v11
 v_mfma_f32_16x16x32_bf16 v[52:55], a[252:255], a[140:143], v[52:55]
 v_sub_u32 v3, v10, v11
 v_mfma_f32_16x16x32_bf16 v[24:27], a[240:243], a[156:159], v[24:27]
 v_mov_b32 v4, 0
 v_mfma_f32_16x16x32_bf16 v[28:31], a[244:247], a[156:159], v[28:31]
 v_mov_b32 v5, 0
 v_mov_b32 v6, 0
 v_mfma_f32_16x16x32_bf16 v[56:59], a[248:251], a[156:159], v[56:59]
 v_mov_b32 v7, 0
 v_mfma_f32_16x16x32_bf16 v[60:63], a[252:255], a[156:159], v[60:63]
 v_mov_b32 v249, 0xff800000
 v_mfma_f32_16x16x32_bf16 v[32:35], a[240:243], a[172:175], v[32:35]
 v_bfe_u32 v250, v0, 3, 2
 v_mfma_f32_16x16x32_bf16 v[36:39], a[244:247], a[172:175], v[36:39]
 v_lshl_add_u32 v250, v250, 7, v124
 v_mfma_f32_16x16x32_bf16 v[64:67], a[248:251], a[172:175], v[64:67]
 s_and_b32 s55, s55, 0xfffffe00
 v_mov_b32 v252, 0x3f803f80
 v_mfma_f32_16x16x32_bf16 v[68:71], a[252:255], a[172:175], v[68:71]
 v_mov_b32 v253, 0x3f803f80
 v_mfma_f32_16x16x32_bf16 v[40:43], a[240:243], a[188:191], v[40:43]
 v_mov_b32 v254, 0x3f803f80
 v_mfma_f32_16x16x32_bf16 v[44:47], a[244:247], a[188:191], v[44:47]
 v_mov_b32 v255, 0x3f803f80
 v_mfma_f32_16x16x32_bf16 v[72:75], a[248:251], a[188:191], v[72:75]
 v_mov_b32 v14, v121
 v_mfma_f32_16x16x32_bf16 v[76:79], a[252:255], a[188:191], v[76:79]
 v_mov_b32 v15, 2
 ds_read_b128 a[192:195], v1 offset:32768
 ds_read_b128 a[196:199], v1 offset:34816
 ds_read_b128 a[200:203], v1 offset:36864
 ds_read_b128 a[204:207], v1 offset:38912
 ds_read_b128 a[208:211], v1 offset:33792
 ds_read_b128 a[212:215], v1 offset:35840
 ds_read_b128 a[216:219], v1 offset:37888
 ds_read_b128 a[220:223], v1 offset:39936
 v_cmp_gt_i32 s[26:27], 0, v3
 v_cmp_gt_i32 s[28:29], 1, v3
 v_cmp_gt_i32 s[30:31], 2, v3
 v_cmp_gt_i32 s[4:5], 3, v3
 s_cmp_eq_u32 s3, 1
 s_cbranch_scc1 L_mk_16
 s_cmp_eq_u32 s3, 2
 s_cbranch_scc1 L_mk_17
 s_cmp_eq_u32 s3, 3
 s_cbranch_scc1 L_mk_18
 v_cndmask_b32 v32, v32, v249, s[26:27]
 v_cndmask_b32 v33, v33, v249, s[28:29]
 v_cndmask_b32 v34, v34, v249, s[30:31]
 v_cndmask_b32 v35, v35, v249, s[4:5]
L_mf_20:
 v_mov_b32 v36, v249
 v_mov_b32 v37, v249
 v_mov_b32 v38, v249
 v_mov_b32 v39, v249
 s_branch L_mf_21
L_mk_16:
 v_cndmask_b32 v36, v36, v249, s[26:27]
 v_cndmask_b32 v37, v37, v249, s[28:29]
 v_cndmask_b32 v38, v38, v249, s[30:31]
 v_cndmask_b32 v39, v39, v249, s[4:5]
L_mf_21:
 v_mov_b32 v64, v249
 v_mov_b32 v65, v249
 v_mov_b32 v66, v249
 v_mov_b32 v67, v249
 s_branch L_mf_22
L_mk_17:
 v_cndmask_b32 v64, v64, v249, s[26:27]
 v_cndmask_b32 v65, v65, v249, s[28:29]
 v_cndmask_b32 v66, v66, v249, s[30:31]
 v_cndmask_b32 v67, v67, v249, s[4:5]
L_mf_22:
 v_mov_b32 v68, v249
 v_mov_b32 v69, v249
 v_mov_b32 v70, v249
 v_mov_b32 v71, v249
 s_branch L_mf_23
L_mk_18:
 v_cndmask_b32 v68, v68, v249, s[26:27]
 v_cndmask_b32 v69, v69, v249, s[28:29]
 v_cndmask_b32 v70, v70, v249, s[30:31]
 v_cndmask_b32 v71, v71, v249, s[4:5]
L_mf_23:
 v_max3_f32 v240, v16, v17, v18
 v_max3_f32 v240, v240, v19, v20
 v_max3_f32 v240, v240, v21, v22
 v_max3_f32 v240, v240, v23, v48
 v_max3_f32 v240, v240, v49, v50
 v_max3_f32 v240, v240, v51, v52
 v_max3_f32 v240, v240, v53, v54
 v_max_f32 v240, v240, v55
 v_max3_f32 v241, v24, v25, v26
 v_max3_f32 v241, v241, v27, v28
 v_max3_f32 v241, v241, v29, v30
 v_max3_f32 v241, v241, v31, v56
 v_max3_f32 v241, v241, v57, v58
 v_max3_f32 v241, v241, v59, v60
 v_max3_f32 v241, v241, v61, v62
 v_max_f32 v241, v241, v63
 v_max3_f32 v242, v32, v33, v34
 v_max3_f32 v242, v242, v35, v36
 v_max3_f32 v242, v242, v37, v38
 v_max3_f32 v242, v242, v39, v64
 v_max3_f32 v242, v242, v65, v66
 v_max3_f32 v242, v242, v67, v68
 v_max3_f32 v242, v242, v69, v70
 v_max_f32 v242, v242, v71
 v_max3_f32 v243, v40, v41, v42
 v_max3_f32 v243, v243, v43, v44
 v_max3_f32 v243, v243, v45, v46
 v_max3_f32 v243, v243, v47, v72
 v_max3_f32 v243, v243, v73, v74
 v_max3_f32 v243, v243, v75, v76
 v_max3_f32 v243, v243, v77, v78
 v_max_f32 v243, v243, v79
 v_mov_b32 v244, v240
 v_mov_b32 v245, v241
 v_mov_b32 v246, v242
 v_mov_b32 v247, v243
 v_permlane16_swap_b32 v240, v244
 v_permlane16_swap_b32 v241, v245
 v_permlane16_swap_b32 v242, v246
 v_permlane16_swap_b32 v243, v247
 v_max_f32 v240, v240, v244
 v_max_f32 v241, v241, v245
 v_max_f32 v242, v242, v246
 v_max_f32 v243, v243, v247
 v_mov_b32 v244, v240
 v_mov_b32 v245, v241
 v_mov_b32 v246, v242
 v_mov_b32 v247, v243
 v_permlane32_swap_b32 v240, v244
 v_permlane32_swap_b32 v241, v245
 v_permlane32_swap_b32 v242, v246
 v_permlane32_swap_b32 v243, v247
 v_max_f32 v240, v240, v244
 v_max_f32 v241, v241, v245
 v_max_f32 v242, v242, v246
 v_max_f32 v243, v243, v247
 v_sub_f32 v208, 0, v240
 v_sub_f32 v209, 0, v240
 v_sub_f32 v210, 0, v240
 v_sub_f32 v211, 0, v240
 v_sub_f32 v212, 0, v241
 v_sub_f32 v213, 0, v241
 v_sub_f32 v214, 0, v241
 v_sub_f32 v215, 0, v241
 v_sub_f32 v216, 0, v242
 v_sub_f32 v217, 0, v242
 v_sub_f32 v218, 0, v242
 v_sub_f32 v219, 0, v242
 v_sub_f32 v220, 0, v243
 v_sub_f32 v221, 0, v243
 v_sub_f32 v222, 0, v243
 v_sub_f32 v223, 0, v243
 v_pk_add_f32 v[16:17], v[16:17], v[208:209]
 v_pk_add_f32 v[18:19], v[18:19], v[208:209]
 v_pk_add_f32 v[20:21], v[20:21], v[208:209]
 v_pk_add_f32 v[22:23], v[22:23], v[208:209]
 v_pk_add_f32 v[48:49], v[48:49], v[208:209]
 v_pk_add_f32 v[50:51], v[50:51], v[208:209]
 v_pk_add_f32 v[52:53], v[52:53], v[208:209]
 v_pk_add_f32 v[54:55], v[54:55], v[208:209]
 v_pk_add_f32 v[24:25], v[24:25], v[212:213]
 v_pk_add_f32 v[26:27], v[26:27], v[212:213]
 v_pk_add_f32 v[28:29], v[28:29], v[212:213]
 v_pk_add_f32 v[30:31], v[30:31], v[212:213]
 v_pk_add_f32 v[56:57], v[56:57], v[212:213]
 v_pk_add_f32 v[58:59], v[58:59], v[212:213]
 v_pk_add_f32 v[60:61], v[60:61], v[212:213]
 v_pk_add_f32 v[62:63], v[62:63], v[212:213]
 v_pk_add_f32 v[32:33], v[32:33], v[216:217]
 v_pk_add_f32 v[34:35], v[34:35], v[216:217]
 v_pk_add_f32 v[36:37], v[36:37], v[216:217]
 v_pk_add_f32 v[38:39], v[38:39], v[216:217]
 v_pk_add_f32 v[64:65], v[64:65], v[216:217]
 v_pk_add_f32 v[66:67], v[66:67], v[216:217]
 v_pk_add_f32 v[68:69], v[68:69], v[216:217]
 v_pk_add_f32 v[70:71], v[70:71], v[216:217]
 v_pk_add_f32 v[40:41], v[40:41], v[220:221]
 v_pk_add_f32 v[42:43], v[42:43], v[220:221]
 v_pk_add_f32 v[44:45], v[44:45], v[220:221]
 v_pk_add_f32 v[46:47], v[46:47], v[220:221]
 v_pk_add_f32 v[72:73], v[72:73], v[220:221]
 v_pk_add_f32 v[74:75], v[74:75], v[220:221]
 v_pk_add_f32 v[76:77], v[76:77], v[220:221]
 v_pk_add_f32 v[78:79], v[78:79], v[220:221]
 s_waitcnt lgkmcnt(4)
 v_mfma_f32_16x16x32_bf16 v[80:83], a[192:195], a[128:131], v[208:211]
 ds_read_b128 a[224:227], v1 offset:40960
 v_exp_f32 v240, v16
 v_mfma_f32_16x16x32_bf16 v[80:83], a[196:199], a[132:135], v[80:83]
 v_exp_f32 v241, v17
 v_exp_f32 v242, v18
 v_mfma_f32_16x16x32_bf16 v[80:83], a[200:203], a[136:139], v[80:83]
 v_exp_f32 v243, v19
 v_exp_f32 v244, v20
 v_mfma_f32_16x16x32_bf16 v[80:83], a[204:207], a[140:143], v[80:83]
 v_exp_f32 v245, v21
 v_exp_f32 v246, v22
 v_mfma_f32_16x16x32_bf16 v[88:91], a[204:207], a[156:159], v[212:215]
 ds_read_b128 a[228:231], v1 offset:43008
 v_exp_f32 v247, v23
 v_cvt_pk_bf16_f32 v144, v240, v241
 v_mfma_f32_16x16x32_bf16 v[88:91], a[200:203], a[152:155], v[88:91]
 v_exp_f32 v240, v24
 v_cvt_pk_bf16_f32 v145, v242, v243
 v_cvt_pk_bf16_f32 v146, v244, v245
 v_cvt_pk_bf16_f32 v147, v246, v247
 v_mfma_f32_16x16x32_bf16 v[88:91], a[196:199], a[148:151], v[88:91]
 v_exp_f32 v241, v25
 v_mfma_f32_16x16x32_bf16 v[88:91], a[192:195], a[144:147], v[88:91]
 v_exp_f32 v242, v26
 v_mfma_f32_16x16x32_bf16 v[224:227], v[252:255], v[144:147], 0
 v_exp_f32 v243, v27
 v_mfma_f32_16x16x32_bf16 v[96:99], a[192:195], a[160:163], v[216:219]
 ds_read_b128 a[232:235], v1 offset:45056
 v_exp_f32 v244, v28
 v_mfma_f32_16x16x32_bf16 v[96:99], a[196:199], a[164:167], v[96:99]
 v_exp_f32 v245, v29
 v_mfma_f32_16x16x32_bf16 v[96:99], a[200:203], a[168:171], v[96:99]
 v_exp_f32 v246, v30
 v_mfma_f32_16x16x32_bf16 v[96:99], a[204:207], a[172:175], v[96:99]
 v_exp_f32 v247, v31
 v_mfma_f32_16x16x32_bf16 v[104:107], a[204:207], a[188:191], v[220:223]
 ds_read_b128 a[236:239], v1 offset:47104
 v_cvt_pk_bf16_f32 v148, v240, v241
 v_cvt_pk_bf16_f32 v149, v242, v243
 v_cvt_pk_bf16_f32 v150, v244, v245
 v_cvt_pk_bf16_f32 v151, v246, v247
 v_mfma_f32_16x16x32_bf16 v[104:107], a[200:203], a[184:187], v[104:107]
 v_exp_f32 v240, v32
 v_exp_f32 v241, v33
 v_mfma_f32_16x16x32_bf16 v[104:107], a[196:199], a[180:183], v[104:107]
 v_exp_f32 v242, v34
 v_exp_f32 v243, v35
 v_mfma_f32_16x16x32_bf16 v[104:107], a[192:195], a[176:179], v[104:107]
 v_exp_f32 v244, v36
 v_exp_f32 v245, v37
 v_mfma_f32_16x16x32_bf16 v[228:231], v[252:255], v[148:151], 0
 s_waitcnt lgkmcnt(4)
 v_exp_f32 v246, v38
 v_cvt_pk_bf16_f32 v152, v240, v241
 v_mfma_f32_16x16x32_bf16 v[84:87], a[208:211], a[128:131], v[208:211]
 ds_read_b128 a[240:243], v1 offset:41984
 v_exp_f32 v247, v39
 v_mfma_f32_16x16x32_bf16 v[84:87], a[212:215], a[132:135], v[84:87]
 v_exp_f32 v240, v40
 v_cvt_pk_bf16_f32 v153, v242, v243
 v_cvt_pk_bf16_f32 v154, v244, v245
 v_cvt_pk_bf16_f32 v155, v246, v247
 v_mfma_f32_16x16x32_bf16 v[84:87], a[216:219], a[136:139], v[84:87]
 v_exp_f32 v241, v41
 v_mfma_f32_16x16x32_bf16 v[84:87], a[220:223], a[140:143], v[84:87]
 v_exp_f32 v242, v42
 v_mfma_f32_16x16x32_bf16 v[232:235], v[252:255], v[152:155], 0
 ds_read_b128 a[244:247], v1 offset:44032
 v_exp_f32 v243, v43
 v_mfma_f32_16x16x32_bf16 v[92:95], a[220:223], a[156:159], v[212:215]
 v_exp_f32 v244, v44
 v_mfma_f32_16x16x32_bf16 v[92:95], a[216:219], a[152:155], v[92:95]
 v_exp_f32 v245, v45
 v_mfma_f32_16x16x32_bf16 v[92:95], a[212:215], a[148:151], v[92:95]
 v_exp_f32 v246, v46
 v_mfma_f32_16x16x32_bf16 v[92:95], a[208:211], a[144:147], v[92:95]
 v_exp_f32 v247, v47
 v_mfma_f32_16x16x32_bf16 v[100:103], a[208:211], a[160:163], v[216:219]
 ds_read_b128 a[248:251], v1 offset:46080
 v_cvt_pk_bf16_f32 v156, v240, v241
 v_cvt_pk_bf16_f32 v157, v242, v243
 v_mfma_f32_16x16x32_bf16 v[100:103], a[212:215], a[164:167], v[100:103]
 v_exp_f32 v240, v48
 v_cvt_pk_bf16_f32 v158, v244, v245
 v_cvt_pk_bf16_f32 v159, v246, v247
 v_mfma_f32_16x16x32_bf16 v[100:103], a[216:219], a[168:171], v[100:103]
 v_exp_f32 v241, v49
 v_mfma_f32_16x16x32_bf16 v[100:103], a[220:223], a[172:175], v[100:103]
 v_exp_f32 v242, v50
 v_mfma_f32_16x16x32_bf16 v[236:239], v[252:255], v[156:159], 0
 ds_read_b128 a[252:255], v1 offset:48128
 v_cvt_pk_bf16_f32 v160, v240, v241
 v_mfma_f32_16x16x32_bf16 v[108:111], a[220:223], a[188:191], v[220:223]
 v_exp_f32 v243, v51
 v_mfma_f32_16x16x32_bf16 v[108:111], a[216:219], a[184:187], v[108:111]
 v_exp_f32 v244, v52
 v_cvt_pk_bf16_f32 v161, v242, v243
 v_mfma_f32_16x16x32_bf16 v[108:111], a[212:215], a[180:183], v[108:111]
 v_exp_f32 v245, v53
 v_mfma_f32_16x16x32_bf16 v[108:111], a[208:211], a[176:179], v[108:111]
 s_waitcnt lgkmcnt(4)
 v_exp_f32 v246, v54
 v_cvt_pk_bf16_f32 v162, v244, v245
 v_mfma_f32_16x16x32_bf16 v[112:115], a[224:227], a[128:131], v[208:211]
 v_exp_f32 v247, v55
 v_mfma_f32_16x16x32_bf16 v[112:115], a[228:231], a[132:135], v[112:115]
 v_exp_f32 v240, v56
 v_exp_f32 v241, v57
 v_cvt_pk_bf16_f32 v163, v246, v247
 v_mfma_f32_16x16x32_bf16 v[112:115], a[232:235], a[136:139], v[112:115]
 v_exp_f32 v242, v58
 v_exp_f32 v243, v59
 v_mfma_f32_16x16x32_bf16 v[112:115], a[236:239], a[140:143], v[112:115]
 s_waitcnt vmcnt(0) lgkmcnt(0)
 s_barrier
 v_exp_f32 v244, v60
 v_cvt_pk_bf16_f32 v164, v240, v241
 v_mfma_f32_16x16x32_bf16 v[224:227], v[252:255], v[160:163], v[224:227]
 ds_read_b128 a[192:195], v2 offset:0
 v_exp_f32 v245, v61
 v_mfma_f32_16x16x32_bf16 v[120:123], a[236:239], a[156:159], v[212:215]
 v_exp_f32 v246, v62
 v_exp_f32 v247, v63
 v_mfma_f32_16x16x32_bf16 v[120:123], a[232:235], a[152:155], v[120:123]
 v_exp_f32 v240, v64
 v_cvt_pk_bf16_f32 v165, v242, v243
 v_cvt_pk_bf16_f32 v166, v244, v245
 v_cvt_pk_bf16_f32 v167, v246, v247
 v_mfma_f32_16x16x32_bf16 v[120:123], a[228:231], a[148:151], v[120:123]
 ds_read_b128 a[196:199], v2 offset:8192
 v_exp_f32 v241, v65
 v_mfma_f32_16x16x32_bf16 v[120:123], a[224:227], a[144:147], v[120:123]
 v_exp_f32 v242, v66
 v_mfma_f32_16x16x32_bf16 v[228:231], v[252:255], v[164:167], v[228:231]
 v_exp_f32 v243, v67
 v_mfma_f32_16x16x32_bf16 v[128:131], a[224:227], a[160:163], v[216:219]
 v_exp_f32 v244, v68
 v_mfma_f32_16x16x32_bf16 v[128:131], a[228:231], a[164:167], v[128:131]
 ds_read_b128 a[200:203], v2 offset:1024
 v_cvt_pk_bf16_f32 v168, v240, v241
 v_cvt_pk_bf16_f32 v169, v242, v243
 v_mfma_f32_16x16x32_bf16 v[128:131], a[232:235], a[168:171], v[128:131]
 v_exp_f32 v245, v69
 v_mfma_f32_16x16x32_bf16 v[128:131], a[236:239], a[172:175], v[128:131]
 v_exp_f32 v246, v70
 v_cvt_pk_bf16_f32 v170, v244, v245
 v_mfma_f32_16x16x32_bf16 v[136:139], a[236:239], a[188:191], v[220:223]
 v_exp_f32 v247, v71
 v_mfma_f32_16x16x32_bf16 v[136:139], a[232:235], a[184:187], v[136:139]
 ds_read_b128 a[204:207], v2 offset:9216
 v_exp_f32 v240, v72
 v_cvt_pk_bf16_f32 v171, v246, v247
 v_mfma_f32_16x16x32_bf16 v[136:139], a[228:231], a[180:183], v[136:139]
 v_exp_f32 v241, v73
 v_mfma_f32_16x16x32_bf16 v[136:139], a[224:227], a[176:179], v[136:139]
 v_exp_f32 v242, v74
 v_mfma_f32_16x16x32_bf16 v[232:235], v[252:255], v[168:171], v[232:235]
 v_exp_f32 v243, v75
 v_mfma_f32_16x16x32_bf16 v[116:119], a[240:243], a[128:131], v[208:211]
 ds_read_b128 a[208:211], v2 offset:2048
 v_exp_f32 v244, v76
 v_mfma_f32_16x16x32_bf16 v[116:119], a[244:247], a[132:135], v[116:119]
 v_exp_f32 v245, v77
 v_mfma_f32_16x16x32_bf16 v[116:119], a[248:251], a[136:139], v[116:119]
 v_exp_f32 v246, v78
 v_mfma_f32_16x16x32_bf16 v[116:119], a[252:255], a[140:143], v[116:119]
 v_exp_f32 v247, v79
 v_mfma_f32_16x16x32_bf16 v[124:127], a[252:255], a[156:159], v[212:215]
 ds_read_b128 a[212:215], v2 offset:10240
 v_cvt_pk_bf16_f32 v172, v240, v241
 v_mfma_f32_16x16x32_bf16 v[124:127], a[248:251], a[152:155], v[124:127]
 v_cvt_pk_bf16_f32 v173, v242, v243
 v_cvt_pk_bf16_f32 v174, v244, v245
 v_cvt_pk_bf16_f32 v175, v246, v247
 v_mfma_f32_16x16x32_bf16 v[124:127], a[244:247], a[148:151], v[124:127]
 v_mfma_f32_16x16x32_bf16 v[124:127], a[240:243], a[144:147], v[124:127]
 v_mfma_f32_16x16x32_bf16 v[236:239], v[252:255], v[172:175], v[236:239]
 ds_read_b128 a[216:219], v2 offset:3072
 v_mfma_f32_16x16x32_bf16 v[132:135], a[240:243], a[160:163], v[216:219]
 v_mfma_f32_16x16x32_bf16 v[132:135], a[244:247], a[164:167], v[132:135]
 v_mfma_f32_16x16x32_bf16 v[132:135], a[248:251], a[168:171], v[132:135]
 s_nop 1
 v_mfma_f32_16x16x32_bf16 v[132:135], a[252:255], a[172:175], v[132:135]
 ds_read_b128 a[220:223], v2 offset:11264
 v_max3_f32 v10, v224, v228, v232
 v_mfma_f32_16x16x32_bf16 v[140:143], a[252:255], a[188:191], v[220:223]
 v_max_f32 v10, v10, v236
 v_mfma_f32_16x16x32_bf16 v[140:143], a[248:251], a[184:187], v[140:143]
 v_cmp_lt_f32 vcc, s54, v10
 v_mfma_f32_16x16x32_bf16 v[140:143], a[244:247], a[180:183], v[140:143]
 v_mfma_f32_16x16x32_bf16 v[140:143], a[240:243], a[176:179], v[140:143]
 s_cbranch_vccnz L_jr_26
L_back_25:
 s_cmp_eq_u32 s63, 0
 s_cbranch_scc1 L_rel_27
L_reld_28:
 buffer_store_dword v15, v14, s[16:19], s94 offen sc1
 s_cmp_eq_u32 s21, 0
 s_cbranch_scc1 L_T1_30
 s_mov_b32 s32, s21
.p2align 6
L_L1_32:
 s_waitcnt lgkmcnt(4)
 v_mfma_f32_16x16x32_bf16 a[0:3], a[192:195], v[144:147], a[0:3]
 ds_read_b128 a[224:227], v2 offset:4096
 v_add_f32 v4, v4, v224
 v_mfma_f32_16x16x32_bf16 a[0:3], a[196:199], v[160:163], a[0:3]
 s_add_u32 m0, s50, 98304
 v_exp_f32 v240, v80
 v_mfma_f32_16x16x32_bf16 a[32:35], a[196:199], v[164:167], a[32:35]
 s_add_u32 s34, s49, s50
 v_add_f32 v5, v5, v228
 v_mfma_f32_16x16x32_bf16 a[32:35], a[192:195], v[148:151], a[32:35]
 buffer_load_dwordx4 v1, s[16:19], s34 offen offset:0 sc1 lds
 v_mfma_f32_16x16x32_bf16 a[64:67], a[192:195], v[152:155], a[64:67]
 ds_read_b128 a[228:231], v2 offset:12288
 v_mfma_f32_16x16x32_bf16 a[64:67], a[196:199], v[168:171], a[64:67]
 v_add_f32 v6, v6, v232
 v_mfma_f32_16x16x32_bf16 a[96:99], a[196:199], v[172:175], a[96:99]
 v_add_f32 v7, v7, v236
 v_mfma_f32_16x16x32_bf16 a[96:99], a[192:195], v[156:159], a[96:99]
 v_exp_f32 v241, v81
 v_mfma_f32_16x16x32_bf16 a[4:7], a[200:203], v[144:147], a[4:7]
 ds_read_b128 a[232:235], v2 offset:5120
 v_cvt_pk_bf16_f32 v176, v240, v241
 v_mfma_f32_16x16x32_bf16 a[4:7], a[204:207], v[160:163], a[4:7]
 buffer_load_dwordx4 v1, s[16:19], s34 offen offset:1024 sc1 lds
 v_mfma_f32_16x16x32_bf16 a[36:39], a[204:207], v[164:167], a[36:39]
 v_exp_f32 v242, v82
 v_mfma_f32_16x16x32_bf16 a[36:39], a[200:203], v[148:151], a[36:39]
 v_exp_f32 v243, v83
 v_mfma_f32_16x16x32_bf16 a[68:71], a[200:203], v[152:155], a[68:71]
 ds_read_b128 a[236:239], v2 offset:13312
 v_cvt_pk_bf16_f32 v177, v242, v243
 v_mfma_f32_16x16x32_bf16 a[68:71], a[204:207], v[168:171], a[68:71]
 buffer_load_dwordx4 v1, s[16:19], s34 offen offset:2048 sc1 lds
 v_mfma_f32_16x16x32_bf16 a[100:103], a[204:207], v[172:175], a[100:103]
 v_exp_f32 v244, v84
 v_mfma_f32_16x16x32_bf16 a[100:103], a[200:203], v[156:159], a[100:103]
 s_waitcnt lgkmcnt(4)
 v_exp_f32 v245, v85
 v_mfma_f32_16x16x32_bf16 a[8:11], a[208:211], v[144:147], a[8:11]
 ds_read_b128 a[240:243], v2 offset:6144
 v_cvt_pk_bf16_f32 v178, v244, v245
 v_mfma_f32_16x16x32_bf16 a[8:11], a[212:215], v[160:163], a[8:11]
 buffer_load_dwordx4 v1, s[16:19], s34 offen offset:3072 sc1 lds
 v_mfma_f32_16x16x32_bf16 a[40:43], a[212:215], v[164:167], a[40:43]
 v_exp_f32 v246, v86
 v_mfma_f32_16x16x32_bf16 a[40:43], a[208:211], v[148:151], a[40:43]
 v_exp_f32 v247, v87
 v_mfma_f32_16x16x32_bf16 a[72:75], a[208:211], v[152:155], a[72:75]
 ds_read_b128 a[244:247], v2 offset:14336
 v_cvt_pk_bf16_f32 v179, v246, v247
 v_mfma_f32_16x16x32_bf16 a[72:75], a[212:215], v[168:171], a[72:75]
 v_exp_f32 v240, v88
 v_mfma_f32_16x16x32_bf16 a[104:107], a[212:215], v[172:175], a[104:107]
 s_add_u32 s49, s49, 16384
 v_exp_f32 v241, v89
 v_mfma_f32_16x16x32_bf16 a[104:107], a[208:211], v[156:159], a[104:107]
 s_cmp_eq_u32 s32, 1
 s_cselect_b32 s22, 0x4000, 0
 v_cvt_pk_bf16_f32 v180, v240, v241
 v_mfma_f32_16x16x32_bf16 v[224:227], v[252:255], v[176:179], 0
 ds_read_b128 a[248:251], v2 offset:7168
 v_mfma_f32_16x16x32_bf16 a[12:15], a[216:219], v[144:147], a[12:15]
 v_exp_f32 v242, v90
 v_mfma_f32_16x16x32_bf16 a[12:15], a[220:223], v[160:163], a[12:15]
 s_add_u32 s48, s48, s22
 v_exp_f32 v243, v91
 v_mfma_f32_16x16x32_bf16 a[44:47], a[220:223], v[164:167], a[44:47]
 v_exp_f32 v244, v92
 v_mfma_f32_16x16x32_bf16 a[44:47], a[216:219], v[148:151], a[44:47]
 ds_read_b128 a[252:255], v2 offset:15360
 s_add_u32 m0, s50, 32768
 v_mfma_f32_16x16x32_bf16 a[76:79], a[216:219], v[152:155], a[76:79]
 s_add_u32 s34, s48, s50
 v_exp_f32 v245, v93
 v_mfma_f32_16x16x32_bf16 a[76:79], a[220:223], v[168:171], a[76:79]
 v_cvt_pk_bf16_f32 v181, v242, v243
 v_cvt_pk_bf16_f32 v182, v244, v245
 v_mfma_f32_16x16x32_bf16 a[108:111], a[220:223], v[172:175], a[108:111]
 buffer_load_dwordx4 v1, s[16:19], s34 offen offset:0 sc1 lds
 v_mfma_f32_16x16x32_bf16 a[108:111], a[216:219], v[156:159], a[108:111]
 s_waitcnt lgkmcnt(4)
 v_mfma_f32_16x16x32_bf16 a[16:19], a[224:227], v[144:147], a[16:19]
 ds_read_b128 a[192:195], v1 offset:0
 v_mfma_f32_16x16x32_bf16 a[16:19], a[228:231], v[160:163], a[16:19]
 v_exp_f32 v246, v94
 v_mfma_f32_16x16x32_bf16 a[48:51], a[228:231], v[164:167], a[48:51]
 buffer_load_dwordx4 v1, s[16:19], s34 offen offset:1024 sc1 lds
 v_mfma_f32_16x16x32_bf16 a[48:51], a[224:227], v[148:151], a[48:51]
 v_exp_f32 v247, v95
 v_mfma_f32_16x16x32_bf16 a[80:83], a[224:227], v[152:155], a[80:83]
 ds_read_b128 a[196:199], v1 offset:2048
 v_cvt_pk_bf16_f32 v183, v246, v247
 v_mfma_f32_16x16x32_bf16 a[80:83], a[228:231], v[168:171], a[80:83]
 v_exp_f32 v240, v96
 v_mfma_f32_16x16x32_bf16 a[112:115], a[228:231], v[172:175], a[112:115]
 v_exp_f32 v241, v97
 v_mfma_f32_16x16x32_bf16 a[112:115], a[224:227], v[156:159], a[112:115]
 buffer_load_dwordx4 v1, s[16:19], s34 offen offset:2048 sc1 lds
 v_mfma_f32_16x16x32_bf16 a[20:23], a[232:235], v[144:147], a[20:23]
 ds_read_b128 a[200:203], v1 offset:4096
 v_cvt_pk_bf16_f32 v184, v240, v241
 v_mfma_f32_16x16x32_bf16 a[20:23], a[236:239], v[160:163], a[20:23]
 v_exp_f32 v242, v98
 v_mfma_f32_16x16x32_bf16 v[228:231], v[252:255], v[180:183], 0
 v_mfma_f32_16x16x32_bf16 a[52:55], a[236:239], v[164:167], a[52:55]
 buffer_load_dwordx4 v1, s[16:19], s34 offen offset:3072 sc1 lds
 v_mfma_f32_16x16x32_bf16 a[52:55], a[232:235], v[148:151], a[52:55]
 ds_read_b128 a[204:207], v1 offset:6144
 v_mfma_f32_16x16x32_bf16 a[84:87], a[232:235], v[152:155], a[84:87]
 v_exp_f32 v243, v99
 v_mfma_f32_16x16x32_bf16 a[84:87], a[236:239], v[168:171], a[84:87]
 v_cvt_pk_bf16_f32 v185, v242, v243
 v_mfma_f32_16x16x32_bf16 a[116:119], a[236:239], v[172:175], a[116:119]
 v_exp_f32 v244, v100
 v_mfma_f32_16x16x32_bf16 a[116:119], a[232:235], v[156:159], a[116:119]
 s_waitcnt lgkmcnt(4)
 s_add_u32 s48, s48, 16384
 v_mfma_f32_16x16x32_bf16 a[24:27], a[240:243], v[144:147], a[24:27]
 ds_read_b128 a[208:211], v1 offset:1024
 v_mfma_f32_16x16x32_bf16 a[24:27], a[244:247], v[160:163], a[24:27]
 v_mfma_f32_16x16x32_bf16 a[56:59], a[244:247], v[164:167], a[56:59]
 v_mfma_f32_16x16x32_bf16 a[56:59], a[240:243], v[148:151], a[56:59]
 v_exp_f32 v245, v101
 v_mfma_f32_16x16x32_bf16 a[88:91], a[240:243], v[152:155], a[88:91]
 ds_read_b128 a[212:215], v1 offset:3072
 v_cvt_pk_bf16_f32 v186, v244, v245
 v_mfma_f32_16x16x32_bf16 a[88:91], a[244:247], v[168:171], a[88:91]
 v_exp_f32 v246, v102
 v_mfma_f32_16x16x32_bf16 a[120:123], a[244:247], v[172:175], a[120:123]
 v_mfma_f32_16x16x32_bf16 a[120:123], a[240:243], v[156:159], a[120:123]
 v_exp_f32 v247, v103
 v_mfma_f32_16x16x32_bf16 a[28:31], a[248:251], v[144:147], a[28:31]
 ds_read_b128 a[216:219], v1 offset:5120
 v_cvt_pk_bf16_f32 v187, v246, v247
 v_mfma_f32_16x16x32_bf16 a[28:31], a[252:255], v[160:163], a[28:31]
 v_exp_f32 v240, v104
 v_mfma_f32_16x16x32_bf16 a[60:63], a[252:255], v[164:167], a[60:63]
 v_exp_f32 v241, v105
 v_mfma_f32_16x16x32_bf16 a[60:63], a[248:251], v[148:151], a[60:63]
 v_exp_f32 v242, v106
 v_mfma_f32_16x16x32_bf16 v[232:235], v[252:255], v[184:187], 0
 ds_read_b128 a[220:223], v1 offset:7168
 v_cvt_pk_bf16_f32 v188, v240, v241
 v_mfma_f32_16x16x32_bf16 a[92:95], a[248:251], v[152:155], a[92:95]
 v_exp_f32 v243, v107
 v_mfma_f32_16x16x32_bf16 a[92:95], a[252:255], v[168:171], a[92:95]
 v_exp_f32 v244, v108
 v_mfma_f32_16x16x32_bf16 a[124:127], a[252:255], v[172:175], a[124:127]
 v_cvt_pk_bf16_f32 v189, v242, v243
 v_mfma_f32_16x16x32_bf16 a[124:127], a[248:251], v[156:159], a[124:127]
 s_waitcnt lgkmcnt(4)
 v_exp_f32 v245, v109
 v_mfma_f32_16x16x32_bf16 v[16:19], a[192:195], a[128:131], v[208:211]
 ds_read_b128 a[224:227], v1 offset:8192
 v_cvt_pk_bf16_f32 v190, v244, v245
 v_mfma_f32_16x16x32_bf16 v[16:19], a[196:199], a[132:135], v[16:19]
 v_exp_f32 v246, v110
 v_mfma_f32_16x16x32_bf16 v[16:19], a[200:203], a[136:139], v[16:19]
 v_exp_f32 v247, v111
 v_mfma_f32_16x16x32_bf16 v[16:19], a[204:207], a[140:143], v[16:19]
 v_exp_f32 v240, v112
 v_mfma_f32_16x16x32_bf16 v[24:27], a[204:207], a[156:159], v[212:215]
 ds_read_b128 a[228:231], v1 offset:10240
 v_cvt_pk_bf16_f32 v191, v246, v247
 v_mfma_f32_16x16x32_bf16 v[24:27], a[200:203], a[152:155], v[24:27]
 v_mfma_f32_16x16x32_bf16 v[24:27], a[196:199], a[148:151], v[24:27]
 v_exp_f32 v241, v113
 v_mfma_f32_16x16x32_bf16 v[24:27], a[192:195], a[144:147], v[24:27]
 v_exp_f32 v242, v114
 v_mfma_f32_16x16x32_bf16 v[236:239], v[252:255], v[188:191], 0
 ds_read_b128 a[232:235], v1 offset:12288
 v_cvt_pk_bf16_f32 v192, v240, v241
 v_mfma_f32_16x16x32_bf16 v[32:35], a[192:195], a[160:163], v[216:219]
 v_exp_f32 v243, v115
 v_mfma_f32_16x16x32_bf16 v[32:35], a[196:199], a[164:167], v[32:35]
 v_exp_f32 v244, v116
 v_mfma_f32_16x16x32_bf16 v[32:35], a[200:203], a[168:171], v[32:35]
 v_exp_f32 v245, v117
 v_mfma_f32_16x16x32_bf16 v[32:35], a[204:207], a[172:175], v[32:35]
 ds_read_b128 a[236:239], v1 offset:14336
 v_cvt_pk_bf16_f32 v193, v242, v243
 v_mfma_f32_16x16x32_bf16 v[40:43], a[204:207], a[188:191], v[220:223]
 v_exp_f32 v246, v118
 v_mfma_f32_16x16x32_bf16 v[40:43], a[200:203], a[184:187], v[40:43]
 v_exp_f32 v247, v119
 v_mfma_f32_16x16x32_bf16 v[40:43], a[196:199], a[180:183], v[40:43]
 v_exp_f32 v240, v120
 v_mfma_f32_16x16x32_bf16 v[40:43], a[192:195], a[176:179], v[40:43]
 s_waitcnt lgkmcnt(4)
 v_exp_f32 v241, v121
 v_mfma_f32_16x16x32_bf16 v[20:23], a[208:211], a[128:131], v[208:211]
 ds_read_b128 a[240:243], v1 offset:9216
 v_cvt_pk_bf16_f32 v194, v244, v245
 v_mfma_f32_16x16x32_bf16 v[20:23], a[212:215], a[132:135], v[20:23]
 v_cvt_pk_bf16_f32 v195, v246, v247
 v_cvt_pk_bf16_f32 v196, v240, v241
 v_mfma_f32_16x16x32_bf16 v[20:23], a[216:219], a[136:139], v[20:23]
 v_exp_f32 v242, v122
 v_mfma_f32_16x16x32_bf16 v[20:23], a[220:223], a[140:143], v[20:23]
 v_exp_f32 v243, v123
 v_mfma_f32_16x16x32_bf16 v[224:227], v[252:255], v[192:195], v[224:227]
 ds_read_b128 a[244:247], v1 offset:11264
 v_cvt_pk_bf16_f32 v197, v242, v243
 v_mfma_f32_16x16x32_bf16 v[28:31], a[220:223], a[156:159], v[212:215]
 v_exp_f32 v244, v124
 v_mfma_f32_16x16x32_bf16 v[28:31], a[216:219], a[152:155], v[28:31]
 v_mfma_f32_16x16x32_bf16 v[28:31], a[212:215], a[148:151], v[28:31]
 v_mfma_f32_16x16x32_bf16 v[28:31], a[208:211], a[144:147], v[28:31]
 v_exp_f32 v245, v125
 v_mfma_f32_16x16x32_bf16 v[36:39], a[208:211], a[160:163], v[216:219]
 ds_read_b128 a[248:251], v1 offset:13312
 v_cvt_pk_bf16_f32 v198, v244, v245
 v_mfma_f32_16x16x32_bf16 v[36:39], a[212:215], a[164:167], v[36:39]
 v_exp_f32 v246, v126
 v_mfma_f32_16x16x32_bf16 v[36:39], a[216:219], a[168:171], v[36:39]
 v_mfma_f32_16x16x32_bf16 v[36:39], a[220:223], a[172:175], v[36:39]
 v_exp_f32 v247, v127
 v_mfma_f32_16x16x32_bf16 v[44:47], a[220:223], a[188:191], v[220:223]
 ds_read_b128 a[252:255], v1 offset:15360
 v_cvt_pk_bf16_f32 v199, v246, v247
 v_mfma_f32_16x16x32_bf16 v[44:47], a[216:219], a[184:187], v[44:47]
 v_exp_f32 v240, v128
 v_mfma_f32_16x16x32_bf16 v[44:47], a[212:215], a[180:183], v[44:47]
 v_exp_f32 v241, v129
 v_mfma_f32_16x16x32_bf16 v[44:47], a[208:211], a[176:179], v[44:47]
 v_exp_f32 v242, v130
 v_mfma_f32_16x16x32_bf16 v[228:231], v[252:255], v[196:199], v[228:231]
 s_waitcnt lgkmcnt(4)
 v_exp_f32 v243, v131
 v_mfma_f32_16x16x32_bf16 v[48:51], a[224:227], a[128:131], v[208:211]
 v_exp_f32 v244, v132
 v_mfma_f32_16x16x32_bf16 v[48:51], a[228:231], a[132:135], v[48:51]
 v_exp_f32 v245, v133
 v_mfma_f32_16x16x32_bf16 v[48:51], a[232:235], a[136:139], v[48:51]
 v_exp_f32 v246, v134
 v_mfma_f32_16x16x32_bf16 v[48:51], a[236:239], a[140:143], v[48:51]
 s_waitcnt vmcnt(0) lgkmcnt(0)
 s_barrier
 v_cvt_pk_bf16_f32 v200, v240, v241
 v_mfma_f32_16x16x32_bf16 v[56:59], a[236:239], a[156:159], v[212:215]
 ds_read_b128 a[192:195], v2 offset:32768
 v_cvt_pk_bf16_f32 v201, v242, v243
 v_mfma_f32_16x16x32_bf16 v[56:59], a[232:235], a[152:155], v[56:59]
 v_exp_f32 v247, v135
 v_mfma_f32_16x16x32_bf16 v[56:59], a[228:231], a[148:151], v[56:59]
 v_cvt_pk_bf16_f32 v202, v244, v245
 v_cvt_pk_bf16_f32 v203, v246, v247
 v_mfma_f32_16x16x32_bf16 v[56:59], a[224:227], a[144:147], v[56:59]
 ds_read_b128 a[196:199], v2 offset:40960
 v_mfma_f32_16x16x32_bf16 v[64:67], a[224:227], a[160:163], v[216:219]
 v_exp_f32 v240, v136
 v_mfma_f32_16x16x32_bf16 v[64:67], a[228:231], a[164:167], v[64:67]
 v_exp_f32 v241, v137
 v_mfma_f32_16x16x32_bf16 v[64:67], a[232:235], a[168:171], v[64:67]
 v_exp_f32 v242, v138
 v_mfma_f32_16x16x32_bf16 v[64:67], a[236:239], a[172:175], v[64:67]
 ds_read_b128 a[200:203], v2 offset:33792
 v_cvt_pk_bf16_f32 v204, v240, v241
 v_mfma_f32_16x16x32_bf16 v[232:235], v[252:255], v[200:203], v[232:235]
 v_exp_f32 v243, v139
 v_mfma_f32_16x16x32_bf16 v[72:75], a[236:239], a[188:191], v[220:223]
 v_exp_f32 v244, v140
 v_mfma_f32_16x16x32_bf16 v[72:75], a[232:235], a[184:187], v[72:75]
 ds_read_b128 a[204:207], v2 offset:41984
 v_cvt_pk_bf16_f32 v205, v242, v243
 v_mfma_f32_16x16x32_bf16 v[72:75], a[228:231], a[180:183], v[72:75]
 v_exp_f32 v245, v141
 v_mfma_f32_16x16x32_bf16 v[72:75], a[224:227], a[176:179], v[72:75]
 v_cvt_pk_bf16_f32 v206, v244, v245
 v_mfma_f32_16x16x32_bf16 v[52:55], a[240:243], a[128:131], v[208:211]
 v_exp_f32 v246, v142
 v_mfma_f32_16x16x32_bf16 v[52:55], a[244:247], a[132:135], v[52:55]
 ds_read_b128 a[208:211], v2 offset:34816
 v_mfma_f32_16x16x32_bf16 v[52:55], a[248:251], a[136:139], v[52:55]
 v_exp_f32 v247, v143
 v_mfma_f32_16x16x32_bf16 v[52:55], a[252:255], a[140:143], v[52:55]
 v_cvt_pk_bf16_f32 v207, v246, v247
 v_mfma_f32_16x16x32_bf16 v[60:63], a[252:255], a[156:159], v[212:215]
 v_mfma_f32_16x16x32_bf16 v[60:63], a[248:251], a[152:155], v[60:63]
 ds_read_b128 a[212:215], v2 offset:43008
 v_mfma_f32_16x16x32_bf16 v[60:63], a[244:247], a[148:151], v[60:63]
 v_mfma_f32_16x16x32_bf16 v[60:63], a[240:243], a[144:147], v[60:63]
 v_mfma_f32_16x16x32_bf16 v[236:239], v[252:255], v[204:207], v[236:239]
 ds_read_b128 a[216:219], v2 offset:35840
 v_mfma_f32_16x16x32_bf16 v[68:71], a[240:243], a[160:163], v[216:219]
 s_sub_u32 s32, s32, 1
 v_mfma_f32_16x16x32_bf16 v[68:71], a[244:247], a[164:167], v[68:71]
 v_mfma_f32_16x16x32_bf16 v[68:71], a[248:251], a[168:171], v[68:71]
 s_nop 0
 v_mfma_f32_16x16x32_bf16 v[68:71], a[252:255], a[172:175], v[68:71]
 ds_read_b128 a[220:223], v2 offset:44032
 v_max3_f32 v10, v224, v228, v232
 v_mfma_f32_16x16x32_bf16 v[76:79], a[252:255], a[188:191], v[220:223]
 v_max_f32 v10, v10, v236
 v_mfma_f32_16x16x32_bf16 v[76:79], a[248:251], a[184:187], v[76:79]
 v_cmp_lt_f32 vcc, s54, v10
 v_mfma_f32_16x16x32_bf16 v[76:79], a[244:247], a[180:183], v[76:79]
 v_mfma_f32_16x16x32_bf16 v[76:79], a[240:243], a[176:179], v[76:79]
 s_cbranch_vccnz L_jr_40
L_back_39:
 s_cmp_eq_u32 s32, 0
 s_cbranch_scc1 L_T0_29
 s_waitcnt lgkmcnt(4)
 v_mfma_f32_16x16x32_bf16 a[0:3], a[192:195], v[176:179], a[0:3]
 ds_read_b128 a[224:227], v2 offset:36864
 v_add_f32 v4, v4, v224
 v_mfma_f32_16x16x32_bf16 a[0:3], a[196:199], v[192:195], a[0:3]
 s_add_u32 m0, s50, 65536
 v_exp_f32 v240, v16
 v_mfma_f32_16x16x32_bf16 a[32:35], a[196:199], v[196:199], a[32:35]
 s_add_u32 s34, s49, s50
 v_add_f32 v5, v5, v228
 v_mfma_f32_16x16x32_bf16 a[32:35], a[192:195], v[180:183], a[32:35]
 buffer_load_dwordx4 v1, s[16:19], s34 offen offset:0 sc1 lds
 v_mfma_f32_16x16x32_bf16 a[64:67], a[192:195], v[184:187], a[64:67]
 ds_read_b128 a[228:231], v2 offset:45056
 v_mfma_f32_16x16x32_bf16 a[64:67], a[196:199], v[200:203], a[64:67]
 v_add_f32 v6, v6, v232
 v_mfma_f32_16x16x32_bf16 a[96:99], a[196:199], v[204:207], a[96:99]
 v_add_f32 v7, v7, v236
 v_mfma_f32_16x16x32_bf16 a[96:99], a[192:195], v[188:191], a[96:99]
 v_exp_f32 v241, v17
 v_mfma_f32_16x16x32_bf16 a[4:7], a[200:203], v[176:179], a[4:7]
 ds_read_b128 a[232:235], v2 offset:37888
 v_cvt_pk_bf16_f32 v144, v240, v241
 v_mfma_f32_16x16x32_bf16 a[4:7], a[204:207], v[192:195], a[4:7]
 buffer_load_dwordx4 v1, s[16:19], s34 offen offset:1024 sc1 lds
 v_mfma_f32_16x16x32_bf16 a[36:39], a[204:207], v[196:199], a[36:39]
 v_exp_f32 v242, v18
 v_mfma_f32_16x16x32_bf16 a[36:39], a[200:203], v[180:183], a[36:39]
 v_exp_f32 v243, v19
 v_mfma_f32_16x16x32_bf16 a[68:71], a[200:203], v[184:187], a[68:71]
 ds_read_b128 a[236:239], v2 offset:46080
 v_cvt_pk_bf16_f32 v145, v242, v243
 v_mfma_f32_16x16x32_bf16 a[68:71], a[204:207], v[200:203], a[68:71]
 v_exp_f32 v244, v20
 v_mfma_f32_16x16x32_bf16 a[100:103], a[204:207], v[204:207], a[100:103]
 buffer_load_dwordx4 v1, s[16:19], s34 offen offset:2048 sc1 lds
 v_mfma_f32_16x16x32_bf16 a[100:103], a[200:203], v[188:191], a[100:103]
 s_waitcnt lgkmcnt(4)
 v_exp_f32 v245, v21
 v_mfma_f32_16x16x32_bf16 a[8:11], a[208:211], v[176:179], a[8:11]
 ds_read_b128 a[240:243], v2 offset:38912
 v_cvt_pk_bf16_f32 v146, v244, v245
 v_mfma_f32_16x16x32_bf16 a[8:11], a[212:215], v[192:195], a[8:11]
 v_exp_f32 v246, v22
 v_mfma_f32_16x16x32_bf16 a[40:43], a[212:215], v[196:199], a[40:43]
 v_exp_f32 v247, v23
 v_mfma_f32_16x16x32_bf16 a[40:43], a[208:211], v[180:183], a[40:43]
 buffer_load_dwordx4 v1, s[16:19], s34 offen offset:3072 sc1 lds
 v_mfma_f32_16x16x32_bf16 a[72:75], a[208:211], v[184:187], a[72:75]
 ds_read_b128 a[244:247], v2 offset:47104
 v_cvt_pk_bf16_f32 v147, v246, v247
 v_mfma_f32_16x16x32_bf16 a[72:75], a[212:215], v[200:203], a[72:75]
 v_exp_f32 v240, v24
 v_mfma_f32_16x16x32_bf16 a[104:107], a[212:215], v[204:207], a[104:107]
 v_exp_f32 v241, v25
 v_mfma_f32_16x16x32_bf16 a[104:107], a[208:211], v[188:191], a[104:107]
 v_exp_f32 v242, v26
 v_mfma_f32_16x16x32_bf16 v[224:227], v[252:255], v[144:147], 0
 ds_read_b128 a[248:251], v2 offset:39936
 s_add_u32 s49, s49, 16384
 v_mfma_f32_16x16x32_bf16 a[12:15], a[216:219], v[176:179], a[12:15]
 v_exp_f32 v243, v27
 v_mfma_f32_16x16x32_bf16 a[12:15], a[220:223], v[192:195], a[12:15]
 s_add_u32 m0, s50, 0
 v_exp_f32 v244, v28
 v_mfma_f32_16x16x32_bf16 a[44:47], a[220:223], v[196:199], a[44:47]
 s_add_u32 s34, s48, s50
 v_exp_f32 v245, v29
 v_mfma_f32_16x16x32_bf16 a[44:47], a[216:219], v[180:183], a[44:47]
 ds_read_b128 a[252:255], v2 offset:48128
 v_cvt_pk_bf16_f32 v148, v240, v241
 v_mfma_f32_16x16x32_bf16 a[76:79], a[216:219], v[184:187], a[76:79]
 buffer_load_dwordx4 v1, s[16:19], s34 offen offset:0 sc1 lds
 v_mfma_f32_16x16x32_bf16 a[76:79], a[220:223], v[200:203], a[76:79]
 v_exp_f32 v246, v30
 v_mfma_f32_16x16x32_bf16 a[108:111], a[220:223], v[204:207], a[108:111]
 v_exp_f32 v247, v31
 v_mfma_f32_16x16x32_bf16 a[108:111], a[216:219], v[188:191], a[108:111]
 s_waitcnt lgkmcnt(4)
 v_cvt_pk_bf16_f32 v149, v242, v243
 v_cvt_pk_bf16_f32 v150, v244, v245
 v_mfma_f32_16x16x32_bf16 a[16:19], a[224:227], v[176:179], a[16:19]
 ds_read_b128 a[192:195], v1 offset:32768
 v_cvt_pk_bf16_f32 v151, v246, v247
 v_mfma_f32_16x16x32_bf16 a[16:19], a[228:231], v[192:195], a[16:19]
 buffer_load_dwordx4 v1, s[16:19], s34 offen offset:1024 sc1 lds
 v_mfma_f32_16x16x32_bf16 a[48:51], a[228:231], v[196:199], a[48:51]
 v_mfma_f32_16x16x32_bf16 a[48:51], a[224:227], v[180:183], a[48:51]
 v_mfma_f32_16x16x32_bf16 a[80:83], a[224:227], v[184:187], a[80:83]
 ds_read_b128 a[196:199], v1 offset:34816
 v_mfma_f32_16x16x32_bf16 a[80:83], a[228:231], v[200:203], a[80:83]
 v_exp_f32 v240, v32
 v_mfma_f32_16x16x32_bf16 a[112:115], a[228:231], v[204:207], a[112:115]
 buffer_load_dwordx4 v1, s[16:19], s34 offen offset:2048 sc1 lds
 v_mfma_f32_16x16x32_bf16 a[112:115], a[224:227], v[188:191], a[112:115]
 v_exp_f32 v241, v33
 v_mfma_f32_16x16x32_bf16 a[20:23], a[232:235], v[176:179], a[20:23]
 ds_read_b128 a[200:203], v1 offset:36864
 v_cvt_pk_bf16_f32 v152, v240, v241
 v_mfma_f32_16x16x32_bf16 a[20:23], a[236:239], v[192:195], a[20:23]
 v_exp_f32 v242, v34
 v_mfma_f32_16x16x32_bf16 v[228:231], v[252:255], v[148:151], 0
 v_exp_f32 v243, v35
 v_mfma_f32_16x16x32_bf16 a[52:55], a[236:239], v[196:199], a[52:55]
 buffer_load_dwordx4 v1, s[16:19], s34 offen offset:3072 sc1 lds
 v_mfma_f32_16x16x32_bf16 a[52:55], a[232:235], v[180:183], a[52:55]
 ds_read_b128 a[204:207], v1 offset:38912
 v_cvt_pk_bf16_f32 v153, v242, v243
 v_mfma_f32_16x16x32_bf16 a[84:87], a[232:235], v[184:187], a[84:87]
 v_exp_f32 v244, v36
 v_mfma_f32_16x16x32_bf16 a[84:87], a[236:239], v[200:203], a[84:87]
 v_exp_f32 v245, v37
 v_mfma_f32_16x16x32_bf16 a[116:119], a[236:239], v[204:207], a[116:119]
 v_exp_f32 v246, v38
 v_mfma_f32_16x16x32_bf16 a[116:119], a[232:235], v[188:191], a[116:119]
 s_waitcnt lgkmcnt(4)
 s_add_u32 s48, s48, 16384
 v_cvt_pk_bf16_f32 v154, v244, v245
 v_mfma_f32_16x16x32_bf16 a[24:27], a[240:243], v[176:179], a[24:27]
 ds_read_b128 a[208:211], v1 offset:33792
 v_mfma_f32_16x16x32_bf16 a[24:27], a[244:247], v[192:195], a[24:27]
 v_exp_f32 v247, v39
 v_mfma_f32_16x16x32_bf16 a[56:59], a[244:247], v[196:199], a[56:59]
 v_cvt_pk_bf16_f32 v155, v246, v247
 v_mfma_f32_16x16x32_bf16 a[56:59], a[240:243], v[180:183], a[56:59]
 v_mfma_f32_16x16x32_bf16 a[88:91], a[240:243], v[184:187], a[88:91]
 ds_read_b128 a[212:215], v1 offset:35840
 v_mfma_f32_16x16x32_bf16 a[88:91], a[244:247], v[200:203], a[88:91]
 v_mfma_f32_16x16x32_bf16 a[120:123], a[244:247], v[204:207], a[120:123]
 v_mfma_f32_16x16x32_bf16 a[120:123], a[240:243], v[188:191], a[120:123]
 v_exp_f32 v240, v40
 v_mfma_f32_16x16x32_bf16 a[28:31], a[248:251], v[176:179], a[28:31]
 ds_read_b128 a[216:219], v1 offset:37888
 v_mfma_f32_16x16x32_bf16 a[28:31], a[252:255], v[192:195], a[28:31]
 v_exp_f32 v241, v41
 v_mfma_f32_16x16x32_bf16 a[60:63], a[252:255], v[196:199], a[60:63]
 v_exp_f32 v242, v42
 v_mfma_f32_16x16x32_bf16 a[60:63], a[248:251], v[180:183], a[60:63]
 v_exp_f32 v243, v43
 v_mfma_f32_16x16x32_bf16 v[232:235], v[252:255], v[152:155], 0
 ds_read_b128 a[220:223], v1 offset:39936
 v_cvt_pk_bf16_f32 v156, v240, v241
 v_mfma_f32_16x16x32_bf16 a[92:95], a[248:251], v[184:187], a[92:95]
 v_exp_f32 v244, v44
 v_mfma_f32_16x16x32_bf16 a[92:95], a[252:255], v[200:203], a[92:95]
 v_exp_f32 v245, v45
 v_mfma_f32_16x16x32_bf16 a[124:127], a[252:255], v[204:207], a[124:127]
 v_exp_f32 v246, v46
 v_mfma_f32_16x16x32_bf16 a[124:127], a[248:251], v[188:191], a[124:127]
 s_waitcnt lgkmcnt(4)
 v_exp_f32 v247, v47
 v_mfma_f32_16x16x32_bf16 v[80:83], a[192:195], a[128:131], v[208:211]
 ds_read_b128 a[224:227], v1 offset:40960
 v_cvt_pk_bf16_f32 v157, v242, v243
 v_mfma_f32_16x16x32_bf16 v[80:83], a[196:199], a[132:135], v[80:83]
 v_cvt_pk_bf16_f32 v158, v244, v245
 v_cvt_pk_bf16_f32 v159, v246, v247
 v_mfma_f32_16x16x32_bf16 v[80:83], a[200:203], a[136:139], v[80:83]
 v_mfma_f32_16x16x32_bf16 v[80:83], a[204:207], a[140:143], v[80:83]
 v_exp_f32 v240, v48
 v_mfma_f32_16x16x32_bf16 v[88:91], a[204:207], a[156:159], v[212:215]
 ds_read_b128 a[228:231], v1 offset:43008
 v_mfma_f32_16x16x32_bf16 v[88:91], a[200:203], a[152:155], v[88:91]
 v_exp_f32 v241, v49
 v_mfma_f32_16x16x32_bf16 v[88:91], a[196:199], a[148:151], v[88:91]
 v_exp_f32 v242, v50
 v_mfma_f32_16x16x32_bf16 v[88:91], a[192:195], a[144:147], v[88:91]
 v_exp_f32 v243, v51
 v_mfma_f32_16x16x32_bf16 v[236:239], v[252:255], v[156:159], 0
 ds_read_b128 a[232:235], v1 offset:45056
 v_cvt_pk_bf16_f32 v160, v240, v241
 v_mfma_f32_16x16x32_bf16 v[96:99], a[192:195], a[160:163], v[216:219]
 v_exp_f32 v244, v52
 v_mfma_f32_16x16x32_bf16 v[96:99], a[196:199], a[164:167], v[96:99]
 v_exp_f32 v245, v53
 v_mfma_f32_16x16x32_bf16 v[96:99], a[200:203], a[168:171], v[96:99]
 v_exp_f32 v246, v54
 v_mfma_f32_16x16x32_bf16 v[96:99], a[204:207], a[172:175], v[96:99]
 ds_read_b128 a[236:239], v1 offset:47104
 v_cvt_pk_bf16_f32 v161, v242, v243
 v_mfma_f32_16x16x32_bf16 v[104:107], a[204:207], a[188:191], v[220:223]
 v_exp_f32 v247, v55
 v_mfma_f32_16x16x32_bf16 v[104:107], a[200:203], a[184:187], v[104:107]
 v_cvt_pk_bf16_f32 v162, v244, v245
 v_cvt_pk_bf16_f32 v163, v246, v247
 v_mfma_f32_16x16x32_bf16 v[104:107], a[196:199], a[180:183], v[104:107]
 v_mfma_f32_16x16x32_bf16 v[104:107], a[192:195], a[176:179], v[104:107]
 s_waitcnt lgkmcnt(4)
 v_exp_f32 v240, v56
 v_mfma_f32_16x16x32_bf16 v[84:87], a[208:211], a[128:131], v[208:211]
 ds_read_b128 a[240:243], v1 offset:41984
 v_mfma_f32_16x16x32_bf16 v[84:87], a[212:215], a[132:135], v[84:87]
 v_exp_f32 v241, v57
 v_mfma_f32_16x16x32_bf16 v[84:87], a[216:219], a[136:139], v[84:87]
 v_exp_f32 v242, v58
 v_mfma_f32_16x16x32_bf16 v[84:87], a[220:223], a[140:143], v[84:87]
 v_exp_f32 v243, v59
 v_mfma_f32_16x16x32_bf16 v[224:227], v[252:255], v[160:163], v[224:227]
 ds_read_b128 a[244:247], v1 offset:44032
 v_cvt_pk_bf16_f32 v164, v240, v241
 v_mfma_f32_16x16x32_bf16 v[92:95], a[220:223], a[156:159], v[212:215]
 v_exp_f32 v244, v60
 v_mfma_f32_16x16x32_bf16 v[92:95], a[216:219], a[152:155], v[92:95]
 v_exp_f32 v245, v61
 v_mfma_f32_16x16x32_bf16 v[92:95], a[212:215], a[148:151], v[92:95]
 v_exp_f32 v246, v62
 v_mfma_f32_16x16x32_bf16 v[92:95], a[208:211], a[144:147], v[92:95]
 v_exp_f32 v247, v63
 v_mfma_f32_16x16x32_bf16 v[100:103], a[208:211], a[160:163], v[216:219]
 ds_read_b128 a[248:251], v1 offset:46080
 v_cvt_pk_bf16_f32 v165, v242, v243
 v_mfma_f32_16x16x32_bf16 v[100:103], a[212:215], a[164:167], v[100:103]
 v_cvt_pk_bf16_f32 v166, v244, v245
 v_cvt_pk_bf16_f32 v167, v246, v247
 v_mfma_f32_16x16x32_bf16 v[100:103], a[216:219], a[168:171], v[100:103]
 v_mfma_f32_16x16x32_bf16 v[100:103], a[220:223], a[172:175], v[100:103]
 v_exp_f32 v240, v64
 v_mfma_f32_16x16x32_bf16 v[108:111], a[220:223], a[188:191], v[220:223]
 ds_read_b128 a[252:255], v1 offset:48128
 v_mfma_f32_16x16x32_bf16 v[108:111], a[216:219], a[184:187], v[108:111]
 v_exp_f32 v241, v65
 v_mfma_f32_16x16x32_bf16 v[108:111], a[212:215], a[180:183], v[108:111]
 v_exp_f32 v242, v66
 v_mfma_f32_16x16x32_bf16 v[108:111], a[208:211], a[176:179], v[108:111]
 v_exp_f32 v243, v67
 v_mfma_f32_16x16x32_bf16 v[228:231], v[252:255], v[164:167], v[228:231]
 s_waitcnt lgkmcnt(4)
 v_exp_f32 v244, v68
 v_mfma_f32_16x16x32_bf16 v[112:115], a[224:227], a[128:131], v[208:211]
 v_exp_f32 v245, v69
 v_mfma_f32_16x16x32_bf16 v[112:115], a[228:231], a[132:135], v[112:115]
 v_exp_f32 v246, v70
 v_mfma_f32_16x16x32_bf16 v[112:115], a[232:235], a[136:139], v[112:115]
 v_exp_f32 v247, v71
 v_mfma_f32_16x16x32_bf16 v[112:115], a[236:239], a[140:143], v[112:115]
 s_waitcnt vmcnt(0) lgkmcnt(0)
 s_barrier
 v_cvt_pk_bf16_f32 v168, v240, v241
 v_mfma_f32_16x16x32_bf16 v[120:123], a[236:239], a[156:159], v[212:215]
 ds_read_b128 a[192:195], v2 offset:0
 v_cvt_pk_bf16_f32 v169, v242, v243
 v_mfma_f32_16x16x32_bf16 v[120:123], a[232:235], a[152:155], v[120:123]
 v_cvt_pk_bf16_f32 v170, v244, v245
 v_cvt_pk_bf16_f32 v171, v246, v247
 v_mfma_f32_16x16x32_bf16 v[120:123], a[228:231], a[148:151], v[120:123]
 v_mfma_f32_16x16x32_bf16 v[120:123], a[224:227], a[144:147], v[120:123]
 ds_read_b128 a[196:199], v2 offset:8192
 v_mfma_f32_16x16x32_bf16 v[128:131], a[224:227], a[160:163], v[216:219]
 v_exp_f32 v240, v72
 v_mfma_f32_16x16x32_bf16 v[128:131], a[228:231], a[164:167], v[128:131]
 v_exp_f32 v241, v73
 v_mfma_f32_16x16x32_bf16 v[128:131], a[232:235], a[168:171], v[128:131]
 v_exp_f32 v242, v74
 v_mfma_f32_16x16x32_bf16 v[128:131], a[236:239], a[172:175], v[128:131]
 ds_read_b128 a[200:203], v2 offset:1024
 v_cvt_pk_bf16_f32 v172, v240, v241
 v_mfma_f32_16x16x32_bf16 v[232:235], v[252:255], v[168:171], v[232:235]
 v_exp_f32 v243, v75
 v_mfma_f32_16x16x32_bf16 v[136:139], a[236:239], a[188:191], v[220:223]
 v_exp_f32 v244, v76
 v_mfma_f32_16x16x32_bf16 v[136:139], a[232:235], a[184:187], v[136:139]
 ds_read_b128 a[204:207], v2 offset:9216
 v_cvt_pk_bf16_f32 v173, v242, v243
 v_mfma_f32_16x16x32_bf16 v[136:139], a[228:231], a[180:183], v[136:139]
 v_exp_f32 v245, v77
 v_mfma_f32_16x16x32_bf16 v[136:139], a[224:227], a[176:179], v[136:139]
 v_exp_f32 v246, v78
 v_mfma_f32_16x16x32_bf16 v[116:119], a[240:243], a[128:131], v[208:211]
 v_exp_f32 v247, v79
 v_mfma_f32_16x16x32_bf16 v[116:119], a[244:247], a[132:135], v[116:119]
 ds_read_b128 a[208:211], v2 offset:2048
 v_cvt_pk_bf16_f32 v174, v244, v245
 v_mfma_f32_16x16x32_bf16 v[116:119], a[248:251], a[136:139], v[116:119]
 v_cvt_pk_bf16_f32 v175, v246, v247
 v_mfma_f32_16x16x32_bf16 v[116:119], a[252:255], a[140:143], v[116:119]
 v_mfma_f32_16x16x32_bf16 v[124:127], a[252:255], a[156:159], v[212:215]
 v_mfma_f32_16x16x32_bf16 v[124:127], a[248:251], a[152:155], v[124:127]
 ds_read_b128 a[212:215], v2 offset:10240
 v_mfma_f32_16x16x32_bf16 v[124:127], a[244:247], a[148:151], v[124:127]
 v_mfma_f32_16x16x32_bf16 v[124:127], a[240:243], a[144:147], v[124:127]
 v_mfma_f32_16x16x32_bf16 v[236:239], v[252:255], v[172:175], v[236:239]
 ds_read_b128 a[216:219], v2 offset:3072
 v_mfma_f32_16x16x32_bf16 v[132:135], a[240:243], a[160:163], v[216:219]
 v_mfma_f32_16x16x32_bf16 v[132:135], a[244:247], a[164:167], v[132:135]
 v_mfma_f32_16x16x32_bf16 v[132:135], a[248:251], a[168:171], v[132:135]
 s_nop 1
 v_mfma_f32_16x16x32_bf16 v[132:135], a[252:255], a[172:175], v[132:135]
 ds_read_b128 a[220:223], v2 offset:11264
 v_max3_f32 v10, v224, v228, v232
 v_mfma_f32_16x16x32_bf16 v[140:143], a[252:255], a[188:191], v[220:223]
 v_max_f32 v10, v10, v236
 v_mfma_f32_16x16x32_bf16 v[140:143], a[248:251], a[184:187], v[140:143]
 v_cmp_lt_f32 vcc, s54, v10
 v_mfma_f32_16x16x32_bf16 v[140:143], a[244:247], a[180:183], v[140:143]
 v_mfma_f32_16x16x32_bf16 v[140:143], a[240:243], a[176:179], v[140:143]
 s_cbranch_vccnz L_jr_42
L_back_41:
 s_branch L_L1_32
L_T0_29:
 s_waitcnt lgkmcnt(4)
 v_mfma_f32_16x16x32_bf16 a[0:3], a[192:195], v[176:179], a[0:3]
 ds_read_b128 a[224:227], v2 offset:36864
 v_add_f32 v4, v4, v224
 v_mfma_f32_16x16x32_bf16 a[0:3], a[196:199], v[192:195], a[0:3]
 s_add_u32 m0, s50, 65536
 s_add_u32 s34, s49, s50
 v_exp_f32 v240, v16
 v_mfma_f32_16x16x32_bf16 a[32:35], a[196:199], v[196:199], a[32:35]
 buffer_load_dwordx4 v1, s[16:19], s34 offen offset:0 sc1 lds
 v_exp_f32 v241, v17
 v_mfma_f32_16x16x32_bf16 a[32:35], a[192:195], v[180:183], a[32:35]
 v_add_f32 v5, v5, v228
 v_exp_f32 v242, v18
 v_mfma_f32_16x16x32_bf16 a[64:67], a[192:195], v[184:187], a[64:67]
 ds_read_b128 a[228:231], v2 offset:45056
 v_add_f32 v6, v6, v232
 v_cvt_pk_bf16_f32 v144, v240, v241
 v_mfma_f32_16x16x32_bf16 a[64:67], a[196:199], v[200:203], a[64:67]
 buffer_load_dwordx4 v1, s[16:19], s34 offen offset:1024 sc1 lds
 v_mfma_f32_16x16x32_bf16 a[96:99], a[196:199], v[204:207], a[96:99]
 buffer_load_dwordx4 v1, s[16:19], s34 offen offset:2048 sc1 lds
 v_mfma_f32_16x16x32_bf16 a[96:99], a[192:195], v[188:191], a[96:99]
 v_add_f32 v7, v7, v236
 v_exp_f32 v243, v19
 v_mfma_f32_16x16x32_bf16 a[4:7], a[200:203], v[176:179], a[4:7]
 ds_read_b128 a[232:235], v2 offset:37888
 v_exp_f32 v244, v20
 v_mfma_f32_16x16x32_bf16 a[4:7], a[204:207], v[192:195], a[4:7]
 buffer_load_dwordx4 v1, s[16:19], s34 offen offset:3072 sc1 lds
 v_cvt_pk_bf16_f32 v145, v242, v243
 v_mfma_f32_16x16x32_bf16 a[36:39], a[204:207], v[196:199], a[36:39]
 s_add_u32 s49, s49, 16384
 v_exp_f32 v245, v21
 v_mfma_f32_16x16x32_bf16 a[36:39], a[200:203], v[180:183], a[36:39]
 s_add_u32 m0, s51, 0
 v_exp_f32 v246, v22
 v_exp_f32 v247, v23
 v_mfma_f32_16x16x32_bf16 a[68:71], a[200:203], v[184:187], a[68:71]
 ds_read_b128 a[236:239], v2 offset:46080
 s_add_u32 s34, s48, s51
 v_cvt_pk_bf16_f32 v146, v244, v245
 v_mfma_f32_16x16x32_bf16 a[68:71], a[204:207], v[200:203], a[68:71]
 buffer_load_dwordx4 v1, s[16:19], s34 offen offset:0 sc1 lds
 v_cvt_pk_bf16_f32 v147, v246, v247
 v_mfma_f32_16x16x32_bf16 a[100:103], a[204:207], v[204:207], a[100:103]
 v_exp_f32 v240, v24
 v_mfma_f32_16x16x32_bf16 a[100:103], a[200:203], v[188:191], a[100:103]
 s_waitcnt lgkmcnt(4)
 v_exp_f32 v241, v25
 v_mfma_f32_16x16x32_bf16 a[8:11], a[208:211], v[176:179], a[8:11]
 ds_read_b128 a[240:243], v2 offset:38912
 v_exp_f32 v242, v26
 v_mfma_f32_16x16x32_bf16 a[8:11], a[212:215], v[192:195], a[8:11]
 buffer_load_dwordx4 v1, s[16:19], s34 offen offset:1024 sc1 lds
 v_cvt_pk_bf16_f32 v148, v240, v241
 v_mfma_f32_16x16x32_bf16 a[40:43], a[212:215], v[196:199], a[40:43]
 buffer_load_dwordx4 v1, s[16:19], s34 offen offset:2048 sc1 lds
 v_mfma_f32_16x16x32_bf16 a[40:43], a[208:211], v[180:183], a[40:43]
 buffer_load_dwordx4 v1, s[16:19], s34 offen offset:3072 sc1 lds
 v_mfma_f32_16x16x32_bf16 v[224:227], v[252:255], v[144:147], 0
 ds_read_b128 a[244:247], v2 offset:47104
 v_exp_f32 v243, v27
 v_mfma_f32_16x16x32_bf16 a[72:75], a[208:211], v[184:187], a[72:75]
 v_exp_f32 v244, v28
 v_cvt_pk_bf16_f32 v149, v242, v243
 v_mfma_f32_16x16x32_bf16 a[72:75], a[212:215], v[200:203], a[72:75]
 s_add_u32 m0, s51, 4096
 s_add_u32 s34, s34, 4096
 v_exp_f32 v245, v29
 v_mfma_f32_16x16x32_bf16 a[104:107], a[212:215], v[204:207], a[104:107]
 buffer_load_dwordx4 v1, s[16:19], s34 offen offset:0 sc1 lds
 v_cvt_pk_bf16_f32 v150, v244, v245
 v_mfma_f32_16x16x32_bf16 a[104:107], a[208:211], v[188:191], a[104:107]
 v_exp_f32 v246, v30
 v_mfma_f32_16x16x32_bf16 a[12:15], a[216:219], v[176:179], a[12:15]
 ds_read_b128 a[248:251], v2 offset:39936
 v_exp_f32 v247, v31
 v_mfma_f32_16x16x32_bf16 a[12:15], a[220:223], v[192:195], a[12:15]
 buffer_load_dwordx4 v1, s[16:19], s34 offen offset:1024 sc1 lds
 v_cvt_pk_bf16_f32 v151, v246, v247
 v_mfma_f32_16x16x32_bf16 a[44:47], a[220:223], v[196:199], a[44:47]
 buffer_load_dwordx4 v1, s[16:19], s34 offen offset:2048 sc1 lds
 v_mfma_f32_16x16x32_bf16 a[44:47], a[216:219], v[180:183], a[44:47]
 v_exp_f32 v240, v32
 v_mfma_f32_16x16x32_bf16 a[76:79], a[216:219], v[184:187], a[76:79]
 ds_read_b128 a[252:255], v2 offset:48128
 v_exp_f32 v241, v33
 v_mfma_f32_16x16x32_bf16 a[76:79], a[220:223], v[200:203], a[76:79]
 buffer_load_dwordx4 v1, s[16:19], s34 offen offset:3072 sc1 lds
 v_mfma_f32_16x16x32_bf16 a[108:111], a[220:223], v[204:207], a[108:111]
 s_add_u32 s48, s48, 32768
 v_exp_f32 v242, v34
 v_mfma_f32_16x16x32_bf16 a[108:111], a[216:219], v[188:191], a[108:111]
 buffer_load_dword v251, v250, s[16:19], s55 offen sc1
 v_mfma_f32_16x16x32_bf16 v[228:231], v[252:255], v[148:151], 0
 s_waitcnt lgkmcnt(4)
 v_exp_f32 v243, v35
 v_mfma_f32_16x16x32_bf16 a[16:19], a[224:227], v[176:179], a[16:19]
 ds_read_b128 a[192:195], v1 offset:32768
 v_exp_f32 v244, v36
 v_mfma_f32_16x16x32_bf16 a[16:19], a[228:231], v[192:195], a[16:19]
 s_sub_u32 s23, s21, 3
 s_cmp_lt_u32 s23, 4
 s_cselect_b32 s23, -1, 0
 v_mfma_f32_16x16x32_bf16 a[48:51], a[228:231], v[196:199], a[48:51]
 v_add_lshl_u32 v248, v0, s68, 7
 v_exp_f32 v245, v37
 v_mfma_f32_16x16x32_bf16 a[48:51], a[224:227], v[180:183], a[48:51]
 v_and_b32 v248, s23, v248
 v_exp_f32 v246, v38
 v_mfma_f32_16x16x32_bf16 a[80:83], a[224:227], v[184:187], a[80:83]
 ds_read_b128 a[196:199], v1 offset:34816
 v_exp_f32 v247, v39
 v_mfma_f32_16x16x32_bf16 a[80:83], a[228:231], v[200:203], a[80:83]
 global_load_dword v8, v248, s[52:53]
 v_mfma_f32_16x16x32_bf16 a[112:115], a[228:231], v[204:207], a[112:115]
 v_and_b32 v12, 7, v0
 v_cvt_pk_bf16_f32 v152, v240, v241
 v_mfma_f32_16x16x32_bf16 a[112:115], a[224:227], v[188:191], a[112:115]
 v_add_lshl_u32 v12, v12, s69, 7
 v_and_b32 v12, s23, v12
 v_mfma_f32_16x16x32_bf16 a[20:23], a[232:235], v[176:179], a[20:23]
 ds_read_b128 a[200:203], v1 offset:36864
 v_cvt_pk_bf16_f32 v153, v242, v243
 v_cvt_pk_bf16_f32 v154, v244, v245
 v_mfma_f32_16x16x32_bf16 a[20:23], a[236:239], v[192:195], a[20:23]
 global_load_dword v8, v12, s[58:59]
 v_cvt_pk_bf16_f32 v155, v246, v247
 v_mfma_f32_16x16x32_bf16 a[52:55], a[236:239], v[196:199], a[52:55]
 v_exp_f32 v240, v40
 v_mfma_f32_16x16x32_bf16 a[52:55], a[232:235], v[180:183], a[52:55]
 v_exp_f32 v241, v41
 v_mfma_f32_16x16x32_bf16 v[232:235], v[252:255], v[152:155], 0
 ds_read_b128 a[204:207], v1 offset:38912
 v_cvt_pk_bf16_f32 v156, v240, v241
 v_mfma_f32_16x16x32_bf16 a[84:87], a[232:235], v[184:187], a[84:87]
 v_exp_f32 v242, v42
 v_mfma_f32_16x16x32_bf16 a[84:87], a[236:239], v[200:203], a[84:87]
 v_exp_f32 v243, v43
 v_mfma_f32_16x16x32_bf16 a[116:119], a[236:239], v[204:207], a[116:119]
 v_exp_f32 v244, v44
 v_mfma_f32_16x16x32_bf16 a[116:119], a[232:235], v[188:191], a[116:119]
 s_waitcnt lgkmcnt(4)
 v_exp_f32 v245, v45
 v_mfma_f32_16x16x32_bf16 a[24:27], a[240:243], v[176:179], a[24:27]
 ds_read_b128 a[208:211], v1 offset:33792
 v_cvt_pk_bf16_f32 v157, v242, v243
 v_mfma_f32_16x16x32_bf16 a[24:27], a[244:247], v[192:195], a[24:27]
 v_exp_f32 v246, v46
 v_mfma_f32_16x16x32_bf16 a[56:59], a[244:247], v[196:199], a[56:59]
 v_cvt_pk_bf16_f32 v158, v244, v245
 v_mfma_f32_16x16x32_bf16 a[56:59], a[240:243], v[180:183], a[56:59]
 v_exp_f32 v247, v47
 v_mfma_f32_16x16x32_bf16 a[88:91], a[240:243], v[184:187], a[88:91]
 ds_read_b128 a[212:215], v1 offset:35840
 v_cvt_pk_bf16_f32 v159, v246, v247
 v_mfma_f32_16x16x32_bf16 a[88:91], a[244:247], v[200:203], a[88:91]
 v_exp_f32 v240, v48
 v_mfma_f32_16x16x32_bf16 a[120:123], a[244:247], v[204:207], a[120:123]
 v_exp_f32 v241, v49
 v_mfma_f32_16x16x32_bf16 a[120:123], a[240:243], v[188:191], a[120:123]
 v_exp_f32 v242, v50
 v_mfma_f32_16x16x32_bf16 v[236:239], v[252:255], v[156:159], 0
 ds_read_b128 a[216:219], v1 offset:37888
 v_cvt_pk_bf16_f32 v160, v240, v241
 v_mfma_f32_16x16x32_bf16 a[28:31], a[248:251], v[176:179], a[28:31]
 v_exp_f32 v243, v51
 v_mfma_f32_16x16x32_bf16 a[28:31], a[252:255], v[192:195], a[28:31]
 v_exp_f32 v244, v52
 v_mfma_f32_16x16x32_bf16 a[60:63], a[252:255], v[196:199], a[60:63]
 v_exp_f32 v245, v53
 v_mfma_f32_16x16x32_bf16 a[60:63], a[248:251], v[180:183], a[60:63]
 ds_read_b128 a[220:223], v1 offset:39936
 v_cvt_pk_bf16_f32 v161, v242, v243
 v_mfma_f32_16x16x32_bf16 a[92:95], a[248:251], v[184:187], a[92:95]
 v_exp_f32 v246, v54
 v_mfma_f32_16x16x32_bf16 a[92:95], a[252:255], v[200:203], a[92:95]
 v_exp_f32 v247, v55
 v_mfma_f32_16x16x32_bf16 a[124:127], a[252:255], v[204:207], a[124:127]
 v_cvt_pk_bf16_f32 v162, v244, v245
 v_cvt_pk_bf16_f32 v163, v246, v247
 v_mfma_f32_16x16x32_bf16 a[124:127], a[248:251], v[188:191], a[124:127]
 s_waitcnt lgkmcnt(4)
 v_exp_f32 v240, v56
 v_mfma_f32_16x16x32_bf16 v[80:83], a[192:195], a[128:131], v[208:211]
 ds_read_b128 a[224:227], v1 offset:40960
 v_mfma_f32_16x16x32_bf16 v[80:83], a[196:199], a[132:135], v[80:83]
 v_mfma_f32_16x16x32_bf16 v[80:83], a[200:203], a[136:139], v[80:83]
 v_exp_f32 v241, v57
 v_mfma_f32_16x16x32_bf16 v[80:83], a[204:207], a[140:143], v[80:83]
 ds_read_b128 a[228:231], v1 offset:43008
 v_cvt_pk_bf16_f32 v164, v240, v241
 v_mfma_f32_16x16x32_bf16 v[224:227], v[252:255], v[160:163], v[224:227]
 v_exp_f32 v242, v58
 v_mfma_f32_16x16x32_bf16 v[88:91], a[204:207], a[156:159], v[212:215]
 v_exp_f32 v243, v59
 v_mfma_f32_16x16x32_bf16 v[88:91], a[200:203], a[152:155], v[88:91]
 ds_read_b128 a[232:235], v1 offset:45056
 v_cvt_pk_bf16_f32 v165, v242, v243
 v_mfma_f32_16x16x32_bf16 v[88:91], a[196:199], a[148:151], v[88:91]
 v_exp_f32 v244, v60
 v_mfma_f32_16x16x32_bf16 v[88:91], a[192:195], a[144:147], v[88:91]
 v_exp_f32 v245, v61
 v_mfma_f32_16x16x32_bf16 v[104:107], a[192:195], a[176:179], v[220:223]
 ds_read_b128 a[236:239], v1 offset:47104
 v_cvt_pk_bf16_f32 v166, v244, v245
 v_mfma_f32_16x16x32_bf16 v[104:107], a[196:199], a[180:183], v[104:107]
 v_mfma_f32_16x16x32_bf16 v[104:107], a[200:203], a[184:187], v[104:107]
 v_exp_f32 v246, v62
 v_mfma_f32_16x16x32_bf16 v[104:107], a[204:207], a[188:191], v[104:107]
 s_waitcnt lgkmcnt(4)
 v_exp_f32 v247, v63
 v_mfma_f32_16x16x32_bf16 v[84:87], a[208:211], a[128:131], v[208:211]
 ds_read_b128 a[240:243], v1 offset:41984
 v_cvt_pk_bf16_f32 v167, v246, v247
 v_mfma_f32_16x16x32_bf16 v[84:87], a[212:215], a[132:135], v[84:87]
 v_exp_f32 v240, v64
 v_mfma_f32_16x16x32_bf16 v[84:87], a[216:219], a[136:139], v[84:87]
 v_exp_f32 v241, v65
 v_mfma_f32_16x16x32_bf16 v[84:87], a[220:223], a[140:143], v[84:87]
 ds_read_b128 a[244:247], v1 offset:44032
 v_cvt_pk_bf16_f32 v168, v240, v241
 v_mfma_f32_16x16x32_bf16 v[228:231], v[252:255], v[164:167], v[228:231]
 v_exp_f32 v242, v66
 v_mfma_f32_16x16x32_bf16 v[92:95], a[220:223], a[156:159], v[212:215]
 v_exp_f32 v243, v67
 v_mfma_f32_16x16x32_bf16 v[92:95], a[216:219], a[152:155], v[92:95]
 ds_read_b128 a[248:251], v1 offset:46080
 v_cvt_pk_bf16_f32 v169, v242, v243
 v_mfma_f32_16x16x32_bf16 v[92:95], a[212:215], a[148:151], v[92:95]
 v_exp_f32 v244, v68
 v_mfma_f32_16x16x32_bf16 v[92:95], a[208:211], a[144:147], v[92:95]
 v_exp_f32 v245, v69
 v_mfma_f32_16x16x32_bf16 v[108:111], a[208:211], a[176:179], v[220:223]
 ds_read_b128 a[252:255], v1 offset:48128
 v_cvt_pk_bf16_f32 v170, v244, v245
 v_mfma_f32_16x16x32_bf16 v[108:111], a[212:215], a[180:183], v[108:111]
 v_exp_f32 v246, v70
 v_mfma_f32_16x16x32_bf16 v[108:111], a[216:219], a[184:187], v[108:111]
 v_exp_f32 v247, v71
 v_mfma_f32_16x16x32_bf16 v[108:111], a[220:223], a[188:191], v[108:111]
 s_waitcnt lgkmcnt(4)
 v_exp_f32 v240, v72
 v_mfma_f32_16x16x32_bf16 v[112:115], a[224:227], a[128:131], v[208:211]
 v_cvt_pk_bf16_f32 v171, v246, v247
 v_mfma_f32_16x16x32_bf16 v[112:115], a[228:231], a[132:135], v[112:115]
 v_exp_f32 v241, v73
 v_mfma_f32_16x16x32_bf16 v[112:115], a[232:235], a[136:139], v[112:115]
 v_exp_f32 v242, v74
 v_mfma_f32_16x16x32_bf16 v[112:115], a[236:239], a[140:143], v[112:115]
 s_waitcnt vmcnt(2) lgkmcnt(0)
 v_cmp_gt_u32 vcc, s47, v251
 s_cbranch_vccnz L_spin_43
L_spun_44:
 s_barrier
 v_cvt_pk_bf16_f32 v172, v240, v241
 v_mfma_f32_16x16x32_bf16 v[232:235], v[252:255], v[168:171], v[232:235]
 ds_read_b128 a[192:195], v2 offset:0
 v_mfma_f32_16x16x32_bf16 v[120:123], a[236:239], a[156:159], v[212:215]
 v_exp_f32 v243, v75
 v_mfma_f32_16x16x32_bf16 v[120:123], a[232:235], a[152:155], v[120:123]
 ds_read_b128 a[196:199], v2 offset:8192
 v_cvt_pk_bf16_f32 v173, v242, v243
 v_mfma_f32_16x16x32_bf16 v[120:123], a[228:231], a[148:151], v[120:123]
 v_exp_f32 v244, v76
 v_mfma_f32_16x16x32_bf16 v[120:123], a[224:227], a[144:147], v[120:123]
 v_exp_f32 v245, v77
 v_mfma_f32_16x16x32_bf16 v[136:139], a[224:227], a[176:179], v[220:223]
 ds_read_b128 a[200:203], v2 offset:1024
 v_cvt_pk_bf16_f32 v174, v244, v245
 v_mfma_f32_16x16x32_bf16 v[136:139], a[228:231], a[180:183], v[136:139]
 v_exp_f32 v246, v78
 v_mfma_f32_16x16x32_bf16 v[136:139], a[232:235], a[184:187], v[136:139]
 ds_read_b128 a[204:207], v2 offset:9216
 v_mfma_f32_16x16x32_bf16 v[136:139], a[236:239], a[188:191], v[136:139]
 v_mfma_f32_16x16x32_bf16 v[116:119], a[240:243], a[128:131], v[208:211]
 v_exp_f32 v247, v79
 v_mfma_f32_16x16x32_bf16 v[116:119], a[244:247], a[132:135], v[116:119]
 ds_read_b128 a[208:211], v2 offset:2048
 v_cvt_pk_bf16_f32 v175, v246, v247
 v_mfma_f32_16x16x32_bf16 v[116:119], a[248:251], a[136:139], v[116:119]
 v_mfma_f32_16x16x32_bf16 v[116:119], a[252:255], a[140:143], v[116:119]
 v_mfma_f32_16x16x32_bf16 v[236:239], v[252:255], v[172:175], v[236:239]
 ds_read_b128 a[212:215], v2 offset:10240
 v_mfma_f32_16x16x32_bf16 v[124:127], a[252:255], a[156:159], v[212:215]
 v_mfma_f32_16x16x32_bf16 v[124:127], a[248:251], a[152:155], v[124:127]
 ds_read_b128 a[216:219], v2 offset:3072
 v_mfma_f32_16x16x32_bf16 v[124:127], a[244:247], a[148:151], v[124:127]
 s_nop 1
 v_mfma_f32_16x16x32_bf16 v[124:127], a[240:243], a[144:147], v[124:127]
 v_max3_f32 v10, v224, v228, v232
 v_mfma_f32_16x16x32_bf16 v[140:143], a[240:243], a[176:179], v[220:223]
 ds_read_b128 a[220:223], v2 offset:11264
 v_max_f32 v10, v10, v236
 v_mfma_f32_16x16x32_bf16 v[140:143], a[244:247], a[180:183], v[140:143]
 v_cmp_lt_f32 vcc, s54, v10
 v_mfma_f32_16x16x32_bf16 v[140:143], a[248:251], a[184:187], v[140:143]
 v_mfma_f32_16x16x32_bf16 v[140:143], a[252:255], a[188:191], v[140:143]
 s_cbranch_vccnz L_jr_46
L_back_45:
L_T1_30:
 v_cmp_gt_i32 s[26:27], 0, v3
 v_cmp_gt_i32 s[28:29], 1, v3
 v_cmp_gt_i32 s[30:31], 2, v3
 v_cmp_gt_i32 s[4:5], 3, v3
 s_nop 3
 s_cmp_eq_u32 s56, 1
 s_cbranch_scc1 L_mk_48
 s_cmp_eq_u32 s56, 2
 s_cbranch_scc1 L_mk_49
 s_cmp_eq_u32 s56, 3
 s_cbranch_scc1 L_mk_50
 v_cndmask_b32 v104, v104, v249, s[26:27]
 v_cndmask_b32 v105, v105, v249, s[28:29]
 v_cndmask_b32 v106, v106, v249, s[30:31]
 v_cndmask_b32 v107, v107, v249, s[4:5]
L_mf_52:
 v_mov_b32 v108, v249
 v_mov_b32 v109, v249
 v_mov_b32 v110, v249
 v_mov_b32 v111, v249
 s_branch L_mf_53
L_mk_48:
 v_cndmask_b32 v108, v108, v249, s[26:27]
 v_cndmask_b32 v109, v109, v249, s[28:29]
 v_cndmask_b32 v110, v110, v249, s[30:31]
 v_cndmask_b32 v111, v111, v249, s[4:5]
L_mf_53:
 v_mov_b32 v136, v249
 v_mov_b32 v137, v249
 v_mov_b32 v138, v249
 v_mov_b32 v139, v249
 s_branch L_mf_54
L_mk_49:
 v_cndmask_b32 v136, v136, v249, s[26:27]
 v_cndmask_b32 v137, v137, v249, s[28:29]
 v_cndmask_b32 v138, v138, v249, s[30:31]
 v_cndmask_b32 v139, v139, v249, s[4:5]
L_mf_54:
 v_mov_b32 v140, v249
 v_mov_b32 v141, v249
 v_mov_b32 v142, v249
 v_mov_b32 v143, v249
 s_branch L_mf_55
L_mk_50:
 v_cndmask_b32 v140, v140, v249, s[26:27]
 v_cndmask_b32 v141, v141, v249, s[28:29]
 v_cndmask_b32 v142, v142, v249, s[30:31]
 v_cndmask_b32 v143, v143, v249, s[4:5]
L_mf_55:
 s_add_u32 s49, s49, 0x4000
 s_cmp_eq_u32 s21, 7
 s_cbranch_scc1 L_T1b_31
 s_waitcnt lgkmcnt(4)
 v_mfma_f32_16x16x32_bf16 a[0:3], a[192:195], v[144:147], a[0:3]
 ds_read_b128 a[224:227], v2 offset:4096
 v_add_f32 v4, v4, v224
 v_mfma_f32_16x16x32_bf16 a[0:3], a[196:199], v[160:163], a[0:3]
 s_add_u32 m0, s50, 98304
 s_add_u32 s34, s49, s50
 v_mfma_f32_16x16x32_bf16 a[32:35], a[196:199], v[164:167], a[32:35]
 buffer_load_dwordx4 v1, s[16:19], s34 offen offset:0 sc1 lds
 v_mfma_f32_16x16x32_bf16 a[32:35], a[192:195], v[148:151], a[32:35]
 v_add_f32 v5, v5, v228
 v_mfma_f32_16x16x32_bf16 a[64:67], a[192:195], v[152:155], a[64:67]
 ds_read_b128 a[228:231], v2 offset:12288
 v_mfma_f32_16x16x32_bf16 a[64:67], a[196:199], v[168:171], a[64:67]
 v_add_f32 v6, v6, v232
 v_mfma_f32_16x16x32_bf16 a[96:99], a[196:199], v[172:175], a[96:99]
 buffer_load_dwordx4 v1, s[16:19], s34 offen offset:1024 sc1 lds
 v_mfma_f32_16x16x32_bf16 a[96:99], a[192:195], v[156:159], a[96:99]
 v_add_f32 v7, v7, v236
 v_mfma_f32_16x16x32_bf16 a[4:7], a[200:203], v[144:147], a[4:7]
 ds_read_b128 a[232:235], v2 offset:5120
 v_mfma_f32_16x16x32_bf16 a[4:7], a[204:207], v[160:163], a[4:7]
 buffer_load_dwordx4 v1, s[16:19], s34 offen offset:2048 sc1 lds
 v_mfma_f32_16x16x32_bf16 a[36:39], a[204:207], v[164:167], a[36:39]
 v_exp_f32 v240, v80
 v_mfma_f32_16x16x32_bf16 a[36:39], a[200:203], v[148:151], a[36:39]
 v_exp_f32 v241, v81
 v_mfma_f32_16x16x32_bf16 a[68:71], a[200:203], v[152:155], a[68:71]
 ds_read_b128 a[236:239], v2 offset:13312
 v_cvt_pk_bf16_f32 v176, v240, v241
 v_mfma_f32_16x16x32_bf16 a[68:71], a[204:207], v[168:171], a[68:71]
 buffer_load_dwordx4 v1, s[16:19], s34 offen offset:3072 sc1 lds
 v_mfma_f32_16x16x32_bf16 a[100:103], a[204:207], v[172:175], a[100:103]
 v_exp_f32 v242, v82
 v_mfma_f32_16x16x32_bf16 a[100:103], a[200:203], v[156:159], a[100:103]
 s_waitcnt lgkmcnt(4)
 v_exp_f32 v243, v83
 v_mfma_f32_16x16x32_bf16 a[8:11], a[208:211], v[144:147], a[8:11]
 ds_read_b128 a[240:243], v2 offset:6144
 s_add_u32 s49, s49, 16384
 v_mfma_f32_16x16x32_bf16 a[8:11], a[212:215], v[160:163], a[8:11]
 s_add_u32 m0, s51, 32768
 v_exp_f32 v244, v84
 v_mfma_f32_16x16x32_bf16 a[40:43], a[212:215], v[164:167], a[40:43]
 s_add_u32 s34, s48, s51
 v_exp_f32 v245, v85
 v_mfma_f32_16x16x32_bf16 a[40:43], a[208:211], v[148:151], a[40:43]
 buffer_load_dwordx4 v1, s[16:19], s34 offen offset:0 sc1 lds
 v_mfma_f32_16x16x32_bf16 a[72:75], a[208:211], v[152:155], a[72:75]
 ds_read_b128 a[244:247], v2 offset:14336
 v_cvt_pk_bf16_f32 v177, v242, v243
 v_mfma_f32_16x16x32_bf16 a[72:75], a[212:215], v[168:171], a[72:75]
 v_exp_f32 v246, v86
 v_mfma_f32_16x16x32_bf16 a[104:107], a[212:215], v[172:175], a[104:107]
 v_cvt_pk_bf16_f32 v178, v244, v245
 v_mfma_f32_16x16x32_bf16 a[104:107], a[208:211], v[156:159], a[104:107]
 buffer_load_dwordx4 v1, s[16:19], s34 offen offset:1024 sc1 lds
 v_mfma_f32_16x16x32_bf16 a[12:15], a[216:219], v[144:147], a[12:15]
 ds_read_b128 a[248:251], v2 offset:7168
 v_mfma_f32_16x16x32_bf16 a[12:15], a[220:223], v[160:163], a[12:15]
 v_exp_f32 v247, v87
 v_mfma_f32_16x16x32_bf16 a[44:47], a[220:223], v[164:167], a[44:47]
 buffer_load_dwordx4 v1, s[16:19], s34 offen offset:2048 sc1 lds
 v_mfma_f32_16x16x32_bf16 a[44:47], a[216:219], v[148:151], a[44:47]
 v_cvt_pk_bf16_f32 v179, v246, v247
 v_mfma_f32_16x16x32_bf16 a[76:79], a[216:219], v[152:155], a[76:79]
 ds_read_b128 a[252:255], v2 offset:15360
 v_mfma_f32_16x16x32_bf16 a[76:79], a[220:223], v[168:171], a[76:79]
 buffer_load_dwordx4 v1, s[16:19], s34 offen offset:3072 sc1 lds
 v_mfma_f32_16x16x32_bf16 v[224:227], v[252:255], v[176:179], 0
 v_exp_f32 v240, v88
 v_mfma_f32_16x16x32_bf16 a[108:111], a[220:223], v[172:175], a[108:111]
 v_exp_f32 v241, v89
 v_mfma_f32_16x16x32_bf16 a[108:111], a[216:219], v[156:159], a[108:111]
 s_waitcnt lgkmcnt(4)
 s_add_u32 m0, s51, 36864
 v_cvt_pk_bf16_f32 v180, v240, v241
 v_mfma_f32_16x16x32_bf16 a[16:19], a[224:227], v[144:147], a[16:19]
 ds_read_b128 a[192:195], v1 offset:0
 v_mfma_f32_16x16x32_bf16 a[16:19], a[228:231], v[160:163], a[16:19]
 s_add_u32 s34, s34, 4096
 v_exp_f32 v242, v90
 v_mfma_f32_16x16x32_bf16 a[48:51], a[228:231], v[164:167], a[48:51]
 buffer_load_dwordx4 v1, s[16:19], s34 offen offset:0 sc1 lds
 v_mfma_f32_16x16x32_bf16 a[48:51], a[224:227], v[148:151], a[48:51]
 v_exp_f32 v243, v91
 v_mfma_f32_16x16x32_bf16 a[80:83], a[224:227], v[152:155], a[80:83]
 ds_read_b128 a[196:199], v1 offset:2048
 v_cvt_pk_bf16_f32 v181, v242, v243
 v_mfma_f32_16x16x32_bf16 a[80:83], a[228:231], v[168:171], a[80:83]
 buffer_load_dwordx4 v1, s[16:19], s34 offen offset:1024 sc1 lds
 v_mfma_f32_16x16x32_bf16 a[112:115], a[228:231], v[172:175], a[112:115]
 v_exp_f32 v244, v92
 v_mfma_f32_16x16x32_bf16 a[112:115], a[224:227], v[156:159], a[112:115]
 v_exp_f32 v245, v93
 v_mfma_f32_16x16x32_bf16 a[20:23], a[232:235], v[144:147], a[20:23]
 ds_read_b128 a[200:203], v1 offset:4096
 v_cvt_pk_bf16_f32 v182, v244, v245
 v_mfma_f32_16x16x32_bf16 a[20:23], a[236:239], v[160:163], a[20:23]
 buffer_load_dwordx4 v1, s[16:19], s34 offen offset:2048 sc1 lds
 v_mfma_f32_16x16x32_bf16 a[52:55], a[236:239], v[164:167], a[52:55]
 v_mfma_f32_16x16x32_bf16 a[52:55], a[232:235], v[148:151], a[52:55]
 v_exp_f32 v246, v94
 v_mfma_f32_16x16x32_bf16 a[84:87], a[232:235], v[152:155], a[84:87]
 ds_read_b128 a[204:207], v1 offset:6144
 v_mfma_f32_16x16x32_bf16 a[84:87], a[236:239], v[168:171], a[84:87]
 buffer_load_dwordx4 v1, s[16:19], s34 offen offset:3072 sc1 lds
 v_mfma_f32_16x16x32_bf16 a[116:119], a[236:239], v[172:175], a[116:119]
 v_exp_f32 v247, v95
 v_mfma_f32_16x16x32_bf16 a[116:119], a[232:235], v[156:159], a[116:119]
 s_waitcnt lgkmcnt(4)
 s_add_u32 s48, s48, 32768
 v_cvt_pk_bf16_f32 v183, v246, v247
 v_mfma_f32_16x16x32_bf16 a[24:27], a[240:243], v[144:147], a[24:27]
 ds_read_b128 a[208:211], v1 offset:1024
 v_mfma_f32_16x16x32_bf16 a[24:27], a[244:247], v[160:163], a[24:27]
 v_mfma_f32_16x16x32_bf16 a[56:59], a[244:247], v[164:167], a[56:59]
 v_exp_f32 v240, v104
 v_mfma_f32_16x16x32_bf16 a[56:59], a[240:243], v[148:151], a[56:59]
 v_exp_f32 v241, v105
 v_mfma_f32_16x16x32_bf16 a[88:91], a[240:243], v[152:155], a[88:91]
 ds_read_b128 a[212:215], v1 offset:3072
 v_cvt_pk_bf16_f32 v188, v240, v241
 v_mfma_f32_16x16x32_bf16 a[88:91], a[244:247], v[168:171], a[88:91]
 v_exp_f32 v242, v106
 v_mfma_f32_16x16x32_bf16 v[228:231], v[252:255], v[180:183], 0
 v_exp_f32 v243, v107
 v_mfma_f32_16x16x32_bf16 a[120:123], a[244:247], v[172:175], a[120:123]
 v_cvt_pk_bf16_f32 v189, v242, v243
 v_mfma_f32_16x16x32_bf16 a[120:123], a[240:243], v[156:159], a[120:123]
 ds_read_b128 a[216:219], v1 offset:5120
 v_mfma_f32_16x16x32_bf16 a[28:31], a[248:251], v[144:147], a[28:31]
 v_mfma_f32_16x16x32_bf16 a[28:31], a[252:255], v[160:163], a[28:31]
 v_exp_f32 v244, v108
 v_mfma_f32_16x16x32_bf16 a[60:63], a[252:255], v[164:167], a[60:63]
 v_mfma_f32_16x16x32_bf16 a[60:63], a[248:251], v[148:151], a[60:63]
 ds_read_b128 a[220:223], v1 offset:7168
 v_mfma_f32_16x16x32_bf16 a[92:95], a[248:251], v[152:155], a[92:95]
 v_mfma_f32_16x16x32_bf16 a[92:95], a[252:255], v[168:171], a[92:95]
 v_mfma_f32_16x16x32_bf16 a[124:127], a[252:255], v[172:175], a[124:127]
 v_exp_f32 v245, v109
 v_mfma_f32_16x16x32_bf16 a[124:127], a[248:251], v[156:159], a[124:127]
 s_waitcnt lgkmcnt(4)
 v_cvt_pk_bf16_f32 v190, v244, v245
 v_mfma_f32_16x16x32_bf16 v[16:19], a[192:195], a[128:131], v[208:211]
 ds_read_b128 a[224:227], v1 offset:8192
 v_mfma_f32_16x16x32_bf16 v[16:19], a[196:199], a[132:135], v[16:19]
 v_exp_f32 v246, v110
 v_mfma_f32_16x16x32_bf16 v[16:19], a[200:203], a[136:139], v[16:19]
 ds_read_b128 a[228:231], v1 offset:10240
 v_mfma_f32_16x16x32_bf16 v[16:19], a[204:207], a[140:143], v[16:19]
 v_mfma_f32_16x16x32_bf16 v[24:27], a[204:207], a[156:159], v[212:215]
 ds_read_b128 a[232:235], v1 offset:12288
 v_mfma_f32_16x16x32_bf16 v[24:27], a[200:203], a[152:155], v[24:27]
 v_exp_f32 v247, v111
 v_mfma_f32_16x16x32_bf16 v[24:27], a[196:199], a[148:151], v[24:27]
 ds_read_b128 a[236:239], v1 offset:14336
 v_cvt_pk_bf16_f32 v191, v246, v247
 v_mfma_f32_16x16x32_bf16 v[24:27], a[192:195], a[144:147], v[24:27]
 s_waitcnt lgkmcnt(4)
 v_exp_f32 v240, v112
 v_mfma_f32_16x16x32_bf16 v[20:23], a[208:211], a[128:131], v[208:211]
 ds_read_b128 a[240:243], v1 offset:9216
 v_mfma_f32_16x16x32_bf16 v[20:23], a[212:215], a[132:135], v[20:23]
 v_exp_f32 v241, v113
 v_mfma_f32_16x16x32_bf16 v[20:23], a[216:219], a[136:139], v[20:23]
 ds_read_b128 a[244:247], v1 offset:11264
 v_cvt_pk_bf16_f32 v192, v240, v241
 v_mfma_f32_16x16x32_bf16 v[20:23], a[220:223], a[140:143], v[20:23]
 v_exp_f32 v242, v114
 v_mfma_f32_16x16x32_bf16 v[236:239], v[252:255], v[188:191], 0
 ds_read_b128 a[248:251], v1 offset:13312
 v_mfma_f32_16x16x32_bf16 v[28:31], a[220:223], a[156:159], v[212:215]
 v_exp_f32 v243, v115
 v_mfma_f32_16x16x32_bf16 v[28:31], a[216:219], a[152:155], v[28:31]
 ds_read_b128 a[252:255], v1 offset:15360
 v_cvt_pk_bf16_f32 v193, v242, v243
 v_mfma_f32_16x16x32_bf16 v[28:31], a[212:215], a[148:151], v[28:31]
 v_exp_f32 v244, v116
 v_mfma_f32_16x16x32_bf16 v[28:31], a[208:211], a[144:147], v[28:31]
 s_waitcnt lgkmcnt(4)
 v_mfma_f32_16x16x32_bf16 v[32:35], a[224:227], a[128:131], v[208:211]
 ds_read_b128 a[192:195], v1 offset:16384
 v_mfma_f32_16x16x32_bf16 v[32:35], a[228:231], a[132:135], v[32:35]
 v_exp_f32 v245, v117
 v_mfma_f32_16x16x32_bf16 v[32:35], a[232:235], a[136:139], v[32:35]
 ds_read_b128 a[196:199], v1 offset:18432
 v_cvt_pk_bf16_f32 v194, v244, v245
 v_mfma_f32_16x16x32_bf16 v[32:35], a[236:239], a[140:143], v[32:35]
 v_exp_f32 v246, v118
 v_mfma_f32_16x16x32_bf16 v[40:43], a[236:239], a[156:159], v[212:215]
 ds_read_b128 a[200:203], v1 offset:20480
 v_mfma_f32_16x16x32_bf16 v[40:43], a[232:235], a[152:155], v[40:43]
 v_mfma_f32_16x16x32_bf16 v[40:43], a[228:231], a[148:151], v[40:43]
 ds_read_b128 a[204:207], v1 offset:22528
 v_mfma_f32_16x16x32_bf16 v[40:43], a[224:227], a[144:147], v[40:43]
 s_waitcnt lgkmcnt(4)
 v_exp_f32 v247, v119
 v_mfma_f32_16x16x32_bf16 v[36:39], a[240:243], a[128:131], v[208:211]
 ds_read_b128 a[208:211], v1 offset:17408
 v_cvt_pk_bf16_f32 v195, v246, v247
 v_mfma_f32_16x16x32_bf16 v[36:39], a[244:247], a[132:135], v[36:39]
 v_exp_f32 v240, v120
 v_mfma_f32_16x16x32_bf16 v[36:39], a[248:251], a[136:139], v[36:39]
 ds_read_b128 a[212:215], v1 offset:19456
 v_mfma_f32_16x16x32_bf16 v[36:39], a[252:255], a[140:143], v[36:39]
 v_exp_f32 v241, v121
 v_mfma_f32_16x16x32_bf16 v[44:47], a[252:255], a[156:159], v[212:215]
 ds_read_b128 a[216:219], v1 offset:21504
 v_cvt_pk_bf16_f32 v196, v240, v241
 v_mfma_f32_16x16x32_bf16 v[44:47], a[248:251], a[152:155], v[44:47]
 v_exp_f32 v242, v122
 v_mfma_f32_16x16x32_bf16 v[44:47], a[244:247], a[148:151], v[44:47]
 ds_read_b128 a[220:223], v1 offset:23552
 v_mfma_f32_16x16x32_bf16 v[44:47], a[240:243], a[144:147], v[44:47]
 v_exp_f32 v243, v123
 v_mfma_f32_16x16x32_bf16 v[224:227], v[252:255], v[192:195], v[224:227]
 s_waitcnt lgkmcnt(4)
 v_exp_f32 v244, v124
 v_mfma_f32_16x16x32_bf16 v[48:51], a[192:195], a[128:131], v[208:211]
 ds_read_b128 a[224:227], v1 offset:24576
 v_cvt_pk_bf16_f32 v197, v242, v243
 v_mfma_f32_16x16x32_bf16 v[48:51], a[196:199], a[132:135], v[48:51]
 v_exp_f32 v245, v125
 v_mfma_f32_16x16x32_bf16 v[48:51], a[200:203], a[136:139], v[48:51]
 ds_read_b128 a[228:231], v1 offset:26624
 v_cvt_pk_bf16_f32 v198, v244, v245
 v_mfma_f32_16x16x32_bf16 v[48:51], a[204:207], a[140:143], v[48:51]
 v_exp_f32 v246, v126
 v_mfma_f32_16x16x32_bf16 v[56:59], a[204:207], a[156:159], v[212:215]
 ds_read_b128 a[232:235], v1 offset:28672
 v_mfma_f32_16x16x32_bf16 v[56:59], a[200:203], a[152:155], v[56:59]
 v_exp_f32 v247, v127
 v_mfma_f32_16x16x32_bf16 v[56:59], a[196:199], a[148:151], v[56:59]
 ds_read_b128 a[236:239], v1 offset:30720
 v_cvt_pk_bf16_f32 v199, v246, v247
 v_mfma_f32_16x16x32_bf16 v[56:59], a[192:195], a[144:147], v[56:59]
 s_waitcnt lgkmcnt(4)
 v_mfma_f32_16x16x32_bf16 v[52:55], a[208:211], a[128:131], v[208:211]
 ds_read_b128 a[240:243], v1 offset:25600
 v_mfma_f32_16x16x32_bf16 v[52:55], a[212:215], a[132:135], v[52:55]
 v_exp_f32 v240, v136
 v_mfma_f32_16x16x32_bf16 v[52:55], a[216:219], a[136:139], v[52:55]
 ds_read_b128 a[244:247], v1 offset:27648
 v_mfma_f32_16x16x32_bf16 v[52:55], a[220:223], a[140:143], v[52:55]
 v_exp_f32 v241, v137
 v_mfma_f32_16x16x32_bf16 v[228:231], v[252:255], v[196:199], v[228:231]
 ds_read_b128 a[248:251], v1 offset:29696
 v_cvt_pk_bf16_f32 v204, v240, v241
 v_mfma_f32_16x16x32_bf16 v[60:63], a[220:223], a[156:159], v[212:215]
 v_exp_f32 v242, v138
 v_mfma_f32_16x16x32_bf16 v[60:63], a[216:219], a[152:155], v[60:63]
 ds_read_b128 a[252:255], v1 offset:31744
 v_mfma_f32_16x16x32_bf16 v[60:63], a[212:215], a[148:151], v[60:63]
 v_exp_f32 v243, v139
 v_mfma_f32_16x16x32_bf16 v[60:63], a[208:211], a[144:147], v[60:63]
 s_waitcnt lgkmcnt(4)
 v_exp_f32 v244, v140
 v_mfma_f32_16x16x32_bf16 v[64:67], a[224:227], a[128:131], v[208:211]
 v_exp_f32 v245, v141
 v_mfma_f32_16x16x32_bf16 v[64:67], a[228:231], a[132:135], v[64:67]
 v_exp_f32 v246, v142
 v_mfma_f32_16x16x32_bf16 v[64:67], a[232:235], a[136:139], v[64:67]
 v_exp_f32 v247, v143
 v_mfma_f32_16x16x32_bf16 v[64:67], a[236:239], a[140:143], v[64:67]
 s_waitcnt vmcnt(0) lgkmcnt(0)
 s_barrier
 v_cvt_pk_bf16_f32 v205, v242, v243
 v_mfma_f32_16x16x32_bf16 v[72:75], a[236:239], a[156:159], v[212:215]
 ds_read_b128 a[192:195], v2 offset:32768
 v_cvt_pk_bf16_f32 v206, v244, v245
 v_mfma_f32_16x16x32_bf16 v[72:75], a[232:235], a[152:155], v[72:75]
 ds_read_b128 a[196:199], v2 offset:40960
 v_cvt_pk_bf16_f32 v207, v246, v247
 v_mfma_f32_16x16x32_bf16 v[72:75], a[228:231], a[148:151], v[72:75]
 v_mfma_f32_16x16x32_bf16 v[72:75], a[224:227], a[144:147], v[72:75]
 ds_read_b128 a[200:203], v2 offset:33792
 v_mfma_f32_16x16x32_bf16 v[236:239], v[252:255], v[204:207], v[236:239]
 ds_read_b128 a[204:207], v2 offset:41984
 v_mfma_f32_16x16x32_bf16 v[68:71], a[240:243], a[128:131], v[208:211]
 v_mfma_f32_16x16x32_bf16 v[68:71], a[244:247], a[132:135], v[68:71]
 ds_read_b128 a[208:211], v2 offset:34816
 v_mfma_f32_16x16x32_bf16 v[68:71], a[248:251], a[136:139], v[68:71]
 ds_read_b128 a[212:215], v2 offset:43008
 v_mfma_f32_16x16x32_bf16 v[68:71], a[252:255], a[140:143], v[68:71]
 v_mfma_f32_16x16x32_bf16 v[76:79], a[252:255], a[156:159], v[212:215]
 ds_read_b128 a[216:219], v2 offset:35840
 v_max3_f32 v10, v224, v228, v236
 v_mfma_f32_16x16x32_bf16 v[76:79], a[248:251], a[152:155], v[76:79]
 ds_read_b128 a[220:223], v2 offset:44032
 v_cmp_lt_f32 vcc, s54, v10
 v_mfma_f32_16x16x32_bf16 v[76:79], a[244:247], a[148:151], v[76:79]
 v_mfma_f32_16x16x32_bf16 v[76:79], a[240:243], a[144:147], v[76:79]
 s_cbranch_vccnz L_jr_58
L_back_57:
 s_waitcnt lgkmcnt(4)
 v_mfma_f32_16x16x32_bf16 a[0:3], a[192:195], v[176:179], a[0:3]
 ds_read_b128 a[224:227], v2 offset:36864
 v_add_f32 v4, v4, v224
 v_mfma_f32_16x16x32_bf16 a[0:3], a[196:199], v[192:195], a[0:3]
 s_add_u32 m0, s51, 65536
 s_add_u32 s34, s49, s51
 v_exp_f32 v240, v16
 v_mfma_f32_16x16x32_bf16 a[32:35], a[196:199], v[196:199], a[32:35]
 buffer_load_dwordx4 v1, s[16:19], s34 offen offset:0 sc1 lds
 v_mfma_f32_16x16x32_bf16 a[32:35], a[192:195], v[180:183], a[32:35]
 ds_read_b128 a[228:231], v2 offset:45056
 v_add_f32 v5, v5, v228
 v_mfma_f32_16x16x32_bf16 a[96:99], a[192:195], v[188:191], a[96:99]
 buffer_load_dwordx4 v1, s[16:19], s34 offen offset:1024 sc1 lds
 v_mfma_f32_16x16x32_bf16 a[96:99], a[196:199], v[204:207], a[96:99]
 v_add_f32 v7, v7, v236
 v_exp_f32 v241, v17
 v_mfma_f32_16x16x32_bf16 a[4:7], a[204:207], v[192:195], a[4:7]
 ds_read_b128 a[232:235], v2 offset:37888
 v_exp_f32 v242, v18
 v_mfma_f32_16x16x32_bf16 a[4:7], a[200:203], v[176:179], a[4:7]
 buffer_load_dwordx4 v1, s[16:19], s34 offen offset:2048 sc1 lds
 v_cvt_pk_bf16_f32 v144, v240, v241
 v_mfma_f32_16x16x32_bf16 a[36:39], a[200:203], v[180:183], a[36:39]
 buffer_load_dwordx4 v1, s[16:19], s34 offen offset:3072 sc1 lds
 v_mfma_f32_16x16x32_bf16 a[36:39], a[204:207], v[196:199], a[36:39]
 ds_read_b128 a[236:239], v2 offset:46080
 v_exp_f32 v243, v19
 v_mfma_f32_16x16x32_bf16 a[100:103], a[204:207], v[204:207], a[100:103]
 s_add_u32 m0, s51, 69632
 v_exp_f32 v244, v20
 v_cvt_pk_bf16_f32 v145, v242, v243
 v_mfma_f32_16x16x32_bf16 a[100:103], a[200:203], v[188:191], a[100:103]
 s_waitcnt lgkmcnt(4)
 s_add_u32 s34, s34, 4096
 v_exp_f32 v245, v21
 v_mfma_f32_16x16x32_bf16 a[8:11], a[208:211], v[176:179], a[8:11]
 ds_read_b128 a[240:243], v2 offset:38912
 v_exp_f32 v246, v22
 v_mfma_f32_16x16x32_bf16 a[8:11], a[212:215], v[192:195], a[8:11]
 buffer_load_dwordx4 v1, s[16:19], s34 offen offset:0 sc1 lds
 v_cvt_pk_bf16_f32 v146, v244, v245
 v_mfma_f32_16x16x32_bf16 a[40:43], a[212:215], v[196:199], a[40:43]
 buffer_load_dwordx4 v1, s[16:19], s34 offen offset:1024 sc1 lds
 v_mfma_f32_16x16x32_bf16 a[40:43], a[208:211], v[180:183], a[40:43]
 ds_read_b128 a[244:247], v2 offset:47104
 v_exp_f32 v247, v23
 v_mfma_f32_16x16x32_bf16 a[104:107], a[208:211], v[188:191], a[104:107]
 buffer_load_dwordx4 v1, s[16:19], s34 offen offset:2048 sc1 lds
 v_cvt_pk_bf16_f32 v147, v246, v247
 v_mfma_f32_16x16x32_bf16 a[104:107], a[212:215], v[204:207], a[104:107]
 v_exp_f32 v240, v24
 v_mfma_f32_16x16x32_bf16 a[12:15], a[220:223], v[192:195], a[12:15]
 ds_read_b128 a[248:251], v2 offset:39936
 v_exp_f32 v241, v25
 v_mfma_f32_16x16x32_bf16 a[12:15], a[216:219], v[176:179], a[12:15]
 buffer_load_dwordx4 v1, s[16:19], s34 offen offset:3072 sc1 lds
 v_exp_f32 v242, v26
 v_mfma_f32_16x16x32_bf16 v[224:227], v[252:255], v[144:147], 0
 s_add_u32 s49, s49, 32768
 v_exp_f32 v243, v27
 v_cvt_pk_bf16_f32 v148, v240, v241
 v_mfma_f32_16x16x32_bf16 a[44:47], a[216:219], v[180:183], a[44:47]
 ds_read_b128 a[252:255], v2 offset:48128
 s_add_u32 m0, s51, 0
 v_cvt_pk_bf16_f32 v149, v242, v243
 v_mfma_f32_16x16x32_bf16 a[44:47], a[220:223], v[196:199], a[44:47]
 s_add_u32 s34, s48, s51
 v_exp_f32 v244, v28
 v_mfma_f32_16x16x32_bf16 a[108:111], a[220:223], v[204:207], a[108:111]
 buffer_load_dwordx4 v1, s[16:19], s34 offen offset:0 sc1 lds
 v_mfma_f32_16x16x32_bf16 a[108:111], a[216:219], v[188:191], a[108:111]
 s_waitcnt lgkmcnt(4)
 v_exp_f32 v245, v29
 v_mfma_f32_16x16x32_bf16 a[16:19], a[224:227], v[176:179], a[16:19]
 ds_read_b128 a[192:195], v1 offset:32768
 v_exp_f32 v246, v30
 v_mfma_f32_16x16x32_bf16 a[16:19], a[228:231], v[192:195], a[16:19]
 buffer_load_dwordx4 v1, s[16:19], s34 offen offset:1024 sc1 lds
 v_cvt_pk_bf16_f32 v150, v244, v245
 v_mfma_f32_16x16x32_bf16 a[48:51], a[228:231], v[196:199], a[48:51]
 buffer_load_dwordx4 v1, s[16:19], s34 offen offset:2048 sc1 lds
 v_mfma_f32_16x16x32_bf16 a[48:51], a[224:227], v[180:183], a[48:51]
 ds_read_b128 a[196:199], v1 offset:34816
 v_exp_f32 v247, v31
 v_mfma_f32_16x16x32_bf16 a[112:115], a[224:227], v[188:191], a[112:115]
 buffer_load_dwordx4 v1, s[16:19], s34 offen offset:3072 sc1 lds
 v_cvt_pk_bf16_f32 v151, v246, v247
 v_mfma_f32_16x16x32_bf16 a[112:115], a[228:231], v[204:207], a[112:115]
 v_exp_f32 v240, v32
 v_mfma_f32_16x16x32_bf16 a[20:23], a[236:239], v[192:195], a[20:23]
 ds_read_b128 a[200:203], v1 offset:36864
 s_add_u32 m0, s51, 4096
 v_mfma_f32_16x16x32_bf16 a[20:23], a[232:235], v[176:179], a[20:23]
 s_add_u32 s34, s34, 4096
 v_exp_f32 v241, v33
 v_mfma_f32_16x16x32_bf16 v[228:231], v[252:255], v[148:151], 0
 buffer_load_dwordx4 v1, s[16:19], s34 offen offset:0 sc1 lds
 v_cvt_pk_bf16_f32 v152, v240, v241
 v_mfma_f32_16x16x32_bf16 a[52:55], a[232:235], v[180:183], a[52:55]
 ds_read_b128 a[204:207], v1 offset:38912
 v_exp_f32 v242, v34
 v_mfma_f32_16x16x32_bf16 a[52:55], a[236:239], v[196:199], a[52:55]
 buffer_load_dwordx4 v1, s[16:19], s34 offen offset:1024 sc1 lds
 v_exp_f32 v243, v35
 v_mfma_f32_16x16x32_bf16 a[116:119], a[236:239], v[204:207], a[116:119]
 buffer_load_dwordx4 v1, s[16:19], s34 offen offset:2048 sc1 lds
 v_cvt_pk_bf16_f32 v153, v242, v243
 v_mfma_f32_16x16x32_bf16 a[116:119], a[232:235], v[188:191], a[116:119]
 s_waitcnt lgkmcnt(4)
 v_exp_f32 v244, v36
 v_mfma_f32_16x16x32_bf16 a[24:27], a[240:243], v[176:179], a[24:27]
 ds_read_b128 a[208:211], v1 offset:33792
 v_exp_f32 v245, v37
 v_mfma_f32_16x16x32_bf16 a[24:27], a[244:247], v[192:195], a[24:27]
 buffer_load_dwordx4 v1, s[16:19], s34 offen offset:3072 sc1 lds
 v_cvt_pk_bf16_f32 v154, v244, v245
 v_mfma_f32_16x16x32_bf16 a[56:59], a[244:247], v[196:199], a[56:59]
 s_add_u32 s48, s48, 32768
 v_exp_f32 v246, v38
 v_mfma_f32_16x16x32_bf16 a[56:59], a[240:243], v[180:183], a[56:59]
 ds_read_b128 a[212:215], v1 offset:35840
 v_exp_f32 v247, v39
 v_mfma_f32_16x16x32_bf16 a[120:123], a[240:243], v[188:191], a[120:123]
 buffer_load_dword v251, v250, s[16:19], s55 offen sc1
 v_cvt_pk_bf16_f32 v155, v246, v247
 v_mfma_f32_16x16x32_bf16 a[120:123], a[244:247], v[204:207], a[120:123]
 s_cmp_eq_u32 s21, 0
 s_cselect_b32 s22, 0x20000000, 0
 v_exp_f32 v240, v40
 v_mfma_f32_16x16x32_bf16 a[28:31], a[252:255], v[192:195], a[28:31]
 ds_read_b128 a[216:219], v1 offset:37888
 v_exp_f32 v241, v41
 v_mfma_f32_16x16x32_bf16 a[28:31], a[248:251], v[176:179], a[28:31]
 s_lshl_b32 s23, s20, 13
 v_and_b32 v12, 15, v0
 v_lshl_add_u32 v12, v12, 2, s22
 v_cvt_pk_bf16_f32 v156, v240, v241
 v_mfma_f32_16x16x32_bf16 v[224:227], v[252:255], v[152:155], v[224:227]
 s_lshl_b32 s22, s93, 6
 v_exp_f32 v242, v42
 v_mfma_f32_16x16x32_bf16 a[60:63], a[248:251], v[180:183], a[60:63]
 ds_read_b128 a[220:223], v1 offset:39936
 s_add_u32 s22, s22, s66
 v_mfma_f32_16x16x32_bf16 a[60:63], a[252:255], v[196:199], a[60:63]
 buffer_load_dword v14, v12, s[16:19], s22 offen offset:0 sc1
 v_mfma_f32_16x16x32_bf16 a[124:127], a[252:255], v[204:207], a[124:127]
 s_add_u32 s23, s23, 0x3800000
 v_exp_f32 v243, v43
 v_mfma_f32_16x16x32_bf16 a[124:127], a[248:251], v[188:191], a[124:127]
 s_waitcnt lgkmcnt(4)
 s_lshl_b32 s22, s45, 6
 s_add_u32 s22, s22, s66
 v_cvt_pk_bf16_f32 v157, v242, v243
 v_mfma_f32_16x16x32_bf16 v[80:83], a[192:195], a[128:131], v[208:211]
 ds_read_b128 a[224:227], v1 offset:40960
 v_exp_f32 v244, v44
 v_mfma_f32_16x16x32_bf16 v[80:83], a[196:199], a[132:135], v[80:83]
 buffer_load_dword v15, v12, s[16:19], s22 offen offset:0 sc1
 v_mfma_f32_16x16x32_bf16 v[80:83], a[200:203], a[136:139], v[80:83]
 ds_read_b128 a[228:231], v1 offset:43008
 v_exp_f32 v245, v45
 v_mfma_f32_16x16x32_bf16 v[80:83], a[204:207], a[140:143], v[80:83]
 s_and_b32 s24, s93, 1
 v_exp_f32 v246, v46
 v_cvt_pk_bf16_f32 v158, v244, v245
 v_mfma_f32_16x16x32_bf16 v[88:91], a[204:207], a[156:159], v[212:215]
 ds_read_b128 a[232:235], v1 offset:45056
 v_exp_f32 v247, v47
 v_mfma_f32_16x16x32_bf16 v[88:91], a[200:203], a[152:155], v[88:91]
 s_lshl_b32 s24, s24, 10
 v_exp_f32 v240, v48
 v_cvt_pk_bf16_f32 v159, v246, v247
 v_mfma_f32_16x16x32_bf16 v[88:91], a[196:199], a[148:151], v[88:91]
 ds_read_b128 a[236:239], v1 offset:47104
 v_exp_f32 v241, v49
 v_mfma_f32_16x16x32_bf16 v[88:91], a[192:195], a[144:147], v[88:91]
 s_lshr_b32 s26, s93, 1
 v_exp_f32 v242, v50
 v_mfma_f32_16x16x32_bf16 v[228:231], v[252:255], v[156:159], v[228:231]
 s_waitcnt lgkmcnt(4)
 v_exp_f32 v243, v51
 v_mfma_f32_16x16x32_bf16 v[84:87], a[208:211], a[128:131], v[208:211]
 ds_read_b128 a[240:243], v1 offset:41984
 v_cvt_pk_bf16_f32 v160, v240, v241
 v_mfma_f32_16x16x32_bf16 v[84:87], a[212:215], a[132:135], v[84:87]
 s_mul_i32 s26, s26, 294912
 v_exp_f32 v244, v52
 v_mfma_f32_16x16x32_bf16 v[84:87], a[216:219], a[136:139], v[84:87]
 ds_read_b128 a[244:247], v1 offset:44032
 v_exp_f32 v245, v53
 v_mfma_f32_16x16x32_bf16 v[84:87], a[220:223], a[140:143], v[84:87]
 s_add_u32 s26, s26, s24
 v_exp_f32 v246, v54
 v_mfma_f32_16x16x32_bf16 v[92:95], a[220:223], a[156:159], v[212:215]
 ds_read_b128 a[248:251], v1 offset:46080
 v_cvt_pk_bf16_f32 v161, v242, v243
 v_mfma_f32_16x16x32_bf16 v[92:95], a[216:219], a[152:155], v[92:95]
 s_add_u32 s26, s26, s23
 v_exp_f32 v247, v55
 v_mfma_f32_16x16x32_bf16 v[92:95], a[212:215], a[148:151], v[92:95]
 ds_read_b128 a[252:255], v1 offset:48128
 v_cvt_pk_bf16_f32 v162, v244, v245
 v_mfma_f32_16x16x32_bf16 v[92:95], a[208:211], a[144:147], v[92:95]
 s_waitcnt lgkmcnt(4)
 v_exp_f32 v240, v56
 v_mfma_f32_16x16x32_bf16 v[96:99], a[224:227], a[128:131], v[208:211]
 ds_read_b128 a[192:195], v1 offset:49152
 v_cvt_pk_bf16_f32 v163, v246, v247
 v_mfma_f32_16x16x32_bf16 v[96:99], a[228:231], a[132:135], v[96:99]
 s_and_b32 s24, s45, 1
 v_exp_f32 v241, v57
 v_mfma_f32_16x16x32_bf16 v[96:99], a[232:235], a[136:139], v[96:99]
 ds_read_b128 a[196:199], v1 offset:51200
 v_cvt_pk_bf16_f32 v164, v240, v241
 v_mfma_f32_16x16x32_bf16 v[96:99], a[236:239], a[140:143], v[96:99]
 s_lshl_b32 s24, s24, 10
 v_exp_f32 v242, v58
 v_mfma_f32_16x16x32_bf16 v[224:227], v[252:255], v[160:163], v[224:227]
 ds_read_b128 a[200:203], v1 offset:53248
 v_mfma_f32_16x16x32_bf16 v[104:107], a[236:239], a[156:159], v[212:215]
 v_exp_f32 v243, v59
 v_mfma_f32_16x16x32_bf16 v[104:107], a[232:235], a[152:155], v[104:107]
 ds_read_b128 a[204:207], v1 offset:55296
 v_cvt_pk_bf16_f32 v165, v242, v243
 v_mfma_f32_16x16x32_bf16 v[104:107], a[228:231], a[148:151], v[104:107]
 s_lshr_b32 s27, s45, 1
 v_exp_f32 v244, v60
 v_mfma_f32_16x16x32_bf16 v[104:107], a[224:227], a[144:147], v[104:107]
 s_waitcnt lgkmcnt(4)
 v_exp_f32 v245, v61
 v_mfma_f32_16x16x32_bf16 v[100:103], a[240:243], a[128:131], v[208:211]
 ds_read_b128 a[208:211], v1 offset:50176
 v_cvt_pk_bf16_f32 v166, v244, v245
 v_mfma_f32_16x16x32_bf16 v[100:103], a[244:247], a[132:135], v[100:103]
 v_exp_f32 v246, v62
 v_mfma_f32_16x16x32_bf16 v[100:103], a[248:251], a[136:139], v[100:103]
 ds_read_b128 a[212:215], v1 offset:52224
 v_mfma_f32_16x16x32_bf16 v[100:103], a[252:255], a[140:143], v[100:103]
 s_mul_i32 s27, s27, 294912
 v_exp_f32 v247, v63
 v_mfma_f32_16x16x32_bf16 v[108:111], a[252:255], a[156:159], v[212:215]
 ds_read_b128 a[216:219], v1 offset:54272
 v_cvt_pk_bf16_f32 v167, v246, v247
 v_mfma_f32_16x16x32_bf16 v[108:111], a[248:251], a[152:155], v[108:111]
 v_exp_f32 v240, v64
 v_mfma_f32_16x16x32_bf16 v[108:111], a[244:247], a[148:151], v[108:111]
 ds_read_b128 a[220:223], v1 offset:56320
 v_mfma_f32_16x16x32_bf16 v[108:111], a[240:243], a[144:147], v[108:111]
 v_exp_f32 v241, v65
 v_mfma_f32_16x16x32_bf16 v[228:231], v[252:255], v[164:167], v[228:231]
 s_waitcnt lgkmcnt(4)
 v_exp_f32 v242, v66
 v_mfma_f32_16x16x32_bf16 v[112:115], a[192:195], a[128:131], v[208:211]
 ds_read_b128 a[224:227], v1 offset:57344
 v_exp_f32 v243, v67
 v_mfma_f32_16x16x32_bf16 v[112:115], a[196:199], a[132:135], v[112:115]
 s_add_u32 s27, s27, s24
 v_exp_f32 v244, v68
 v_mfma_f32_16x16x32_bf16 v[112:115], a[200:203], a[136:139], v[112:115]
 ds_read_b128 a[228:231], v1 offset:59392
 v_cvt_pk_bf16_f32 v168, v240, v241
 v_mfma_f32_16x16x32_bf16 v[112:115], a[204:207], a[140:143], v[112:115]
 v_exp_f32 v245, v69
 v_mfma_f32_16x16x32_bf16 v[120:123], a[204:207], a[156:159], v[212:215]
 ds_read_b128 a[232:235], v1 offset:61440
 v_cvt_pk_bf16_f32 v169, v242, v243
 v_mfma_f32_16x16x32_bf16 v[120:123], a[200:203], a[152:155], v[120:123]
 s_add_u32 s27, s27, s23
 v_exp_f32 v246, v70
 v_mfma_f32_16x16x32_bf16 v[120:123], a[196:199], a[148:151], v[120:123]
 ds_read_b128 a[236:239], v1 offset:63488
 v_cvt_pk_bf16_f32 v170, v244, v245
 v_mfma_f32_16x16x32_bf16 v[120:123], a[192:195], a[144:147], v[120:123]
 s_waitcnt lgkmcnt(4)
 v_exp_f32 v247, v71
 v_mfma_f32_16x16x32_bf16 v[116:119], a[208:211], a[128:131], v[208:211]
 ds_read_b128 a[240:243], v1 offset:58368
 v_cvt_pk_bf16_f32 v171, v246, v247
 v_mfma_f32_16x16x32_bf16 v[116:119], a[212:215], a[132:135], v[116:119]
 v_exp_f32 v240, v72
 v_mfma_f32_16x16x32_bf16 v[116:119], a[216:219], a[136:139], v[116:119]
 ds_read_b128 a[244:247], v1 offset:60416
 v_mfma_f32_16x16x32_bf16 v[116:119], a[220:223], a[140:143], v[116:119]
 v_exp_f32 v241, v73
 v_mfma_f32_16x16x32_bf16 v[224:227], v[252:255], v[168:171], v[224:227]
 ds_read_b128 a[248:251], v1 offset:62464
 v_cvt_pk_bf16_f32 v172, v240, v241
 v_mfma_f32_16x16x32_bf16 v[124:127], a[220:223], a[156:159], v[212:215]
 v_exp_f32 v242, v74
 v_mfma_f32_16x16x32_bf16 v[124:127], a[216:219], a[152:155], v[124:127]
 ds_read_b128 a[252:255], v1 offset:64512
 v_mfma_f32_16x16x32_bf16 v[124:127], a[212:215], a[148:151], v[124:127]
 v_exp_f32 v243, v75
 v_mfma_f32_16x16x32_bf16 v[124:127], a[208:211], a[144:147], v[124:127]
 s_waitcnt lgkmcnt(4)
 v_exp_f32 v244, v76
 v_mfma_f32_16x16x32_bf16 v[128:131], a[224:227], a[128:131], v[208:211]
 v_exp_f32 v245, v77
 v_mfma_f32_16x16x32_bf16 v[128:131], a[228:231], a[132:135], v[128:131]
 v_exp_f32 v246, v78
 v_mfma_f32_16x16x32_bf16 v[128:131], a[232:235], a[136:139], v[128:131]
 v_exp_f32 v247, v79
 v_mfma_f32_16x16x32_bf16 v[128:131], a[236:239], a[140:143], v[128:131]
 s_waitcnt vmcnt(0) lgkmcnt(0)
 v_cmp_gt_u32 vcc, s47, v251
 s_cbranch_vccnz L_spin_59
L_spun_60:
 s_barrier
 v_cvt_pk_bf16_f32 v173, v242, v243
 v_mfma_f32_16x16x32_bf16 v[136:139], a[236:239], a[156:159], v[212:215]
 ds_read_b128 a[192:195], v2 offset:0
 v_cvt_pk_bf16_f32 v174, v244, v245
 v_mfma_f32_16x16x32_bf16 v[136:139], a[232:235], a[152:155], v[136:139]
 ds_read_b128 a[196:199], v2 offset:8192
 v_cvt_pk_bf16_f32 v175, v246, v247
 v_mfma_f32_16x16x32_bf16 v[136:139], a[228:231], a[148:151], v[136:139]
 v_mfma_f32_16x16x32_bf16 v[136:139], a[224:227], a[144:147], v[136:139]
 ds_read_b128 a[200:203], v2 offset:16384
 v_mfma_f32_16x16x32_bf16 v[228:231], v[252:255], v[172:175], v[228:231]
 ds_read_b128 a[204:207], v2 offset:24576
 v_mfma_f32_16x16x32_bf16 v[132:135], a[240:243], a[128:131], v[208:211]
 v_mfma_f32_16x16x32_bf16 v[132:135], a[244:247], a[132:135], v[132:135]
 ds_read_b128 a[208:211], v2 offset:1024
 v_mfma_f32_16x16x32_bf16 v[132:135], a[248:251], a[136:139], v[132:135]
 ds_read_b128 a[212:215], v2 offset:9216
 v_mfma_f32_16x16x32_bf16 v[132:135], a[252:255], a[140:143], v[132:135]
 v_mfma_f32_16x16x32_bf16 v[140:143], a[252:255], a[156:159], v[212:215]
 ds_read_b128 a[216:219], v2 offset:17408
 v_max_f32 v10, v224, v228
 v_mfma_f32_16x16x32_bf16 v[140:143], a[248:251], a[152:155], v[140:143]
 ds_read_b128 a[220:223], v2 offset:25600
 v_cmp_lt_f32 vcc, s54, v10
 v_mfma_f32_16x16x32_bf16 v[140:143], a[244:247], a[148:151], v[140:143]
 v_mfma_f32_16x16x32_bf16 v[140:143], a[240:243], a[144:147], v[140:143]
 s_cbranch_vccnz L_jr_63
L_back_62:
 s_cmp_eq_u32 s21, 0
 s_cbranch_scc1 L_nofin_64
 v_rcp_f32 v6, v6
 v_rcp_f32 v7, v7
 v_sub_f32 v14, 1.0, v14
 v_sub_f32 v15, 1.0, v15
 v_mul_f32 v6, v6, v14
 v_mul_f32 v7, v7, v15
 v_accvgpr_read_b32 v16, a64
 v_accvgpr_read_b32 v17, a65
 v_accvgpr_read_b32 v18, a66
 v_accvgpr_read_b32 v19, a67
 v_accvgpr_read_b32 v20, a68
 v_accvgpr_read_b32 v21, a69
 v_accvgpr_read_b32 v22, a70
 v_accvgpr_read_b32 v23, a71
 v_pk_mul_f32 v[16:17], v[16:17], v[6:7] op_sel:[0,0] op_sel_hi:[1,0]
 v_pk_mul_f32 v[18:19], v[18:19], v[6:7] op_sel:[0,0] op_sel_hi:[1,0]
 v_pk_mul_f32 v[20:21], v[20:21], v[6:7] op_sel:[0,0] op_sel_hi:[1,0]
 v_pk_mul_f32 v[22:23], v[22:23], v[6:7] op_sel:[0,0] op_sel_hi:[1,0]
 v_cvt_pk_bf16_f32 v16, v16, v17
 v_cvt_pk_bf16_f32 v17, v18, v19
 v_cvt_pk_bf16_f32 v18, v20, v21
 v_cvt_pk_bf16_f32 v19, v22, v23
 buffer_store_dwordx4 v[16:19], v1, s[16:19], s26 offen offset:0 sc1
 v_accvgpr_read_b32 v24, a96
 v_accvgpr_read_b32 v25, a97
 v_accvgpr_read_b32 v26, a98
 v_accvgpr_read_b32 v27, a99
 v_accvgpr_read_b32 v28, a100
 v_accvgpr_read_b32 v29, a101
 v_accvgpr_read_b32 v30, a102
 v_accvgpr_read_b32 v31, a103
 v_pk_mul_f32 v[24:25], v[24:25], v[6:7] op_sel:[0,1] op_sel_hi:[1,1]
 v_pk_mul_f32 v[26:27], v[26:27], v[6:7] op_sel:[0,1] op_sel_hi:[1,1]
 v_pk_mul_f32 v[28:29], v[28:29], v[6:7] op_sel:[0,1] op_sel_hi:[1,1]
 v_pk_mul_f32 v[30:31], v[30:31], v[6:7] op_sel:[0,1] op_sel_hi:[1,1]
 v_cvt_pk_bf16_f32 v24, v24, v25
 v_cvt_pk_bf16_f32 v25, v26, v27
 v_cvt_pk_bf16_f32 v26, v28, v29
 v_cvt_pk_bf16_f32 v27, v30, v31
 buffer_store_dwordx4 v[24:27], v1, s[16:19], s27 offen offset:0 sc1
 v_accvgpr_read_b32 v32, a72
 v_accvgpr_read_b32 v33, a73
 v_accvgpr_read_b32 v34, a74
 v_accvgpr_read_b32 v35, a75
 v_accvgpr_read_b32 v36, a76
 v_accvgpr_read_b32 v37, a77
 v_accvgpr_read_b32 v38, a78
 v_accvgpr_read_b32 v39, a79
 v_pk_mul_f32 v[32:33], v[32:33], v[6:7] op_sel:[0,0] op_sel_hi:[1,0]
 v_pk_mul_f32 v[34:35], v[34:35], v[6:7] op_sel:[0,0] op_sel_hi:[1,0]
 v_pk_mul_f32 v[36:37], v[36:37], v[6:7] op_sel:[0,0] op_sel_hi:[1,0]
 v_pk_mul_f32 v[38:39], v[38:39], v[6:7] op_sel:[0,0] op_sel_hi:[1,0]
 v_cvt_pk_bf16_f32 v32, v32, v33
 v_cvt_pk_bf16_f32 v33, v34, v35
 v_cvt_pk_bf16_f32 v34, v36, v37
 v_cvt_pk_bf16_f32 v35, v38, v39
 buffer_store_dwordx4 v[32:35], v1, s[16:19], s26 offen offset:2048 sc1
 v_accvgpr_read_b32 v40, a104
 v_accvgpr_read_b32 v41, a105
 v_accvgpr_read_b32 v42, a106
 v_accvgpr_read_b32 v43, a107
 v_accvgpr_read_b32 v44, a108
 v_accvgpr_read_b32 v45, a109
 v_accvgpr_read_b32 v46, a110
 v_accvgpr_read_b32 v47, a111
 v_pk_mul_f32 v[40:41], v[40:41], v[6:7] op_sel:[0,1] op_sel_hi:[1,1]
 v_pk_mul_f32 v[42:43], v[42:43], v[6:7] op_sel:[0,1] op_sel_hi:[1,1]
 v_pk_mul_f32 v[44:45], v[44:45], v[6:7] op_sel:[0,1] op_sel_hi:[1,1]
 v_pk_mul_f32 v[46:47], v[46:47], v[6:7] op_sel:[0,1] op_sel_hi:[1,1]
 v_cvt_pk_bf16_f32 v40, v40, v41
 v_cvt_pk_bf16_f32 v41, v42, v43
 v_cvt_pk_bf16_f32 v42, v44, v45
 v_cvt_pk_bf16_f32 v43, v46, v47
 buffer_store_dwordx4 v[40:43], v1, s[16:19], s27 offen offset:2048 sc1
 v_accvgpr_read_b32 v48, a80
 v_accvgpr_read_b32 v49, a81
 v_accvgpr_read_b32 v50, a82
 v_accvgpr_read_b32 v51, a83
 v_accvgpr_read_b32 v52, a84
 v_accvgpr_read_b32 v53, a85
 v_accvgpr_read_b32 v54, a86
 v_accvgpr_read_b32 v55, a87
 v_pk_mul_f32 v[48:49], v[48:49], v[6:7] op_sel:[0,0] op_sel_hi:[1,0]
 v_pk_mul_f32 v[50:51], v[50:51], v[6:7] op_sel:[0,0] op_sel_hi:[1,0]
 v_pk_mul_f32 v[52:53], v[52:53], v[6:7] op_sel:[0,0] op_sel_hi:[1,0]
 v_pk_mul_f32 v[54:55], v[54:55], v[6:7] op_sel:[0,0] op_sel_hi:[1,0]
 v_cvt_pk_bf16_f32 v48, v48, v49
 v_cvt_pk_bf16_f32 v49, v50, v51
 v_cvt_pk_bf16_f32 v50, v52, v53
 v_cvt_pk_bf16_f32 v51, v54, v55
 s_add_u32 s26, s26, 4096
 buffer_store_dwordx4 v[48:51], v1, s[16:19], s26 offen offset:0 sc1
 v_accvgpr_read_b32 v56, a112
 v_accvgpr_read_b32 v57, a113
 v_accvgpr_read_b32 v58, a114
 v_accvgpr_read_b32 v59, a115
 v_accvgpr_read_b32 v60, a116
 v_accvgpr_read_b32 v61, a117
 v_accvgpr_read_b32 v62, a118
 v_accvgpr_read_b32 v63, a119
 v_pk_mul_f32 v[56:57], v[56:57], v[6:7] op_sel:[0,1] op_sel_hi:[1,1]
 v_pk_mul_f32 v[58:59], v[58:59], v[6:7] op_sel:[0,1] op_sel_hi:[1,1]
 v_pk_mul_f32 v[60:61], v[60:61], v[6:7] op_sel:[0,1] op_sel_hi:[1,1]
 v_pk_mul_f32 v[62:63], v[62:63], v[6:7] op_sel:[0,1] op_sel_hi:[1,1]
 v_cvt_pk_bf16_f32 v56, v56, v57
 v_cvt_pk_bf16_f32 v57, v58, v59
 v_cvt_pk_bf16_f32 v58, v60, v61
 v_cvt_pk_bf16_f32 v59, v62, v63
 s_add_u32 s27, s27, 4096
 buffer_store_dwordx4 v[56:59], v1, s[16:19], s27 offen offset:0 sc1
 v_accvgpr_read_b32 v64, a88
 v_accvgpr_read_b32 v65, a89
 v_accvgpr_read_b32 v66, a90
 v_accvgpr_read_b32 v67, a91
 v_accvgpr_read_b32 v68, a92
 v_accvgpr_read_b32 v69, a93
 v_accvgpr_read_b32 v70, a94
 v_accvgpr_read_b32 v71, a95
 v_pk_mul_f32 v[64:65], v[64:65], v[6:7] op_sel:[0,0] op_sel_hi:[1,0]
 v_pk_mul_f32 v[66:67], v[66:67], v[6:7] op_sel:[0,0] op_sel_hi:[1,0]
 v_pk_mul_f32 v[68:69], v[68:69], v[6:7] op_sel:[0,0] op_sel_hi:[1,0]
 v_pk_mul_f32 v[70:71], v[70:71], v[6:7] op_sel:[0,0] op_sel_hi:[1,0]
 v_cvt_pk_bf16_f32 v64, v64, v65
 v_cvt_pk_bf16_f32 v65, v66, v67
 v_cvt_pk_bf16_f32 v66, v68, v69
 v_cvt_pk_bf16_f32 v67, v70, v71
 buffer_store_dwordx4 v[64:67], v1, s[16:19], s26 offen offset:2048 sc1
 v_accvgpr_read_b32 v72, a120
 v_accvgpr_read_b32 v73, a121
 v_accvgpr_read_b32 v74, a122
 v_accvgpr_read_b32 v75, a123
 v_accvgpr_read_b32 v76, a124
 v_accvgpr_read_b32 v77, a125
 v_accvgpr_read_b32 v78, a126
 v_accvgpr_read_b32 v79, a127
 v_pk_mul_f32 v[72:73], v[72:73], v[6:7] op_sel:[0,1] op_sel_hi:[1,1]
 v_pk_mul_f32 v[74:75], v[74:75], v[6:7] op_sel:[0,1] op_sel_hi:[1,1]
 v_pk_mul_f32 v[76:77], v[76:77], v[6:7] op_sel:[0,1] op_sel_hi:[1,1]
 v_pk_mul_f32 v[78:79], v[78:79], v[6:7] op_sel:[0,1] op_sel_hi:[1,1]
 v_cvt_pk_bf16_f32 v72, v72, v73
 v_cvt_pk_bf16_f32 v73, v74, v75
 v_cvt_pk_bf16_f32 v74, v76, v77
 v_cvt_pk_bf16_f32 v75, v78, v79
 buffer_store_dwordx4 v[72:75], v1, s[16:19], s27 offen offset:2048 sc1
L_nofin_64:
 s_sub_u32 s32, 6, s21
 s_cmp_eq_u32 s32, 0
 s_cbranch_scc1 L_S15_34
.p2align 6
L_L2_33:
 s_waitcnt lgkmcnt(4)
 v_mfma_f32_16x16x32_bf16 a[0:3], a[192:195], v[144:147], a[0:3]
 ds_read_b128 a[224:227], v2 offset:2048
 v_add_f32 v4, v4, v224
 v_mfma_f32_16x16x32_bf16 a[0:3], a[196:199], v[152:155], a[0:3]
 s_add_u32 m0, s51, 98304
 s_add_u32 s34, s49, s51
 v_exp_f32 v240, v80
 v_mfma_f32_16x16x32_bf16 a[0:3], a[200:203], v[160:163], a[0:3]
 ds_read_b128 a[228:231], v2 offset:10240
 v_exp_f32 v241, v81
 v_mfma_f32_16x16x32_bf16 a[0:3], a[204:207], v[168:171], a[0:3]
 buffer_load_dwordx4 v1, s[16:19], s34 offen offset:0 sc1 lds
 v_mfma_f32_16x16x32_bf16 a[32:35], a[204:207], v[172:175], a[32:35]
 ds_read_b128 a[232:235], v2 offset:18432
 v_exp_f32 v242, v82
 v_mfma_f32_16x16x32_bf16 a[32:35], a[200:203], v[164:167], a[32:35]
 buffer_load_dwordx4 v1, s[16:19], s34 offen offset:1024 sc1 lds
 v_mfma_f32_16x16x32_bf16 a[32:35], a[196:199], v[156:159], a[32:35]
 ds_read_b128 a[236:239], v2 offset:26624
 v_add_f32 v5, v5, v228
 v_mfma_f32_16x16x32_bf16 a[32:35], a[192:195], v[148:151], a[32:35]
 s_waitcnt lgkmcnt(4)
 v_exp_f32 v243, v83
 v_mfma_f32_16x16x32_bf16 a[4:7], a[208:211], v[144:147], a[4:7]
 ds_read_b128 a[240:243], v2 offset:3072
 v_exp_f32 v244, v84
 v_mfma_f32_16x16x32_bf16 a[4:7], a[212:215], v[152:155], a[4:7]
 buffer_load_dwordx4 v1, s[16:19], s34 offen offset:2048 sc1 lds
 v_mfma_f32_16x16x32_bf16 a[4:7], a[216:219], v[160:163], a[4:7]
 ds_read_b128 a[244:247], v2 offset:11264
 v_exp_f32 v245, v85
 v_mfma_f32_16x16x32_bf16 a[4:7], a[220:223], v[168:171], a[4:7]
 buffer_load_dwordx4 v1, s[16:19], s34 offen offset:3072 sc1 lds
 v_mfma_f32_16x16x32_bf16 a[36:39], a[220:223], v[172:175], a[36:39]
 ds_read_b128 a[248:251], v2 offset:19456
 v_exp_f32 v246, v86
 v_mfma_f32_16x16x32_bf16 a[36:39], a[216:219], v[164:167], a[36:39]
 s_add_u32 m0, s51, 102400
 s_add_u32 s34, s34, 4096
 v_cvt_pk_bf16_f32 v176, v240, v241
 v_mfma_f32_16x16x32_bf16 a[36:39], a[212:215], v[156:159], a[36:39]
 ds_read_b128 a[252:255], v2 offset:27648
 v_cvt_pk_bf16_f32 v177, v242, v243
 v_mfma_f32_16x16x32_bf16 a[36:39], a[208:211], v[148:151], a[36:39]
 s_waitcnt lgkmcnt(4)
 v_exp_f32 v247, v87
 v_mfma_f32_16x16x32_bf16 a[8:11], a[224:227], v[144:147], a[8:11]
 ds_read_b128 a[192:195], v2 offset:4096
 v_cvt_pk_bf16_f32 v178, v244, v245
 v_mfma_f32_16x16x32_bf16 a[8:11], a[228:231], v[152:155], a[8:11]
 buffer_load_dwordx4 v1, s[16:19], s34 offen offset:0 sc1 lds
 v_mfma_f32_16x16x32_bf16 a[8:11], a[232:235], v[160:163], a[8:11]
 ds_read_b128 a[196:199], v2 offset:12288
 v_cvt_pk_bf16_f32 v179, v246, v247
 v_mfma_f32_16x16x32_bf16 a[8:11], a[236:239], v[168:171], a[8:11]
 buffer_load_dwordx4 v1, s[16:19], s34 offen offset:1024 sc1 lds
 v_mfma_f32_16x16x32_bf16 a[40:43], a[236:239], v[172:175], a[40:43]
 ds_read_b128 a[200:203], v2 offset:20480
 v_exp_f32 v240, v88
 v_mfma_f32_16x16x32_bf16 a[40:43], a[232:235], v[164:167], a[40:43]
 buffer_load_dwordx4 v1, s[16:19], s34 offen offset:2048 sc1 lds
 v_mfma_f32_16x16x32_bf16 a[40:43], a[228:231], v[156:159], a[40:43]
 ds_read_b128 a[204:207], v2 offset:28672
 v_exp_f32 v241, v89
 v_mfma_f32_16x16x32_bf16 a[40:43], a[224:227], v[148:151], a[40:43]
 buffer_load_dwordx4 v1, s[16:19], s34 offen offset:3072 sc1 lds
 v_mfma_f32_16x16x32_bf16 v[224:227], v[252:255], v[176:179], 0
 s_waitcnt lgkmcnt(4)
 s_add_u32 s49, s49, 32768
 v_exp_f32 v242, v90
 v_mfma_f32_16x16x32_bf16 a[12:15], a[240:243], v[144:147], a[12:15]
 ds_read_b128 a[208:211], v2 offset:5120
 v_exp_f32 v243, v91
 v_mfma_f32_16x16x32_bf16 a[12:15], a[244:247], v[152:155], a[12:15]
 s_add_u32 m0, s51, 32768
 s_add_u32 s34, s48, s51
 v_exp_f32 v244, v92
 v_mfma_f32_16x16x32_bf16 a[12:15], a[248:251], v[160:163], a[12:15]
 ds_read_b128 a[212:215], v2 offset:13312
 v_exp_f32 v245, v93
 v_mfma_f32_16x16x32_bf16 a[12:15], a[252:255], v[168:171], a[12:15]
 buffer_load_dwordx4 v1, s[16:19], s34 offen offset:0 sc1 lds
 v_mfma_f32_16x16x32_bf16 a[44:47], a[252:255], v[172:175], a[44:47]
 ds_read_b128 a[216:219], v2 offset:21504
 v_exp_f32 v246, v94
 v_mfma_f32_16x16x32_bf16 a[44:47], a[248:251], v[164:167], a[44:47]
 buffer_load_dwordx4 v1, s[16:19], s34 offen offset:1024 sc1 lds
 v_mfma_f32_16x16x32_bf16 a[44:47], a[244:247], v[156:159], a[44:47]
 ds_read_b128 a[220:223], v2 offset:29696
 v_cvt_pk_bf16_f32 v180, v240, v241
 v_mfma_f32_16x16x32_bf16 a[44:47], a[240:243], v[148:151], a[44:47]
 s_waitcnt lgkmcnt(4)
 v_exp_f32 v247, v95
 v_mfma_f32_16x16x32_bf16 a[16:19], a[192:195], v[144:147], a[16:19]
 ds_read_b128 a[224:227], v2 offset:6144
 v_cvt_pk_bf16_f32 v181, v242, v243
 v_mfma_f32_16x16x32_bf16 a[16:19], a[196:199], v[152:155], a[16:19]
 buffer_load_dwordx4 v1, s[16:19], s34 offen offset:2048 sc1 lds
 v_mfma_f32_16x16x32_bf16 a[16:19], a[200:203], v[160:163], a[16:19]
 ds_read_b128 a[228:231], v2 offset:14336
 v_cvt_pk_bf16_f32 v182, v244, v245
 v_cvt_pk_bf16_f32 v183, v246, v247
 v_mfma_f32_16x16x32_bf16 a[16:19], a[204:207], v[168:171], a[16:19]
 buffer_load_dwordx4 v1, s[16:19], s34 offen offset:3072 sc1 lds
 v_mfma_f32_16x16x32_bf16 a[48:51], a[204:207], v[172:175], a[48:51]
 ds_read_b128 a[232:235], v2 offset:22528
 v_exp_f32 v240, v96
 v_mfma_f32_16x16x32_bf16 a[48:51], a[200:203], v[164:167], a[48:51]
 s_add_u32 m0, s51, 36864
 s_add_u32 s34, s34, 4096
 v_exp_f32 v241, v97
 v_mfma_f32_16x16x32_bf16 a[48:51], a[196:199], v[156:159], a[48:51]
 ds_read_b128 a[236:239], v2 offset:30720
 v_exp_f32 v242, v98
 v_mfma_f32_16x16x32_bf16 a[48:51], a[192:195], v[148:151], a[48:51]
 buffer_load_dwordx4 v1, s[16:19], s34 offen offset:0 sc1 lds
 v_mfma_f32_16x16x32_bf16 v[228:231], v[252:255], v[180:183], 0
 s_waitcnt lgkmcnt(4)
 v_exp_f32 v243, v99
 v_mfma_f32_16x16x32_bf16 a[20:23], a[208:211], v[144:147], a[20:23]
 ds_read_b128 a[240:243], v2 offset:7168
 v_exp_f32 v244, v100
 v_mfma_f32_16x16x32_bf16 a[20:23], a[212:215], v[152:155], a[20:23]
 buffer_load_dwordx4 v1, s[16:19], s34 offen offset:1024 sc1 lds
 v_mfma_f32_16x16x32_bf16 a[20:23], a[216:219], v[160:163], a[20:23]
 ds_read_b128 a[244:247], v2 offset:15360
 v_cvt_pk_bf16_f32 v184, v240, v241
 v_mfma_f32_16x16x32_bf16 a[20:23], a[220:223], v[168:171], a[20:23]
 buffer_load_dwordx4 v1, s[16:19], s34 offen offset:2048 sc1 lds
 v_mfma_f32_16x16x32_bf16 a[52:55], a[220:223], v[172:175], a[52:55]
 ds_read_b128 a[248:251], v2 offset:23552
 v_cvt_pk_bf16_f32 v185, v242, v243
 v_mfma_f32_16x16x32_bf16 a[52:55], a[216:219], v[164:167], a[52:55]
 buffer_load_dwordx4 v1, s[16:19], s34 offen offset:3072 sc1 lds
 v_mfma_f32_16x16x32_bf16 a[52:55], a[212:215], v[156:159], a[52:55]
 ds_read_b128 a[252:255], v2 offset:31744
 v_mfma_f32_16x16x32_bf16 a[52:55], a[208:211], v[148:151], a[52:55]
 s_waitcnt lgkmcnt(4)
 s_add_u32 s48, s48, 32768
 v_mfma_f32_16x16x32_bf16 a[24:27], a[224:227], v[144:147], a[24:27]
 ds_read_b128 a[192:195], v1 offset:0
 v_mfma_f32_16x16x32_bf16 a[24:27], a[228:231], v[152:155], a[24:27]
 v_exp_f32 v245, v101
 v_mfma_f32_16x16x32_bf16 a[24:27], a[232:235], v[160:163], a[24:27]
 ds_read_b128 a[196:199], v1 offset:2048
 v_cvt_pk_bf16_f32 v186, v244, v245
 v_mfma_f32_16x16x32_bf16 a[24:27], a[236:239], v[168:171], a[24:27]
 v_exp_f32 v246, v102
 v_mfma_f32_16x16x32_bf16 a[56:59], a[236:239], v[172:175], a[56:59]
 ds_read_b128 a[200:203], v1 offset:4096
 v_mfma_f32_16x16x32_bf16 a[56:59], a[232:235], v[164:167], a[56:59]
 v_exp_f32 v247, v103
 v_mfma_f32_16x16x32_bf16 a[56:59], a[228:231], v[156:159], a[56:59]
 ds_read_b128 a[204:207], v1 offset:6144
 v_cvt_pk_bf16_f32 v187, v246, v247
 v_mfma_f32_16x16x32_bf16 a[56:59], a[224:227], v[148:151], a[56:59]
 s_waitcnt lgkmcnt(4)
 v_exp_f32 v240, v104
 v_mfma_f32_16x16x32_bf16 a[28:31], a[240:243], v[144:147], a[28:31]
 ds_read_b128 a[208:211], v1 offset:1024
 v_exp_f32 v241, v105
 v_mfma_f32_16x16x32_bf16 a[28:31], a[244:247], v[152:155], a[28:31]
 v_exp_f32 v242, v106
 v_mfma_f32_16x16x32_bf16 a[28:31], a[248:251], v[160:163], a[28:31]
 ds_read_b128 a[212:215], v1 offset:3072
 v_cvt_pk_bf16_f32 v188, v240, v241
 v_mfma_f32_16x16x32_bf16 a[28:31], a[252:255], v[168:171], a[28:31]
 v_exp_f32 v243, v107
 v_mfma_f32_16x16x32_bf16 v[224:227], v[252:255], v[184:187], v[224:227]
 ds_read_b128 a[216:219], v1 offset:5120
 v_cvt_pk_bf16_f32 v189, v242, v243
 v_mfma_f32_16x16x32_bf16 a[60:63], a[252:255], v[172:175], a[60:63]
 v_exp_f32 v244, v108
 v_mfma_f32_16x16x32_bf16 a[60:63], a[248:251], v[164:167], a[60:63]
 ds_read_b128 a[220:223], v1 offset:7168
 v_mfma_f32_16x16x32_bf16 a[60:63], a[244:247], v[156:159], a[60:63]
 v_exp_f32 v245, v109
 v_mfma_f32_16x16x32_bf16 a[60:63], a[240:243], v[148:151], a[60:63]
 s_waitcnt lgkmcnt(4)
 v_exp_f32 v246, v110
 v_mfma_f32_16x16x32_bf16 v[16:19], a[192:195], a[128:131], v[208:211]
 ds_read_b128 a[224:227], v1 offset:8192
 v_cvt_pk_bf16_f32 v190, v244, v245
 v_mfma_f32_16x16x32_bf16 v[16:19], a[196:199], a[132:135], v[16:19]
 v_exp_f32 v247, v111
 v_mfma_f32_16x16x32_bf16 v[16:19], a[200:203], a[136:139], v[16:19]
 ds_read_b128 a[228:231], v1 offset:10240
 v_cvt_pk_bf16_f32 v191, v246, v247
 v_mfma_f32_16x16x32_bf16 v[16:19], a[204:207], a[140:143], v[16:19]
 v_exp_f32 v240, v112
 v_mfma_f32_16x16x32_bf16 v[24:27], a[204:207], a[156:159], v[212:215]
 ds_read_b128 a[232:235], v1 offset:12288
 v_exp_f32 v241, v113
 v_mfma_f32_16x16x32_bf16 v[24:27], a[200:203], a[152:155], v[24:27]
 v_exp_f32 v242, v114
 v_mfma_f32_16x16x32_bf16 v[24:27], a[196:199], a[148:151], v[24:27]
 ds_read_b128 a[236:239], v1 offset:14336
 v_cvt_pk_bf16_f32 v192, v240, v241
 v_mfma_f32_16x16x32_bf16 v[24:27], a[192:195], a[144:147], v[24:27]
 v_exp_f32 v243, v115
 v_mfma_f32_16x16x32_bf16 v[228:231], v[252:255], v[188:191], v[228:231]
 s_waitcnt lgkmcnt(4)
 v_exp_f32 v244, v116
 v_mfma_f32_16x16x32_bf16 v[20:23], a[208:211], a[128:131], v[208:211]
 ds_read_b128 a[240:243], v1 offset:9216
 v_cvt_pk_bf16_f32 v193, v242, v243
 v_mfma_f32_16x16x32_bf16 v[20:23], a[212:215], a[132:135], v[20:23]
 v_exp_f32 v245, v117
 v_mfma_f32_16x16x32_bf16 v[20:23], a[216:219], a[136:139], v[20:23]
 ds_read_b128 a[244:247], v1 offset:11264
 v_cvt_pk_bf16_f32 v194, v244, v245
 v_mfma_f32_16x16x32_bf16 v[20:23], a[220:223], a[140:143], v[20:23]
 v_exp_f32 v246, v118
 v_mfma_f32_16x16x32_bf16 v[28:31], a[220:223], a[156:159], v[212:215]
 ds_read_b128 a[248:251], v1 offset:13312
 v_mfma_f32_16x16x32_bf16 v[28:31], a[216:219], a[152:155], v[28:31]
 v_exp_f32 v247, v119
 v_mfma_f32_16x16x32_bf16 v[28:31], a[212:215], a[148:151], v[28:31]
 ds_read_b128 a[252:255], v1 offset:15360
 v_cvt_pk_bf16_f32 v195, v246, v247
 v_mfma_f32_16x16x32_bf16 v[28:31], a[208:211], a[144:147], v[28:31]
 s_waitcnt lgkmcnt(4)
 v_exp_f32 v240, v120
 v_mfma_f32_16x16x32_bf16 v[32:35], a[224:227], a[128:131], v[208:211]
 ds_read_b128 a[192:195], v1 offset:16384
 v_exp_f32 v241, v121
 v_mfma_f32_16x16x32_bf16 v[32:35], a[228:231], a[132:135], v[32:35]
 v_exp_f32 v242, v122
 v_mfma_f32_16x16x32_bf16 v[32:35], a[232:235], a[136:139], v[32:35]
 ds_read_b128 a[196:199], v1 offset:18432
 v_cvt_pk_bf16_f32 v196, v240, v241
 v_mfma_f32_16x16x32_bf16 v[32:35], a[236:239], a[140:143], v[32:35]
 v_exp_f32 v243, v123
 v_mfma_f32_16x16x32_bf16 v[224:227], v[252:255], v[192:195], v[224:227]
 ds_read_b128 a[200:203], v1 offset:20480
 v_cvt_pk_bf16_f32 v197, v242, v243
 v_mfma_f32_16x16x32_bf16 v[40:43], a[236:239], a[156:159], v[212:215]
 v_exp_f32 v244, v124
 v_mfma_f32_16x16x32_bf16 v[40:43], a[232:235], a[152:155], v[40:43]
 ds_read_b128 a[204:207], v1 offset:22528
 v_mfma_f32_16x16x32_bf16 v[40:43], a[228:231], a[148:151], v[40:43]
 v_exp_f32 v245, v125
 v_mfma_f32_16x16x32_bf16 v[40:43], a[224:227], a[144:147], v[40:43]
 s_waitcnt lgkmcnt(4)
 v_exp_f32 v246, v126
 v_mfma_f32_16x16x32_bf16 v[36:39], a[240:243], a[128:131], v[208:211]
 ds_read_b128 a[208:211], v1 offset:17408
 v_cvt_pk_bf16_f32 v198, v244, v245
 v_mfma_f32_16x16x32_bf16 v[36:39], a[244:247], a[132:135], v[36:39]
 v_exp_f32 v247, v127
 v_mfma_f32_16x16x32_bf16 v[36:39], a[248:251], a[136:139], v[36:39]
 ds_read_b128 a[212:215], v1 offset:19456
 v_cvt_pk_bf16_f32 v199, v246, v247
 v_mfma_f32_16x16x32_bf16 v[36:39], a[252:255], a[140:143], v[36:39]
 v_exp_f32 v240, v128
 v_mfma_f32_16x16x32_bf16 v[44:47], a[252:255], a[156:159], v[212:215]
 ds_read_b128 a[216:219], v1 offset:21504
 v_exp_f32 v241, v129
 v_mfma_f32_16x16x32_bf16 v[44:47], a[248:251], a[152:155], v[44:47]
 v_exp_f32 v242, v130
 v_mfma_f32_16x16x32_bf16 v[44:47], a[244:247], a[148:151], v[44:47]
 ds_read_b128 a[220:223], v1 offset:23552
 v_cvt_pk_bf16_f32 v200, v240, v241
 v_mfma_f32_16x16x32_bf16 v[44:47], a[240:243], a[144:147], v[44:47]
 v_exp_f32 v243, v131
 v_mfma_f32_16x16x32_bf16 v[228:231], v[252:255], v[196:199], v[228:231]
 s_waitcnt lgkmcnt(4)
 v_exp_f32 v244, v132
 v_mfma_f32_16x16x32_bf16 v[48:51], a[192:195], a[128:131], v[208:211]
 ds_read_b128 a[224:227], v1 offset:24576
 v_cvt_pk_bf16_f32 v201, v242, v243
 v_mfma_f32_16x16x32_bf16 v[48:51], a[196:199], a[132:135], v[48:51]
 v_exp_f32 v245, v133
 v_mfma_f32_16x16x32_bf16 v[48:51], a[200:203], a[136:139], v[48:51]
 ds_read_b128 a[228:231], v1 offset:26624
 v_cvt_pk_bf16_f32 v202, v244, v245
 v_mfma_f32_16x16x32_bf16 v[48:51], a[204:207], a[140:143], v[48:51]
 v_exp_f32 v246, v134
 v_mfma_f32_16x16x32_bf16 v[56:59], a[204:207], a[156:159], v[212:215]
 ds_read_b128 a[232:235], v1 offset:28672
 v_mfma_f32_16x16x32_bf16 v[56:59], a[200:203], a[152:155], v[56:59]
 v_exp_f32 v247, v135
 v_mfma_f32_16x16x32_bf16 v[56:59], a[196:199], a[148:151], v[56:59]
 ds_read_b128 a[236:239], v1 offset:30720
 v_cvt_pk_bf16_f32 v203, v246, v247
 v_mfma_f32_16x16x32_bf16 v[56:59], a[192:195], a[144:147], v[56:59]
 s_waitcnt lgkmcnt(4)
 v_exp_f32 v240, v136
 v_mfma_f32_16x16x32_bf16 v[52:55], a[208:211], a[128:131], v[208:211]
 ds_read_b128 a[240:243], v1 offset:25600
 v_mfma_f32_16x16x32_bf16 v[52:55], a[212:215], a[132:135], v[52:55]
 v_exp_f32 v241, v137
 v_mfma_f32_16x16x32_bf16 v[52:55], a[216:219], a[136:139], v[52:55]
 ds_read_b128 a[244:247], v1 offset:27648
 v_cvt_pk_bf16_f32 v204, v240, v241
 v_mfma_f32_16x16x32_bf16 v[52:55], a[220:223], a[140:143], v[52:55]
 v_exp_f32 v242, v138
 v_mfma_f32_16x16x32_bf16 v[224:227], v[252:255], v[200:203], v[224:227]
 ds_read_b128 a[248:251], v1 offset:29696
 v_mfma_f32_16x16x32_bf16 v[60:63], a[220:223], a[156:159], v[212:215]
 v_exp_f32 v243, v139
 v_mfma_f32_16x16x32_bf16 v[60:63], a[216:219], a[152:155], v[60:63]
 ds_read_b128 a[252:255], v1 offset:31744
 v_cvt_pk_bf16_f32 v205, v242, v243
 v_mfma_f32_16x16x32_bf16 v[60:63], a[212:215], a[148:151], v[60:63]
 v_exp_f32 v244, v140
 v_mfma_f32_16x16x32_bf16 v[60:63], a[208:211], a[144:147], v[60:63]
 s_waitcnt lgkmcnt(4)
 v_exp_f32 v245, v141
 v_mfma_f32_16x16x32_bf16 v[64:67], a[224:227], a[128:131], v[208:211]
 v_exp_f32 v246, v142
 v_mfma_f32_16x16x32_bf16 v[64:67], a[228:231], a[132:135], v[64:67]
 v_exp_f32 v247, v143
 v_mfma_f32_16x16x32_bf16 v[64:67], a[232:235], a[136:139], v[64:67]
 v_cvt_pk_bf16_f32 v206, v244, v245
 v_cvt_pk_bf16_f32 v207, v246, v247
 v_mfma_f32_16x16x32_bf16 v[64:67], a[236:239], a[140:143], v[64:67]
 s_waitcnt vmcnt(0) lgkmcnt(0)
 s_barrier
 v_mfma_f32_16x16x32_bf16 v[72:75], a[236:239], a[156:159], v[212:215]
 ds_read_b128 a[192:195], v2 offset:32768
 v_mfma_f32_16x16x32_bf16 v[72:75], a[232:235], a[152:155], v[72:75]
 ds_read_b128 a[196:199], v2 offset:40960
 v_mfma_f32_16x16x32_bf16 v[72:75], a[228:231], a[148:151], v[72:75]
 v_mfma_f32_16x16x32_bf16 v[72:75], a[224:227], a[144:147], v[72:75]
 ds_read_b128 a[200:203], v2 offset:49152
 v_mfma_f32_16x16x32_bf16 v[228:231], v[252:255], v[204:207], v[228:231]
 ds_read_b128 a[204:207], v2 offset:57344
 v_mfma_f32_16x16x32_bf16 v[68:71], a[240:243], a[128:131], v[208:211]
 v_mfma_f32_16x16x32_bf16 v[68:71], a[244:247], a[132:135], v[68:71]
 ds_read_b128 a[208:211], v2 offset:33792
 v_mfma_f32_16x16x32_bf16 v[68:71], a[248:251], a[136:139], v[68:71]
 ds_read_b128 a[212:215], v2 offset:41984
 v_mfma_f32_16x16x32_bf16 v[68:71], a[252:255], a[140:143], v[68:71]
 v_mfma_f32_16x16x32_bf16 v[76:79], a[252:255], a[156:159], v[212:215]
 ds_read_b128 a[216:219], v2 offset:50176
 v_max_f32 v10, v224, v228
 v_mfma_f32_16x16x32_bf16 v[76:79], a[248:251], a[152:155], v[76:79]
 ds_read_b128 a[220:223], v2 offset:58368
 v_cmp_lt_f32 vcc, s54, v10
 v_mfma_f32_16x16x32_bf16 v[76:79], a[244:247], a[148:151], v[76:79]
 v_mfma_f32_16x16x32_bf16 v[76:79], a[240:243], a[144:147], v[76:79]
 s_cbranch_vccnz L_jr_67
L_back_66:
 s_waitcnt lgkmcnt(4)
 v_mfma_f32_16x16x32_bf16 a[0:3], a[192:195], v[176:179], a[0:3]
 ds_read_b128 a[224:227], v2 offset:34816
 v_add_f32 v4, v4, v224
 v_mfma_f32_16x16x32_bf16 a[0:3], a[196:199], v[184:187], a[0:3]
 s_add_u32 m0, s51, 65536
 s_add_u32 s34, s49, s51
 v_exp_f32 v240, v16
 v_mfma_f32_16x16x32_bf16 a[0:3], a[200:203], v[192:195], a[0:3]
 ds_read_b128 a[228:231], v2 offset:43008
 v_exp_f32 v241, v17
 v_mfma_f32_16x16x32_bf16 a[0:3], a[204:207], v[200:203], a[0:3]
 buffer_load_dwordx4 v1, s[16:19], s34 offen offset:0 sc1 lds
 v_mfma_f32_16x16x32_bf16 a[32:35], a[204:207], v[204:207], a[32:35]
 ds_read_b128 a[232:235], v2 offset:51200
 v_exp_f32 v242, v18
 v_mfma_f32_16x16x32_bf16 a[32:35], a[200:203], v[196:199], a[32:35]
 buffer_load_dwordx4 v1, s[16:19], s34 offen offset:1024 sc1 lds
 v_mfma_f32_16x16x32_bf16 a[32:35], a[196:199], v[188:191], a[32:35]
 ds_read_b128 a[236:239], v2 offset:59392
 v_add_f32 v5, v5, v228
 v_mfma_f32_16x16x32_bf16 a[32:35], a[192:195], v[180:183], a[32:35]
 s_waitcnt lgkmcnt(4)
 v_exp_f32 v243, v19
 v_mfma_f32_16x16x32_bf16 a[4:7], a[208:211], v[176:179], a[4:7]
 ds_read_b128 a[240:243], v2 offset:35840
 v_exp_f32 v244, v20
 v_mfma_f32_16x16x32_bf16 a[4:7], a[212:215], v[184:187], a[4:7]
 buffer_load_dwordx4 v1, s[16:19], s34 offen offset:2048 sc1 lds
 v_mfma_f32_16x16x32_bf16 a[4:7], a[216:219], v[192:195], a[4:7]
 ds_read_b128 a[244:247], v2 offset:44032
 v_exp_f32 v245, v21
 v_mfma_f32_16x16x32_bf16 a[4:7], a[220:223], v[200:203], a[4:7]
 buffer_load_dwordx4 v1, s[16:19], s34 offen offset:3072 sc1 lds
 v_mfma_f32_16x16x32_bf16 a[36:39], a[220:223], v[204:207], a[36:39]
 ds_read_b128 a[248:251], v2 offset:52224
 v_exp_f32 v246, v22
 v_mfma_f32_16x16x32_bf16 a[36:39], a[216:219], v[196:199], a[36:39]
 s_add_u32 m0, s51, 69632
 s_add_u32 s34, s34, 4096
 v_cvt_pk_bf16_f32 v144, v240, v241
 v_mfma_f32_16x16x32_bf16 a[36:39], a[212:215], v[188:191], a[36:39]
 ds_read_b128 a[252:255], v2 offset:60416
 v_cvt_pk_bf16_f32 v145, v242, v243
 v_mfma_f32_16x16x32_bf16 a[36:39], a[208:211], v[180:183], a[36:39]
 s_waitcnt lgkmcnt(4)
 v_exp_f32 v247, v23
 v_mfma_f32_16x16x32_bf16 a[8:11], a[224:227], v[176:179], a[8:11]
 ds_read_b128 a[192:195], v2 offset:36864
 v_cvt_pk_bf16_f32 v146, v244, v245
 v_mfma_f32_16x16x32_bf16 a[8:11], a[228:231], v[184:187], a[8:11]
 buffer_load_dwordx4 v1, s[16:19], s34 offen offset:0 sc1 lds
 v_mfma_f32_16x16x32_bf16 a[8:11], a[232:235], v[192:195], a[8:11]
 ds_read_b128 a[196:199], v2 offset:45056
 v_cvt_pk_bf16_f32 v147, v246, v247
 v_mfma_f32_16x16x32_bf16 a[8:11], a[236:239], v[200:203], a[8:11]
 buffer_load_dwordx4 v1, s[16:19], s34 offen offset:1024 sc1 lds
 v_mfma_f32_16x16x32_bf16 a[40:43], a[236:239], v[204:207], a[40:43]
 ds_read_b128 a[200:203], v2 offset:53248
 v_exp_f32 v240, v24
 v_mfma_f32_16x16x32_bf16 a[40:43], a[232:235], v[196:199], a[40:43]
 buffer_load_dwordx4 v1, s[16:19], s34 offen offset:2048 sc1 lds
 v_mfma_f32_16x16x32_bf16 a[40:43], a[228:231], v[188:191], a[40:43]
 ds_read_b128 a[204:207], v2 offset:61440
 v_exp_f32 v241, v25
 v_mfma_f32_16x16x32_bf16 a[40:43], a[224:227], v[180:183], a[40:43]
 buffer_load_dwordx4 v1, s[16:19], s34 offen offset:3072 sc1 lds
 v_mfma_f32_16x16x32_bf16 v[224:227], v[252:255], v[144:147], 0
 s_waitcnt lgkmcnt(4)
 s_add_u32 s49, s49, 32768
 v_exp_f32 v242, v26
 v_mfma_f32_16x16x32_bf16 a[12:15], a[240:243], v[176:179], a[12:15]
 ds_read_b128 a[208:211], v2 offset:37888
 v_exp_f32 v243, v27
 v_mfma_f32_16x16x32_bf16 a[12:15], a[244:247], v[184:187], a[12:15]
 s_add_u32 m0, s51, 0
 s_add_u32 s34, s48, s51
 v_exp_f32 v244, v28
 v_mfma_f32_16x16x32_bf16 a[12:15], a[248:251], v[192:195], a[12:15]
 ds_read_b128 a[212:215], v2 offset:46080
 v_exp_f32 v245, v29
 v_mfma_f32_16x16x32_bf16 a[12:15], a[252:255], v[200:203], a[12:15]
 buffer_load_dwordx4 v1, s[16:19], s34 offen offset:0 sc1 lds
 v_mfma_f32_16x16x32_bf16 a[44:47], a[252:255], v[204:207], a[44:47]
 ds_read_b128 a[216:219], v2 offset:54272
 v_exp_f32 v246, v30
 v_mfma_f32_16x16x32_bf16 a[44:47], a[248:251], v[196:199], a[44:47]
 buffer_load_dwordx4 v1, s[16:19], s34 offen offset:1024 sc1 lds
 v_mfma_f32_16x16x32_bf16 a[44:47], a[244:247], v[188:191], a[44:47]
 ds_read_b128 a[220:223], v2 offset:62464
 v_cvt_pk_bf16_f32 v148, v240, v241
 v_mfma_f32_16x16x32_bf16 a[44:47], a[240:243], v[180:183], a[44:47]
 s_waitcnt lgkmcnt(4)
 v_exp_f32 v247, v31
 v_mfma_f32_16x16x32_bf16 a[16:19], a[192:195], v[176:179], a[16:19]
 ds_read_b128 a[224:227], v2 offset:38912
 v_cvt_pk_bf16_f32 v149, v242, v243
 v_mfma_f32_16x16x32_bf16 a[16:19], a[196:199], v[184:187], a[16:19]
 buffer_load_dwordx4 v1, s[16:19], s34 offen offset:2048 sc1 lds
 v_mfma_f32_16x16x32_bf16 a[16:19], a[200:203], v[192:195], a[16:19]
 ds_read_b128 a[228:231], v2 offset:47104
 v_cvt_pk_bf16_f32 v150, v244, v245
 v_cvt_pk_bf16_f32 v151, v246, v247
 v_mfma_f32_16x16x32_bf16 a[16:19], a[204:207], v[200:203], a[16:19]
 buffer_load_dwordx4 v1, s[16:19], s34 offen offset:3072 sc1 lds
 v_mfma_f32_16x16x32_bf16 a[48:51], a[204:207], v[204:207], a[48:51]
 ds_read_b128 a[232:235], v2 offset:55296
 v_exp_f32 v240, v32
 v_mfma_f32_16x16x32_bf16 a[48:51], a[200:203], v[196:199], a[48:51]
 s_add_u32 m0, s51, 4096
 s_add_u32 s34, s34, 4096
 v_exp_f32 v241, v33
 v_mfma_f32_16x16x32_bf16 a[48:51], a[196:199], v[188:191], a[48:51]
 ds_read_b128 a[236:239], v2 offset:63488
 v_exp_f32 v242, v34
 v_mfma_f32_16x16x32_bf16 a[48:51], a[192:195], v[180:183], a[48:51]
 buffer_load_dwordx4 v1, s[16:19], s34 offen offset:0 sc1 lds
 v_mfma_f32_16x16x32_bf16 v[228:231], v[252:255], v[148:151], 0
 s_waitcnt lgkmcnt(4)
 v_exp_f32 v243, v35
 v_mfma_f32_16x16x32_bf16 a[20:23], a[208:211], v[176:179], a[20:23]
 ds_read_b128 a[240:243], v2 offset:39936
 v_exp_f32 v244, v36
 v_mfma_f32_16x16x32_bf16 a[20:23], a[212:215], v[184:187], a[20:23]
 buffer_load_dwordx4 v1, s[16:19], s34 offen offset:1024 sc1 lds
 v_mfma_f32_16x16x32_bf16 a[20:23], a[216:219], v[192:195], a[20:23]
 ds_read_b128 a[244:247], v2 offset:48128
 v_cvt_pk_bf16_f32 v152, v240, v241
 v_mfma_f32_16x16x32_bf16 a[20:23], a[220:223], v[200:203], a[20:23]
 buffer_load_dwordx4 v1, s[16:19], s34 offen offset:2048 sc1 lds
 v_mfma_f32_16x16x32_bf16 a[52:55], a[220:223], v[204:207], a[52:55]
 ds_read_b128 a[248:251], v2 offset:56320
 v_cvt_pk_bf16_f32 v153, v242, v243
 v_mfma_f32_16x16x32_bf16 a[52:55], a[216:219], v[196:199], a[52:55]
 buffer_load_dwordx4 v1, s[16:19], s34 offen offset:3072 sc1 lds
 v_mfma_f32_16x16x32_bf16 a[52:55], a[212:215], v[188:191], a[52:55]
 ds_read_b128 a[252:255], v2 offset:64512
 v_mfma_f32_16x16x32_bf16 a[52:55], a[208:211], v[180:183], a[52:55]
 s_waitcnt lgkmcnt(4)
 s_add_u32 s48, s48, 32768
 v_mfma_f32_16x16x32_bf16 a[24:27], a[224:227], v[176:179], a[24:27]
 ds_read_b128 a[192:195], v1 offset:32768
 v_mfma_f32_16x16x32_bf16 a[24:27], a[228:231], v[184:187], a[24:27]
 v_exp_f32 v245, v37
 v_mfma_f32_16x16x32_bf16 a[24:27], a[232:235], v[192:195], a[24:27]
 ds_read_b128 a[196:199], v1 offset:34816
 v_cvt_pk_bf16_f32 v154, v244, v245
 v_mfma_f32_16x16x32_bf16 a[24:27], a[236:239], v[200:203], a[24:27]
 v_exp_f32 v246, v38
 v_mfma_f32_16x16x32_bf16 a[56:59], a[236:239], v[204:207], a[56:59]
 ds_read_b128 a[200:203], v1 offset:36864
 v_mfma_f32_16x16x32_bf16 a[56:59], a[232:235], v[196:199], a[56:59]
 v_exp_f32 v247, v39
 v_mfma_f32_16x16x32_bf16 a[56:59], a[228:231], v[188:191], a[56:59]
 ds_read_b128 a[204:207], v1 offset:38912
 v_cvt_pk_bf16_f32 v155, v246, v247
 v_mfma_f32_16x16x32_bf16 a[56:59], a[224:227], v[180:183], a[56:59]
 s_waitcnt lgkmcnt(4)
 v_exp_f32 v240, v40
 v_mfma_f32_16x16x32_bf16 a[28:31], a[240:243], v[176:179], a[28:31]
 ds_read_b128 a[208:211], v1 offset:33792
 v_exp_f32 v241, v41
 v_mfma_f32_16x16x32_bf16 a[28:31], a[244:247], v[184:187], a[28:31]
 v_exp_f32 v242, v42
 v_mfma_f32_16x16x32_bf16 a[28:31], a[248:251], v[192:195], a[28:31]
 ds_read_b128 a[212:215], v1 offset:35840
 v_cvt_pk_bf16_f32 v156, v240, v241
 v_mfma_f32_16x16x32_bf16 a[28:31], a[252:255], v[200:203], a[28:31]
 v_exp_f32 v243, v43
 v_mfma_f32_16x16x32_bf16 v[224:227], v[252:255], v[152:155], v[224:227]
 ds_read_b128 a[216:219], v1 offset:37888
 v_cvt_pk_bf16_f32 v157, v242, v243
 v_mfma_f32_16x16x32_bf16 a[60:63], a[252:255], v[204:207], a[60:63]
 v_exp_f32 v244, v44
 v_mfma_f32_16x16x32_bf16 a[60:63], a[248:251], v[196:199], a[60:63]
 ds_read_b128 a[220:223], v1 offset:39936
 v_mfma_f32_16x16x32_bf16 a[60:63], a[244:247], v[188:191], a[60:63]
 v_exp_f32 v245, v45
 v_mfma_f32_16x16x32_bf16 a[60:63], a[240:243], v[180:183], a[60:63]
 s_waitcnt lgkmcnt(4)
 v_exp_f32 v246, v46
 v_mfma_f32_16x16x32_bf16 v[80:83], a[192:195], a[128:131], v[208:211]
 ds_read_b128 a[224:227], v1 offset:40960
 v_cvt_pk_bf16_f32 v158, v244, v245
 v_mfma_f32_16x16x32_bf16 v[80:83], a[196:199], a[132:135], v[80:83]
 v_exp_f32 v247, v47
 v_mfma_f32_16x16x32_bf16 v[80:83], a[200:203], a[136:139], v[80:83]
 ds_read_b128 a[228:231], v1 offset:43008
 v_cvt_pk_bf16_f32 v159, v246, v247
 v_mfma_f32_16x16x32_bf16 v[80:83], a[204:207], a[140:143], v[80:83]
 v_exp_f32 v240, v48
 v_mfma_f32_16x16x32_bf16 v[88:91], a[204:207], a[156:159], v[212:215]
 ds_read_b128 a[232:235], v1 offset:45056
 v_exp_f32 v241, v49
 v_mfma_f32_16x16x32_bf16 v[88:91], a[200:203], a[152:155], v[88:91]
 v_exp_f32 v242, v50
 v_mfma_f32_16x16x32_bf16 v[88:91], a[196:199], a[148:151], v[88:91]
 ds_read_b128 a[236:239], v1 offset:47104
 v_cvt_pk_bf16_f32 v160, v240, v241
 v_mfma_f32_16x16x32_bf16 v[88:91], a[192:195], a[144:147], v[88:91]
 v_exp_f32 v243, v51
 v_mfma_f32_16x16x32_bf16 v[228:231], v[252:255], v[156:159], v[228:231]
 s_waitcnt lgkmcnt(4)
 v_exp_f32 v244, v52
 v_mfma_f32_16x16x32_bf16 v[84:87], a[208:211], a[128:131], v[208:211]
 ds_read_b128 a[240:243], v1 offset:41984
 v_cvt_pk_bf16_f32 v161, v242, v243
 v_mfma_f32_16x16x32_bf16 v[84:87], a[212:215], a[132:135], v[84:87]
 v_exp_f32 v245, v53
 v_mfma_f32_16x16x32_bf16 v[84:87], a[216:219], a[136:139], v[84:87]
 ds_read_b128 a[244:247], v1 offset:44032
 v_cvt_pk_bf16_f32 v162, v244, v245
 v_mfma_f32_16x16x32_bf16 v[84:87], a[220:223], a[140:143], v[84:87]
 v_exp_f32 v246, v54
 v_mfma_f32_16x16x32_bf16 v[92:95], a[220:223], a[156:159], v[212:215]
 ds_read_b128 a[248:251], v1 offset:46080
 v_mfma_f32_16x16x32_bf16 v[92:95], a[216:219], a[152:155], v[92:95]
 v_exp_f32 v247, v55
 v_mfma_f32_16x16x32_bf16 v[92:95], a[212:215], a[148:151], v[92:95]
 ds_read_b128 a[252:255], v1 offset:48128
 v_cvt_pk_bf16_f32 v163, v246, v247
 v_mfma_f32_16x16x32_bf16 v[92:95], a[208:211], a[144:147], v[92:95]
 s_waitcnt lgkmcnt(4)
 v_exp_f32 v240, v56
 v_mfma_f32_16x16x32_bf16 v[96:99], a[224:227], a[128:131], v[208:211]
 ds_read_b128 a[192:195], v1 offset:49152
 v_exp_f32 v241, v57
 v_mfma_f32_16x16x32_bf16 v[96:99], a[228:231], a[132:135], v[96:99]
 v_exp_f32 v242, v58
 v_mfma_f32_16x16x32_bf16 v[96:99], a[232:235], a[136:139], v[96:99]
 ds_read_b128 a[196:199], v1 offset:51200
 v_cvt_pk_bf16_f32 v164, v240, v241
 v_mfma_f32_16x16x32_bf16 v[96:99], a[236:239], a[140:143], v[96:99]
 v_exp_f32 v243, v59
 v_mfma_f32_16x16x32_bf16 v[224:227], v[252:255], v[160:163], v[224:227]
 ds_read_b128 a[200:203], v1 offset:53248
 v_cvt_pk_bf16_f32 v165, v242, v243
 v_mfma_f32_16x16x32_bf16 v[104:107], a[236:239], a[156:159], v[212:215]
 v_exp_f32 v244, v60
 v_mfma_f32_16x16x32_bf16 v[104:107], a[232:235], a[152:155], v[104:107]
 ds_read_b128 a[204:207], v1 offset:55296
 v_mfma_f32_16x16x32_bf16 v[104:107], a[228:231], a[148:151], v[104:107]
 v_exp_f32 v245, v61
 v_mfma_f32_16x16x32_bf16 v[104:107], a[224:227], a[144:147], v[104:107]
 s_waitcnt lgkmcnt(4)
 v_exp_f32 v246, v62
 v_mfma_f32_16x16x32_bf16 v[100:103], a[240:243], a[128:131], v[208:211]
 ds_read_b128 a[208:211], v1 offset:50176
 v_cvt_pk_bf16_f32 v166, v244, v245
 v_mfma_f32_16x16x32_bf16 v[100:103], a[244:247], a[132:135], v[100:103]
 v_exp_f32 v247, v63
 v_mfma_f32_16x16x32_bf16 v[100:103], a[248:251], a[136:139], v[100:103]
 ds_read_b128 a[212:215], v1 offset:52224
 v_cvt_pk_bf16_f32 v167, v246, v247
 v_mfma_f32_16x16x32_bf16 v[100:103], a[252:255], a[140:143], v[100:103]
 v_exp_f32 v240, v64
 v_mfma_f32_16x16x32_bf16 v[108:111], a[252:255], a[156:159], v[212:215]
 ds_read_b128 a[216:219], v1 offset:54272
 v_exp_f32 v241, v65
 v_mfma_f32_16x16x32_bf16 v[108:111], a[248:251], a[152:155], v[108:111]
 v_exp_f32 v242, v66
 v_mfma_f32_16x16x32_bf16 v[108:111], a[244:247], a[148:151], v[108:111]
 ds_read_b128 a[220:223], v1 offset:56320
 v_cvt_pk_bf16_f32 v168, v240, v241
 v_mfma_f32_16x16x32_bf16 v[108:111], a[240:243], a[144:147], v[108:111]
 v_exp_f32 v243, v67
 v_mfma_f32_16x16x32_bf16 v[228:231], v[252:255], v[164:167], v[228:231]
 s_waitcnt lgkmcnt(4)
 v_exp_f32 v244, v68
 v_mfma_f32_16x16x32_bf16 v[112:115], a[192:195], a[128:131], v[208:211]
 ds_read_b128 a[224:227], v1 offset:57344
 v_cvt_pk_bf16_f32 v169, v242, v243
 v_mfma_f32_16x16x32_bf16 v[112:115], a[196:199], a[132:135], v[112:115]
 v_exp_f32 v245, v69
 v_mfma_f32_16x16x32_bf16 v[112:115], a[200:203], a[136:139], v[112:115]
 ds_read_b128 a[228:231], v1 offset:59392
 v_cvt_pk_bf16_f32 v170, v244, v245
 v_mfma_f32_16x16x32_bf16 v[112:115], a[204:207], a[140:143], v[112:115]
 v_exp_f32 v246, v70
 v_mfma_f32_16x16x32_bf16 v[120:123], a[204:207], a[156:159], v[212:215]
 ds_read_b128 a[232:235], v1 offset:61440
 v_mfma_f32_16x16x32_bf16 v[120:123], a[200:203], a[152:155], v[120:123]
 v_exp_f32 v247, v71
 v_mfma_f32_16x16x32_bf16 v[120:123], a[196:199], a[148:151], v[120:123]
 ds_read_b128 a[236:239], v1 offset:63488
 v_cvt_pk_bf16_f32 v171, v246, v247
 v_mfma_f32_16x16x32_bf16 v[120:123], a[192:195], a[144:147], v[120:123]
 s_waitcnt lgkmcnt(4)
 v_exp_f32 v240, v72
 v_mfma_f32_16x16x32_bf16 v[116:119], a[208:211], a[128:131], v[208:211]
 ds_read_b128 a[240:243], v1 offset:58368
 v_mfma_f32_16x16x32_bf16 v[116:119], a[212:215], a[132:135], v[116:119]
 v_exp_f32 v241, v73
 v_mfma_f32_16x16x32_bf16 v[116:119], a[216:219], a[136:139], v[116:119]
 ds_read_b128 a[244:247], v1 offset:60416
 v_cvt_pk_bf16_f32 v172, v240, v241
 v_mfma_f32_16x16x32_bf16 v[116:119], a[220:223], a[140:143], v[116:119]
 v_exp_f32 v242, v74
 v_mfma_f32_16x16x32_bf16 v[224:227], v[252:255], v[168:171], v[224:227]
 ds_read_b128 a[248:251], v1 offset:62464
 v_mfma_f32_16x16x32_bf16 v[124:127], a[220:223], a[156:159], v[212:215]
 v_exp_f32 v243, v75
 v_mfma_f32_16x16x32_bf16 v[124:127], a[216:219], a[152:155], v[124:127]
 ds_read_b128 a[252:255], v1 offset:64512
 v_cvt_pk_bf16_f32 v173, v242, v243
 v_mfma_f32_16x16x32_bf16 v[124:127], a[212:215], a[148:151], v[124:127]
 v_exp_f32 v244, v76
 v_mfma_f32_16x16x32_bf16 v[124:127], a[208:211], a[144:147], v[124:127]
 s_waitcnt lgkmcnt(4)
 v_exp_f32 v245, v77
 v_mfma_f32_16x16x32_bf16 v[128:131], a[224:227], a[128:131], v[208:211]
 v_exp_f32 v246, v78
 v_mfma_f32_16x16x32_bf16 v[128:131], a[228:231], a[132:135], v[128:131]
 v_exp_f32 v247, v79
 v_mfma_f32_16x16x32_bf16 v[128:131], a[232:235], a[136:139], v[128:131]
 v_cvt_pk_bf16_f32 v174, v244, v245
 v_cvt_pk_bf16_f32 v175, v246, v247
 v_mfma_f32_16x16x32_bf16 v[128:131], a[236:239], a[140:143], v[128:131]
 s_waitcnt vmcnt(0) lgkmcnt(0)
 s_barrier
 v_mfma_f32_16x16x32_bf16 v[136:139], a[236:239], a[156:159], v[212:215]
 ds_read_b128 a[192:195], v2 offset:0
 v_mfma_f32_16x16x32_bf16 v[136:139], a[232:235], a[152:155], v[136:139]
 ds_read_b128 a[196:199], v2 offset:8192
 v_mfma_f32_16x16x32_bf16 v[136:139], a[228:231], a[148:151], v[136:139]
 v_mfma_f32_16x16x32_bf16 v[136:139], a[224:227], a[144:147], v[136:139]
 ds_read_b128 a[200:203], v2 offset:16384
 v_mfma_f32_16x16x32_bf16 v[228:231], v[252:255], v[172:175], v[228:231]
 ds_read_b128 a[204:207], v2 offset:24576
 v_mfma_f32_16x16x32_bf16 v[132:135], a[240:243], a[128:131], v[208:211]
 s_sub_u32 s32, s32, 1
 v_mfma_f32_16x16x32_bf16 v[132:135], a[244:247], a[132:135], v[132:135]
 ds_read_b128 a[208:211], v2 offset:1024
 v_mfma_f32_16x16x32_bf16 v[132:135], a[248:251], a[136:139], v[132:135]
 ds_read_b128 a[212:215], v2 offset:9216
 v_mfma_f32_16x16x32_bf16 v[132:135], a[252:255], a[140:143], v[132:135]
 v_mfma_f32_16x16x32_bf16 v[140:143], a[252:255], a[156:159], v[212:215]
 ds_read_b128 a[216:219], v2 offset:17408
 v_max_f32 v10, v224, v228
 v_mfma_f32_16x16x32_bf16 v[140:143], a[248:251], a[152:155], v[140:143]
 ds_read_b128 a[220:223], v2 offset:25600
 v_cmp_lt_f32 vcc, s54, v10
 v_mfma_f32_16x16x32_bf16 v[140:143], a[244:247], a[148:151], v[140:143]
 v_mfma_f32_16x16x32_bf16 v[140:143], a[240:243], a[144:147], v[140:143]
 s_cbranch_vccnz L_jr_69
L_back_68:
 s_cmp_lg_u32 s32, 0
 s_cbranch_scc1 L_L2_33
L_S15_34:
 s_add_u32 s48, s49, 32768
 s_waitcnt lgkmcnt(4)
 v_mfma_f32_16x16x32_bf16 a[0:3], a[192:195], v[144:147], a[0:3]
 ds_read_b128 a[224:227], v2 offset:2048
 v_add_f32 v4, v4, v224
 v_mfma_f32_16x16x32_bf16 a[0:3], a[196:199], v[152:155], a[0:3]
 v_and_b32 v12, 15, v0
 v_lshlrev_b32 v12, 2, v12
 v_mfma_f32_16x16x32_bf16 a[0:3], a[200:203], v[160:163], a[0:3]
 ds_read_b128 a[228:231], v2 offset:10240
 s_lshl_b32 s22, s92, 6
 v_exp_f32 v240, v80
 v_mfma_f32_16x16x32_bf16 a[0:3], a[204:207], v[168:171], a[0:3]
 s_add_u32 s22, s22, s66
 v_exp_f32 v241, v81
 v_mfma_f32_16x16x32_bf16 a[32:35], a[204:207], v[172:175], a[32:35]
 ds_read_b128 a[232:235], v2 offset:18432
 v_add_f32 v5, v5, v228
 v_exp_f32 v242, v82
 v_mfma_f32_16x16x32_bf16 a[32:35], a[200:203], v[164:167], a[32:35]
 buffer_load_dword v8, v12, s[16:19], s22 offen offset:0 sc1
 v_cvt_pk_bf16_f32 v176, v240, v241
 v_mfma_f32_16x16x32_bf16 a[32:35], a[196:199], v[156:159], a[32:35]
 ds_read_b128 a[236:239], v2 offset:26624
 s_lshl_b32 s22, s67, 6
 v_mfma_f32_16x16x32_bf16 a[32:35], a[192:195], v[148:151], a[32:35]
 s_waitcnt lgkmcnt(4)
 s_add_u32 s22, s22, s66
 v_exp_f32 v243, v83
 v_mfma_f32_16x16x32_bf16 a[4:7], a[208:211], v[144:147], a[4:7]
 ds_read_b128 a[240:243], v2 offset:3072
 v_exp_f32 v244, v84
 v_mfma_f32_16x16x32_bf16 a[4:7], a[212:215], v[152:155], a[4:7]
 buffer_load_dword v9, v12, s[16:19], s22 offen offset:0 sc1
 v_cvt_pk_bf16_f32 v177, v242, v243
 v_mfma_f32_16x16x32_bf16 a[4:7], a[216:219], v[160:163], a[4:7]
 ds_read_b128 a[244:247], v2 offset:11264
 s_lshl_b32 s22, s93, 6
 v_exp_f32 v245, v85
 v_mfma_f32_16x16x32_bf16 a[4:7], a[220:223], v[168:171], a[4:7]
 s_add_u32 s22, s22, s66
 v_exp_f32 v246, v86
 v_cvt_pk_bf16_f32 v178, v244, v245
 v_mfma_f32_16x16x32_bf16 a[36:39], a[220:223], v[172:175], a[36:39]
 ds_read_b128 a[248:251], v2 offset:19456
 v_exp_f32 v247, v87
 v_mfma_f32_16x16x32_bf16 a[36:39], a[216:219], v[164:167], a[36:39]
 buffer_load_dword v14, v12, s[16:19], s22 offen offset:0 sc1
 v_cvt_pk_bf16_f32 v179, v246, v247
 v_mfma_f32_16x16x32_bf16 a[36:39], a[212:215], v[156:159], a[36:39]
 ds_read_b128 a[252:255], v2 offset:27648
 s_lshl_b32 s22, s45, 6
 s_mov_b32 s8, s52
 v_mfma_f32_16x16x32_bf16 a[36:39], a[208:211], v[148:151], a[36:39]
 s_waitcnt lgkmcnt(4)
 s_add_u32 s22, s22, s66
 v_exp_f32 v240, v88
 v_mfma_f32_16x16x32_bf16 a[8:11], a[224:227], v[144:147], a[8:11]
 ds_read_b128 a[192:195], v2 offset:4096
 v_exp_f32 v241, v89
 s_mov_b32 s9, s53
 v_mfma_f32_16x16x32_bf16 a[8:11], a[228:231], v[152:155], a[8:11]
 buffer_load_dword v15, v12, s[16:19], s22 offen offset:0 sc1
 v_cvt_pk_bf16_f32 v180, v240, v241
 v_mfma_f32_16x16x32_bf16 a[8:11], a[232:235], v[160:163], a[8:11]
 ds_read_b128 a[196:199], v2 offset:12288
 s_add_u32 m0, s51, 98304
 s_mov_b32 s10, 0x400000
 v_mfma_f32_16x16x32_bf16 a[8:11], a[236:239], v[168:171], a[8:11]
 s_add_u32 s34, s49, s51
 v_exp_f32 v242, v90
 v_mfma_f32_16x16x32_bf16 v[224:227], v[252:255], v[176:179], 0
 ds_read_b128 a[200:203], v2 offset:20480
 v_exp_f32 v243, v91
 s_mov_b32 s12, s58
 v_mfma_f32_16x16x32_bf16 a[40:43], a[236:239], v[172:175], a[40:43]
 buffer_load_dwordx4 v1, s[16:19], s34 offen offset:0 sc1 lds
 v_cvt_pk_bf16_f32 v181, v242, v243
 v_mfma_f32_16x16x32_bf16 a[40:43], a[232:235], v[164:167], a[40:43]
 ds_read_b128 a[204:207], v2 offset:28672
 v_exp_f32 v244, v92
 s_mov_b32 s13, s59
 v_mfma_f32_16x16x32_bf16 a[40:43], a[228:231], v[156:159], a[40:43]
 buffer_load_dwordx4 v1, s[16:19], s34 offen offset:1024 sc1 lds
 v_mfma_f32_16x16x32_bf16 a[40:43], a[224:227], v[148:151], a[40:43]
 s_waitcnt lgkmcnt(4)
 v_exp_f32 v245, v93
 s_mov_b32 s14, 0x80000
 v_mfma_f32_16x16x32_bf16 a[12:15], a[240:243], v[144:147], a[12:15]
 ds_read_b128 a[208:211], v2 offset:5120
 v_exp_f32 v246, v94
 v_mfma_f32_16x16x32_bf16 a[12:15], a[244:247], v[152:155], a[12:15]
 buffer_load_dwordx4 v1, s[16:19], s34 offen offset:2048 sc1 lds
 v_cvt_pk_bf16_f32 v182, v244, v245
 v_mfma_f32_16x16x32_bf16 a[12:15], a[248:251], v[160:163], a[12:15]
 ds_read_b128 a[212:215], v2 offset:13312
 v_exp_f32 v247, v95
 s_lshr_b32 s24, s20, 3
 v_mfma_f32_16x16x32_bf16 a[12:15], a[252:255], v[168:171], a[12:15]
 buffer_load_dwordx4 v1, s[16:19], s34 offen offset:3072 sc1 lds
 v_cvt_pk_bf16_f32 v183, v246, v247
 v_mfma_f32_16x16x32_bf16 a[44:47], a[252:255], v[172:175], a[44:47]
 ds_read_b128 a[216:219], v2 offset:21504
 s_add_u32 m0, s51, 102400
 s_lshl_b32 s25, s24, 20
 v_mfma_f32_16x16x32_bf16 a[44:47], a[248:251], v[164:167], a[44:47]
 s_add_u32 s34, s34, 4096
 v_exp_f32 v240, v96
 v_mfma_f32_16x16x32_bf16 a[44:47], a[244:247], v[156:159], a[44:47]
 ds_read_b128 a[220:223], v2 offset:29696
 v_exp_f32 v241, v97
 s_and_b32 s23, s20, 3
 v_mfma_f32_16x16x32_bf16 a[44:47], a[240:243], v[148:151], a[44:47]
 buffer_load_dwordx4 v1, s[16:19], s34 offen offset:0 sc1 lds
 v_cvt_pk_bf16_f32 v184, v240, v241
 v_mfma_f32_16x16x32_bf16 v[228:231], v[252:255], v[180:183], 0
 s_waitcnt lgkmcnt(4)
 v_exp_f32 v242, v98
 s_lshl_b32 s23, s23, 8
 v_mfma_f32_16x16x32_bf16 a[16:19], a[192:195], v[144:147], a[16:19]
 ds_read_b128 a[224:227], v2 offset:6144
 buffer_load_dwordx4 v1, s[16:19], s34 offen offset:1024 sc1 lds
 v_mfma_f32_16x16x32_bf16 a[16:19], a[196:199], v[152:155], a[16:19]
 buffer_load_dwordx4 v1, s[16:19], s34 offen offset:2048 sc1 lds
 s_add_u32 s25, s25, s23
 v_mfma_f32_16x16x32_bf16 a[16:19], a[200:203], v[160:163], a[16:19]
 ds_read_b128 a[228:231], v2 offset:14336
 v_exp_f32 v243, v99
 v_mfma_f32_16x16x32_bf16 a[16:19], a[204:207], v[168:171], a[16:19]
 buffer_load_dwordx4 v1, s[16:19], s34 offen offset:3072 sc1 lds
 v_exp_f32 v244, v100
 s_lshl_b32 s23, s3, 14
 v_mfma_f32_16x16x32_bf16 a[48:51], a[204:207], v[172:175], a[48:51]
 ds_read_b128 a[232:235], v2 offset:22528
 s_add_u32 s49, s49, 32768
 v_cvt_pk_bf16_f32 v185, v242, v243
 v_mfma_f32_16x16x32_bf16 a[48:51], a[200:203], v[164:167], a[48:51]
 s_add_u32 m0, s51, 32768
 s_add_u32 s34, s48, s51
 v_exp_f32 v245, v101
 s_add_u32 s25, s25, s23
 v_mfma_f32_16x16x32_bf16 a[48:51], a[196:199], v[156:159], a[48:51]
 ds_read_b128 a[236:239], v2 offset:30720
 v_exp_f32 v246, v102
 v_mfma_f32_16x16x32_bf16 a[48:51], a[192:195], v[148:151], a[48:51]
 s_waitcnt lgkmcnt(4)
 v_exp_f32 v247, v103
 v_cvt_pk_bf16_f32 v186, v244, v245
 s_and_b32 s32, s20, 7
 v_mfma_f32_16x16x32_bf16 a[20:23], a[208:211], v[144:147], a[20:23]
 ds_read_b128 a[240:243], v2 offset:7168
 buffer_load_dwordx4 v1, s[16:19], s34 offen offset:0 sc1 lds
 v_mfma_f32_16x16x32_bf16 a[20:23], a[212:215], v[152:155], a[20:23]
 buffer_load_dwordx4 v1, s[16:19], s34 offen offset:1024 sc1 lds
 v_cvt_pk_bf16_f32 v187, v246, v247
 s_mov_b32 s35, s32
 v_mfma_f32_16x16x32_bf16 a[20:23], a[216:219], v[160:163], a[20:23]
 ds_read_b128 a[244:247], v2 offset:15360
 v_exp_f32 v240, v104
 v_mfma_f32_16x16x32_bf16 a[20:23], a[220:223], v[168:171], a[20:23]
 buffer_load_dwordx4 v1, s[16:19], s34 offen offset:2048 sc1 lds
 v_exp_f32 v241, v105
 s_lshl_b32 s23, s60, 2
 v_mfma_f32_16x16x32_bf16 v[224:227], v[252:255], v[184:187], v[224:227]
 ds_read_b128 a[248:251], v2 offset:23552
 v_exp_f32 v242, v106
 v_mfma_f32_16x16x32_bf16 a[52:55], a[220:223], v[172:175], a[52:55]
 buffer_load_dwordx4 v1, s[16:19], s34 offen offset:3072 sc1 lds
 v_exp_f32 v243, v107
 s_add_u32 s23, s23, s3
 v_mfma_f32_16x16x32_bf16 a[52:55], a[216:219], v[164:167], a[52:55]
 ds_read_b128 a[252:255], v2 offset:31744
 s_add_u32 m0, s51, 36864
 v_cvt_pk_bf16_f32 v188, v240, v241
 v_mfma_f32_16x16x32_bf16 a[52:55], a[212:215], v[156:159], a[52:55]
 s_add_u32 s34, s34, 4096
 v_exp_f32 v244, v108
 v_cvt_pk_bf16_f32 v189, v242, v243
 s_mul_i32 s98, s23, 294912
 s_lshl_b32 s24, s24, 16
 s_add_u32 s98, s98, s24
 s_add_u32 s98, s98, 0x3800000
 s_lshl_b32 s23, s20, 13
 s_add_u32 s23, s23, 0x3800000
 v_mfma_f32_16x16x32_bf16 a[52:55], a[208:211], v[148:151], a[52:55]
 s_waitcnt lgkmcnt(4)
 v_exp_f32 v245, v109
 v_mfma_f32_16x16x32_bf16 a[24:27], a[224:227], v[144:147], a[24:27]
 ds_read_b128 a[192:195], v1 offset:0
 buffer_load_dwordx4 v1, s[16:19], s34 offen offset:0 sc1 lds
 v_mfma_f32_16x16x32_bf16 a[24:27], a[228:231], v[152:155], a[24:27]
 buffer_load_dwordx4 v1, s[16:19], s34 offen offset:1024 sc1 lds
 v_cvt_pk_bf16_f32 v190, v244, v245
 v_mfma_f32_16x16x32_bf16 a[24:27], a[232:235], v[160:163], a[24:27]
 ds_read_b128 a[196:199], v1 offset:2048
 buffer_load_dwordx4 v1, s[16:19], s34 offen offset:2048 sc1 lds
 buffer_load_dwordx4 v1, s[16:19], s34 offen offset:3072 sc1 lds
 s_add_u32 s48, s48, 32768
 v_mfma_f32_16x16x32_bf16 a[24:27], a[236:239], v[168:171], a[24:27]
 s_and_b32 s24, s92, 1
 v_exp_f32 v246, v110
 v_mfma_f32_16x16x32_bf16 a[56:59], a[236:239], v[172:175], a[56:59]
 ds_read_b128 a[200:203], v1 offset:4096
 v_exp_f32 v247, v111
 v_mfma_f32_16x16x32_bf16 a[56:59], a[232:235], v[164:167], a[56:59]
 s_lshl_b32 s24, s24, 10
 v_exp_f32 v240, v112
 v_cvt_pk_bf16_f32 v191, v246, v247
 v_mfma_f32_16x16x32_bf16 a[56:59], a[228:231], v[156:159], a[56:59]
 ds_read_b128 a[204:207], v1 offset:6144
 v_exp_f32 v241, v113
 v_mfma_f32_16x16x32_bf16 a[56:59], a[224:227], v[148:151], a[56:59]
 s_lshr_b32 s92, s92, 1
 v_exp_f32 v242, v114
 v_mfma_f32_16x16x32_bf16 v[228:231], v[252:255], v[188:191], v[228:231]
 s_waitcnt lgkmcnt(4)
 v_exp_f32 v243, v115
 v_mfma_f32_16x16x32_bf16 a[28:31], a[240:243], v[144:147], a[28:31]
 ds_read_b128 a[208:211], v1 offset:1024
 v_exp_f32 v244, v116
 v_mfma_f32_16x16x32_bf16 a[28:31], a[244:247], v[152:155], a[28:31]
 s_mul_i32 s92, s92, 294912
 v_exp_f32 v245, v117
 v_mfma_f32_16x16x32_bf16 a[28:31], a[248:251], v[160:163], a[28:31]
 ds_read_b128 a[212:215], v1 offset:3072
 v_cvt_pk_bf16_f32 v192, v240, v241
 v_mfma_f32_16x16x32_bf16 a[28:31], a[252:255], v[168:171], a[28:31]
 s_add_u32 s92, s92, s24
 v_exp_f32 v246, v118
 v_mfma_f32_16x16x32_bf16 a[60:63], a[252:255], v[172:175], a[60:63]
 ds_read_b128 a[216:219], v1 offset:5120
 v_cvt_pk_bf16_f32 v193, v242, v243
 v_mfma_f32_16x16x32_bf16 a[60:63], a[248:251], v[164:167], a[60:63]
 s_add_u32 s92, s92, s23
 v_exp_f32 v247, v119
 v_mfma_f32_16x16x32_bf16 a[60:63], a[244:247], v[156:159], a[60:63]
 ds_read_b128 a[220:223], v1 offset:7168
 v_cvt_pk_bf16_f32 v194, v244, v245
 v_mfma_f32_16x16x32_bf16 a[60:63], a[240:243], v[148:151], a[60:63]
 s_waitcnt lgkmcnt(4)
 v_exp_f32 v240, v120
 v_mfma_f32_16x16x32_bf16 v[16:19], a[192:195], a[128:131], v[208:211]
 ds_read_b128 a[224:227], v1 offset:8192
 v_cvt_pk_bf16_f32 v195, v246, v247
 v_mfma_f32_16x16x32_bf16 v[16:19], a[196:199], a[132:135], v[16:19]
 s_and_b32 s24, s67, 1
 v_exp_f32 v241, v121
 v_mfma_f32_16x16x32_bf16 v[16:19], a[200:203], a[136:139], v[16:19]
 ds_read_b128 a[228:231], v1 offset:10240
 v_cvt_pk_bf16_f32 v196, v240, v241
 v_mfma_f32_16x16x32_bf16 v[16:19], a[204:207], a[140:143], v[16:19]
 s_lshl_b32 s24, s24, 10
 v_exp_f32 v242, v122
 v_mfma_f32_16x16x32_bf16 v[224:227], v[252:255], v[192:195], v[224:227]
 ds_read_b128 a[232:235], v1 offset:12288
 v_exp_f32 v243, v123
 v_mfma_f32_16x16x32_bf16 v[24:27], a[204:207], a[156:159], v[212:215]
 s_lshr_b32 s67, s67, 1
 v_exp_f32 v244, v124
 v_mfma_f32_16x16x32_bf16 v[24:27], a[200:203], a[152:155], v[24:27]
 ds_read_b128 a[236:239], v1 offset:14336
 v_cvt_pk_bf16_f32 v197, v242, v243
 v_mfma_f32_16x16x32_bf16 v[24:27], a[196:199], a[148:151], v[24:27]
 s_mul_i32 s67, s67, 294912
 v_exp_f32 v245, v125
 v_mfma_f32_16x16x32_bf16 v[24:27], a[192:195], a[144:147], v[24:27]
 s_waitcnt lgkmcnt(4)
 v_exp_f32 v246, v126
 v_mfma_f32_16x16x32_bf16 v[20:23], a[208:211], a[128:131], v[208:211]
 ds_read_b128 a[240:243], v1 offset:9216
 v_cvt_pk_bf16_f32 v198, v244, v245
 v_mfma_f32_16x16x32_bf16 v[20:23], a[212:215], a[132:135], v[20:23]
 s_add_u32 s67, s67, s24
 v_exp_f32 v247, v127
 v_mfma_f32_16x16x32_bf16 v[20:23], a[216:219], a[136:139], v[20:23]
 ds_read_b128 a[244:247], v1 offset:11264
 v_cvt_pk_bf16_f32 v199, v246, v247
 v_mfma_f32_16x16x32_bf16 v[20:23], a[220:223], a[140:143], v[20:23]
 s_add_u32 s67, s67, s23
 v_exp_f32 v240, v128
 v_mfma_f32_16x16x32_bf16 v[28:31], a[220:223], a[156:159], v[212:215]
 ds_read_b128 a[248:251], v1 offset:13312
 s_and_b32 s24, s93, 1
 v_mfma_f32_16x16x32_bf16 v[28:31], a[216:219], a[152:155], v[28:31]
 s_lshl_b32 s24, s24, 10
 v_exp_f32 v241, v129
 v_mfma_f32_16x16x32_bf16 v[28:31], a[212:215], a[148:151], v[28:31]
 ds_read_b128 a[252:255], v1 offset:15360
 v_cvt_pk_bf16_f32 v200, v240, v241
 v_mfma_f32_16x16x32_bf16 v[28:31], a[208:211], a[144:147], v[28:31]
 s_lshr_b32 s93, s93, 1
 v_exp_f32 v242, v130
 v_mfma_f32_16x16x32_bf16 v[228:231], v[252:255], v[196:199], v[228:231]
 s_waitcnt lgkmcnt(4)
 v_exp_f32 v243, v131
 v_mfma_f32_16x16x32_bf16 v[32:35], a[224:227], a[128:131], v[208:211]
 ds_read_b128 a[192:195], v1 offset:16384
 v_cvt_pk_bf16_f32 v201, v242, v243
 v_mfma_f32_16x16x32_bf16 v[32:35], a[228:231], a[132:135], v[32:35]
 s_mul_i32 s93, s93, 294912
 v_exp_f32 v244, v132
 v_mfma_f32_16x16x32_bf16 v[32:35], a[232:235], a[136:139], v[32:35]
 ds_read_b128 a[196:199], v1 offset:18432
 v_exp_f32 v245, v133
 v_mfma_f32_16x16x32_bf16 v[32:35], a[236:239], a[140:143], v[32:35]
 s_add_u32 s93, s93, s24
 v_exp_f32 v246, v134
 v_mfma_f32_16x16x32_bf16 v[40:43], a[236:239], a[156:159], v[212:215]
 ds_read_b128 a[200:203], v1 offset:20480
 v_cvt_pk_bf16_f32 v202, v244, v245
 v_mfma_f32_16x16x32_bf16 v[40:43], a[232:235], a[152:155], v[40:43]
 s_add_u32 s93, s93, s23
 v_exp_f32 v247, v135
 v_mfma_f32_16x16x32_bf16 v[40:43], a[228:231], a[148:151], v[40:43]
 ds_read_b128 a[204:207], v1 offset:22528
 v_cvt_pk_bf16_f32 v203, v246, v247
 v_mfma_f32_16x16x32_bf16 v[40:43], a[224:227], a[144:147], v[40:43]
 s_waitcnt lgkmcnt(4)
 v_exp_f32 v240, v136
 v_mfma_f32_16x16x32_bf16 v[36:39], a[240:243], a[128:131], v[208:211]
 ds_read_b128 a[208:211], v1 offset:17408
 v_exp_f32 v241, v137
 v_mfma_f32_16x16x32_bf16 v[36:39], a[244:247], a[132:135], v[36:39]
 s_and_b32 s24, s45, 1
 v_exp_f32 v242, v138
 v_mfma_f32_16x16x32_bf16 v[36:39], a[248:251], a[136:139], v[36:39]
 ds_read_b128 a[212:215], v1 offset:19456
 v_cvt_pk_bf16_f32 v204, v240, v241
 v_mfma_f32_16x16x32_bf16 v[36:39], a[252:255], a[140:143], v[36:39]
 s_lshl_b32 s24, s24, 10
 v_exp_f32 v243, v139
 v_mfma_f32_16x16x32_bf16 v[224:227], v[252:255], v[200:203], v[224:227]
 ds_read_b128 a[216:219], v1 offset:21504
 v_exp_f32 v244, v140
 v_mfma_f32_16x16x32_bf16 v[44:47], a[252:255], a[156:159], v[212:215]
 s_lshr_b32 s45, s45, 1
 v_exp_f32 v245, v141
 v_mfma_f32_16x16x32_bf16 v[44:47], a[248:251], a[152:155], v[44:47]
 ds_read_b128 a[220:223], v1 offset:23552
 v_cvt_pk_bf16_f32 v205, v242, v243
 v_mfma_f32_16x16x32_bf16 v[44:47], a[244:247], a[148:151], v[44:47]
 s_mul_i32 s45, s45, 294912
 v_exp_f32 v246, v142
 v_mfma_f32_16x16x32_bf16 v[44:47], a[240:243], a[144:147], v[44:47]
 s_waitcnt lgkmcnt(4)
 v_exp_f32 v247, v143
 v_mfma_f32_16x16x32_bf16 v[56:59], a[192:195], a[144:147], v[212:215]
 ds_read_b128 a[224:227], v1 offset:24576
 v_cvt_pk_bf16_f32 v206, v244, v245
 v_mfma_f32_16x16x32_bf16 v[56:59], a[196:199], a[148:151], v[56:59]
 ds_read_b128 a[228:231], v1 offset:26624
 v_cvt_pk_bf16_f32 v207, v246, v247
 v_mfma_f32_16x16x32_bf16 v[56:59], a[200:203], a[152:155], v[56:59]
 ds_read_b128 a[232:235], v1 offset:28672
 s_add_u32 s45, s45, s24
 v_mfma_f32_16x16x32_bf16 v[56:59], a[204:207], a[156:159], v[56:59]
 ds_read_b128 a[236:239], v1 offset:30720
 s_waitcnt lgkmcnt(4)
 v_mfma_f32_16x16x32_bf16 v[60:63], a[208:211], a[144:147], v[212:215]
 ds_read_b128 a[240:243], v1 offset:25600
 s_add_u32 s45, s45, s23
 v_mfma_f32_16x16x32_bf16 v[60:63], a[212:215], a[148:151], v[60:63]
 ds_read_b128 a[244:247], v1 offset:27648
 v_mfma_f32_16x16x32_bf16 v[60:63], a[216:219], a[152:155], v[60:63]
 ds_read_b128 a[248:251], v1 offset:29696
 v_mfma_f32_16x16x32_bf16 v[60:63], a[220:223], a[156:159], v[60:63]
 ds_read_b128 a[252:255], v1 offset:31744
 v_mfma_f32_16x16x32_bf16 v[228:231], v[252:255], v[204:207], v[228:231]
 s_waitcnt lgkmcnt(4)
 v_mfma_f32_16x16x32_bf16 v[72:75], a[224:227], a[144:147], v[212:215]
 v_mfma_f32_16x16x32_bf16 v[72:75], a[228:231], a[148:151], v[72:75]
 v_mfma_f32_16x16x32_bf16 v[72:75], a[232:235], a[152:155], v[72:75]
 s_waitcnt vmcnt(0) lgkmcnt(0)
 s_barrier
 v_mfma_f32_16x16x32_bf16 v[72:75], a[236:239], a[156:159], v[72:75]
 ds_read_b128 a[192:195], v2 offset:32768
 ds_read_b128 a[196:199], v2 offset:40960
 v_mfma_f32_16x16x32_bf16 v[76:79], a[240:243], a[144:147], v[212:215]
 ds_read_b128 a[200:203], v2 offset:49152
 ds_read_b128 a[204:207], v2 offset:57344
 v_max_f32 v10, v224, v228
 v_mfma_f32_16x16x32_bf16 v[76:79], a[244:247], a[148:151], v[76:79]
 ds_read_b128 a[208:211], v2 offset:33792
 ds_read_b128 a[212:215], v2 offset:41984
 v_cmp_lt_f32 vcc, s54, v10
 v_mfma_f32_16x16x32_bf16 v[76:79], a[248:251], a[152:155], v[76:79]
 ds_read_b128 a[216:219], v2 offset:50176
 ds_read_b128 a[220:223], v2 offset:58368
 v_mfma_f32_16x16x32_bf16 v[76:79], a[252:255], a[156:159], v[76:79]
 s_cbranch_vccnz L_jr_71
L_back_70:
 v_add_f32 v4, v4, v224
 v_add_f32 v5, v5, v228
 s_branch L_MID_35
L_T1b_31:
 s_add_u32 s48, s49, 16384
 s_waitcnt lgkmcnt(4)
 v_mfma_f32_16x16x32_bf16 a[0:3], a[192:195], v[144:147], a[0:3]
 ds_read_b128 a[224:227], v2 offset:4096
 v_add_f32 v4, v4, v224
 v_mfma_f32_16x16x32_bf16 a[0:3], a[196:199], v[160:163], a[0:3]
 v_and_b32 v12, 15, v0
 v_lshlrev_b32 v12, 2, v12
 v_mfma_f32_16x16x32_bf16 a[32:35], a[196:199], v[164:167], a[32:35]
 s_lshl_b32 s22, s92, 6
 s_add_u32 s22, s22, s66
 v_exp_f32 v240, v80
 v_mfma_f32_16x16x32_bf16 a[32:35], a[192:195], v[148:151], a[32:35]
 buffer_load_dword v8, v12, s[16:19], s22 offen offset:0 sc1
 v_mfma_f32_16x16x32_bf16 a[64:67], a[192:195], v[152:155], a[64:67]
 ds_read_b128 a[228:231], v2 offset:12288
 v_add_f32 v5, v5, v228
 v_mfma_f32_16x16x32_bf16 a[64:67], a[196:199], v[168:171], a[64:67]
 s_lshl_b32 s22, s67, 6
 v_add_f32 v6, v6, v232
 v_exp_f32 v241, v81
 v_mfma_f32_16x16x32_bf16 a[96:99], a[196:199], v[172:175], a[96:99]
 s_add_u32 s22, s22, s66
 v_add_f32 v7, v7, v236
 v_exp_f32 v242, v82
 v_mfma_f32_16x16x32_bf16 a[96:99], a[192:195], v[156:159], a[96:99]
 buffer_load_dword v9, v12, s[16:19], s22 offen offset:0 sc1
 v_mfma_f32_16x16x32_bf16 a[4:7], a[200:203], v[144:147], a[4:7]
 ds_read_b128 a[232:235], v2 offset:5120
 s_lshl_b32 s22, s93, 6
 v_mfma_f32_16x16x32_bf16 a[4:7], a[204:207], v[160:163], a[4:7]
 s_add_u32 s22, s22, s66
 v_exp_f32 v243, v83
 v_mfma_f32_16x16x32_bf16 a[36:39], a[204:207], v[164:167], a[36:39]
 buffer_load_dword v14, v12, s[16:19], s22 offen offset:0 sc1
 v_mfma_f32_16x16x32_bf16 a[36:39], a[200:203], v[148:151], a[36:39]
 s_lshl_b32 s22, s45, 6
 v_exp_f32 v244, v84
 v_mfma_f32_16x16x32_bf16 a[68:71], a[200:203], v[152:155], a[68:71]
 ds_read_b128 a[236:239], v2 offset:13312
 s_add_u32 s22, s22, s66
 v_mfma_f32_16x16x32_bf16 a[68:71], a[204:207], v[168:171], a[68:71]
 buffer_load_dword v15, v12, s[16:19], s22 offen offset:0 sc1
 v_mfma_f32_16x16x32_bf16 a[100:103], a[204:207], v[172:175], a[100:103]
 s_mov_b32 s8, s52
 v_exp_f32 v245, v85
 v_mfma_f32_16x16x32_bf16 a[100:103], a[200:203], v[156:159], a[100:103]
 s_waitcnt lgkmcnt(4)
 s_add_u32 m0, s50, 98304
 s_add_u32 s34, s49, s50
 v_mfma_f32_16x16x32_bf16 a[8:11], a[208:211], v[144:147], a[8:11]
 ds_read_b128 a[240:243], v2 offset:6144
 v_exp_f32 v246, v86
 s_mov_b32 s9, s53
 v_mfma_f32_16x16x32_bf16 a[8:11], a[212:215], v[160:163], a[8:11]
 buffer_load_dwordx4 v1, s[16:19], s34 offen offset:0 sc1 lds
 v_mfma_f32_16x16x32_bf16 a[40:43], a[212:215], v[164:167], a[40:43]
 buffer_load_dwordx4 v1, s[16:19], s34 offen offset:1024 sc1 lds
 s_mov_b32 s10, 0x400000
 v_mfma_f32_16x16x32_bf16 a[40:43], a[208:211], v[148:151], a[40:43]
 s_mov_b32 s12, s58
 v_exp_f32 v247, v87
 v_mfma_f32_16x16x32_bf16 a[72:75], a[208:211], v[152:155], a[72:75]
 ds_read_b128 a[244:247], v2 offset:14336
 v_cvt_pk_bf16_f32 v176, v240, v241
 v_cvt_pk_bf16_f32 v177, v242, v243
 v_mfma_f32_16x16x32_bf16 a[72:75], a[212:215], v[168:171], a[72:75]
 buffer_load_dwordx4 v1, s[16:19], s34 offen offset:2048 sc1 lds
 v_cvt_pk_bf16_f32 v178, v244, v245
 v_mfma_f32_16x16x32_bf16 a[104:107], a[212:215], v[172:175], a[104:107]
 buffer_load_dwordx4 v1, s[16:19], s34 offen offset:3072 sc1 lds
 v_cvt_pk_bf16_f32 v179, v246, v247
 s_mov_b32 s13, s59
 v_mfma_f32_16x16x32_bf16 a[104:107], a[208:211], v[156:159], a[104:107]
 s_mov_b32 s14, 0x80000
 v_exp_f32 v240, v88
 v_mfma_f32_16x16x32_bf16 a[12:15], a[216:219], v[144:147], a[12:15]
 ds_read_b128 a[248:251], v2 offset:7168
 s_add_u32 s49, s49, 16384
 v_mfma_f32_16x16x32_bf16 a[12:15], a[220:223], v[160:163], a[12:15]
 s_add_u32 m0, s51, 32768
 s_add_u32 s34, s48, s51
 s_lshr_b32 s24, s20, 3
 v_mfma_f32_16x16x32_bf16 v[224:227], v[252:255], v[176:179], 0
 buffer_load_dwordx4 v1, s[16:19], s34 offen offset:0 sc1 lds
 v_mfma_f32_16x16x32_bf16 a[44:47], a[220:223], v[164:167], a[44:47]
 s_lshl_b32 s25, s24, 20
 v_exp_f32 v241, v89
 v_mfma_f32_16x16x32_bf16 a[44:47], a[216:219], v[148:151], a[44:47]
 ds_read_b128 a[252:255], v2 offset:15360
 v_cvt_pk_bf16_f32 v180, v240, v241
 v_mfma_f32_16x16x32_bf16 a[76:79], a[216:219], v[152:155], a[76:79]
 buffer_load_dwordx4 v1, s[16:19], s34 offen offset:1024 sc1 lds
 v_mfma_f32_16x16x32_bf16 a[76:79], a[220:223], v[168:171], a[76:79]
 buffer_load_dwordx4 v1, s[16:19], s34 offen offset:2048 sc1 lds
 v_mfma_f32_16x16x32_bf16 a[108:111], a[220:223], v[172:175], a[108:111]
 s_and_b32 s23, s20, 3
 v_exp_f32 v242, v90
 v_mfma_f32_16x16x32_bf16 a[108:111], a[216:219], v[156:159], a[108:111]
 s_waitcnt lgkmcnt(4)
 v_exp_f32 v243, v91
 v_mfma_f32_16x16x32_bf16 a[16:19], a[224:227], v[144:147], a[16:19]
 ds_read_b128 a[192:195], v1 offset:0
 v_exp_f32 v244, v92
 s_lshl_b32 s23, s23, 8
 v_mfma_f32_16x16x32_bf16 a[16:19], a[228:231], v[160:163], a[16:19]
 buffer_load_dwordx4 v1, s[16:19], s34 offen offset:3072 sc1 lds
 v_mfma_f32_16x16x32_bf16 a[48:51], a[228:231], v[164:167], a[48:51]
 s_add_u32 m0, s51, 36864
 s_add_u32 s34, s34, 4096
 v_cvt_pk_bf16_f32 v181, v242, v243
 s_add_u32 s25, s25, s23
 v_mfma_f32_16x16x32_bf16 a[48:51], a[224:227], v[148:151], a[48:51]
 buffer_load_dwordx4 v1, s[16:19], s34 offen offset:0 sc1 lds
 v_mfma_f32_16x16x32_bf16 a[80:83], a[224:227], v[152:155], a[80:83]
 ds_read_b128 a[196:199], v1 offset:2048
 s_lshl_b32 s23, s3, 14
 v_mfma_f32_16x16x32_bf16 a[80:83], a[228:231], v[168:171], a[80:83]
 buffer_load_dwordx4 v1, s[16:19], s34 offen offset:1024 sc1 lds
 v_mfma_f32_16x16x32_bf16 a[112:115], a[228:231], v[172:175], a[112:115]
 buffer_load_dwordx4 v1, s[16:19], s34 offen offset:2048 sc1 lds
 s_add_u32 s25, s25, s23
 v_mfma_f32_16x16x32_bf16 a[112:115], a[224:227], v[156:159], a[112:115]
 s_and_b32 s32, s20, 7
 v_exp_f32 v245, v93
 v_mfma_f32_16x16x32_bf16 a[20:23], a[232:235], v[144:147], a[20:23]
 ds_read_b128 a[200:203], v1 offset:4096
 v_exp_f32 v246, v94
 v_mfma_f32_16x16x32_bf16 a[20:23], a[236:239], v[160:163], a[20:23]
 buffer_load_dwordx4 v1, s[16:19], s34 offen offset:3072 sc1 lds
 v_mfma_f32_16x16x32_bf16 a[52:55], a[236:239], v[164:167], a[52:55]
 s_add_u32 s48, s48, 32768
 v_exp_f32 v247, v95
 s_mov_b32 s35, s32
 v_mfma_f32_16x16x32_bf16 a[52:55], a[232:235], v[148:151], a[52:55]
 s_lshl_b32 s23, s60, 2
 v_cvt_pk_bf16_f32 v182, v244, v245
 v_cvt_pk_bf16_f32 v183, v246, v247
 v_mfma_f32_16x16x32_bf16 a[84:87], a[232:235], v[152:155], a[84:87]
 ds_read_b128 a[204:207], v1 offset:6144
 s_add_u32 s23, s23, s3
 v_mfma_f32_16x16x32_bf16 a[84:87], a[236:239], v[168:171], a[84:87]
 s_mul_i32 s98, s23, 294912
 v_exp_f32 v240, v104
 v_mfma_f32_16x16x32_bf16 v[228:231], v[252:255], v[180:183], 0
 s_lshl_b32 s24, s24, 16
 v_exp_f32 v241, v105
 v_mfma_f32_16x16x32_bf16 a[116:119], a[236:239], v[172:175], a[116:119]
 s_add_u32 s98, s98, s24
 v_cvt_pk_bf16_f32 v188, v240, v241
 s_add_u32 s98, s98, 0x3800000
 v_mfma_f32_16x16x32_bf16 a[116:119], a[232:235], v[156:159], a[116:119]
 s_waitcnt lgkmcnt(4)
 v_exp_f32 v242, v106
 s_lshl_b32 s23, s20, 13
 s_add_u32 s23, s23, 0x3800000
 v_mfma_f32_16x16x32_bf16 a[24:27], a[240:243], v[144:147], a[24:27]
 ds_read_b128 a[208:211], v1 offset:1024
 s_and_b32 s24, s92, 1
 v_mfma_f32_16x16x32_bf16 a[24:27], a[244:247], v[160:163], a[24:27]
 s_lshl_b32 s24, s24, 10
 v_exp_f32 v243, v107
 v_mfma_f32_16x16x32_bf16 a[56:59], a[244:247], v[164:167], a[56:59]
 s_lshr_b32 s92, s92, 1
 v_exp_f32 v244, v108
 v_mfma_f32_16x16x32_bf16 a[56:59], a[240:243], v[148:151], a[56:59]
 s_mul_i32 s92, s92, 294912
 v_exp_f32 v245, v109
 v_mfma_f32_16x16x32_bf16 a[88:91], a[240:243], v[152:155], a[88:91]
 ds_read_b128 a[212:215], v1 offset:3072
 v_cvt_pk_bf16_f32 v189, v242, v243
 v_mfma_f32_16x16x32_bf16 a[88:91], a[244:247], v[168:171], a[88:91]
 s_add_u32 s92, s92, s24
 v_exp_f32 v246, v110
 v_mfma_f32_16x16x32_bf16 a[120:123], a[244:247], v[172:175], a[120:123]
 s_add_u32 s92, s92, s23
 v_cvt_pk_bf16_f32 v190, v244, v245
 v_mfma_f32_16x16x32_bf16 a[120:123], a[240:243], v[156:159], a[120:123]
 v_mfma_f32_16x16x32_bf16 a[28:31], a[248:251], v[144:147], a[28:31]
 ds_read_b128 a[216:219], v1 offset:5120
 s_and_b32 s24, s67, 1
 v_mfma_f32_16x16x32_bf16 a[28:31], a[252:255], v[160:163], a[28:31]
 v_exp_f32 v247, v111
 v_mfma_f32_16x16x32_bf16 a[60:63], a[252:255], v[164:167], a[60:63]
 s_lshl_b32 s24, s24, 10
 v_exp_f32 v240, v112
 v_mfma_f32_16x16x32_bf16 a[60:63], a[248:251], v[148:151], a[60:63]
 v_cvt_pk_bf16_f32 v191, v246, v247
 v_mfma_f32_16x16x32_bf16 a[92:95], a[248:251], v[152:155], a[92:95]
 ds_read_b128 a[220:223], v1 offset:7168
 v_mfma_f32_16x16x32_bf16 a[92:95], a[252:255], v[168:171], a[92:95]
 s_lshr_b32 s67, s67, 1
 v_exp_f32 v241, v113
 v_mfma_f32_16x16x32_bf16 a[124:127], a[252:255], v[172:175], a[124:127]
 v_cvt_pk_bf16_f32 v192, v240, v241
 v_mfma_f32_16x16x32_bf16 a[124:127], a[248:251], v[156:159], a[124:127]
 s_waitcnt lgkmcnt(4)
 v_mfma_f32_16x16x32_bf16 v[16:19], a[192:195], a[128:131], v[208:211]
 ds_read_b128 a[224:227], v1 offset:8192
 s_mul_i32 s67, s67, 294912
 v_mfma_f32_16x16x32_bf16 v[16:19], a[196:199], a[132:135], v[16:19]
 v_exp_f32 v242, v114
 v_mfma_f32_16x16x32_bf16 v[16:19], a[200:203], a[136:139], v[16:19]
 ds_read_b128 a[228:231], v1 offset:10240
 s_add_u32 s67, s67, s24
 v_mfma_f32_16x16x32_bf16 v[16:19], a[204:207], a[140:143], v[16:19]
 v_exp_f32 v243, v115
 v_mfma_f32_16x16x32_bf16 v[236:239], v[252:255], v[188:191], 0
 ds_read_b128 a[232:235], v1 offset:12288
 v_cvt_pk_bf16_f32 v193, v242, v243
 v_mfma_f32_16x16x32_bf16 v[24:27], a[204:207], a[156:159], v[212:215]
 s_add_u32 s67, s67, s23
 v_exp_f32 v244, v116
 v_mfma_f32_16x16x32_bf16 v[24:27], a[200:203], a[152:155], v[24:27]
 ds_read_b128 a[236:239], v1 offset:14336
 v_mfma_f32_16x16x32_bf16 v[24:27], a[196:199], a[148:151], v[24:27]
 v_exp_f32 v245, v117
 v_mfma_f32_16x16x32_bf16 v[24:27], a[192:195], a[144:147], v[24:27]
 s_waitcnt lgkmcnt(4)
 v_exp_f32 v246, v118
 v_mfma_f32_16x16x32_bf16 v[20:23], a[208:211], a[128:131], v[208:211]
 ds_read_b128 a[240:243], v1 offset:9216
 v_cvt_pk_bf16_f32 v194, v244, v245
 v_mfma_f32_16x16x32_bf16 v[20:23], a[212:215], a[132:135], v[20:23]
 s_and_b32 s24, s93, 1
 v_exp_f32 v247, v119
 v_mfma_f32_16x16x32_bf16 v[20:23], a[216:219], a[136:139], v[20:23]
 ds_read_b128 a[244:247], v1 offset:11264
 v_cvt_pk_bf16_f32 v195, v246, v247
 v_mfma_f32_16x16x32_bf16 v[20:23], a[220:223], a[140:143], v[20:23]
 s_lshl_b32 s24, s24, 10
 v_exp_f32 v240, v120
 v_mfma_f32_16x16x32_bf16 v[28:31], a[220:223], a[156:159], v[212:215]
 ds_read_b128 a[248:251], v1 offset:13312
 s_lshr_b32 s93, s93, 1
 v_mfma_f32_16x16x32_bf16 v[28:31], a[216:219], a[152:155], v[28:31]
 v_exp_f32 v241, v121
 v_mfma_f32_16x16x32_bf16 v[28:31], a[212:215], a[148:151], v[28:31]
 ds_read_b128 a[252:255], v1 offset:15360
 v_cvt_pk_bf16_f32 v196, v240, v241
 v_mfma_f32_16x16x32_bf16 v[28:31], a[208:211], a[144:147], v[28:31]
 s_mul_i32 s93, s93, 294912
 v_exp_f32 v242, v122
 v_mfma_f32_16x16x32_bf16 v[224:227], v[252:255], v[192:195], v[224:227]
 s_waitcnt lgkmcnt(4)
 v_exp_f32 v243, v123
 v_mfma_f32_16x16x32_bf16 v[32:35], a[224:227], a[128:131], v[208:211]
 ds_read_b128 a[192:195], v1 offset:16384
 v_exp_f32 v244, v124
 v_mfma_f32_16x16x32_bf16 v[32:35], a[228:231], a[132:135], v[32:35]
 s_add_u32 s93, s93, s24
 v_exp_f32 v245, v125
 v_mfma_f32_16x16x32_bf16 v[32:35], a[232:235], a[136:139], v[32:35]
 ds_read_b128 a[196:199], v1 offset:18432
 v_cvt_pk_bf16_f32 v197, v242, v243
 v_mfma_f32_16x16x32_bf16 v[32:35], a[236:239], a[140:143], v[32:35]
 s_add_u32 s93, s93, s23
 v_exp_f32 v246, v126
 v_mfma_f32_16x16x32_bf16 v[40:43], a[236:239], a[156:159], v[212:215]
 ds_read_b128 a[200:203], v1 offset:20480
 v_cvt_pk_bf16_f32 v198, v244, v245
 v_mfma_f32_16x16x32_bf16 v[40:43], a[232:235], a[152:155], v[40:43]
 v_exp_f32 v247, v127
 v_mfma_f32_16x16x32_bf16 v[40:43], a[228:231], a[148:151], v[40:43]
 ds_read_b128 a[204:207], v1 offset:22528
 v_exp_f32 v240, v136
 v_mfma_f32_16x16x32_bf16 v[40:43], a[224:227], a[144:147], v[40:43]
 s_waitcnt lgkmcnt(4)
 v_exp_f32 v241, v137
 v_mfma_f32_16x16x32_bf16 v[36:39], a[240:243], a[128:131], v[208:211]
 ds_read_b128 a[208:211], v1 offset:17408
 v_cvt_pk_bf16_f32 v199, v246, v247
 v_mfma_f32_16x16x32_bf16 v[36:39], a[244:247], a[132:135], v[36:39]
 s_and_b32 s24, s45, 1
 v_exp_f32 v242, v138
 v_mfma_f32_16x16x32_bf16 v[36:39], a[248:251], a[136:139], v[36:39]
 ds_read_b128 a[212:215], v1 offset:19456
 v_cvt_pk_bf16_f32 v204, v240, v241
 v_mfma_f32_16x16x32_bf16 v[36:39], a[252:255], a[140:143], v[36:39]
 s_lshl_b32 s24, s24, 10
 v_exp_f32 v243, v139
 v_mfma_f32_16x16x32_bf16 v[228:231], v[252:255], v[196:199], v[228:231]
 ds_read_b128 a[216:219], v1 offset:21504
 v_cvt_pk_bf16_f32 v205, v242, v243
 v_mfma_f32_16x16x32_bf16 v[44:47], a[252:255], a[156:159], v[212:215]
 s_lshr_b32 s45, s45, 1
 v_exp_f32 v244, v140
 v_mfma_f32_16x16x32_bf16 v[44:47], a[248:251], a[152:155], v[44:47]
 ds_read_b128 a[220:223], v1 offset:23552
 s_mul_i32 s45, s45, 294912
 v_mfma_f32_16x16x32_bf16 v[44:47], a[244:247], a[148:151], v[44:47]
 v_exp_f32 v245, v141
 v_mfma_f32_16x16x32_bf16 v[44:47], a[240:243], a[144:147], v[44:47]
 s_waitcnt lgkmcnt(4)
 v_exp_f32 v246, v142
 v_mfma_f32_16x16x32_bf16 v[56:59], a[192:195], a[144:147], v[212:215]
 ds_read_b128 a[224:227], v1 offset:24576
 v_cvt_pk_bf16_f32 v206, v244, v245
 v_mfma_f32_16x16x32_bf16 v[56:59], a[196:199], a[148:151], v[56:59]
 ds_read_b128 a[228:231], v1 offset:26624
 v_exp_f32 v247, v143
 v_mfma_f32_16x16x32_bf16 v[56:59], a[200:203], a[152:155], v[56:59]
 ds_read_b128 a[232:235], v1 offset:28672
 v_cvt_pk_bf16_f32 v207, v246, v247
 v_mfma_f32_16x16x32_bf16 v[56:59], a[204:207], a[156:159], v[56:59]
 ds_read_b128 a[236:239], v1 offset:30720
 s_waitcnt lgkmcnt(4)
 v_mfma_f32_16x16x32_bf16 v[60:63], a[208:211], a[144:147], v[212:215]
 ds_read_b128 a[240:243], v1 offset:25600
 s_add_u32 s45, s45, s24
 v_mfma_f32_16x16x32_bf16 v[60:63], a[212:215], a[148:151], v[60:63]
 ds_read_b128 a[244:247], v1 offset:27648
 s_add_u32 s45, s45, s23
 v_mfma_f32_16x16x32_bf16 v[60:63], a[216:219], a[152:155], v[60:63]
 ds_read_b128 a[248:251], v1 offset:29696
 v_mfma_f32_16x16x32_bf16 v[60:63], a[220:223], a[156:159], v[60:63]
 ds_read_b128 a[252:255], v1 offset:31744
 v_mfma_f32_16x16x32_bf16 v[236:239], v[252:255], v[204:207], v[236:239]
 s_waitcnt lgkmcnt(4)
 v_mfma_f32_16x16x32_bf16 v[72:75], a[224:227], a[144:147], v[212:215]
 v_mfma_f32_16x16x32_bf16 v[72:75], a[228:231], a[148:151], v[72:75]
 v_mfma_f32_16x16x32_bf16 v[72:75], a[232:235], a[152:155], v[72:75]
 s_waitcnt vmcnt(0) lgkmcnt(0)
 s_barrier
 v_mfma_f32_16x16x32_bf16 v[72:75], a[236:239], a[156:159], v[72:75]
 ds_read_b128 a[192:195], v2 offset:32768
 ds_read_b128 a[196:199], v2 offset:40960
 v_mfma_f32_16x16x32_bf16 v[76:79], a[240:243], a[144:147], v[212:215]
 ds_read_b128 a[200:203], v2 offset:33792
 ds_read_b128 a[204:207], v2 offset:41984
 v_max3_f32 v10, v224, v228, v236
 v_mfma_f32_16x16x32_bf16 v[76:79], a[244:247], a[148:151], v[76:79]
 ds_read_b128 a[208:211], v2 offset:34816
 ds_read_b128 a[212:215], v2 offset:43008
 v_cmp_lt_f32 vcc, s54, v10
 v_mfma_f32_16x16x32_bf16 v[76:79], a[248:251], a[152:155], v[76:79]
 ds_read_b128 a[216:219], v2 offset:35840
 ds_read_b128 a[220:223], v2 offset:44032
 v_mfma_f32_16x16x32_bf16 v[76:79], a[252:255], a[156:159], v[76:79]
 s_cbranch_vccnz L_jr_73
L_back_72:
 v_add_f32 v4, v4, v224
 v_add_f32 v5, v5, v228
 v_add_f32 v7, v7, v236
L_MID_35:
 buffer_load_dwordx4 a[128:131], v1, s[16:19], s38 offen offset:0 sc1
 buffer_load_dwordx4 a[132:135], v1, s[16:19], s38 offen offset:1024 sc1
 buffer_load_dwordx4 a[136:139], v1, s[16:19], s70 offen offset:0 sc1
 buffer_load_dwordx4 a[140:143], v1, s[16:19], s70 offen offset:1024 sc1
 buffer_load_dwordx4 a[144:147], v1, s[16:19], s39 offen offset:1024 sc1
 buffer_load_dwordx4 a[148:151], v1, s[16:19], s71 offen offset:0 sc1
 buffer_load_dwordx4 a[152:155], v1, s[16:19], s71 offen offset:1024 sc1
 buffer_load_dwordx4 a[156:159], v1, s[16:19], s64 offen offset:0 sc1
 buffer_load_dwordx4 a[160:163], v1, s[16:19], s64 offen offset:1024 sc1
 v_and_b32 v12, 15, v0
 v_lshlrev_b32 v12, 2, v12
 buffer_load_dword a164, v12, s[16:19], s65 offen offset:0 sc1
 buffer_load_dword a165, v12, s[16:19], s65 offen offset:64 sc1
 v_cmp_gt_i32 s[26:27], 0, v3
 v_cmp_gt_i32 s[28:29], 1, v3
 v_cmp_gt_i32 s[30:31], 2, v3
 v_cmp_gt_i32 s[4:5], 3, v3
 s_cmp_eq_u32 s3, 1
 s_cbranch_scc1 L_mk_75
 s_cmp_eq_u32 s3, 2
 s_cbranch_scc1 L_mk_76
 s_cmp_eq_u32 s3, 3
 s_cbranch_scc1 L_mk_77
 v_cndmask_b32 v16, v16, v249, s[26:27]
 v_cndmask_b32 v17, v17, v249, s[28:29]
 v_cndmask_b32 v18, v18, v249, s[30:31]
 v_cndmask_b32 v19, v19, v249, s[4:5]
L_mf_79:
 v_mov_b32 v20, v249
 v_mov_b32 v21, v249
 v_mov_b32 v22, v249
 v_mov_b32 v23, v249
 s_branch L_mf_80
L_mk_75:
 v_cndmask_b32 v20, v20, v249, s[26:27]
 v_cndmask_b32 v21, v21, v249, s[28:29]
 v_cndmask_b32 v22, v22, v249, s[30:31]
 v_cndmask_b32 v23, v23, v249, s[4:5]
L_mf_80:
 v_mov_b32 v32, v249
 v_mov_b32 v33, v249
 v_mov_b32 v34, v249
 v_mov_b32 v35, v249
 s_branch L_mf_81
L_mk_76:
 v_cndmask_b32 v32, v32, v249, s[26:27]
 v_cndmask_b32 v33, v33, v249, s[28:29]
 v_cndmask_b32 v34, v34, v249, s[30:31]
 v_cndmask_b32 v35, v35, v249, s[4:5]
L_mf_81:
 v_mov_b32 v36, v249
 v_mov_b32 v37, v249
 v_mov_b32 v38, v249
 v_mov_b32 v39, v249
 s_branch L_mf_82
L_mk_77:
 v_cndmask_b32 v36, v36, v249, s[26:27]
 v_cndmask_b32 v37, v37, v249, s[28:29]
 v_cndmask_b32 v38, v38, v249, s[30:31]
 v_cndmask_b32 v39, v39, v249, s[4:5]
L_mf_82:
 s_cmp_eq_u32 s56, 1
 s_cbranch_scc1 L_mk_84
 s_cmp_eq_u32 s56, 2
 s_cbranch_scc1 L_mk_85
 s_cmp_eq_u32 s56, 3
 s_cbranch_scc1 L_mk_86
 v_cndmask_b32 v56, v56, v249, s[26:27]
 v_cndmask_b32 v57, v57, v249, s[28:29]
 v_cndmask_b32 v58, v58, v249, s[30:31]
 v_cndmask_b32 v59, v59, v249, s[4:5]
L_mf_88:
 v_mov_b32 v60, v249
 v_mov_b32 v61, v249
 v_mov_b32 v62, v249
 v_mov_b32 v63, v249
 s_branch L_mf_89
L_mk_84:
 v_cndmask_b32 v60, v60, v249, s[26:27]
 v_cndmask_b32 v61, v61, v249, s[28:29]
 v_cndmask_b32 v62, v62, v249, s[30:31]
 v_cndmask_b32 v63, v63, v249, s[4:5]
L_mf_89:
 v_mov_b32 v72, v249
 v_mov_b32 v73, v249
 v_mov_b32 v74, v249
 v_mov_b32 v75, v249
 s_branch L_mf_90
L_mk_85:
 v_cndmask_b32 v72, v72, v249, s[26:27]
 v_cndmask_b32 v73, v73, v249, s[28:29]
 v_cndmask_b32 v74, v74, v249, s[30:31]
 v_cndmask_b32 v75, v75, v249, s[4:5]
L_mf_90:
 v_mov_b32 v76, v249
 v_mov_b32 v77, v249
 v_mov_b32 v78, v249
 v_mov_b32 v79, v249
 s_branch L_mf_91
L_mk_86:
 v_cndmask_b32 v76, v76, v249, s[26:27]
 v_cndmask_b32 v77, v77, v249, s[28:29]
 v_cndmask_b32 v78, v78, v249, s[30:31]
 v_cndmask_b32 v79, v79, v249, s[4:5]
L_mf_91:
 v_lshrrev_b32 v10, 4, v0
 v_and_b32 v11, 15, v0
 v_lshlrev_b32 v12, 2, v10
 v_xor_b32 v11, v11, v12
 v_lshlrev_b32 v11, 4, v11
 v_lshl_add_u32 v232, v10, 10, v11
 v_xor_b32 v11, 16, v232
 v_add_u32 v234, 6144, v232
 v_add_u32 v233, 3072, v11
 v_add_u32 v235, 9216, v11
 s_cmp_eq_u32 s21, 7
 s_cbranch_scc1 L_I7_36
 s_cmp_lg_u32 s21, 0
 s_cbranch_scc1 L_nofin_92
 v_rcp_f32 v6, v6
 v_rcp_f32 v7, v7
 v_sub_f32 v14, 1.0, v14
 v_sub_f32 v15, 1.0, v15
 v_mul_f32 v6, v6, v14
 v_mul_f32 v7, v7, v15
 v_accvgpr_read_b32 v80, a64
 v_accvgpr_read_b32 v81, a65
 v_accvgpr_read_b32 v82, a66
 v_accvgpr_read_b32 v83, a67
 v_accvgpr_read_b32 v84, a68
 v_accvgpr_read_b32 v85, a69
 v_accvgpr_read_b32 v86, a70
 v_accvgpr_read_b32 v87, a71
 v_pk_mul_f32 v[80:81], v[80:81], v[6:7] op_sel:[0,0] op_sel_hi:[1,0]
 v_pk_mul_f32 v[82:83], v[82:83], v[6:7] op_sel:[0,0] op_sel_hi:[1,0]
 v_pk_mul_f32 v[84:85], v[84:85], v[6:7] op_sel:[0,0] op_sel_hi:[1,0]
 v_pk_mul_f32 v[86:87], v[86:87], v[6:7] op_sel:[0,0] op_sel_hi:[1,0]
 v_cvt_pk_bf16_f32 v80, v80, v81
 v_cvt_pk_bf16_f32 v81, v82, v83
 v_cvt_pk_bf16_f32 v82, v84, v85
 v_cvt_pk_bf16_f32 v83, v86, v87
 buffer_store_dwordx4 v[80:83], v1, s[16:19], s93 offen offset:0 sc1
 v_accvgpr_read_b32 v88, a96
 v_accvgpr_read_b32 v89, a97
 v_accvgpr_read_b32 v90, a98
 v_accvgpr_read_b32 v91, a99
 v_accvgpr_read_b32 v92, a100
 v_accvgpr_read_b32 v93, a101
 v_accvgpr_read_b32 v94, a102
 v_accvgpr_read_b32 v95, a103
 v_pk_mul_f32 v[88:89], v[88:89], v[6:7] op_sel:[0,1] op_sel_hi:[1,1]
 v_pk_mul_f32 v[90:91], v[90:91], v[6:7] op_sel:[0,1] op_sel_hi:[1,1]
 v_pk_mul_f32 v[92:93], v[92:93], v[6:7] op_sel:[0,1] op_sel_hi:[1,1]
 v_pk_mul_f32 v[94:95], v[94:95], v[6:7] op_sel:[0,1] op_sel_hi:[1,1]
 v_cvt_pk_bf16_f32 v88, v88, v89
 v_cvt_pk_bf16_f32 v89, v90, v91
 v_cvt_pk_bf16_f32 v90, v92, v93
 v_cvt_pk_bf16_f32 v91, v94, v95
 buffer_store_dwordx4 v[88:91], v1, s[16:19], s45 offen offset:0 sc1
 v_accvgpr_read_b32 v96, a72
 v_accvgpr_read_b32 v97, a73
 v_accvgpr_read_b32 v98, a74
 v_accvgpr_read_b32 v99, a75
 v_accvgpr_read_b32 v100, a76
 v_accvgpr_read_b32 v101, a77
 v_accvgpr_read_b32 v102, a78
 v_accvgpr_read_b32 v103, a79
 v_pk_mul_f32 v[96:97], v[96:97], v[6:7] op_sel:[0,0] op_sel_hi:[1,0]
 v_pk_mul_f32 v[98:99], v[98:99], v[6:7] op_sel:[0,0] op_sel_hi:[1,0]
 v_pk_mul_f32 v[100:101], v[100:101], v[6:7] op_sel:[0,0] op_sel_hi:[1,0]
 v_pk_mul_f32 v[102:103], v[102:103], v[6:7] op_sel:[0,0] op_sel_hi:[1,0]
 v_cvt_pk_bf16_f32 v96, v96, v97
 v_cvt_pk_bf16_f32 v97, v98, v99
 v_cvt_pk_bf16_f32 v98, v100, v101
 v_cvt_pk_bf16_f32 v99, v102, v103
 buffer_store_dwordx4 v[96:99], v1, s[16:19], s93 offen offset:2048 sc1
 v_accvgpr_read_b32 v104, a104
 v_accvgpr_read_b32 v105, a105
 v_accvgpr_read_b32 v106, a106
 v_accvgpr_read_b32 v107, a107
 v_accvgpr_read_b32 v108, a108
 v_accvgpr_read_b32 v109, a109
 v_accvgpr_read_b32 v110, a110
 v_accvgpr_read_b32 v111, a111
 v_pk_mul_f32 v[104:105], v[104:105], v[6:7] op_sel:[0,1] op_sel_hi:[1,1]
 v_pk_mul_f32 v[106:107], v[106:107], v[6:7] op_sel:[0,1] op_sel_hi:[1,1]
 v_pk_mul_f32 v[108:109], v[108:109], v[6:7] op_sel:[0,1] op_sel_hi:[1,1]
 v_pk_mul_f32 v[110:111], v[110:111], v[6:7] op_sel:[0,1] op_sel_hi:[1,1]
 v_cvt_pk_bf16_f32 v104, v104, v105
 v_cvt_pk_bf16_f32 v105, v106, v107
 v_cvt_pk_bf16_f32 v106, v108, v109
 v_cvt_pk_bf16_f32 v107, v110, v111
 buffer_store_dwordx4 v[104:107], v1, s[16:19], s45 offen offset:2048 sc1
 v_accvgpr_read_b32 v112, a80
 v_accvgpr_read_b32 v113, a81
 v_accvgpr_read_b32 v114, a82
 v_accvgpr_read_b32 v115, a83
 v_accvgpr_read_b32 v116, a84
 v_accvgpr_read_b32 v117, a85
 v_accvgpr_read_b32 v118, a86
 v_accvgpr_read_b32 v119, a87
 v_pk_mul_f32 v[112:113], v[112:113], v[6:7] op_sel:[0,0] op_sel_hi:[1,0]
 v_pk_mul_f32 v[114:115], v[114:115], v[6:7] op_sel:[0,0] op_sel_hi:[1,0]
 v_pk_mul_f32 v[116:117], v[116:117], v[6:7] op_sel:[0,0] op_sel_hi:[1,0]
 v_pk_mul_f32 v[118:119], v[118:119], v[6:7] op_sel:[0,0] op_sel_hi:[1,0]
 v_cvt_pk_bf16_f32 v112, v112, v113
 v_cvt_pk_bf16_f32 v113, v114, v115
 v_cvt_pk_bf16_f32 v114, v116, v117
 v_cvt_pk_bf16_f32 v115, v118, v119
 s_add_u32 s93, s93, 4096
 buffer_store_dwordx4 v[112:115], v1, s[16:19], s93 offen offset:0 sc1
 v_accvgpr_read_b32 v120, a112
 v_accvgpr_read_b32 v121, a113
 v_accvgpr_read_b32 v122, a114
 v_accvgpr_read_b32 v123, a115
 v_accvgpr_read_b32 v124, a116
 v_accvgpr_read_b32 v125, a117
 v_accvgpr_read_b32 v126, a118
 v_accvgpr_read_b32 v127, a119
 v_pk_mul_f32 v[120:121], v[120:121], v[6:7] op_sel:[0,1] op_sel_hi:[1,1]
 v_pk_mul_f32 v[122:123], v[122:123], v[6:7] op_sel:[0,1] op_sel_hi:[1,1]
 v_pk_mul_f32 v[124:125], v[124:125], v[6:7] op_sel:[0,1] op_sel_hi:[1,1]
 v_pk_mul_f32 v[126:127], v[126:127], v[6:7] op_sel:[0,1] op_sel_hi:[1,1]
 v_cvt_pk_bf16_f32 v120, v120, v121
 v_cvt_pk_bf16_f32 v121, v122, v123
 v_cvt_pk_bf16_f32 v122, v124, v125
 v_cvt_pk_bf16_f32 v123, v126, v127
 s_add_u32 s45, s45, 4096
 buffer_store_dwordx4 v[120:123], v1, s[16:19], s45 offen offset:0 sc1
 v_accvgpr_read_b32 v128, a88
 v_accvgpr_read_b32 v129, a89
 v_accvgpr_read_b32 v130, a90
 v_accvgpr_read_b32 v131, a91
 v_accvgpr_read_b32 v132, a92
 v_accvgpr_read_b32 v133, a93
 v_accvgpr_read_b32 v134, a94
 v_accvgpr_read_b32 v135, a95
 v_pk_mul_f32 v[128:129], v[128:129], v[6:7] op_sel:[0,0] op_sel_hi:[1,0]
 v_pk_mul_f32 v[130:131], v[130:131], v[6:7] op_sel:[0,0] op_sel_hi:[1,0]
 v_pk_mul_f32 v[132:133], v[132:133], v[6:7] op_sel:[0,0] op_sel_hi:[1,0]
 v_pk_mul_f32 v[134:135], v[134:135], v[6:7] op_sel:[0,0] op_sel_hi:[1,0]
 v_cvt_pk_bf16_f32 v128, v128, v129
 v_cvt_pk_bf16_f32 v129, v130, v131
 v_cvt_pk_bf16_f32 v130, v132, v133
 v_cvt_pk_bf16_f32 v131, v134, v135
 buffer_store_dwordx4 v[128:131], v1, s[16:19], s93 offen offset:2048 sc1
 v_accvgpr_read_b32 v136, a120
 v_accvgpr_read_b32 v137, a121
 v_accvgpr_read_b32 v138, a122
 v_accvgpr_read_b32 v139, a123
 v_accvgpr_read_b32 v140, a124
 v_accvgpr_read_b32 v141, a125
 v_accvgpr_read_b32 v142, a126
 v_accvgpr_read_b32 v143, a127
 v_pk_mul_f32 v[136:137], v[136:137], v[6:7] op_sel:[0,1] op_sel_hi:[1,1]
 v_pk_mul_f32 v[138:139], v[138:139], v[6:7] op_sel:[0,1] op_sel_hi:[1,1]
 v_pk_mul_f32 v[140:141], v[140:141], v[6:7] op_sel:[0,1] op_sel_hi:[1,1]
 v_pk_mul_f32 v[142:143], v[142:143], v[6:7] op_sel:[0,1] op_sel_hi:[1,1]
 v_cvt_pk_bf16_f32 v136, v136, v137
 v_cvt_pk_bf16_f32 v137, v138, v139
 v_cvt_pk_bf16_f32 v138, v140, v141
 v_cvt_pk_bf16_f32 v139, v142, v143
 buffer_store_dwordx4 v[136:139], v1, s[16:19], s45 offen offset:2048 sc1
L_nofin_92:
 s_waitcnt lgkmcnt(4)
 v_mfma_f32_16x16x32_bf16 a[0:3], a[192:195], v[176:179], a[0:3]
 ds_read_b128 a[224:227], v2 offset:34816
 v_exp_f32 v240, v16
 v_mfma_f32_16x16x32_bf16 a[0:3], a[196:199], v[184:187], a[0:3]
 s_lshl_b32 s33, s32, 17
 s_add_u32 s33, s33, s25
 v_exp_f32 v241, v17
 v_mfma_f32_16x16x32_bf16 a[0:3], a[200:203], v[192:195], a[0:3]
 ds_read_b128 a[228:231], v2 offset:43008
 s_add_u32 s32, s32, 1
 v_exp_f32 v242, v18
 v_mfma_f32_16x16x32_bf16 a[0:3], a[204:207], v[200:203], a[0:3]
 s_add_u32 m0, s50, 0
 v_exp_f32 v243, v19
 v_exp_f32 v244, v20
 v_mfma_f32_16x16x32_bf16 a[32:35], a[204:207], v[204:207], a[32:35]
 ds_read_b128 a[232:235], v2 offset:51200
 s_and_b32 s32, s32, 7
 v_cvt_pk_bf16_f32 v144, v240, v241
 v_mfma_f32_16x16x32_bf16 a[32:35], a[200:203], v[196:199], a[32:35]
 buffer_load_dwordx4 v232, s[8:11], s33 offen offset:0  lds
 v_cvt_pk_bf16_f32 v145, v242, v243
 v_mfma_f32_16x16x32_bf16 a[32:35], a[196:199], v[188:191], a[32:35]
 ds_read_b128 a[236:239], v2 offset:59392
 v_exp_f32 v245, v21
 v_mfma_f32_16x16x32_bf16 a[32:35], a[192:195], v[180:183], a[32:35]
 s_waitcnt lgkmcnt(4)
 v_exp_f32 v246, v22
 v_cvt_pk_bf16_f32 v146, v244, v245
 v_mfma_f32_16x16x32_bf16 a[4:7], a[208:211], v[176:179], a[4:7]
 ds_read_b128 a[240:243], v2 offset:35840
 v_exp_f32 v247, v23
 v_mfma_f32_16x16x32_bf16 a[4:7], a[212:215], v[184:187], a[4:7]
 buffer_load_dwordx4 v233, s[8:11], s33 offen offset:1024  lds
 v_exp_f32 v240, v24
 v_cvt_pk_bf16_f32 v147, v246, v247
 v_mfma_f32_16x16x32_bf16 a[4:7], a[216:219], v[192:195], a[4:7]
 ds_read_b128 a[244:247], v2 offset:44032
 v_exp_f32 v241, v25
 v_mfma_f32_16x16x32_bf16 a[4:7], a[220:223], v[200:203], a[4:7]
 buffer_load_dwordx4 v234, s[8:11], s33 offen offset:2048  lds
 v_exp_f32 v242, v26
 v_mfma_f32_16x16x32_bf16 v[224:227], v[252:255], v[144:147], 0
 ds_read_b128 a[248:251], v2 offset:52224
 v_exp_f32 v243, v27
 v_mfma_f32_16x16x32_bf16 a[36:39], a[220:223], v[204:207], a[36:39]
 v_exp_f32 v244, v28
 v_cvt_pk_bf16_f32 v148, v240, v241
 v_mfma_f32_16x16x32_bf16 a[36:39], a[216:219], v[196:199], a[36:39]
 ds_read_b128 a[252:255], v2 offset:60416
 v_exp_f32 v245, v29
 v_mfma_f32_16x16x32_bf16 a[36:39], a[212:215], v[188:191], a[36:39]
 buffer_load_dwordx4 v235, s[8:11], s33 offen offset:3072  lds
 v_cvt_pk_bf16_f32 v149, v242, v243
 v_cvt_pk_bf16_f32 v150, v244, v245
 v_mfma_f32_16x16x32_bf16 a[36:39], a[208:211], v[180:183], a[36:39]
 s_waitcnt lgkmcnt(4)
 s_add_u32 m0, s50, 16384
 v_exp_f32 v246, v30
 v_mfma_f32_16x16x32_bf16 a[8:11], a[224:227], v[176:179], a[8:11]
 ds_read_b128 a[192:195], v2 offset:36864
 v_exp_f32 v247, v31
 v_mfma_f32_16x16x32_bf16 a[8:11], a[228:231], v[184:187], a[8:11]
 s_add_u32 s33, s33, 65536
 v_exp_f32 v240, v32
 v_exp_f32 v241, v33
 v_cvt_pk_bf16_f32 v151, v246, v247
 v_mfma_f32_16x16x32_bf16 a[8:11], a[232:235], v[192:195], a[8:11]
 ds_read_b128 a[196:199], v2 offset:45056
 v_exp_f32 v242, v34
 v_mfma_f32_16x16x32_bf16 a[8:11], a[236:239], v[200:203], a[8:11]
 buffer_load_dwordx4 v232, s[8:11], s33 offen offset:0  lds
 v_exp_f32 v243, v35
 v_mfma_f32_16x16x32_bf16 v[228:231], v[252:255], v[148:151], 0
 ds_read_b128 a[200:203], v2 offset:53248
 v_exp_f32 v244, v36
 v_mfma_f32_16x16x32_bf16 a[40:43], a[236:239], v[204:207], a[40:43]
 buffer_load_dwordx4 v233, s[8:11], s33 offen offset:1024  lds
 v_cvt_pk_bf16_f32 v152, v240, v241
 v_mfma_f32_16x16x32_bf16 a[40:43], a[232:235], v[196:199], a[40:43]
 ds_read_b128 a[204:207], v2 offset:61440
 v_exp_f32 v245, v37
 v_mfma_f32_16x16x32_bf16 a[40:43], a[228:231], v[188:191], a[40:43]
 buffer_load_dwordx4 v234, s[8:11], s33 offen offset:2048  lds
 v_cvt_pk_bf16_f32 v153, v242, v243
 v_mfma_f32_16x16x32_bf16 a[40:43], a[224:227], v[180:183], a[40:43]
 s_waitcnt lgkmcnt(4)
 v_exp_f32 v246, v38
 v_cvt_pk_bf16_f32 v154, v244, v245
 v_mfma_f32_16x16x32_bf16 a[12:15], a[240:243], v[176:179], a[12:15]
 ds_read_b128 a[208:211], v2 offset:37888
 v_exp_f32 v247, v39
 v_mfma_f32_16x16x32_bf16 a[12:15], a[244:247], v[184:187], a[12:15]
 buffer_load_dwordx4 v235, s[8:11], s33 offen offset:3072  lds
 v_exp_f32 v240, v40
 v_cvt_pk_bf16_f32 v155, v246, v247
 v_mfma_f32_16x16x32_bf16 a[12:15], a[248:251], v[192:195], a[12:15]
 ds_read_b128 a[212:215], v2 offset:46080
 v_exp_f32 v241, v41
 v_mfma_f32_16x16x32_bf16 a[12:15], a[252:255], v[200:203], a[12:15]
 v_exp_f32 v242, v42
 v_exp_f32 v243, v43
 v_mfma_f32_16x16x32_bf16 v[224:227], v[252:255], v[152:155], v[224:227]
 ds_read_b128 a[216:219], v2 offset:54272
 s_lshl_b32 s33, s32, 17
 v_cvt_pk_bf16_f32 v156, v240, v241
 v_mfma_f32_16x16x32_bf16 a[44:47], a[252:255], v[204:207], a[44:47]
 s_add_u32 s33, s33, s25
 v_exp_f32 v244, v44
 v_cvt_pk_bf16_f32 v157, v242, v243
 v_mfma_f32_16x16x32_bf16 a[44:47], a[248:251], v[196:199], a[44:47]
 ds_read_b128 a[220:223], v2 offset:62464
 s_add_u32 s32, s32, 1
 v_mfma_f32_16x16x32_bf16 a[44:47], a[244:247], v[188:191], a[44:47]
 s_add_u32 m0, s50, 65536
 v_exp_f32 v245, v45
 v_mfma_f32_16x16x32_bf16 a[44:47], a[240:243], v[180:183], a[44:47]
 s_waitcnt lgkmcnt(4)
 s_and_b32 s32, s32, 7
 v_exp_f32 v246, v46
 v_cvt_pk_bf16_f32 v158, v244, v245
 v_mfma_f32_16x16x32_bf16 a[16:19], a[192:195], v[176:179], a[16:19]
 ds_read_b128 a[224:227], v2 offset:38912
 v_exp_f32 v247, v47
 v_mfma_f32_16x16x32_bf16 a[16:19], a[196:199], v[184:187], a[16:19]
 buffer_load_dwordx4 v232, s[8:11], s33 offen offset:0  lds
 v_exp_f32 v240, v56
 v_cvt_pk_bf16_f32 v159, v246, v247
 v_mfma_f32_16x16x32_bf16 a[16:19], a[200:203], v[192:195], a[16:19]
 ds_read_b128 a[228:231], v2 offset:47104
 v_exp_f32 v241, v57
 v_mfma_f32_16x16x32_bf16 a[16:19], a[204:207], v[200:203], a[16:19]
 buffer_load_dwordx4 v233, s[8:11], s33 offen offset:1024  lds
 v_exp_f32 v242, v58
 v_mfma_f32_16x16x32_bf16 v[228:231], v[252:255], v[156:159], v[228:231]
 ds_read_b128 a[232:235], v2 offset:55296
 v_exp_f32 v243, v59
 v_mfma_f32_16x16x32_bf16 a[48:51], a[204:207], v[204:207], a[48:51]
 buffer_load_dwordx4 v234, s[8:11], s33 offen offset:2048  lds
 v_cvt_pk_bf16_f32 v164, v240, v241
 v_mfma_f32_16x16x32_bf16 a[48:51], a[200:203], v[196:199], a[48:51]
 ds_read_b128 a[236:239], v2 offset:63488
 v_exp_f32 v244, v60
 v_mfma_f32_16x16x32_bf16 a[48:51], a[196:199], v[188:191], a[48:51]
 v_exp_f32 v245, v61
 v_cvt_pk_bf16_f32 v165, v242, v243
 v_mfma_f32_16x16x32_bf16 a[48:51], a[192:195], v[180:183], a[48:51]
 s_waitcnt lgkmcnt(4)
 v_exp_f32 v246, v62
 v_cvt_pk_bf16_f32 v166, v244, v245
 v_mfma_f32_16x16x32_bf16 a[20:23], a[208:211], v[176:179], a[20:23]
 ds_read_b128 a[240:243], v2 offset:39936
 v_exp_f32 v247, v63
 v_mfma_f32_16x16x32_bf16 a[20:23], a[212:215], v[184:187], a[20:23]
 buffer_load_dwordx4 v235, s[8:11], s33 offen offset:3072  lds
 v_exp_f32 v240, v72
 v_cvt_pk_bf16_f32 v167, v246, v247
 v_mfma_f32_16x16x32_bf16 a[20:23], a[216:219], v[192:195], a[20:23]
 ds_read_b128 a[244:247], v2 offset:48128
 s_add_u32 m0, s50, 81920
 v_mfma_f32_16x16x32_bf16 a[20:23], a[220:223], v[200:203], a[20:23]
 s_add_u32 s33, s33, 65536
 v_exp_f32 v241, v73
 v_mfma_f32_16x16x32_bf16 v[228:231], v[252:255], v[164:167], v[228:231]
 ds_read_b128 a[248:251], v2 offset:56320
 v_exp_f32 v242, v74
 v_mfma_f32_16x16x32_bf16 a[52:55], a[220:223], v[204:207], a[52:55]
 buffer_load_dwordx4 v232, s[8:11], s33 offen offset:0  lds
 v_mfma_f32_16x16x32_bf16 a[52:55], a[216:219], v[196:199], a[52:55]
 ds_read_b128 a[252:255], v2 offset:64512
 v_exp_f32 v243, v75
 v_mfma_f32_16x16x32_bf16 a[52:55], a[212:215], v[188:191], a[52:55]
 buffer_load_dwordx4 v233, s[8:11], s33 offen offset:1024  lds
 v_mfma_f32_16x16x32_bf16 a[52:55], a[208:211], v[180:183], a[52:55]
 s_waitcnt lgkmcnt(4)
 v_exp_f32 v244, v76
 v_mfma_f32_16x16x32_bf16 a[24:27], a[224:227], v[176:179], a[24:27]
 ds_read_b128 a[192:195], v1 offset:32768
 v_exp_f32 v245, v77
 v_mfma_f32_16x16x32_bf16 a[24:27], a[228:231], v[184:187], a[24:27]
 buffer_load_dwordx4 v234, s[8:11], s33 offen offset:2048  lds
 v_mfma_f32_16x16x32_bf16 a[24:27], a[232:235], v[192:195], a[24:27]
 ds_read_b128 a[196:199], v1 offset:40960
 v_exp_f32 v246, v78
 v_mfma_f32_16x16x32_bf16 a[24:27], a[236:239], v[200:203], a[24:27]
 buffer_load_dwordx4 v235, s[8:11], s33 offen offset:3072  lds
 v_mfma_f32_16x16x32_bf16 a[56:59], a[236:239], v[204:207], a[56:59]
 ds_read_b128 a[200:203], v1 offset:49152
 v_exp_f32 v247, v79
 v_mfma_f32_16x16x32_bf16 a[56:59], a[232:235], v[196:199], a[56:59]
 v_cvt_pk_bf16_f32 v172, v240, v241
 v_cvt_pk_bf16_f32 v173, v242, v243
 v_cvt_pk_bf16_f32 v174, v244, v245
 v_cvt_pk_bf16_f32 v175, v246, v247
 v_mfma_f32_16x16x32_bf16 a[56:59], a[228:231], v[188:191], a[56:59]
 ds_read_b128 a[204:207], v1 offset:57344
 v_mfma_f32_16x16x32_bf16 a[56:59], a[224:227], v[180:183], a[56:59]
 v_mfma_f32_16x16x32_bf16 v[228:231], v[252:255], v[172:175], v[228:231]
 s_waitcnt lgkmcnt(4)
 v_mfma_f32_16x16x32_bf16 a[28:31], a[240:243], v[176:179], a[28:31]
 ds_read_b128 a[208:211], v1 offset:33792
 v_mfma_f32_16x16x32_bf16 a[28:31], a[244:247], v[184:187], a[28:31]
 v_mfma_f32_16x16x32_bf16 a[28:31], a[248:251], v[192:195], a[28:31]
 ds_read_b128 a[212:215], v1 offset:41984
 v_mfma_f32_16x16x32_bf16 a[28:31], a[252:255], v[200:203], a[28:31]
 v_mfma_f32_16x16x32_bf16 a[60:63], a[252:255], v[204:207], a[60:63]
 ds_read_b128 a[216:219], v1 offset:50176
 v_max_f32 v10, v224, v228
 v_mfma_f32_16x16x32_bf16 a[60:63], a[248:251], v[196:199], a[60:63]
 v_cmp_lt_f32 vcc, s54, v10
 v_mfma_f32_16x16x32_bf16 a[60:63], a[244:247], v[188:191], a[60:63]
 ds_read_b128 a[220:223], v1 offset:58368
 v_mfma_f32_16x16x32_bf16 a[60:63], a[240:243], v[180:183], a[60:63]
 s_cbranch_vccnz L_jr_95
L_back_94:
 v_add_f32 v4, v4, v224
 v_add_f32 v5, v5, v228
 s_waitcnt lgkmcnt(4)
 v_mfma_f32_16x16x32_bf16 a[0:3], a[192:195], v[144:147], a[0:3]
 ds_read_b128 a[224:227], v1 offset:34816
 v_mfma_f32_16x16x32_bf16 a[0:3], a[196:199], v[152:155], a[0:3]
 ds_read_b128 a[228:231], v1 offset:43008
 s_lshl_b32 s33, s32, 17
 v_mfma_f32_16x16x32_bf16 a[32:35], a[204:207], v[172:175], a[32:35]
 s_add_u32 s33, s33, s25
 s_add_u32 s32, s32, 1
 v_mfma_f32_16x16x32_bf16 a[32:35], a[200:203], v[164:167], a[32:35]
 ds_read_b128 a[232:235], v1 offset:51200
 s_add_u32 m0, s50, 131072
 v_mfma_f32_16x16x32_bf16 a[32:35], a[196:199], v[156:159], a[32:35]
 ds_read_b128 a[236:239], v1 offset:59392
 v_mfma_f32_16x16x32_bf16 a[32:35], a[192:195], v[148:151], a[32:35]
 s_waitcnt lgkmcnt(4)
 s_and_b32 s32, s32, 7
 v_mfma_f32_16x16x32_bf16 a[4:7], a[208:211], v[144:147], a[4:7]
 ds_read_b128 a[240:243], v1 offset:35840
 v_mfma_f32_16x16x32_bf16 a[4:7], a[212:215], v[152:155], a[4:7]
 ds_read_b128 a[244:247], v1 offset:44032
 v_mfma_f32_16x16x32_bf16 a[36:39], a[220:223], v[172:175], a[36:39]
 buffer_load_dwordx4 v232, s[8:11], s33 offen offset:0  lds
 v_mfma_f32_16x16x32_bf16 a[36:39], a[216:219], v[164:167], a[36:39]
 ds_read_b128 a[248:251], v1 offset:52224
 v_mfma_f32_16x16x32_bf16 a[36:39], a[212:215], v[156:159], a[36:39]
 ds_read_b128 a[252:255], v1 offset:60416
 v_rcp_f32 v4, v4
 v_mfma_f32_16x16x32_bf16 a[36:39], a[208:211], v[148:151], a[36:39]
 s_waitcnt lgkmcnt(4)
 v_rcp_f32 v5, v5
 v_mfma_f32_16x16x32_bf16 a[8:11], a[224:227], v[144:147], a[8:11]
 ds_read_b128 a[192:195], v1 offset:36864
 v_sub_f32 v8, 1.0, v8
 v_mfma_f32_16x16x32_bf16 a[8:11], a[228:231], v[152:155], a[8:11]
 ds_read_b128 a[196:199], v1 offset:45056
 v_sub_f32 v9, 1.0, v9
 v_mfma_f32_16x16x32_bf16 a[40:43], a[236:239], v[172:175], a[40:43]
 buffer_load_dwordx4 v233, s[8:11], s33 offen offset:1024  lds
 v_mfma_f32_16x16x32_bf16 a[40:43], a[232:235], v[164:167], a[40:43]
 ds_read_b128 a[200:203], v1 offset:53248
 v_mul_f32 v4, v4, v8
 v_mfma_f32_16x16x32_bf16 a[40:43], a[228:231], v[156:159], a[40:43]
 ds_read_b128 a[204:207], v1 offset:61440
 v_mul_f32 v5, v5, v9
 v_mfma_f32_16x16x32_bf16 a[40:43], a[224:227], v[148:151], a[40:43]
 s_waitcnt lgkmcnt(4)
 v_accvgpr_read_b32 v16, a0
 v_accvgpr_read_b32 v17, a1
 v_accvgpr_read_b32 v18, a2
 v_accvgpr_read_b32 v19, a3
 v_accvgpr_read_b32 v20, a4
 v_accvgpr_read_b32 v21, a5
 v_accvgpr_read_b32 v22, a6
 v_accvgpr_read_b32 v23, a7
 v_mul_f32 v16, v4, v16
 v_mfma_f32_16x16x32_bf16 a[12:15], a[240:243], v[144:147], a[12:15]
 ds_read_b128 a[208:211], v1 offset:37888
 v_mul_f32 v17, v4, v17
 v_mul_f32 v18, v4, v18
 v_mul_f32 v19, v4, v19
 v_mul_f32 v20, v4, v20
 v_mul_f32 v21, v4, v21
 v_mul_f32 v22, v4, v22
 v_mul_f32 v23, v4, v23
 v_mfma_f32_16x16x32_bf16 a[12:15], a[244:247], v[152:155], a[12:15]
 ds_read_b128 a[212:215], v1 offset:46080
 v_cvt_pk_bf16_f32 v16, v16, v17
 v_cvt_pk_bf16_f32 v17, v18, v19
 v_cvt_pk_bf16_f32 v18, v20, v21
 v_cvt_pk_bf16_f32 v19, v22, v23
 buffer_store_dwordx4 v[16:19], v1, s[16:19], s92 offen offset:0 sc1
 v_mfma_f32_16x16x32_bf16 a[44:47], a[252:255], v[172:175], a[44:47]
 buffer_load_dwordx4 v234, s[8:11], s33 offen offset:2048  lds
 v_mfma_f32_16x16x32_bf16 a[44:47], a[248:251], v[164:167], a[44:47]
 ds_read_b128 a[216:219], v1 offset:54272
 v_accvgpr_read_b32 v24, a32
 v_accvgpr_read_b32 v25, a33
 v_accvgpr_read_b32 v26, a34
 v_mfma_f32_16x16x32_bf16 a[44:47], a[244:247], v[156:159], a[44:47]
 ds_read_b128 a[220:223], v1 offset:62464
 v_accvgpr_read_b32 v27, a35
 v_accvgpr_read_b32 v28, a36
 v_accvgpr_read_b32 v29, a37
 v_accvgpr_read_b32 v30, a38
 v_accvgpr_read_b32 v31, a39
 v_mul_f32 v24, v5, v24
 v_mfma_f32_16x16x32_bf16 a[44:47], a[240:243], v[148:151], a[44:47]
 buffer_load_dwordx4 v235, s[8:11], s33 offen offset:3072  lds
 s_waitcnt lgkmcnt(4)
 v_mfma_f32_16x16x32_bf16 a[16:19], a[192:195], v[144:147], a[16:19]
 ds_read_b128 a[224:227], v1 offset:38912
 s_add_u32 m0, s50, 147456
 v_mfma_f32_16x16x32_bf16 a[16:19], a[196:199], v[152:155], a[16:19]
 ds_read_b128 a[228:231], v1 offset:47104
 s_add_u32 s33, s33, 65536
 v_mfma_f32_16x16x32_bf16 a[48:51], a[204:207], v[172:175], a[48:51]
 buffer_load_dwordx4 v232, s[8:11], s33 offen offset:0  lds
 v_mfma_f32_16x16x32_bf16 a[48:51], a[200:203], v[164:167], a[48:51]
 ds_read_b128 a[232:235], v1 offset:55296
 v_mul_f32 v25, v5, v25
 v_mul_f32 v26, v5, v26
 v_mul_f32 v27, v5, v27
 v_mul_f32 v28, v5, v28
 v_mul_f32 v29, v5, v29
 v_mul_f32 v30, v5, v30
 v_mul_f32 v31, v5, v31
 v_mfma_f32_16x16x32_bf16 a[48:51], a[196:199], v[156:159], a[48:51]
 ds_read_b128 a[236:239], v1 offset:63488
 v_cvt_pk_bf16_f32 v24, v24, v25
 v_cvt_pk_bf16_f32 v25, v26, v27
 v_cvt_pk_bf16_f32 v26, v28, v29
 v_cvt_pk_bf16_f32 v27, v30, v31
 buffer_store_dwordx4 v[24:27], v1, s[16:19], s67 offen offset:0 sc1
 v_mfma_f32_16x16x32_bf16 a[48:51], a[192:195], v[148:151], a[48:51]
 buffer_load_dwordx4 v233, s[8:11], s33 offen offset:1024  lds
 s_waitcnt lgkmcnt(4)
 buffer_load_dwordx4 v234, s[8:11], s33 offen offset:2048  lds
 buffer_load_dwordx4 v235, s[8:11], s33 offen offset:3072  lds
 v_mfma_f32_16x16x32_bf16 a[20:23], a[208:211], v[144:147], a[20:23]
 ds_read_b128 a[240:243], v1 offset:39936
 v_accvgpr_read_b32 v32, a8
 v_mfma_f32_16x16x32_bf16 a[20:23], a[212:215], v[152:155], a[20:23]
 ds_read_b128 a[244:247], v1 offset:48128
 v_accvgpr_read_b32 v33, a9
 v_mfma_f32_16x16x32_bf16 a[52:55], a[220:223], v[172:175], a[52:55]
 v_accvgpr_read_b32 v34, a10
 v_accvgpr_read_b32 v35, a11
 v_accvgpr_read_b32 v36, a12
 v_accvgpr_read_b32 v37, a13
 v_accvgpr_read_b32 v38, a14
 v_accvgpr_read_b32 v39, a15
 v_mfma_f32_16x16x32_bf16 a[52:55], a[216:219], v[164:167], a[52:55]
 ds_read_b128 a[248:251], v1 offset:56320
 v_mul_f32 v32, v4, v32
 v_mul_f32 v33, v4, v33
 v_mul_f32 v34, v4, v34
 v_mfma_f32_16x16x32_bf16 a[52:55], a[212:215], v[156:159], a[52:55]
 ds_read_b128 a[252:255], v1 offset:64512
 v_mul_f32 v35, v4, v35
 v_mul_f32 v36, v4, v36
 v_mul_f32 v37, v4, v37
 v_mfma_f32_16x16x32_bf16 a[52:55], a[208:211], v[148:151], a[52:55]
 s_waitcnt lgkmcnt(4)
 v_mul_f32 v38, v4, v38
 v_mul_f32 v39, v4, v39
 v_cvt_pk_bf16_f32 v32, v32, v33
 v_cvt_pk_bf16_f32 v33, v34, v35
 v_cvt_pk_bf16_f32 v34, v36, v37
 v_cvt_pk_bf16_f32 v35, v38, v39
 v_mfma_f32_16x16x32_bf16 a[24:27], a[224:227], v[144:147], a[24:27]
 buffer_store_dwordx4 v[32:35], v1, s[16:19], s92 offen offset:2048 sc1
 v_mfma_f32_16x16x32_bf16 a[24:27], a[228:231], v[152:155], a[24:27]
 v_accvgpr_read_b32 v40, a40
 v_accvgpr_read_b32 v41, a41
 v_accvgpr_read_b32 v42, a42
 v_accvgpr_read_b32 v43, a43
 v_accvgpr_read_b32 v44, a44
 v_mfma_f32_16x16x32_bf16 a[56:59], a[236:239], v[172:175], a[56:59]
 v_accvgpr_read_b32 v45, a45
 v_accvgpr_read_b32 v46, a46
 v_accvgpr_read_b32 v47, a47
 v_mul_f32 v40, v5, v40
 v_mul_f32 v41, v5, v41
 v_mul_f32 v42, v5, v42
 v_mfma_f32_16x16x32_bf16 a[56:59], a[232:235], v[164:167], a[56:59]
 v_mul_f32 v43, v5, v43
 v_mul_f32 v44, v5, v44
 v_mul_f32 v45, v5, v45
 v_mul_f32 v46, v5, v46
 v_mul_f32 v47, v5, v47
 v_cvt_pk_bf16_f32 v40, v40, v41
 v_mfma_f32_16x16x32_bf16 a[56:59], a[228:231], v[156:159], a[56:59]
 v_cvt_pk_bf16_f32 v41, v42, v43
 v_cvt_pk_bf16_f32 v42, v44, v45
 v_cvt_pk_bf16_f32 v43, v46, v47
 buffer_store_dwordx4 v[40:43], v1, s[16:19], s67 offen offset:2048 sc1
 v_mfma_f32_16x16x32_bf16 a[56:59], a[224:227], v[148:151], a[56:59]
 s_waitcnt lgkmcnt(0)
 v_accvgpr_read_b32 v48, a16
 v_accvgpr_read_b32 v49, a17
 v_accvgpr_read_b32 v50, a18
 v_accvgpr_read_b32 v51, a19
 v_accvgpr_read_b32 v52, a20
 v_mfma_f32_16x16x32_bf16 a[28:31], a[240:243], v[144:147], a[28:31]
 v_accvgpr_read_b32 v53, a21
 v_accvgpr_read_b32 v54, a22
 v_accvgpr_read_b32 v55, a23
 v_mul_f32 v48, v4, v48
 v_mul_f32 v49, v4, v49
 v_mul_f32 v50, v4, v50
 v_mul_f32 v51, v4, v51
 v_mul_f32 v52, v4, v52
 v_mul_f32 v53, v4, v53
 v_mfma_f32_16x16x32_bf16 a[28:31], a[244:247], v[152:155], a[28:31]
 v_mul_f32 v54, v4, v54
 v_mul_f32 v55, v4, v55
 v_cvt_pk_bf16_f32 v48, v48, v49
 v_cvt_pk_bf16_f32 v49, v50, v51
 v_cvt_pk_bf16_f32 v50, v52, v53
 v_cvt_pk_bf16_f32 v51, v54, v55
 s_add_u32 s92, s92, 4096
 buffer_store_dwordx4 v[48:51], v1, s[16:19], s92 offen offset:0 sc1
 v_mfma_f32_16x16x32_bf16 a[60:63], a[252:255], v[172:175], a[60:63]
 v_accvgpr_read_b32 v56, a48
 v_accvgpr_read_b32 v57, a49
 v_accvgpr_read_b32 v58, a50
 v_accvgpr_read_b32 v59, a51
 v_accvgpr_read_b32 v60, a52
 v_mfma_f32_16x16x32_bf16 a[60:63], a[248:251], v[164:167], a[60:63]
 v_accvgpr_read_b32 v61, a53
 v_accvgpr_read_b32 v62, a54
 v_accvgpr_read_b32 v63, a55
 v_mul_f32 v56, v5, v56
 v_mul_f32 v57, v5, v57
 v_mul_f32 v58, v5, v58
 v_mul_f32 v59, v5, v59
 v_mul_f32 v60, v5, v60
 v_mul_f32 v61, v5, v61
 v_mfma_f32_16x16x32_bf16 a[60:63], a[244:247], v[156:159], a[60:63]
 v_mul_f32 v62, v5, v62
 v_mul_f32 v63, v5, v63
 v_cvt_pk_bf16_f32 v56, v56, v57
 v_cvt_pk_bf16_f32 v57, v58, v59
 v_cvt_pk_bf16_f32 v58, v60, v61
 v_cvt_pk_bf16_f32 v59, v62, v63
 s_add_u32 s67, s67, 4096
 buffer_store_dwordx4 v[56:59], v1, s[16:19], s67 offen offset:0 sc1
 v_mfma_f32_16x16x32_bf16 a[60:63], a[240:243], v[148:151], a[60:63]
 s_nop 7
 v_accvgpr_read_b32 v64, a24
 v_accvgpr_read_b32 v65, a25
 v_accvgpr_read_b32 v66, a26
 v_accvgpr_read_b32 v67, a27
 v_accvgpr_read_b32 v68, a28
 v_accvgpr_read_b32 v69, a29
 v_accvgpr_read_b32 v70, a30
 v_accvgpr_read_b32 v71, a31
 v_pk_mul_f32 v[64:65], v[64:65], v[4:5] op_sel:[0,0] op_sel_hi:[1,0]
 v_pk_mul_f32 v[66:67], v[66:67], v[4:5] op_sel:[0,0] op_sel_hi:[1,0]
 v_pk_mul_f32 v[68:69], v[68:69], v[4:5] op_sel:[0,0] op_sel_hi:[1,0]
 v_pk_mul_f32 v[70:71], v[70:71], v[4:5] op_sel:[0,0] op_sel_hi:[1,0]
 v_cvt_pk_bf16_f32 v64, v64, v65
 v_cvt_pk_bf16_f32 v65, v66, v67
 v_cvt_pk_bf16_f32 v66, v68, v69
 v_cvt_pk_bf16_f32 v67, v70, v71
 buffer_store_dwordx4 v[64:67], v1, s[16:19], s92 offen offset:2048 sc1
 v_accvgpr_read_b32 v72, a56
 v_accvgpr_read_b32 v73, a57
 v_accvgpr_read_b32 v74, a58
 v_accvgpr_read_b32 v75, a59
 v_accvgpr_read_b32 v76, a60
 v_accvgpr_read_b32 v77, a61
 v_accvgpr_read_b32 v78, a62
 v_accvgpr_read_b32 v79, a63
 v_pk_mul_f32 v[72:73], v[72:73], v[4:5] op_sel:[0,1] op_sel_hi:[1,1]
 v_pk_mul_f32 v[74:75], v[74:75], v[4:5] op_sel:[0,1] op_sel_hi:[1,1]
 v_pk_mul_f32 v[76:77], v[76:77], v[4:5] op_sel:[0,1] op_sel_hi:[1,1]
 v_pk_mul_f32 v[78:79], v[78:79], v[4:5] op_sel:[0,1] op_sel_hi:[1,1]
 v_cvt_pk_bf16_f32 v72, v72, v73
 v_cvt_pk_bf16_f32 v73, v74, v75
 v_cvt_pk_bf16_f32 v74, v76, v77
 v_cvt_pk_bf16_f32 v75, v78, v79
 buffer_store_dwordx4 v[72:75], v1, s[16:19], s67 offen offset:2048 sc1
 s_branch L_END_37
L_I7_36:
 s_waitcnt lgkmcnt(4)
 v_mfma_f32_16x16x32_bf16 a[0:3], a[192:195], v[176:179], a[0:3]
 ds_read_b128 a[224:227], v2 offset:36864
 v_exp_f32 v240, v16
 v_mfma_f32_16x16x32_bf16 a[0:3], a[196:199], v[192:195], a[0:3]
 s_lshl_b32 s33, s32, 17
 s_add_u32 s33, s33, s25
 v_exp_f32 v241, v17
 v_mfma_f32_16x16x32_bf16 a[32:35], a[196:199], v[196:199], a[32:35]
 s_add_u32 s32, s32, 1
 v_exp_f32 v242, v18
 v_exp_f32 v243, v19
 v_mfma_f32_16x16x32_bf16 a[32:35], a[192:195], v[180:183], a[32:35]
 ds_read_b128 a[228:231], v2 offset:45056
 s_add_u32 m0, s50, 0
 v_exp_f32 v244, v20
 v_mfma_f32_16x16x32_bf16 a[96:99], a[192:195], v[188:191], a[96:99]
 s_and_b32 s32, s32, 7
 v_exp_f32 v245, v21
 v_exp_f32 v246, v22
 v_mfma_f32_16x16x32_bf16 a[96:99], a[196:199], v[204:207], a[96:99]
 buffer_load_dwordx4 v232, s[8:11], s33 offen offset:0  lds
 v_cvt_pk_bf16_f32 v144, v240, v241
 v_cvt_pk_bf16_f32 v145, v242, v243
 v_mfma_f32_16x16x32_bf16 a[4:7], a[204:207], v[192:195], a[4:7]
 ds_read_b128 a[232:235], v2 offset:37888
 v_exp_f32 v247, v23
 v_cvt_pk_bf16_f32 v146, v244, v245
 v_mfma_f32_16x16x32_bf16 a[4:7], a[200:203], v[176:179], a[4:7]
 buffer_load_dwordx4 v233, s[8:11], s33 offen offset:1024  lds
 v_exp_f32 v240, v24
 v_cvt_pk_bf16_f32 v147, v246, v247
 v_mfma_f32_16x16x32_bf16 a[36:39], a[200:203], v[180:183], a[36:39]
 v_exp_f32 v241, v25
 v_exp_f32 v242, v26
 v_mfma_f32_16x16x32_bf16 a[36:39], a[204:207], v[196:199], a[36:39]
 ds_read_b128 a[236:239], v2 offset:46080
 v_exp_f32 v243, v27
 v_mfma_f32_16x16x32_bf16 v[224:227], v[252:255], v[144:147], 0
 buffer_load_dwordx4 v234, s[8:11], s33 offen offset:2048  lds
 v_exp_f32 v244, v28
 v_mfma_f32_16x16x32_bf16 a[100:103], a[204:207], v[204:207], a[100:103]
 v_exp_f32 v245, v29
 v_cvt_pk_bf16_f32 v148, v240, v241
 v_mfma_f32_16x16x32_bf16 a[100:103], a[200:203], v[188:191], a[100:103]
 s_waitcnt lgkmcnt(4)
 v_exp_f32 v246, v30
 v_cvt_pk_bf16_f32 v149, v242, v243
 v_cvt_pk_bf16_f32 v150, v244, v245
 v_mfma_f32_16x16x32_bf16 a[8:11], a[208:211], v[176:179], a[8:11]
 ds_read_b128 a[240:243], v2 offset:38912
 v_exp_f32 v247, v31
 v_mfma_f32_16x16x32_bf16 a[8:11], a[212:215], v[192:195], a[8:11]
 buffer_load_dwordx4 v235, s[8:11], s33 offen offset:3072  lds
 v_exp_f32 v240, v32
 v_cvt_pk_bf16_f32 v151, v246, v247
 v_mfma_f32_16x16x32_bf16 a[40:43], a[212:215], v[196:199], a[40:43]
 s_add_u32 m0, s50, 16384
 s_add_u32 s33, s33, 65536
 v_exp_f32 v241, v33
 v_mfma_f32_16x16x32_bf16 a[40:43], a[208:211], v[180:183], a[40:43]
 ds_read_b128 a[244:247], v2 offset:47104
 v_exp_f32 v242, v34
 v_cvt_pk_bf16_f32 v152, v240, v241
 v_mfma_f32_16x16x32_bf16 v[228:231], v[252:255], v[148:151], 0
 buffer_load_dwordx4 v232, s[8:11], s33 offen offset:0  lds
 v_exp_f32 v243, v35
 v_mfma_f32_16x16x32_bf16 a[104:107], a[208:211], v[188:191], a[104:107]
 v_exp_f32 v244, v36
 v_exp_f32 v245, v37
 v_mfma_f32_16x16x32_bf16 a[104:107], a[212:215], v[204:207], a[104:107]
 buffer_load_dwordx4 v233, s[8:11], s33 offen offset:1024  lds
 v_exp_f32 v246, v38
 v_mfma_f32_16x16x32_bf16 a[12:15], a[220:223], v[192:195], a[12:15]
 ds_read_b128 a[248:251], v2 offset:39936
 v_exp_f32 v247, v39
 v_cvt_pk_bf16_f32 v153, v242, v243
 v_cvt_pk_bf16_f32 v154, v244, v245
 v_mfma_f32_16x16x32_bf16 a[12:15], a[216:219], v[176:179], a[12:15]
 buffer_load_dwordx4 v234, s[8:11], s33 offen offset:2048  lds
 v_exp_f32 v240, v40
 v_cvt_pk_bf16_f32 v155, v246, v247
 v_mfma_f32_16x16x32_bf16 a[44:47], a[216:219], v[180:183], a[44:47]
 v_exp_f32 v241, v41
 v_exp_f32 v242, v42
 v_mfma_f32_16x16x32_bf16 a[44:47], a[220:223], v[196:199], a[44:47]
 ds_read_b128 a[252:255], v2 offset:48128
 v_exp_f32 v243, v43
 v_mfma_f32_16x16x32_bf16 v[224:227], v[252:255], v[152:155], v[224:227]
 buffer_load_dwordx4 v235, s[8:11], s33 offen offset:3072  lds
 v_exp_f32 v244, v44
 v_mfma_f32_16x16x32_bf16 a[108:111], a[220:223], v[204:207], a[108:111]
 v_exp_f32 v245, v45
 v_exp_f32 v246, v46
 v_mfma_f32_16x16x32_bf16 a[108:111], a[216:219], v[188:191], a[108:111]
 s_waitcnt lgkmcnt(4)
 s_lshl_b32 s33, s32, 17
 v_exp_f32 v247, v47
 v_mfma_f32_16x16x32_bf16 a[16:19], a[224:227], v[176:179], a[16:19]
 ds_read_b128 a[192:195], v1 offset:32768
 s_add_u32 s33, s33, s25
 v_cvt_pk_bf16_f32 v156, v240, v241
 v_cvt_pk_bf16_f32 v157, v242, v243
 v_cvt_pk_bf16_f32 v158, v244, v245
 v_mfma_f32_16x16x32_bf16 a[16:19], a[228:231], v[192:195], a[16:19]
 s_add_u32 s32, s32, 1
 v_exp_f32 v240, v56
 v_exp_f32 v241, v57
 v_cvt_pk_bf16_f32 v159, v246, v247
 v_mfma_f32_16x16x32_bf16 a[48:51], a[228:231], v[196:199], a[48:51]
 s_add_u32 m0, s50, 65536
 v_exp_f32 v242, v58
 v_exp_f32 v243, v59
 v_mfma_f32_16x16x32_bf16 a[48:51], a[224:227], v[180:183], a[48:51]
 ds_read_b128 a[196:199], v1 offset:40960
 s_and_b32 s32, s32, 7
 v_exp_f32 v244, v60
 v_mfma_f32_16x16x32_bf16 v[228:231], v[252:255], v[156:159], v[228:231]
 buffer_load_dwordx4 v232, s[8:11], s33 offen offset:0  lds
 v_exp_f32 v245, v61
 v_mfma_f32_16x16x32_bf16 a[112:115], a[224:227], v[188:191], a[112:115]
 v_exp_f32 v246, v62
 v_cvt_pk_bf16_f32 v164, v240, v241
 v_mfma_f32_16x16x32_bf16 a[112:115], a[228:231], v[204:207], a[112:115]
 buffer_load_dwordx4 v233, s[8:11], s33 offen offset:1024  lds
 v_cvt_pk_bf16_f32 v165, v242, v243
 v_cvt_pk_bf16_f32 v166, v244, v245
 v_mfma_f32_16x16x32_bf16 a[20:23], a[236:239], v[192:195], a[20:23]
 ds_read_b128 a[200:203], v1 offset:49152
 v_exp_f32 v247, v63
 v_mfma_f32_16x16x32_bf16 a[20:23], a[232:235], v[176:179], a[20:23]
 v_exp_f32 v240, v72
 v_exp_f32 v241, v73
 v_cvt_pk_bf16_f32 v167, v246, v247
 v_mfma_f32_16x16x32_bf16 a[52:55], a[232:235], v[180:183], a[52:55]
 buffer_load_dwordx4 v234, s[8:11], s33 offen offset:2048  lds
 v_exp_f32 v242, v74
 v_mfma_f32_16x16x32_bf16 a[52:55], a[236:239], v[196:199], a[52:55]
 ds_read_b128 a[204:207], v1 offset:57344
 v_exp_f32 v243, v75
 v_mfma_f32_16x16x32_bf16 v[228:231], v[252:255], v[164:167], v[228:231]
 buffer_load_dwordx4 v235, s[8:11], s33 offen offset:3072  lds
 v_exp_f32 v244, v76
 v_mfma_f32_16x16x32_bf16 a[116:119], a[236:239], v[204:207], a[116:119]
 v_exp_f32 v245, v77
 v_mfma_f32_16x16x32_bf16 a[116:119], a[232:235], v[188:191], a[116:119]
 s_waitcnt lgkmcnt(4)
 s_add_u32 m0, s50, 81920
 v_exp_f32 v246, v78
 v_mfma_f32_16x16x32_bf16 a[24:27], a[240:243], v[176:179], a[24:27]
 ds_read_b128 a[208:211], v1 offset:33792
 v_exp_f32 v247, v79
 v_mfma_f32_16x16x32_bf16 a[24:27], a[244:247], v[192:195], a[24:27]
 s_add_u32 s33, s33, 65536
 v_cvt_pk_bf16_f32 v172, v240, v241
 v_cvt_pk_bf16_f32 v173, v242, v243
 v_cvt_pk_bf16_f32 v174, v244, v245
 v_cvt_pk_bf16_f32 v175, v246, v247
 v_mfma_f32_16x16x32_bf16 a[56:59], a[244:247], v[196:199], a[56:59]
 buffer_load_dwordx4 v232, s[8:11], s33 offen offset:0  lds
 v_mfma_f32_16x16x32_bf16 a[56:59], a[240:243], v[180:183], a[56:59]
 ds_read_b128 a[212:215], v1 offset:41984
 v_mfma_f32_16x16x32_bf16 v[228:231], v[252:255], v[172:175], v[228:231]
 buffer_load_dwordx4 v233, s[8:11], s33 offen offset:1024  lds
 v_mfma_f32_16x16x32_bf16 a[120:123], a[240:243], v[188:191], a[120:123]
 v_mfma_f32_16x16x32_bf16 a[120:123], a[244:247], v[204:207], a[120:123]
 ds_read_b128 a[216:219], v1 offset:50176
 v_mfma_f32_16x16x32_bf16 a[28:31], a[252:255], v[192:195], a[28:31]
 buffer_load_dwordx4 v234, s[8:11], s33 offen offset:2048  lds
 v_mfma_f32_16x16x32_bf16 a[28:31], a[248:251], v[176:179], a[28:31]
 v_mfma_f32_16x16x32_bf16 a[60:63], a[248:251], v[180:183], a[60:63]
 ds_read_b128 a[220:223], v1 offset:58368
 v_max_f32 v10, v224, v228
 v_mfma_f32_16x16x32_bf16 a[60:63], a[252:255], v[196:199], a[60:63]
 buffer_load_dwordx4 v235, s[8:11], s33 offen offset:3072  lds
 v_cmp_lt_f32 vcc, s54, v10
 v_mfma_f32_16x16x32_bf16 a[124:127], a[252:255], v[204:207], a[124:127]
 v_mfma_f32_16x16x32_bf16 a[124:127], a[248:251], v[188:191], a[124:127]
 s_cbranch_vccnz L_jr_97
L_back_96:
 v_add_f32 v4, v4, v224
 v_add_f32 v5, v5, v228
 s_waitcnt lgkmcnt(4)
 v_mfma_f32_16x16x32_bf16 a[0:3], a[192:195], v[144:147], a[0:3]
 ds_read_b128 a[224:227], v1 offset:34816
 v_rcp_f32 v6, v6
 v_rcp_f32 v7, v7
 v_sub_f32 v14, 1.0, v14
 v_sub_f32 v15, 1.0, v15
 v_mul_f32 v6, v6, v14
 v_mul_f32 v7, v7, v15
 v_accvgpr_read_b32 v80, a64
 v_accvgpr_read_b32 v81, a65
 v_accvgpr_read_b32 v82, a66
 v_accvgpr_read_b32 v83, a67
 v_accvgpr_read_b32 v84, a68
 v_mfma_f32_16x16x32_bf16 a[0:3], a[196:199], v[152:155], a[0:3]
 ds_read_b128 a[228:231], v1 offset:43008
 s_lshl_b32 s33, s32, 17
 v_mfma_f32_16x16x32_bf16 a[32:35], a[204:207], v[172:175], a[32:35]
 s_add_u32 s33, s33, s25
 s_add_u32 s32, s32, 1
 v_accvgpr_read_b32 v85, a69
 v_accvgpr_read_b32 v86, a70
 v_accvgpr_read_b32 v87, a71
 v_mul_f32 v80, v6, v80
 v_mul_f32 v81, v6, v81
 v_mul_f32 v82, v6, v82
 v_mul_f32 v83, v6, v83
 v_mul_f32 v84, v6, v84
 v_mul_f32 v85, v6, v85
 v_mul_f32 v86, v6, v86
 v_mul_f32 v87, v6, v87
 v_cvt_pk_bf16_f32 v80, v80, v81
 v_cvt_pk_bf16_f32 v81, v82, v83
 v_cvt_pk_bf16_f32 v82, v84, v85
 v_cvt_pk_bf16_f32 v83, v86, v87
 buffer_store_dwordx4 v[80:83], v1, s[16:19], s93 offen offset:0 sc1
 v_mfma_f32_16x16x32_bf16 a[32:35], a[200:203], v[164:167], a[32:35]
 ds_read_b128 a[232:235], v1 offset:51200
 s_add_u32 m0, s50, 131072
 v_mfma_f32_16x16x32_bf16 a[32:35], a[196:199], v[156:159], a[32:35]
 ds_read_b128 a[236:239], v1 offset:59392
 v_accvgpr_read_b32 v88, a96
 v_accvgpr_read_b32 v89, a97
 v_accvgpr_read_b32 v90, a98
 v_accvgpr_read_b32 v91, a99
 v_accvgpr_read_b32 v92, a100
 v_accvgpr_read_b32 v93, a101
 v_accvgpr_read_b32 v94, a102
 v_accvgpr_read_b32 v95, a103
 v_mul_f32 v88, v7, v88
 v_mul_f32 v89, v7, v89
 v_mul_f32 v90, v7, v90
 v_mfma_f32_16x16x32_bf16 a[32:35], a[192:195], v[148:151], a[32:35]
 s_waitcnt lgkmcnt(4)
 s_and_b32 s32, s32, 7
 v_mul_f32 v91, v7, v91
 v_mul_f32 v92, v7, v92
 v_mul_f32 v93, v7, v93
 v_mul_f32 v94, v7, v94
 v_mul_f32 v95, v7, v95
 v_cvt_pk_bf16_f32 v88, v88, v89
 v_cvt_pk_bf16_f32 v89, v90, v91
 v_cvt_pk_bf16_f32 v90, v92, v93
 v_cvt_pk_bf16_f32 v91, v94, v95
 buffer_store_dwordx4 v[88:91], v1, s[16:19], s45 offen offset:0 sc1
 v_accvgpr_read_b32 v96, a72
 v_mfma_f32_16x16x32_bf16 a[4:7], a[208:211], v[144:147], a[4:7]
 ds_read_b128 a[240:243], v1 offset:35840
 v_accvgpr_read_b32 v97, a73
 v_accvgpr_read_b32 v98, a74
 v_accvgpr_read_b32 v99, a75
 v_accvgpr_read_b32 v100, a76
 v_accvgpr_read_b32 v101, a77
 v_accvgpr_read_b32 v102, a78
 v_accvgpr_read_b32 v103, a79
 v_mul_f32 v96, v6, v96
 v_mul_f32 v97, v6, v97
 v_mul_f32 v98, v6, v98
 v_mul_f32 v99, v6, v99
 v_mul_f32 v100, v6, v100
 v_mul_f32 v101, v6, v101
 v_mul_f32 v102, v6, v102
 v_mul_f32 v103, v6, v103
 v_cvt_pk_bf16_f32 v96, v96, v97
 v_mfma_f32_16x16x32_bf16 a[4:7], a[212:215], v[152:155], a[4:7]
 ds_read_b128 a[244:247], v1 offset:44032
 v_cvt_pk_bf16_f32 v97, v98, v99
 v_cvt_pk_bf16_f32 v98, v100, v101
 v_cvt_pk_bf16_f32 v99, v102, v103
 buffer_store_dwordx4 v[96:99], v1, s[16:19], s93 offen offset:2048 sc1
 v_accvgpr_read_b32 v104, a104
 v_accvgpr_read_b32 v105, a105
 v_accvgpr_read_b32 v106, a106
 v_accvgpr_read_b32 v107, a107
 v_accvgpr_read_b32 v108, a108
 v_accvgpr_read_b32 v109, a109
 v_accvgpr_read_b32 v110, a110
 v_mfma_f32_16x16x32_bf16 a[36:39], a[220:223], v[172:175], a[36:39]
 buffer_load_dwordx4 v232, s[8:11], s33 offen offset:0  lds
 v_mfma_f32_16x16x32_bf16 a[36:39], a[216:219], v[164:167], a[36:39]
 ds_read_b128 a[248:251], v1 offset:52224
 v_accvgpr_read_b32 v111, a111
 v_mul_f32 v104, v7, v104
 v_mul_f32 v105, v7, v105
 v_mul_f32 v106, v7, v106
 v_mul_f32 v107, v7, v107
 v_mul_f32 v108, v7, v108
 v_mul_f32 v109, v7, v109
 v_mul_f32 v110, v7, v110
 v_mul_f32 v111, v7, v111
 v_cvt_pk_bf16_f32 v104, v104, v105
 v_cvt_pk_bf16_f32 v105, v106, v107
 v_cvt_pk_bf16_f32 v106, v108, v109
 v_cvt_pk_bf16_f32 v107, v110, v111
 buffer_store_dwordx4 v[104:107], v1, s[16:19], s45 offen offset:2048 sc1
 v_mfma_f32_16x16x32_bf16 a[36:39], a[212:215], v[156:159], a[36:39]
 ds_read_b128 a[252:255], v1 offset:60416
 v_accvgpr_read_b32 v112, a80
 v_accvgpr_read_b32 v113, a81
 v_accvgpr_read_b32 v114, a82
 v_accvgpr_read_b32 v115, a83
 v_accvgpr_read_b32 v116, a84
 v_accvgpr_read_b32 v117, a85
 v_accvgpr_read_b32 v118, a86
 v_accvgpr_read_b32 v119, a87
 v_mul_f32 v112, v6, v112
 v_mul_f32 v113, v6, v113
 v_mul_f32 v114, v6, v114
 v_mul_f32 v115, v6, v115
 v_mul_f32 v116, v6, v116
 v_mul_f32 v117, v6, v117
 v_mfma_f32_16x16x32_bf16 a[36:39], a[208:211], v[148:151], a[36:39]
 s_waitcnt lgkmcnt(4)
 v_mul_f32 v118, v6, v118
 v_mul_f32 v119, v6, v119
 v_cvt_pk_bf16_f32 v112, v112, v113
 v_cvt_pk_bf16_f32 v113, v114, v115
 v_cvt_pk_bf16_f32 v114, v116, v117
 v_cvt_pk_bf16_f32 v115, v118, v119
 s_add_u32 s93, s93, 4096
 buffer_store_dwordx4 v[112:115], v1, s[16:19], s93 offen offset:0 sc1
 v_accvgpr_read_b32 v120, a112
 v_accvgpr_read_b32 v121, a113
 v_accvgpr_read_b32 v122, a114
 v_accvgpr_read_b32 v123, a115
 v_accvgpr_read_b32 v124, a116
 v_accvgpr_read_b32 v125, a117
 v_accvgpr_read_b32 v126, a118
 v_accvgpr_read_b32 v127, a119
 v_mul_f32 v120, v7, v120
 v_mul_f32 v121, v7, v121
 v_mul_f32 v122, v7, v122
 v_mul_f32 v123, v7, v123
 v_mul_f32 v124, v7, v124
 v_mul_f32 v125, v7, v125
 v_mul_f32 v126, v7, v126
 v_mul_f32 v127, v7, v127
 v_cvt_pk_bf16_f32 v120, v120, v121
 v_cvt_pk_bf16_f32 v121, v122, v123
 v_cvt_pk_bf16_f32 v122, v124, v125
 v_mfma_f32_16x16x32_bf16 a[8:11], a[224:227], v[144:147], a[8:11]
 ds_read_b128 a[192:195], v1 offset:36864
 v_cvt_pk_bf16_f32 v123, v126, v127
 s_add_u32 s45, s45, 4096
 buffer_store_dwordx4 v[120:123], v1, s[16:19], s45 offen offset:0 sc1
 v_accvgpr_read_b32 v128, a88
 v_accvgpr_read_b32 v129, a89
 v_accvgpr_read_b32 v130, a90
 v_accvgpr_read_b32 v131, a91
 v_accvgpr_read_b32 v132, a92
 v_accvgpr_read_b32 v133, a93
 v_accvgpr_read_b32 v134, a94
 v_accvgpr_read_b32 v135, a95
 v_mfma_f32_16x16x32_bf16 a[8:11], a[228:231], v[152:155], a[8:11]
 ds_read_b128 a[196:199], v1 offset:45056
 v_mul_f32 v128, v6, v128
 v_mul_f32 v129, v6, v129
 v_mul_f32 v130, v6, v130
 v_mul_f32 v131, v6, v131
 v_mul_f32 v132, v6, v132
 v_mul_f32 v133, v6, v133
 v_mul_f32 v134, v6, v134
 v_mul_f32 v135, v6, v135
 v_cvt_pk_bf16_f32 v128, v128, v129
 v_cvt_pk_bf16_f32 v129, v130, v131
 v_cvt_pk_bf16_f32 v130, v132, v133
 v_cvt_pk_bf16_f32 v131, v134, v135
 buffer_store_dwordx4 v[128:131], v1, s[16:19], s93 offen offset:2048 sc1
 v_mfma_f32_16x16x32_bf16 a[40:43], a[236:239], v[172:175], a[40:43]
 buffer_load_dwordx4 v233, s[8:11], s33 offen offset:1024  lds
 v_mfma_f32_16x16x32_bf16 a[40:43], a[232:235], v[164:167], a[40:43]
 ds_read_b128 a[200:203], v1 offset:53248
 v_accvgpr_read_b32 v136, a120
 v_accvgpr_read_b32 v137, a121
 v_accvgpr_read_b32 v138, a122
 v_accvgpr_read_b32 v139, a123
 v_accvgpr_read_b32 v140, a124
 v_accvgpr_read_b32 v141, a125
 v_accvgpr_read_b32 v142, a126
 v_accvgpr_read_b32 v143, a127
 v_mul_f32 v136, v7, v136
 v_mul_f32 v137, v7, v137
 v_mul_f32 v138, v7, v138
 v_mul_f32 v139, v7, v139
 v_mul_f32 v140, v7, v140
 v_mul_f32 v141, v7, v141
 v_mfma_f32_16x16x32_bf16 a[40:43], a[228:231], v[156:159], a[40:43]
 ds_read_b128 a[204:207], v1 offset:61440
 v_mul_f32 v142, v7, v142
 v_mul_f32 v143, v7, v143
 v_cvt_pk_bf16_f32 v136, v136, v137
 v_cvt_pk_bf16_f32 v137, v138, v139
 v_cvt_pk_bf16_f32 v138, v140, v141
 v_cvt_pk_bf16_f32 v139, v142, v143
 buffer_store_dwordx4 v[136:139], v1, s[16:19], s45 offen offset:2048 sc1
 v_rcp_f32 v4, v4
 v_rcp_f32 v5, v5
 v_sub_f32 v8, 1.0, v8
 v_sub_f32 v9, 1.0, v9
 v_mul_f32 v4, v4, v8
 v_mul_f32 v5, v5, v9
 v_mfma_f32_16x16x32_bf16 a[40:43], a[224:227], v[148:151], a[40:43]
 s_waitcnt lgkmcnt(4)
 v_accvgpr_read_b32 v16, a0
 v_accvgpr_read_b32 v17, a1
 v_accvgpr_read_b32 v18, a2
 v_accvgpr_read_b32 v19, a3
 v_accvgpr_read_b32 v20, a4
 v_accvgpr_read_b32 v21, a5
 v_accvgpr_read_b32 v22, a6
 v_accvgpr_read_b32 v23, a7
 v_mul_f32 v16, v4, v16
 v_mfma_f32_16x16x32_bf16 a[12:15], a[240:243], v[144:147], a[12:15]
 ds_read_b128 a[208:211], v1 offset:37888
 v_mul_f32 v17, v4, v17
 v_mul_f32 v18, v4, v18
 v_mul_f32 v19, v4, v19
 v_mul_f32 v20, v4, v20
 v_mul_f32 v21, v4, v21
 v_mul_f32 v22, v4, v22
 v_mul_f32 v23, v4, v23
 v_mfma_f32_16x16x32_bf16 a[12:15], a[244:247], v[152:155], a[12:15]
 ds_read_b128 a[212:215], v1 offset:46080
 v_cvt_pk_bf16_f32 v16, v16, v17
 v_cvt_pk_bf16_f32 v17, v18, v19
 v_cvt_pk_bf16_f32 v18, v20, v21
 v_cvt_pk_bf16_f32 v19, v22, v23
 buffer_store_dwordx4 v[16:19], v1, s[16:19], s92 offen offset:0 sc1
 v_mfma_f32_16x16x32_bf16 a[44:47], a[252:255], v[172:175], a[44:47]
 buffer_load_dwordx4 v234, s[8:11], s33 offen offset:2048  lds
 v_mfma_f32_16x16x32_bf16 a[44:47], a[248:251], v[164:167], a[44:47]
 ds_read_b128 a[216:219], v1 offset:54272
 v_accvgpr_read_b32 v24, a32
 v_accvgpr_read_b32 v25, a33
 v_accvgpr_read_b32 v26, a34
 v_mfma_f32_16x16x32_bf16 a[44:47], a[244:247], v[156:159], a[44:47]
 ds_read_b128 a[220:223], v1 offset:62464
 v_accvgpr_read_b32 v27, a35
 v_accvgpr_read_b32 v28, a36
 v_accvgpr_read_b32 v29, a37
 v_accvgpr_read_b32 v30, a38
 v_accvgpr_read_b32 v31, a39
 v_mul_f32 v24, v5, v24
 v_mfma_f32_16x16x32_bf16 a[44:47], a[240:243], v[148:151], a[44:47]
 buffer_load_dwordx4 v235, s[8:11], s33 offen offset:3072  lds
 s_waitcnt lgkmcnt(4)
 v_mfma_f32_16x16x32_bf16 a[16:19], a[192:195], v[144:147], a[16:19]
 ds_read_b128 a[224:227], v1 offset:38912
 s_add_u32 m0, s50, 147456
 v_mfma_f32_16x16x32_bf16 a[16:19], a[196:199], v[152:155], a[16:19]
 ds_read_b128 a[228:231], v1 offset:47104
 s_add_u32 s33, s33, 65536
 v_mfma_f32_16x16x32_bf16 a[48:51], a[204:207], v[172:175], a[48:51]
 buffer_load_dwordx4 v232, s[8:11], s33 offen offset:0  lds
 v_mfma_f32_16x16x32_bf16 a[48:51], a[200:203], v[164:167], a[48:51]
 ds_read_b128 a[232:235], v1 offset:55296
 v_mul_f32 v25, v5, v25
 v_mul_f32 v26, v5, v26
 v_mul_f32 v27, v5, v27
 v_mul_f32 v28, v5, v28
 v_mul_f32 v29, v5, v29
 v_mul_f32 v30, v5, v30
 v_mul_f32 v31, v5, v31
 v_mfma_f32_16x16x32_bf16 a[48:51], a[196:199], v[156:159], a[48:51]
 ds_read_b128 a[236:239], v1 offset:63488
 v_cvt_pk_bf16_f32 v24, v24, v25
 v_cvt_pk_bf16_f32 v25, v26, v27
 v_cvt_pk_bf16_f32 v26, v28, v29
 v_cvt_pk_bf16_f32 v27, v30, v31
 buffer_store_dwordx4 v[24:27], v1, s[16:19], s67 offen offset:0 sc1
 v_mfma_f32_16x16x32_bf16 a[48:51], a[192:195], v[148:151], a[48:51]
 buffer_load_dwordx4 v233, s[8:11], s33 offen offset:1024  lds
 s_waitcnt lgkmcnt(4)
 buffer_load_dwordx4 v234, s[8:11], s33 offen offset:2048  lds
 buffer_load_dwordx4 v235, s[8:11], s33 offen offset:3072  lds
 v_mfma_f32_16x16x32_bf16 a[20:23], a[208:211], v[144:147], a[20:23]
 ds_read_b128 a[240:243], v1 offset:39936
 v_accvgpr_read_b32 v32, a8
 v_mfma_f32_16x16x32_bf16 a[20:23], a[212:215], v[152:155], a[20:23]
 ds_read_b128 a[244:247], v1 offset:48128
 v_accvgpr_read_b32 v33, a9
 v_mfma_f32_16x16x32_bf16 a[52:55], a[220:223], v[172:175], a[52:55]
 v_accvgpr_read_b32 v34, a10
 v_accvgpr_read_b32 v35, a11
 v_accvgpr_read_b32 v36, a12
 v_accvgpr_read_b32 v37, a13
 v_accvgpr_read_b32 v38, a14
 v_accvgpr_read_b32 v39, a15
 v_mfma_f32_16x16x32_bf16 a[52:55], a[216:219], v[164:167], a[52:55]
 ds_read_b128 a[248:251], v1 offset:56320
 v_mul_f32 v32, v4, v32
 v_mul_f32 v33, v4, v33
 v_mul_f32 v34, v4, v34
 v_mfma_f32_16x16x32_bf16 a[52:55], a[212:215], v[156:159], a[52:55]
 ds_read_b128 a[252:255], v1 offset:64512
 v_mul_f32 v35, v4, v35
 v_mul_f32 v36, v4, v36
 v_mul_f32 v37, v4, v37
 v_mfma_f32_16x16x32_bf16 a[52:55], a[208:211], v[148:151], a[52:55]
 s_waitcnt lgkmcnt(4)
 v_mul_f32 v38, v4, v38
 v_mul_f32 v39, v4, v39
 v_cvt_pk_bf16_f32 v32, v32, v33
 v_cvt_pk_bf16_f32 v33, v34, v35
 v_cvt_pk_bf16_f32 v34, v36, v37
 v_cvt_pk_bf16_f32 v35, v38, v39
 v_mfma_f32_16x16x32_bf16 a[24:27], a[224:227], v[144:147], a[24:27]
 buffer_store_dwordx4 v[32:35], v1, s[16:19], s92 offen offset:2048 sc1
 v_mfma_f32_16x16x32_bf16 a[24:27], a[228:231], v[152:155], a[24:27]
 v_accvgpr_read_b32 v40, a40
 v_accvgpr_read_b32 v41, a41
 v_accvgpr_read_b32 v42, a42
 v_accvgpr_read_b32 v43, a43
 v_accvgpr_read_b32 v44, a44
 v_mfma_f32_16x16x32_bf16 a[56:59], a[236:239], v[172:175], a[56:59]
 v_accvgpr_read_b32 v45, a45
 v_accvgpr_read_b32 v46, a46
 v_accvgpr_read_b32 v47, a47
 v_mul_f32 v40, v5, v40
 v_mul_f32 v41, v5, v41
 v_mul_f32 v42, v5, v42
 v_mfma_f32_16x16x32_bf16 a[56:59], a[232:235], v[164:167], a[56:59]
 v_mul_f32 v43, v5, v43
 v_mul_f32 v44, v5, v44
 v_mul_f32 v45, v5, v45
 v_mul_f32 v46, v5, v46
 v_mul_f32 v47, v5, v47
 v_cvt_pk_bf16_f32 v40, v40, v41
 v_mfma_f32_16x16x32_bf16 a[56:59], a[228:231], v[156:159], a[56:59]
 v_cvt_pk_bf16_f32 v41, v42, v43
 v_cvt_pk_bf16_f32 v42, v44, v45
 v_cvt_pk_bf16_f32 v43, v46, v47
 buffer_store_dwordx4 v[40:43], v1, s[16:19], s67 offen offset:2048 sc1
 v_mfma_f32_16x16x32_bf16 a[56:59], a[224:227], v[148:151], a[56:59]
 s_waitcnt lgkmcnt(0)
 v_accvgpr_read_b32 v48, a16
 v_accvgpr_read_b32 v49, a17
 v_accvgpr_read_b32 v50, a18
 v_accvgpr_read_b32 v51, a19
 v_accvgpr_read_b32 v52, a20
 v_mfma_f32_16x16x32_bf16 a[28:31], a[240:243], v[144:147], a[28:31]
 v_accvgpr_read_b32 v53, a21
 v_accvgpr_read_b32 v54, a22
 v_accvgpr_read_b32 v55, a23
 v_mul_f32 v48, v4, v48
 v_mul_f32 v49, v4, v49
 v_mul_f32 v50, v4, v50
 v_mul_f32 v51, v4, v51
 v_mul_f32 v52, v4, v52
 v_mul_f32 v53, v4, v53
 v_mfma_f32_16x16x32_bf16 a[28:31], a[244:247], v[152:155], a[28:31]
 v_mul_f32 v54, v4, v54
 v_mul_f32 v55, v4, v55
 v_cvt_pk_bf16_f32 v48, v48, v49
 v_cvt_pk_bf16_f32 v49, v50, v51
 v_cvt_pk_bf16_f32 v50, v52, v53
 v_cvt_pk_bf16_f32 v51, v54, v55
 s_add_u32 s92, s92, 4096
 buffer_store_dwordx4 v[48:51], v1, s[16:19], s92 offen offset:0 sc1
 v_mfma_f32_16x16x32_bf16 a[60:63], a[252:255], v[172:175], a[60:63]
 v_accvgpr_read_b32 v56, a48
 v_accvgpr_read_b32 v57, a49
 v_accvgpr_read_b32 v58, a50
 v_accvgpr_read_b32 v59, a51
 v_accvgpr_read_b32 v60, a52
 v_mfma_f32_16x16x32_bf16 a[60:63], a[248:251], v[164:167], a[60:63]
 v_accvgpr_read_b32 v61, a53
 v_accvgpr_read_b32 v62, a54
 v_accvgpr_read_b32 v63, a55
 v_mul_f32 v56, v5, v56
 v_mul_f32 v57, v5, v57
 v_mul_f32 v58, v5, v58
 v_mul_f32 v59, v5, v59
 v_mul_f32 v60, v5, v60
 v_mul_f32 v61, v5, v61
 v_mfma_f32_16x16x32_bf16 a[60:63], a[244:247], v[156:159], a[60:63]
 v_mul_f32 v62, v5, v62
 v_mul_f32 v63, v5, v63
 v_cvt_pk_bf16_f32 v56, v56, v57
 v_cvt_pk_bf16_f32 v57, v58, v59
 v_cvt_pk_bf16_f32 v58, v60, v61
 v_cvt_pk_bf16_f32 v59, v62, v63
 s_add_u32 s67, s67, 4096
 buffer_store_dwordx4 v[56:59], v1, s[16:19], s67 offen offset:0 sc1
 v_mfma_f32_16x16x32_bf16 a[60:63], a[240:243], v[148:151], a[60:63]
 s_nop 7
 v_accvgpr_read_b32 v64, a24
 v_accvgpr_read_b32 v65, a25
 v_accvgpr_read_b32 v66, a26
 v_accvgpr_read_b32 v67, a27
 v_accvgpr_read_b32 v68, a28
 v_accvgpr_read_b32 v69, a29
 v_accvgpr_read_b32 v70, a30
 v_accvgpr_read_b32 v71, a31
 v_pk_mul_f32 v[64:65], v[64:65], v[4:5] op_sel:[0,0] op_sel_hi:[1,0]
 v_pk_mul_f32 v[66:67], v[66:67], v[4:5] op_sel:[0,0] op_sel_hi:[1,0]
 v_pk_mul_f32 v[68:69], v[68:69], v[4:5] op_sel:[0,0] op_sel_hi:[1,0]
 v_pk_mul_f32 v[70:71], v[70:71], v[4:5] op_sel:[0,0] op_sel_hi:[1,0]
 v_cvt_pk_bf16_f32 v64, v64, v65
 v_cvt_pk_bf16_f32 v65, v66, v67
 v_cvt_pk_bf16_f32 v66, v68, v69
 v_cvt_pk_bf16_f32 v67, v70, v71
 buffer_store_dwordx4 v[64:67], v1, s[16:19], s92 offen offset:2048 sc1
 v_accvgpr_read_b32 v72, a56
 v_accvgpr_read_b32 v73, a57
 v_accvgpr_read_b32 v74, a58
 v_accvgpr_read_b32 v75, a59
 v_accvgpr_read_b32 v76, a60
 v_accvgpr_read_b32 v77, a61
 v_accvgpr_read_b32 v78, a62
 v_accvgpr_read_b32 v79, a63
 v_pk_mul_f32 v[72:73], v[72:73], v[4:5] op_sel:[0,1] op_sel_hi:[1,1]
 v_pk_mul_f32 v[74:75], v[74:75], v[4:5] op_sel:[0,1] op_sel_hi:[1,1]
 v_pk_mul_f32 v[76:77], v[76:77], v[4:5] op_sel:[0,1] op_sel_hi:[1,1]
 v_pk_mul_f32 v[78:79], v[78:79], v[4:5] op_sel:[0,1] op_sel_hi:[1,1]
 v_cvt_pk_bf16_f32 v72, v72, v73
 v_cvt_pk_bf16_f32 v73, v74, v75
 v_cvt_pk_bf16_f32 v74, v76, v77
 v_cvt_pk_bf16_f32 v75, v78, v79
 buffer_store_dwordx4 v[72:75], v1, s[16:19], s67 offen offset:2048 sc1
L_END_37:
 v_min_u32 v9, 1, v0
 v_lshlrev_b32 v9, 29, v9
 v_mov_b32 v10, 1
 v_and_b32 v8, 7, v0
 v_lshlrev_b32 v8, 2, v8
 s_cmp_eq_u32 s3, 0
 s_cselect_b32 s46, 2, 0
 s_cselect_b32 s29, 1, 0
 s_cselect_b32 s22, 0, 0x20000000
 v_add_u32 v220, s22, v8
 v_or_b32 v221, s22, v9
 v_mov_b32 v222, 2
 v_and_b32 v11, 0x2000000c, v220
 s_and_b32 s47, s96, 0xffffff80
 s_and_b32 s30, s97, 0xffffff80
 v_add_u32 v246, 14, v3
 v_mov_b32 v244, 0x5555
 v_mov_b32 v245, 0
 s_cmp_eq_u32 s36, 0
 s_cselect_b32 s24, -1, 0
 v_lshlrev_b64 v[244:245], v246, v[244:245]
 v_alignbit_b32 v244, v245, v244, 12
 v_not_b32 v244, v244
 v_bfe_i32 v208, v244, 16, 1
 v_bfe_i32 v209, v244, 17, 1
 v_bfe_i32 v210, v244, 18, 1
 v_bfe_i32 v211, v244, 19, 1
 v_bfe_i32 v212, v244, 0, 1
 v_bfe_i32 v213, v244, 1, 1
 v_bfe_i32 v214, v244, 2, 1
 v_bfe_i32 v215, v244, 3, 1
 v_or_b32 v216, s24, v212
 v_or_b32 v217, s24, v213
 v_or_b32 v218, s24, v214
 v_or_b32 v219, s24, v215
 v_and_b32 v208, v249, v208
 v_and_b32 v209, v249, v209
 v_and_b32 v210, v249, v210
 v_and_b32 v211, v249, v211
 v_and_b32 v212, v249, v212
 v_and_b32 v213, v249, v213
 v_and_b32 v214, v249, v214
 v_and_b32 v215, v249, v215
 v_and_b32 v216, v249, v216
 v_and_b32 v217, v249, v217
 v_and_b32 v218, v249, v218
 v_and_b32 v219, v249, v219
 v_and_b32 v244, 1, v0
 v_lshlrev_b32 v244, 4, v244
 v_mov_b32 v245, 0xffff
 v_lshlrev_b32 v250, v244, v245
 s_waitcnt vmcnt(32)
 v_mfma_f32_16x16x16_bf16 v[144:147], a[144:145], a[128:129], v[216:219]
 v_mfma_f32_16x16x16_bf16 v[148:151], a[136:137], a[128:129], v[208:211]
 v_mfma_f32_16x16x16_bf16 v[152:155], a[136:137], a[132:133], v[212:215]
 v_mfma_f32_16x16x16_bf16 v[156:159], a[140:141], a[132:133], v[208:211]
 v_mfma_f32_16x16x16_bf16 v[160:163], a[146:147], a[130:131], v[216:219]
 v_mfma_f32_16x16x16_bf16 v[164:167], a[138:139], a[130:131], v[208:211]
 v_mfma_f32_16x16x16_bf16 v[168:171], a[138:139], a[134:135], v[212:215]
 v_mfma_f32_16x16x16_bf16 v[172:175], a[142:143], a[134:135], v[208:211]
 s_mov_b32 s4, s100
 s_mov_b32 s5, s101
 s_mov_b32 s6, 0x200000
 s_mov_b32 s7, 0x20000
 s_lshr_b32 s26, s20, 3
 s_and_b32 s22, s3, 1
 s_lshl_b32 s22, s22, 1
 s_and_b32 s23, s26, 1
 s_add_u32 s24, s22, s23
 s_lshl_b32 s22, s24, 12
 v_add_u32 v2, s22, v1
 v_xor_b32 v3, 4096, v2
 v_lshrrev_b32 v9, 2, v0
 v_and_b32 v8, 3, v9
 v_bfe_u32 v7, v0, 4, 1
 v_and_b32 v13, 2, v0
 v_or_b32 v7, v7, v13
 v_and_b32 v13, 1, v0
 v_lshlrev_b32 v13, 3, v13
 s_and_b32 s22, s3, 2
 s_lshr_b32 s23, s26, 1
 s_add_u32 s22, s22, s23
 v_xor_b32 v8, s22, v8
 v_lshl_or_b32 v8, v8, 2, v7
 v_lshlrev_b32 v8, 4, v8
 v_lshl_add_u32 v8, v9, 8, v8
 v_add_u32 v4, v8, v13
 v_xor_b32 v5, 16, v4
 v_xor_b32 v14, 64, v4
 v_xor_b32 v15, 80, v4
 v_add_u32 v236, 0x10000, v2
 v_add_u32 v237, 0x10000, v3
 v_add_u32 v224, 0x10000, v4
 v_add_u32 v225, 0x10000, v5
 v_add_u32 v226, 0x10000, v14
 v_add_u32 v227, 0x10000, v15
 v_add_u32 v228, 0x20000, v4
 v_add_u32 v229, 0x20000, v5
 v_add_u32 v230, 0x20000, v14
 v_add_u32 v231, 0x20000, v15
 s_and_b32 s23, s20, 3
 s_lshl_b32 s23, s23, 2
 s_add_u32 s23, s23, s22
 s_lshl_b32 s28, s23, 6
 s_lshl_b32 s22, s60, 2
 s_add_u32 s22, s22, s24
 s_lshl_b32 s22, s22, 15
 s_add_u32 s28, s28, s22
 v_and_b32 v6, 15, v0
 v_lshlrev_b32 v6, 10, v6
 v_lshrrev_b32 v7, 4, v0
 v_lshl_add_u32 v6, v7, 4, v6
 v_max_f32 v176, v144, v145
 v_max_f32 v177, v146, v147
 v_max_f32 v178, v148, v149
 v_max_f32 v179, v150, v151
 v_max_f32 v180, v152, v153
 v_max_f32 v181, v154, v155
 v_max_f32 v182, v156, v157
 v_max_f32 v183, v158, v159
 v_max_f32 v184, v160, v161
 v_max_f32 v185, v162, v163
 v_max_f32 v186, v164, v165
 v_max_f32 v187, v166, v167
 v_max_f32 v188, v168, v169
 v_max_f32 v189, v170, v171
 v_max_f32 v190, v172, v173
 v_max_f32 v191, v174, v175
 v_max3_f32 v240, v176, v177, v178
 v_max_f32 v240, v240, v179
 v_max3_f32 v241, v180, v181, v182
 v_max_f32 v241, v241, v183
 v_max3_f32 v242, v184, v185, v186
 v_max_f32 v242, v242, v187
 v_max3_f32 v243, v188, v189, v190
 v_max_f32 v243, v243, v191
 v_mov_b32 v244, v240
 v_mov_b32 v245, v241
 v_mov_b32 v246, v242
 v_mov_b32 v247, v243
 v_permlane16_swap_b32 v240, v244
 v_permlane16_swap_b32 v241, v245
 v_permlane16_swap_b32 v242, v246
 v_permlane16_swap_b32 v243, v247
 v_max_f32 v240, v240, v244
 v_max_f32 v241, v241, v245
 v_max_f32 v242, v242, v246
 v_max_f32 v243, v243, v247
 v_mov_b32 v244, v240
 v_mov_b32 v245, v241
 v_mov_b32 v246, v242
 v_mov_b32 v247, v243
 v_permlane32_swap_b32 v240, v244
 v_permlane32_swap_b32 v241, v245
 v_permlane32_swap_b32 v242, v246
 v_permlane32_swap_b32 v243, v247
 v_max_f32 v240, v240, v244
 v_max_f32 v241, v241, v245
 v_max_f32 v242, v242, v246
 v_max_f32 v243, v243, v247
 v_sub_f32 v176, v176, v240
 v_sub_f32 v177, v177, v240
 v_sub_f32 v178, v178, v240
 v_sub_f32 v179, v179, v240
 v_sub_f32 v180, v180, v241
 s_waitcnt vmcnt(0)
 s_barrier
 buffer_store_dword v10, v221, s[16:19], s96 offen sc1
 s_lshl_b32 s57, s35, 13
 s_add_u32 s57, s57, s98
 s_add_u32 s35, s35, 1
 s_add_u32 m0, s50, 32768
 s_and_b32 s35, s35, 7
 buffer_load_dwordx4 v1, s[16:19], s57 offen offset:0 sc1 lds
 buffer_load_dwordx4 v1, s[16:19], s57 offen offset:1024 sc1 lds
 buffer_load_dwordx4 v1, s[16:19], s57 offen offset:2048 sc1 lds
 buffer_load_dwordx4 v1, s[16:19], s57 offen offset:3072 sc1 lds
 s_add_u32 m0, s50, 49152
 s_add_u32 s57, s57, 4096
 buffer_load_dwordx4 v1, s[16:19], s57 offen offset:0 sc1 lds
 buffer_load_dwordx4 v1, s[16:19], s57 offen offset:1024 sc1 lds
 buffer_load_dwordx4 v1, s[16:19], s57 offen offset:2048 sc1 lds
 buffer_load_dwordx4 v1, s[16:19], s57 offen offset:3072 sc1 lds
 v_sub_f32 v181, v181, v241
 v_sub_f32 v182, v182, v241
 v_sub_f32 v183, v183, v241
 v_sub_f32 v184, v184, v242
 v_sub_f32 v185, v185, v242
 v_sub_f32 v186, v186, v242
 v_sub_f32 v187, v187, v242
 v_sub_f32 v188, v188, v243
 v_sub_f32 v189, v189, v243
 v_sub_f32 v190, v190, v243
 v_sub_f32 v191, v191, v243
 v_exp_f32 v176, v176
 v_exp_f32 v177, v177
 v_exp_f32 v178, v178
 v_exp_f32 v179, v179
 v_exp_f32 v180, v180
 v_exp_f32 v181, v181
 v_exp_f32 v182, v182
 v_exp_f32 v183, v183
 v_exp_f32 v184, v184
 v_exp_f32 v185, v185
 v_exp_f32 v186, v186
 v_exp_f32 v187, v187
 v_exp_f32 v188, v188
 v_exp_f32 v189, v189
 v_exp_f32 v190, v190
 v_exp_f32 v191, v191
 v_cvt_pk_bf16_f32 v176, v176, v176
 v_cvt_pk_bf16_f32 v177, v177, v177
 v_cvt_pk_bf16_f32 v178, v178, v178
 v_cvt_pk_bf16_f32 v179, v179, v179
 v_cvt_pk_bf16_f32 v180, v180, v180
 v_cvt_pk_bf16_f32 v181, v181, v181
 v_cvt_pk_bf16_f32 v182, v182, v182
 v_cvt_pk_bf16_f32 v183, v183, v183
 v_cvt_pk_bf16_f32 v184, v184, v184
 v_cvt_pk_bf16_f32 v185, v185, v185
 v_cvt_pk_bf16_f32 v186, v186, v186
 v_cvt_pk_bf16_f32 v187, v187, v187
 v_cvt_pk_bf16_f32 v188, v188, v188
 v_cvt_pk_bf16_f32 v189, v189, v189
 v_cvt_pk_bf16_f32 v190, v190, v190
 v_cvt_pk_bf16_f32 v191, v191, v191
 v_and_b32 v176, v250, v176
 v_and_b32 v177, v250, v177
 v_and_b32 v178, v250, v178
 v_and_b32 v179, v250, v179
 v_and_b32 v180, v250, v180
 v_and_b32 v181, v250, v181
 v_and_b32 v182, v250, v182
 buffer_load_dword v12, v220, s[16:19], s47 offen sc1
 v_and_b32 v183, v250, v183
 v_and_b32 v184, v250, v184
 v_and_b32 v185, v250, v185
 v_and_b32 v186, v250, v186
 v_and_b32 v187, v250, v187
 v_and_b32 v188, v250, v188
 v_and_b32 v189, v250, v189
 v_and_b32 v190, v250, v190
 v_and_b32 v191, v250, v191
 v_accvgpr_read_b32 v246, a164
 v_accvgpr_read_b32 v247, a165
 v_mfma_f32_16x16x32_bf16 v[160:163], v[252:255], v[176:179], 0
 v_mfma_f32_16x16x32_bf16 v[164:167], v[252:255], v[180:183], 0
 v_mfma_f32_16x16x32_bf16 v[168:171], v[252:255], v[184:187], 0
 v_mfma_f32_16x16x32_bf16 v[172:175], v[252:255], v[188:191], 0
 v_mfma_f32_16x16x16_bf16 v[144:147], a[158:159], v[176:177], 0
 v_mfma_f32_16x16x32_bf16 v[152:155], a[148:151], v[180:183], 0
 v_mfma_f32_16x16x16_bf16 v[148:151], a[162:163], v[184:185], 0
 v_mfma_f32_16x16x32_bf16 v[156:159], a[152:155], v[188:191], 0
 v_mfma_f32_16x16x16_bf16 v[144:147], a[148:149], v[178:179], v[144:147]
 v_mfma_f32_16x16x16_bf16 v[148:151], a[152:153], v[186:187], v[148:151]
 s_mul_i32 s38, s36, 294912
 s_lshl_b32 s39, s37, 11
 s_add_u32 s38, s38, s39
 s_add_u32 s38, s38, 0x3840000
 v_rcp_f32 v240, v160
 v_rcp_f32 v241, v164
 v_rcp_f32 v242, v168
 v_rcp_f32 v243, v172
 v_mul_f32 v240, v240, v246
 v_mul_f32 v241, v241, v247
 v_mul_f32 v242, v242, v246
 v_mul_f32 v243, v243, v247
 v_mul_f32 v144, v240, v144
 v_mul_f32 v145, v240, v145
 v_mul_f32 v146, v240, v146
 v_mul_f32 v147, v240, v147
 v_mul_f32 v148, v242, v148
 v_mul_f32 v149, v242, v149
 v_mul_f32 v150, v242, v150
 v_mul_f32 v151, v242, v151
 v_cvt_pk_bf16_f32 v212, v144, v145
 v_cvt_pk_bf16_f32 v213, v146, v147
 v_cvt_pk_bf16_f32 v214, v148, v149
 v_cvt_pk_bf16_f32 v215, v150, v151
 v_mul_f32 v152, v241, v152
 v_mul_f32 v153, v241, v153
 v_mul_f32 v154, v241, v154
 v_mul_f32 v155, v241, v155
 v_mul_f32 v156, v243, v156
 v_mul_f32 v157, v243, v157
 v_mul_f32 v158, v243, v158
 v_mul_f32 v159, v243, v159
 v_cvt_pk_bf16_f32 v216, v152, v153
 v_cvt_pk_bf16_f32 v217, v154, v155
 v_cvt_pk_bf16_f32 v218, v156, v157
 v_cvt_pk_bf16_f32 v219, v158, v159
 s_waitcnt vmcnt(0)
 v_cmp_gt_u32 vcc, s29, v12
 s_cbranch_vccnz L_spin_98
L_spun_99:
 s_barrier
 s_lshl_b32 s57, s35, 13
 s_add_u32 s57, s57, s98
 s_add_u32 s35, s35, 1
 s_add_u32 m0, s50, 98304
 s_and_b32 s35, s35, 7
 buffer_load_dwordx4 v1, s[16:19], s57 offen offset:0 sc1 lds
 buffer_load_dwordx4 v1, s[16:19], s57 offen offset:1024 sc1 lds
 buffer_load_dwordx4 v1, s[16:19], s57 offen offset:2048 sc1 lds
 buffer_load_dwordx4 v1, s[16:19], s57 offen offset:3072 sc1 lds
 s_add_u32 m0, s50, 114688
 s_add_u32 s57, s57, 4096
 buffer_load_dwordx4 v1, s[16:19], s57 offen offset:0 sc1 lds
 buffer_load_dwordx4 v1, s[16:19], s57 offen offset:1024 sc1 lds
 buffer_load_dwordx4 v1, s[16:19], s57 offen offset:2048 sc1 lds
 buffer_load_dwordx4 v1, s[16:19], s57 offen offset:3072 sc1 lds
 buffer_store_dwordx4 v[212:215], v1, s[16:19], s38 offen offset:0 sc1
 buffer_store_dwordx4 v[216:219], v1, s[16:19], s38 offen offset:1024 sc1
 ds_read_b64_tr_b16 v[96:97], v4 offset:0
 ds_read_b64_tr_b16 v[98:99], v4 offset:4096
 ds_read_b64_tr_b16 v[128:129], v4 offset:8192
 ds_read_b64_tr_b16 v[130:131], v4 offset:12288
 ds_read_b128 v[80:83], v2 offset:32768
 ds_read_b128 v[112:115], v2 offset:34816
 ds_read_b128 v[84:87], v2 offset:33792
 ds_read_b128 v[116:119], v2 offset:35840
 ds_read_b128 v[88:91], v3 offset:32768
 ds_read_b128 v[120:123], v3 offset:34816
 ds_read_b128 v[92:95], v3 offset:33792
 ds_read_b128 v[124:127], v3 offset:35840
 s_waitcnt lgkmcnt(4)
 v_mfma_f32_16x16x32_bf16 v[16:19], v[96:99], v[80:83], 0
 ds_read_b64_tr_b16 v[100:101], v5 offset:0
 ds_read_b64_tr_b16 v[102:103], v5 offset:4096
 v_mfma_f32_16x16x32_bf16 v[16:19], v[128:131], v[112:115], v[16:19]
 ds_read_b64_tr_b16 v[132:133], v5 offset:8192
 ds_read_b64_tr_b16 v[134:135], v5 offset:12288
 v_mfma_f32_16x16x32_bf16 v[24:27], v[96:99], v[84:87], 0
 ds_read_b64_tr_b16 v[104:105], v14 offset:0
 ds_read_b64_tr_b16 v[106:107], v14 offset:4096
 v_mfma_f32_16x16x32_bf16 v[24:27], v[128:131], v[116:119], v[24:27]
 ds_read_b64_tr_b16 v[136:137], v14 offset:8192
 ds_read_b64_tr_b16 v[138:139], v14 offset:12288
 s_waitcnt lgkmcnt(8)
 v_mfma_f32_16x16x32_bf16 v[32:35], v[96:99], v[88:91], 0
 ds_read_b64_tr_b16 v[108:109], v15 offset:0
 ds_read_b64_tr_b16 v[110:111], v15 offset:4096
 v_mfma_f32_16x16x32_bf16 v[32:35], v[128:131], v[120:123], v[32:35]
 ds_read_b64_tr_b16 v[140:141], v15 offset:8192
 s_lshl_b32 s57, s35, 13
 v_mfma_f32_16x16x32_bf16 v[40:43], v[96:99], v[92:95], 0
 ds_read_b64_tr_b16 v[142:143], v15 offset:12288
 s_add_u32 s57, s57, s98
 v_mfma_f32_16x16x32_bf16 v[40:43], v[128:131], v[124:127], v[40:43]
 s_waitcnt lgkmcnt(8)
 s_add_u32 s35, s35, 1
 s_and_b32 s35, s35, 7
 v_mfma_f32_16x16x32_bf16 v[20:23], v[100:103], v[80:83], 0
 v_mfma_f32_16x16x32_bf16 v[20:23], v[132:135], v[112:115], v[20:23]
 v_mfma_f32_16x16x32_bf16 v[28:31], v[100:103], v[84:87], 0
 v_mfma_f32_16x16x32_bf16 v[28:31], v[132:135], v[116:119], v[28:31]
 v_mfma_f32_16x16x32_bf16 v[36:39], v[100:103], v[88:91], 0
 v_mfma_f32_16x16x32_bf16 v[36:39], v[132:135], v[120:123], v[36:39]
 v_mfma_f32_16x16x32_bf16 v[44:47], v[100:103], v[92:95], 0
 v_mfma_f32_16x16x32_bf16 v[44:47], v[132:135], v[124:127], v[44:47]
 s_waitcnt vmcnt(10) lgkmcnt(0)
 s_barrier
 v_mfma_f32_16x16x32_bf16 v[48:51], v[104:107], v[80:83], 0
 ds_read_b64_tr_b16 v[160:161], v4 offset:16384
 s_add_u32 m0, s50, 32768
 v_mfma_f32_16x16x32_bf16 v[48:51], v[136:139], v[112:115], v[48:51]
 buffer_load_dwordx4 v1, s[16:19], s57 offen offset:0 sc1 lds
 v_mfma_f32_16x16x32_bf16 v[56:59], v[104:107], v[84:87], 0
 ds_read_b64_tr_b16 v[162:163], v4 offset:20480
 s_lshl_b32 s33, s32, 17
 v_mfma_f32_16x16x32_bf16 v[56:59], v[136:139], v[116:119], v[56:59]
 ds_read_b64_tr_b16 v[192:193], v4 offset:24576
 s_add_u32 s33, s33, s25
 v_mfma_f32_16x16x32_bf16 v[64:67], v[104:107], v[88:91], 0
 ds_read_b64_tr_b16 v[194:195], v4 offset:28672
 s_add_u32 s32, s32, 1
 v_mfma_f32_16x16x32_bf16 v[64:67], v[136:139], v[120:123], v[64:67]
 buffer_load_dwordx4 v1, s[16:19], s57 offen offset:1024 sc1 lds
 v_mfma_f32_16x16x32_bf16 v[72:75], v[104:107], v[92:95], 0
 ds_read_b128 v[144:147], v2 offset:49152
 s_and_b32 s32, s32, 7
 v_mfma_f32_16x16x32_bf16 v[72:75], v[136:139], v[124:127], v[72:75]
 ds_read_b128 v[176:179], v2 offset:51200
 v_mfma_f32_16x16x32_bf16 v[52:55], v[108:111], v[80:83], 0
 ds_read_b128 v[148:151], v2 offset:50176
 v_mfma_f32_16x16x32_bf16 v[52:55], v[140:143], v[112:115], v[52:55]
 buffer_load_dwordx4 v1, s[16:19], s57 offen offset:2048 sc1 lds
 v_mfma_f32_16x16x32_bf16 v[60:63], v[108:111], v[84:87], 0
 ds_read_b128 v[180:183], v2 offset:52224
 ds_read_b128 v[152:155], v3 offset:49152
 v_mfma_f32_16x16x32_bf16 v[60:63], v[140:143], v[116:119], v[60:63]
 ds_read_b128 v[184:187], v3 offset:51200
 v_mfma_f32_16x16x32_bf16 v[68:71], v[108:111], v[88:91], 0
 ds_read_b128 v[156:159], v3 offset:50176
 v_mfma_f32_16x16x32_bf16 v[68:71], v[140:143], v[120:123], v[68:71]
 buffer_load_dwordx4 v1, s[16:19], s57 offen offset:3072 sc1 lds
 v_mfma_f32_16x16x32_bf16 v[76:79], v[108:111], v[92:95], 0
 ds_read_b128 v[188:191], v3 offset:52224
 s_add_u32 s57, s57, 4096
 v_mfma_f32_16x16x32_bf16 v[76:79], v[140:143], v[124:127], v[76:79]
 ds_read_b64_tr_b16 v[164:165], v5 offset:16384
 s_waitcnt lgkmcnt(5)
 v_mfma_f32_16x16x32_bf16 v[16:19], v[160:163], v[144:147], v[16:19]
 ds_read_b64_tr_b16 v[166:167], v5 offset:20480
 v_mfma_f32_16x16x32_bf16 v[16:19], v[192:195], v[176:179], v[16:19]
 ds_read_b64_tr_b16 v[196:197], v5 offset:24576
 v_mfma_f32_16x16x32_bf16 v[24:27], v[192:195], v[180:183], v[24:27]
 ds_read_b64_tr_b16 v[198:199], v5 offset:28672
 v_mfma_f32_16x16x32_bf16 v[24:27], v[160:163], v[148:151], v[24:27]
 ds_read_b64_tr_b16 v[168:169], v14 offset:16384
 s_waitcnt lgkmcnt(5)
 s_add_u32 m0, s50, 0
 v_mfma_f32_16x16x32_bf16 v[32:35], v[160:163], v[152:155], v[32:35]
 buffer_load_dwordx4 v232, s[8:11], s33 offen offset:0  lds
 v_mfma_f32_16x16x32_bf16 v[32:35], v[192:195], v[184:187], v[32:35]
 ds_read_b64_tr_b16 v[170:171], v14 offset:20480
 v_mfma_f32_16x16x32_bf16 v[40:43], v[192:195], v[188:191], v[40:43]
 ds_read_b64_tr_b16 v[200:201], v14 offset:24576
 v_mfma_f32_16x16x32_bf16 v[40:43], v[160:163], v[156:159], v[40:43]
 ds_read_b64_tr_b16 v[202:203], v14 offset:28672
 s_waitcnt lgkmcnt(4)
 v_mfma_f32_16x16x32_bf16 v[20:23], v[164:167], v[144:147], v[20:23]
 ds_read_b64_tr_b16 v[172:173], v15 offset:16384
 v_mfma_f32_16x16x32_bf16 v[20:23], v[196:199], v[176:179], v[20:23]
 ds_read_b64_tr_b16 v[174:175], v15 offset:20480
 v_mfma_f32_16x16x32_bf16 v[28:31], v[196:199], v[180:183], v[28:31]
 ds_read_b64_tr_b16 v[204:205], v15 offset:24576
 v_mfma_f32_16x16x32_bf16 v[28:31], v[164:167], v[148:151], v[28:31]
 ds_read_b64_tr_b16 v[206:207], v15 offset:28672
 v_mfma_f32_16x16x32_bf16 v[36:39], v[164:167], v[152:155], v[36:39]
 buffer_load_dwordx4 v233, s[8:11], s33 offen offset:1024  lds
 v_mfma_f32_16x16x32_bf16 v[36:39], v[196:199], v[184:187], v[36:39]
 buffer_load_dwordx4 v234, s[8:11], s33 offen offset:2048  lds
 v_mfma_f32_16x16x32_bf16 v[44:47], v[196:199], v[188:191], v[44:47]
 buffer_load_dwordx4 v235, s[8:11], s33 offen offset:3072  lds
 v_mfma_f32_16x16x32_bf16 v[44:47], v[164:167], v[156:159], v[44:47]
 s_waitcnt vmcnt(14) lgkmcnt(0)
 s_barrier
 v_mfma_f32_16x16x32_bf16 v[48:51], v[168:171], v[144:147], v[48:51]
 ds_read_b64_tr_b16 v[96:97], v224 offset:0
 s_add_u32 m0, s50, 49152
 v_mfma_f32_16x16x32_bf16 v[48:51], v[200:203], v[176:179], v[48:51]
 buffer_load_dwordx4 v1, s[16:19], s57 offen offset:0 sc1 lds
 v_mfma_f32_16x16x32_bf16 v[56:59], v[200:203], v[180:183], v[56:59]
 ds_read_b64_tr_b16 v[98:99], v224 offset:4096
 s_add_u32 s33, s33, 65536
 v_mfma_f32_16x16x32_bf16 v[56:59], v[168:171], v[148:151], v[56:59]
 ds_read_b64_tr_b16 v[128:129], v224 offset:8192
 v_mfma_f32_16x16x32_bf16 v[64:67], v[168:171], v[152:155], v[64:67]
 ds_read_b64_tr_b16 v[130:131], v224 offset:12288
 v_mfma_f32_16x16x32_bf16 v[64:67], v[200:203], v[184:187], v[64:67]
 buffer_load_dwordx4 v1, s[16:19], s57 offen offset:1024 sc1 lds
 v_mfma_f32_16x16x32_bf16 v[72:75], v[200:203], v[188:191], v[72:75]
 ds_read_b128 v[80:83], v236 offset:32768
 v_mfma_f32_16x16x32_bf16 v[72:75], v[168:171], v[156:159], v[72:75]
 ds_read_b128 v[112:115], v236 offset:34816
 v_mfma_f32_16x16x32_bf16 v[52:55], v[172:175], v[144:147], v[52:55]
 ds_read_b128 v[84:87], v236 offset:33792
 v_mfma_f32_16x16x32_bf16 v[52:55], v[204:207], v[176:179], v[52:55]
 buffer_load_dwordx4 v1, s[16:19], s57 offen offset:2048 sc1 lds
 v_mfma_f32_16x16x32_bf16 v[60:63], v[204:207], v[180:183], v[60:63]
 ds_read_b128 v[116:119], v236 offset:35840
 ds_read_b128 v[88:91], v237 offset:32768
 v_mfma_f32_16x16x32_bf16 v[60:63], v[172:175], v[148:151], v[60:63]
 ds_read_b128 v[120:123], v237 offset:34816
 v_mfma_f32_16x16x32_bf16 v[68:71], v[172:175], v[152:155], v[68:71]
 ds_read_b128 v[92:95], v237 offset:33792
 v_mfma_f32_16x16x32_bf16 v[68:71], v[204:207], v[184:187], v[68:71]
 buffer_load_dwordx4 v1, s[16:19], s57 offen offset:3072 sc1 lds
 v_mfma_f32_16x16x32_bf16 v[76:79], v[204:207], v[188:191], v[76:79]
 ds_read_b128 v[124:127], v237 offset:35840
 s_lshl_b32 s57, s35, 13
 v_mfma_f32_16x16x32_bf16 v[76:79], v[172:175], v[156:159], v[76:79]
 ds_read_b64_tr_b16 v[100:101], v225 offset:0
 s_waitcnt lgkmcnt(5)
 v_mfma_f32_16x16x32_bf16 v[16:19], v[96:99], v[80:83], v[16:19]
 ds_read_b64_tr_b16 v[102:103], v225 offset:4096
 s_add_u32 s57, s57, s98
 v_mfma_f32_16x16x32_bf16 v[16:19], v[128:131], v[112:115], v[16:19]
 ds_read_b64_tr_b16 v[132:133], v225 offset:8192
 s_add_u32 s35, s35, 1
 v_mfma_f32_16x16x32_bf16 v[24:27], v[128:131], v[116:119], v[24:27]
 ds_read_b64_tr_b16 v[134:135], v225 offset:12288
 s_and_b32 s35, s35, 7
 v_mfma_f32_16x16x32_bf16 v[24:27], v[96:99], v[84:87], v[24:27]
 ds_read_b64_tr_b16 v[104:105], v226 offset:0
 s_waitcnt lgkmcnt(5)
 s_add_u32 m0, s50, 16384
 v_mfma_f32_16x16x32_bf16 v[32:35], v[96:99], v[88:91], v[32:35]
 buffer_load_dwordx4 v232, s[8:11], s33 offen offset:0  lds
 v_mfma_f32_16x16x32_bf16 v[32:35], v[128:131], v[120:123], v[32:35]
 ds_read_b64_tr_b16 v[106:107], v226 offset:4096
 v_mfma_f32_16x16x32_bf16 v[40:43], v[128:131], v[124:127], v[40:43]
 ds_read_b64_tr_b16 v[136:137], v226 offset:8192
 v_mfma_f32_16x16x32_bf16 v[40:43], v[96:99], v[92:95], v[40:43]
 ds_read_b64_tr_b16 v[138:139], v226 offset:12288
 s_waitcnt lgkmcnt(4)
 v_mfma_f32_16x16x32_bf16 v[20:23], v[100:103], v[80:83], v[20:23]
 ds_read_b64_tr_b16 v[108:109], v227 offset:0
 v_mfma_f32_16x16x32_bf16 v[20:23], v[132:135], v[112:115], v[20:23]
 ds_read_b64_tr_b16 v[110:111], v227 offset:4096
 v_mfma_f32_16x16x32_bf16 v[28:31], v[132:135], v[116:119], v[28:31]
 ds_read_b64_tr_b16 v[140:141], v227 offset:8192
 v_mfma_f32_16x16x32_bf16 v[28:31], v[100:103], v[84:87], v[28:31]
 ds_read_b64_tr_b16 v[142:143], v227 offset:12288
 v_mfma_f32_16x16x32_bf16 v[36:39], v[100:103], v[88:91], v[36:39]
 buffer_load_dwordx4 v233, s[8:11], s33 offen offset:1024  lds
 v_mfma_f32_16x16x32_bf16 v[36:39], v[132:135], v[120:123], v[36:39]
 buffer_load_dwordx4 v234, s[8:11], s33 offen offset:2048  lds
 v_mfma_f32_16x16x32_bf16 v[44:47], v[132:135], v[124:127], v[44:47]
 buffer_load_dwordx4 v235, s[8:11], s33 offen offset:3072  lds
 v_mfma_f32_16x16x32_bf16 v[44:47], v[100:103], v[92:95], v[44:47]
 s_waitcnt vmcnt(18) lgkmcnt(0)
 s_barrier
 v_mfma_f32_16x16x32_bf16 v[48:51], v[104:107], v[80:83], v[48:51]
 ds_read_b64_tr_b16 v[160:161], v224 offset:16384
 s_add_u32 m0, s50, 98304
 v_mfma_f32_16x16x32_bf16 v[48:51], v[136:139], v[112:115], v[48:51]
 buffer_load_dwordx4 v1, s[16:19], s57 offen offset:0 sc1 lds
 v_mfma_f32_16x16x32_bf16 v[56:59], v[136:139], v[116:119], v[56:59]
 ds_read_b64_tr_b16 v[162:163], v224 offset:20480
 s_lshl_b32 s33, s32, 17
 v_mfma_f32_16x16x32_bf16 v[56:59], v[104:107], v[84:87], v[56:59]
 ds_read_b64_tr_b16 v[192:193], v224 offset:24576
 s_add_u32 s33, s33, s25
 v_mfma_f32_16x16x32_bf16 v[64:67], v[104:107], v[88:91], v[64:67]
 ds_read_b64_tr_b16 v[194:195], v224 offset:28672
 s_add_u32 s32, s32, 1
 v_mfma_f32_16x16x32_bf16 v[64:67], v[136:139], v[120:123], v[64:67]
 buffer_load_dwordx4 v1, s[16:19], s57 offen offset:1024 sc1 lds
 v_mfma_f32_16x16x32_bf16 v[72:75], v[136:139], v[124:127], v[72:75]
 ds_read_b128 v[144:147], v236 offset:49152
 s_and_b32 s32, s32, 7
 v_mfma_f32_16x16x32_bf16 v[72:75], v[104:107], v[92:95], v[72:75]
 ds_read_b128 v[176:179], v236 offset:51200
 v_mfma_f32_16x16x32_bf16 v[52:55], v[108:111], v[80:83], v[52:55]
 ds_read_b128 v[148:151], v236 offset:50176
 v_mfma_f32_16x16x32_bf16 v[52:55], v[140:143], v[112:115], v[52:55]
 buffer_load_dwordx4 v1, s[16:19], s57 offen offset:2048 sc1 lds
 v_mfma_f32_16x16x32_bf16 v[60:63], v[140:143], v[116:119], v[60:63]
 ds_read_b128 v[180:183], v236 offset:52224
 ds_read_b128 v[152:155], v237 offset:49152
 v_mfma_f32_16x16x32_bf16 v[60:63], v[108:111], v[84:87], v[60:63]
 ds_read_b128 v[184:187], v237 offset:51200
 v_mfma_f32_16x16x32_bf16 v[68:71], v[108:111], v[88:91], v[68:71]
 ds_read_b128 v[156:159], v237 offset:50176
 v_mfma_f32_16x16x32_bf16 v[68:71], v[140:143], v[120:123], v[68:71]
 buffer_load_dwordx4 v1, s[16:19], s57 offen offset:3072 sc1 lds
 v_mfma_f32_16x16x32_bf16 v[76:79], v[140:143], v[124:127], v[76:79]
 ds_read_b128 v[188:191], v237 offset:52224
 s_add_u32 s57, s57, 4096
 v_mfma_f32_16x16x32_bf16 v[76:79], v[108:111], v[92:95], v[76:79]
 ds_read_b64_tr_b16 v[164:165], v225 offset:16384
 s_waitcnt lgkmcnt(5)
 v_mfma_f32_16x16x32_bf16 v[16:19], v[160:163], v[144:147], v[16:19]
 ds_read_b64_tr_b16 v[166:167], v225 offset:20480
 v_mfma_f32_16x16x32_bf16 v[16:19], v[192:195], v[176:179], v[16:19]
 ds_read_b64_tr_b16 v[196:197], v225 offset:24576
 v_mfma_f32_16x16x32_bf16 v[24:27], v[192:195], v[180:183], v[24:27]
 ds_read_b64_tr_b16 v[198:199], v225 offset:28672
 v_mfma_f32_16x16x32_bf16 v[24:27], v[160:163], v[148:151], v[24:27]
 ds_read_b64_tr_b16 v[168:169], v226 offset:16384
 s_waitcnt lgkmcnt(5)
 s_add_u32 m0, s50, 65536
 v_mfma_f32_16x16x32_bf16 v[32:35], v[160:163], v[152:155], v[32:35]
 buffer_load_dwordx4 v232, s[8:11], s33 offen offset:0  lds
 v_mfma_f32_16x16x32_bf16 v[32:35], v[192:195], v[184:187], v[32:35]
 ds_read_b64_tr_b16 v[170:171], v226 offset:20480
 v_mfma_f32_16x16x32_bf16 v[40:43], v[192:195], v[188:191], v[40:43]
 ds_read_b64_tr_b16 v[200:201], v226 offset:24576
 v_mfma_f32_16x16x32_bf16 v[40:43], v[160:163], v[156:159], v[40:43]
 ds_read_b64_tr_b16 v[202:203], v226 offset:28672
 s_waitcnt lgkmcnt(4)
 v_mfma_f32_16x16x32_bf16 v[20:23], v[164:167], v[144:147], v[20:23]
 ds_read_b64_tr_b16 v[172:173], v227 offset:16384
 v_mfma_f32_16x16x32_bf16 v[20:23], v[196:199], v[176:179], v[20:23]
 ds_read_b64_tr_b16 v[174:175], v227 offset:20480
 v_mfma_f32_16x16x32_bf16 v[28:31], v[196:199], v[180:183], v[28:31]
 ds_read_b64_tr_b16 v[204:205], v227 offset:24576
 v_mfma_f32_16x16x32_bf16 v[28:31], v[164:167], v[148:151], v[28:31]
 ds_read_b64_tr_b16 v[206:207], v227 offset:28672
 v_mfma_f32_16x16x32_bf16 v[36:39], v[164:167], v[152:155], v[36:39]
 buffer_load_dwordx4 v233, s[8:11], s33 offen offset:1024  lds
 v_mfma_f32_16x16x32_bf16 v[36:39], v[196:199], v[184:187], v[36:39]
 buffer_load_dwordx4 v234, s[8:11], s33 offen offset:2048  lds
 v_mfma_f32_16x16x32_bf16 v[44:47], v[196:199], v[188:191], v[44:47]
 buffer_load_dwordx4 v235, s[8:11], s33 offen offset:3072  lds
 v_mfma_f32_16x16x32_bf16 v[44:47], v[164:167], v[156:159], v[44:47]
 s_waitcnt vmcnt(20) lgkmcnt(0)
 s_barrier
 v_mfma_f32_16x16x32_bf16 v[48:51], v[168:171], v[144:147], v[48:51]
 ds_read_b64_tr_b16 v[96:97], v228 offset:0
 s_add_u32 m0, s50, 114688
 v_mfma_f32_16x16x32_bf16 v[48:51], v[200:203], v[176:179], v[48:51]
 buffer_load_dwordx4 v1, s[16:19], s57 offen offset:0 sc1 lds
 v_mfma_f32_16x16x32_bf16 v[56:59], v[200:203], v[180:183], v[56:59]
 ds_read_b64_tr_b16 v[98:99], v228 offset:4096
 s_add_u32 s33, s33, 65536
 v_mfma_f32_16x16x32_bf16 v[56:59], v[168:171], v[148:151], v[56:59]
 ds_read_b64_tr_b16 v[128:129], v228 offset:8192
 v_mfma_f32_16x16x32_bf16 v[64:67], v[168:171], v[152:155], v[64:67]
 ds_read_b64_tr_b16 v[130:131], v228 offset:12288
 v_mfma_f32_16x16x32_bf16 v[64:67], v[200:203], v[184:187], v[64:67]
 buffer_load_dwordx4 v1, s[16:19], s57 offen offset:1024 sc1 lds
 v_mfma_f32_16x16x32_bf16 v[72:75], v[200:203], v[188:191], v[72:75]
 ds_read_b128 v[80:83], v2 offset:32768
 v_mfma_f32_16x16x32_bf16 v[72:75], v[168:171], v[156:159], v[72:75]
 ds_read_b128 v[112:115], v2 offset:34816
 v_mfma_f32_16x16x32_bf16 v[52:55], v[172:175], v[144:147], v[52:55]
 ds_read_b128 v[84:87], v2 offset:33792
 v_mfma_f32_16x16x32_bf16 v[52:55], v[204:207], v[176:179], v[52:55]
 buffer_load_dwordx4 v1, s[16:19], s57 offen offset:2048 sc1 lds
 v_mfma_f32_16x16x32_bf16 v[60:63], v[204:207], v[180:183], v[60:63]
 ds_read_b128 v[116:119], v2 offset:35840
 ds_read_b128 v[88:91], v3 offset:32768
 v_mfma_f32_16x16x32_bf16 v[60:63], v[172:175], v[148:151], v[60:63]
 ds_read_b128 v[120:123], v3 offset:34816
 v_mfma_f32_16x16x32_bf16 v[68:71], v[172:175], v[152:155], v[68:71]
 ds_read_b128 v[92:95], v3 offset:33792
 v_mfma_f32_16x16x32_bf16 v[68:71], v[204:207], v[184:187], v[68:71]
 buffer_load_dwordx4 v1, s[16:19], s57 offen offset:3072 sc1 lds
 v_mfma_f32_16x16x32_bf16 v[76:79], v[204:207], v[188:191], v[76:79]
 ds_read_b128 v[124:127], v3 offset:35840
 s_lshl_b32 s57, s35, 13
 v_mfma_f32_16x16x32_bf16 v[76:79], v[172:175], v[156:159], v[76:79]
 ds_read_b64_tr_b16 v[100:101], v229 offset:0
 s_waitcnt lgkmcnt(5)
 v_mfma_f32_16x16x32_bf16 v[16:19], v[96:99], v[80:83], v[16:19]
 ds_read_b64_tr_b16 v[102:103], v229 offset:4096
 s_add_u32 s57, s57, s98
 v_mfma_f32_16x16x32_bf16 v[16:19], v[128:131], v[112:115], v[16:19]
 ds_read_b64_tr_b16 v[132:133], v229 offset:8192
 s_add_u32 s35, s35, 1
 v_mfma_f32_16x16x32_bf16 v[24:27], v[128:131], v[116:119], v[24:27]
 ds_read_b64_tr_b16 v[134:135], v229 offset:12288
 s_and_b32 s35, s35, 7
 v_mfma_f32_16x16x32_bf16 v[24:27], v[96:99], v[84:87], v[24:27]
 ds_read_b64_tr_b16 v[104:105], v230 offset:0
 s_waitcnt lgkmcnt(5)
 s_add_u32 m0, s50, 81920
 v_mfma_f32_16x16x32_bf16 v[32:35], v[96:99], v[88:91], v[32:35]
 buffer_load_dwordx4 v232, s[8:11], s33 offen offset:0  lds
 v_mfma_f32_16x16x32_bf16 v[32:35], v[128:131], v[120:123], v[32:35]
 ds_read_b64_tr_b16 v[106:107], v230 offset:4096
 v_mfma_f32_16x16x32_bf16 v[40:43], v[128:131], v[124:127], v[40:43]
 ds_read_b64_tr_b16 v[136:137], v230 offset:8192
 v_mfma_f32_16x16x32_bf16 v[40:43], v[96:99], v[92:95], v[40:43]
 ds_read_b64_tr_b16 v[138:139], v230 offset:12288
 s_waitcnt lgkmcnt(4)
 v_mfma_f32_16x16x32_bf16 v[20:23], v[100:103], v[80:83], v[20:23]
 ds_read_b64_tr_b16 v[108:109], v231 offset:0
 v_mfma_f32_16x16x32_bf16 v[20:23], v[132:135], v[112:115], v[20:23]
 ds_read_b64_tr_b16 v[110:111], v231 offset:4096
 v_mfma_f32_16x16x32_bf16 v[28:31], v[132:135], v[116:119], v[28:31]
 ds_read_b64_tr_b16 v[140:141], v231 offset:8192
 v_mfma_f32_16x16x32_bf16 v[28:31], v[100:103], v[84:87], v[28:31]
 ds_read_b64_tr_b16 v[142:143], v231 offset:12288
 v_mfma_f32_16x16x32_bf16 v[36:39], v[100:103], v[88:91], v[36:39]
 buffer_load_dwordx4 v233, s[8:11], s33 offen offset:1024  lds
 v_mfma_f32_16x16x32_bf16 v[36:39], v[132:135], v[120:123], v[36:39]
 buffer_load_dwordx4 v234, s[8:11], s33 offen offset:2048  lds
 v_mfma_f32_16x16x32_bf16 v[44:47], v[132:135], v[124:127], v[44:47]
 buffer_load_dwordx4 v235, s[8:11], s33 offen offset:3072  lds
 v_mfma_f32_16x16x32_bf16 v[44:47], v[100:103], v[92:95], v[44:47]
 s_waitcnt vmcnt(20) lgkmcnt(0)
 s_barrier
 v_mfma_f32_16x16x32_bf16 v[48:51], v[104:107], v[80:83], v[48:51]
 ds_read_b64_tr_b16 v[160:161], v228 offset:16384
 s_add_u32 m0, s50, 32768
 v_mfma_f32_16x16x32_bf16 v[48:51], v[136:139], v[112:115], v[48:51]
 buffer_load_dwordx4 v1, s[16:19], s57 offen offset:0 sc1 lds
 v_mfma_f32_16x16x32_bf16 v[56:59], v[136:139], v[116:119], v[56:59]
 ds_read_b64_tr_b16 v[162:163], v228 offset:20480
 s_lshl_b32 s33, s32, 17
 v_mfma_f32_16x16x32_bf16 v[56:59], v[104:107], v[84:87], v[56:59]
 ds_read_b64_tr_b16 v[192:193], v228 offset:24576
 s_add_u32 s33, s33, s25
 v_mfma_f32_16x16x32_bf16 v[64:67], v[104:107], v[88:91], v[64:67]
 ds_read_b64_tr_b16 v[194:195], v228 offset:28672
 s_add_u32 s32, s32, 1
 v_mfma_f32_16x16x32_bf16 v[64:67], v[136:139], v[120:123], v[64:67]
 buffer_load_dwordx4 v1, s[16:19], s57 offen offset:1024 sc1 lds
 v_mfma_f32_16x16x32_bf16 v[72:75], v[136:139], v[124:127], v[72:75]
 ds_read_b128 v[144:147], v2 offset:49152
 s_and_b32 s32, s32, 7
 v_mfma_f32_16x16x32_bf16 v[72:75], v[104:107], v[92:95], v[72:75]
 ds_read_b128 v[176:179], v2 offset:51200
 v_mfma_f32_16x16x32_bf16 v[52:55], v[108:111], v[80:83], v[52:55]
 ds_read_b128 v[148:151], v2 offset:50176
 v_mfma_f32_16x16x32_bf16 v[52:55], v[140:143], v[112:115], v[52:55]
 buffer_load_dwordx4 v1, s[16:19], s57 offen offset:2048 sc1 lds
 v_mfma_f32_16x16x32_bf16 v[60:63], v[140:143], v[116:119], v[60:63]
 ds_read_b128 v[180:183], v2 offset:52224
 ds_read_b128 v[152:155], v3 offset:49152
 v_mfma_f32_16x16x32_bf16 v[60:63], v[108:111], v[84:87], v[60:63]
 ds_read_b128 v[184:187], v3 offset:51200
 v_mfma_f32_16x16x32_bf16 v[68:71], v[108:111], v[88:91], v[68:71]
 ds_read_b128 v[156:159], v3 offset:50176
 v_mfma_f32_16x16x32_bf16 v[68:71], v[140:143], v[120:123], v[68:71]
 buffer_load_dwordx4 v1, s[16:19], s57 offen offset:3072 sc1 lds
 v_mfma_f32_16x16x32_bf16 v[76:79], v[140:143], v[124:127], v[76:79]
 ds_read_b128 v[188:191], v3 offset:52224
 s_add_u32 s57, s57, 4096
 v_mfma_f32_16x16x32_bf16 v[76:79], v[108:111], v[92:95], v[76:79]
 ds_read_b64_tr_b16 v[164:165], v229 offset:16384
 s_waitcnt lgkmcnt(5)
 v_mfma_f32_16x16x32_bf16 v[16:19], v[160:163], v[144:147], v[16:19]
 ds_read_b64_tr_b16 v[166:167], v229 offset:20480
 v_mfma_f32_16x16x32_bf16 v[16:19], v[192:195], v[176:179], v[16:19]
 ds_read_b64_tr_b16 v[196:197], v229 offset:24576
 v_mfma_f32_16x16x32_bf16 v[24:27], v[192:195], v[180:183], v[24:27]
 ds_read_b64_tr_b16 v[198:199], v229 offset:28672
 buffer_store_dword v222, v221, s[16:19], s96 offen sc1
 v_mfma_f32_16x16x32_bf16 v[24:27], v[160:163], v[148:151], v[24:27]
 ds_read_b64_tr_b16 v[168:169], v230 offset:16384
 s_waitcnt lgkmcnt(5)
 s_add_u32 m0, s50, 131072
 v_mfma_f32_16x16x32_bf16 v[32:35], v[160:163], v[152:155], v[32:35]
 buffer_load_dwordx4 v232, s[8:11], s33 offen offset:0  lds
 v_mfma_f32_16x16x32_bf16 v[32:35], v[192:195], v[184:187], v[32:35]
 ds_read_b64_tr_b16 v[170:171], v230 offset:20480
 v_mfma_f32_16x16x32_bf16 v[40:43], v[192:195], v[188:191], v[40:43]
 ds_read_b64_tr_b16 v[200:201], v230 offset:24576
 v_mfma_f32_16x16x32_bf16 v[40:43], v[160:163], v[156:159], v[40:43]
 ds_read_b64_tr_b16 v[202:203], v230 offset:28672
 s_waitcnt lgkmcnt(4)
 v_mfma_f32_16x16x32_bf16 v[20:23], v[164:167], v[144:147], v[20:23]
 ds_read_b64_tr_b16 v[172:173], v231 offset:16384
 v_mfma_f32_16x16x32_bf16 v[20:23], v[196:199], v[176:179], v[20:23]
 ds_read_b64_tr_b16 v[174:175], v231 offset:20480
 v_mfma_f32_16x16x32_bf16 v[28:31], v[196:199], v[180:183], v[28:31]
 ds_read_b64_tr_b16 v[204:205], v231 offset:24576
 v_mfma_f32_16x16x32_bf16 v[28:31], v[164:167], v[148:151], v[28:31]
 ds_read_b64_tr_b16 v[206:207], v231 offset:28672
 v_mfma_f32_16x16x32_bf16 v[36:39], v[164:167], v[152:155], v[36:39]
 buffer_load_dwordx4 v233, s[8:11], s33 offen offset:1024  lds
 v_mfma_f32_16x16x32_bf16 v[36:39], v[196:199], v[184:187], v[36:39]
 buffer_load_dwordx4 v234, s[8:11], s33 offen offset:2048  lds
 v_mfma_f32_16x16x32_bf16 v[44:47], v[196:199], v[188:191], v[44:47]
 buffer_load_dwordx4 v235, s[8:11], s33 offen offset:3072  lds
 v_mfma_f32_16x16x32_bf16 v[44:47], v[164:167], v[156:159], v[44:47]
 s_waitcnt vmcnt(21) lgkmcnt(0)
 s_barrier
 v_mfma_f32_16x16x32_bf16 v[48:51], v[168:171], v[144:147], v[48:51]
 ds_read_b64_tr_b16 v[96:97], v4 offset:0
 s_add_u32 m0, s50, 49152
 v_mfma_f32_16x16x32_bf16 v[48:51], v[200:203], v[176:179], v[48:51]
 buffer_load_dwordx4 v1, s[16:19], s57 offen offset:0 sc1 lds
 v_mfma_f32_16x16x32_bf16 v[56:59], v[200:203], v[180:183], v[56:59]
 ds_read_b64_tr_b16 v[98:99], v4 offset:4096
 s_add_u32 s33, s33, 65536
 v_mfma_f32_16x16x32_bf16 v[56:59], v[168:171], v[148:151], v[56:59]
 ds_read_b64_tr_b16 v[128:129], v4 offset:8192
 v_mfma_f32_16x16x32_bf16 v[64:67], v[168:171], v[152:155], v[64:67]
 ds_read_b64_tr_b16 v[130:131], v4 offset:12288
 v_mfma_f32_16x16x32_bf16 v[64:67], v[200:203], v[184:187], v[64:67]
 buffer_load_dwordx4 v1, s[16:19], s57 offen offset:1024 sc1 lds
 v_mfma_f32_16x16x32_bf16 v[72:75], v[200:203], v[188:191], v[72:75]
 ds_read_b128 v[80:83], v236 offset:32768
 v_mfma_f32_16x16x32_bf16 v[72:75], v[168:171], v[156:159], v[72:75]
 ds_read_b128 v[112:115], v236 offset:34816
 v_mfma_f32_16x16x32_bf16 v[52:55], v[172:175], v[144:147], v[52:55]
 ds_read_b128 v[84:87], v236 offset:33792
 v_mfma_f32_16x16x32_bf16 v[52:55], v[204:207], v[176:179], v[52:55]
 buffer_load_dwordx4 v1, s[16:19], s57 offen offset:2048 sc1 lds
 v_mfma_f32_16x16x32_bf16 v[60:63], v[204:207], v[180:183], v[60:63]
 ds_read_b128 v[116:119], v236 offset:35840
 ds_read_b128 v[88:91], v237 offset:32768
 v_mfma_f32_16x16x32_bf16 v[60:63], v[172:175], v[148:151], v[60:63]
 ds_read_b128 v[120:123], v237 offset:34816
 v_mfma_f32_16x16x32_bf16 v[68:71], v[172:175], v[152:155], v[68:71]
 ds_read_b128 v[92:95], v237 offset:33792
 v_mfma_f32_16x16x32_bf16 v[68:71], v[204:207], v[184:187], v[68:71]
 buffer_load_dwordx4 v1, s[16:19], s57 offen offset:3072 sc1 lds
 v_mfma_f32_16x16x32_bf16 v[76:79], v[204:207], v[188:191], v[76:79]
 ds_read_b128 v[124:127], v237 offset:35840
 s_lshl_b32 s57, s35, 13
 v_mfma_f32_16x16x32_bf16 v[76:79], v[172:175], v[156:159], v[76:79]
 ds_read_b64_tr_b16 v[100:101], v5 offset:0
 s_waitcnt lgkmcnt(5)
 v_mfma_f32_16x16x32_bf16 v[16:19], v[96:99], v[80:83], v[16:19]
 ds_read_b64_tr_b16 v[102:103], v5 offset:4096
 s_add_u32 s57, s57, s98
 v_mfma_f32_16x16x32_bf16 v[16:19], v[128:131], v[112:115], v[16:19]
 ds_read_b64_tr_b16 v[132:133], v5 offset:8192
 s_add_u32 s35, s35, 1
 v_mfma_f32_16x16x32_bf16 v[24:27], v[128:131], v[116:119], v[24:27]
 ds_read_b64_tr_b16 v[134:135], v5 offset:12288
 s_and_b32 s35, s35, 7
 v_mfma_f32_16x16x32_bf16 v[24:27], v[96:99], v[84:87], v[24:27]
 ds_read_b64_tr_b16 v[104:105], v14 offset:0
 s_waitcnt lgkmcnt(5)
 s_add_u32 m0, s50, 147456
 v_mfma_f32_16x16x32_bf16 v[32:35], v[96:99], v[88:91], v[32:35]
 buffer_load_dwordx4 v232, s[8:11], s33 offen offset:0  lds
 v_mfma_f32_16x16x32_bf16 v[32:35], v[128:131], v[120:123], v[32:35]
 ds_read_b64_tr_b16 v[106:107], v14 offset:4096
 v_mfma_f32_16x16x32_bf16 v[40:43], v[128:131], v[124:127], v[40:43]
 ds_read_b64_tr_b16 v[136:137], v14 offset:8192
 v_mfma_f32_16x16x32_bf16 v[40:43], v[96:99], v[92:95], v[40:43]
 ds_read_b64_tr_b16 v[138:139], v14 offset:12288
 s_waitcnt lgkmcnt(4)
 v_mfma_f32_16x16x32_bf16 v[20:23], v[100:103], v[80:83], v[20:23]
 ds_read_b64_tr_b16 v[108:109], v15 offset:0
 v_mfma_f32_16x16x32_bf16 v[20:23], v[132:135], v[112:115], v[20:23]
 ds_read_b64_tr_b16 v[110:111], v15 offset:4096
 v_mfma_f32_16x16x32_bf16 v[28:31], v[132:135], v[116:119], v[28:31]
 ds_read_b64_tr_b16 v[140:141], v15 offset:8192
 v_mfma_f32_16x16x32_bf16 v[28:31], v[100:103], v[84:87], v[28:31]
 ds_read_b64_tr_b16 v[142:143], v15 offset:12288
 v_mfma_f32_16x16x32_bf16 v[36:39], v[100:103], v[88:91], v[36:39]
 buffer_load_dwordx4 v233, s[8:11], s33 offen offset:1024  lds
 v_mfma_f32_16x16x32_bf16 v[36:39], v[132:135], v[120:123], v[36:39]
 buffer_load_dwordx4 v234, s[8:11], s33 offen offset:2048  lds
 v_mfma_f32_16x16x32_bf16 v[44:47], v[132:135], v[124:127], v[44:47]
 buffer_load_dwordx4 v235, s[8:11], s33 offen offset:3072  lds
 v_mfma_f32_16x16x32_bf16 v[44:47], v[100:103], v[92:95], v[44:47]
 s_waitcnt vmcnt(21) lgkmcnt(0)
 s_barrier
 v_mfma_f32_16x16x32_bf16 v[48:51], v[104:107], v[80:83], v[48:51]
 ds_read_b64_tr_b16 v[160:161], v4 offset:16384
 s_add_u32 m0, s50, 98304
 v_mfma_f32_16x16x32_bf16 v[48:51], v[136:139], v[112:115], v[48:51]
 buffer_load_dwordx4 v1, s[16:19], s57 offen offset:0 sc1 lds
 v_mfma_f32_16x16x32_bf16 v[56:59], v[136:139], v[116:119], v[56:59]
 ds_read_b64_tr_b16 v[162:163], v4 offset:20480
 s_lshl_b32 s33, s32, 17
 v_mfma_f32_16x16x32_bf16 v[56:59], v[104:107], v[84:87], v[56:59]
 ds_read_b64_tr_b16 v[192:193], v4 offset:24576
 s_add_u32 s33, s33, s25
 v_mfma_f32_16x16x32_bf16 v[64:67], v[104:107], v[88:91], v[64:67]
 ds_read_b64_tr_b16 v[194:195], v4 offset:28672
 s_add_u32 s32, s32, 1
 v_mfma_f32_16x16x32_bf16 v[64:67], v[136:139], v[120:123], v[64:67]
 buffer_load_dwordx4 v1, s[16:19], s57 offen offset:1024 sc1 lds
 v_mfma_f32_16x16x32_bf16 v[72:75], v[136:139], v[124:127], v[72:75]
 ds_read_b128 v[144:147], v236 offset:49152
 s_and_b32 s32, s32, 7
 v_mfma_f32_16x16x32_bf16 v[72:75], v[104:107], v[92:95], v[72:75]
 ds_read_b128 v[176:179], v236 offset:51200
 v_mfma_f32_16x16x32_bf16 v[52:55], v[108:111], v[80:83], v[52:55]
 ds_read_b128 v[148:151], v236 offset:50176
 v_mfma_f32_16x16x32_bf16 v[52:55], v[140:143], v[112:115], v[52:55]
 buffer_load_dwordx4 v1, s[16:19], s57 offen offset:2048 sc1 lds
 v_mfma_f32_16x16x32_bf16 v[60:63], v[140:143], v[116:119], v[60:63]
 ds_read_b128 v[180:183], v236 offset:52224
 ds_read_b128 v[152:155], v237 offset:49152
 v_mfma_f32_16x16x32_bf16 v[60:63], v[108:111], v[84:87], v[60:63]
 ds_read_b128 v[184:187], v237 offset:51200
 v_mfma_f32_16x16x32_bf16 v[68:71], v[108:111], v[88:91], v[68:71]
 ds_read_b128 v[156:159], v237 offset:50176
 v_mfma_f32_16x16x32_bf16 v[68:71], v[140:143], v[120:123], v[68:71]
 buffer_load_dwordx4 v1, s[16:19], s57 offen offset:3072 sc1 lds
 v_mfma_f32_16x16x32_bf16 v[76:79], v[140:143], v[124:127], v[76:79]
 ds_read_b128 v[188:191], v237 offset:52224
 s_add_u32 s57, s57, 4096
 v_mfma_f32_16x16x32_bf16 v[76:79], v[108:111], v[92:95], v[76:79]
 ds_read_b64_tr_b16 v[164:165], v5 offset:16384
 s_waitcnt lgkmcnt(5)
 v_mfma_f32_16x16x32_bf16 v[16:19], v[160:163], v[144:147], v[16:19]
 ds_read_b64_tr_b16 v[166:167], v5 offset:20480
 v_mfma_f32_16x16x32_bf16 v[16:19], v[192:195], v[176:179], v[16:19]
 ds_read_b64_tr_b16 v[196:197], v5 offset:24576
 v_mfma_f32_16x16x32_bf16 v[24:27], v[192:195], v[180:183], v[24:27]
 ds_read_b64_tr_b16 v[198:199], v5 offset:28672
 v_mfma_f32_16x16x32_bf16 v[24:27], v[160:163], v[148:151], v[24:27]
 ds_read_b64_tr_b16 v[168:169], v14 offset:16384
 s_waitcnt lgkmcnt(5)
 s_add_u32 m0, s50, 0
 v_mfma_f32_16x16x32_bf16 v[32:35], v[160:163], v[152:155], v[32:35]
 buffer_load_dwordx4 v232, s[8:11], s33 offen offset:0  lds
 v_mfma_f32_16x16x32_bf16 v[32:35], v[192:195], v[184:187], v[32:35]
 ds_read_b64_tr_b16 v[170:171], v14 offset:20480
 v_mfma_f32_16x16x32_bf16 v[40:43], v[192:195], v[188:191], v[40:43]
 ds_read_b64_tr_b16 v[200:201], v14 offset:24576
 v_mfma_f32_16x16x32_bf16 v[40:43], v[160:163], v[156:159], v[40:43]
 ds_read_b64_tr_b16 v[202:203], v14 offset:28672
 s_waitcnt lgkmcnt(4)
 v_mfma_f32_16x16x32_bf16 v[20:23], v[164:167], v[144:147], v[20:23]
 ds_read_b64_tr_b16 v[172:173], v15 offset:16384
 v_mfma_f32_16x16x32_bf16 v[20:23], v[196:199], v[176:179], v[20:23]
 ds_read_b64_tr_b16 v[174:175], v15 offset:20480
 v_mfma_f32_16x16x32_bf16 v[28:31], v[196:199], v[180:183], v[28:31]
 ds_read_b64_tr_b16 v[204:205], v15 offset:24576
 v_mfma_f32_16x16x32_bf16 v[28:31], v[164:167], v[148:151], v[28:31]
 ds_read_b64_tr_b16 v[206:207], v15 offset:28672
 v_mfma_f32_16x16x32_bf16 v[36:39], v[164:167], v[152:155], v[36:39]
 buffer_load_dwordx4 v233, s[8:11], s33 offen offset:1024  lds
 v_mfma_f32_16x16x32_bf16 v[36:39], v[196:199], v[184:187], v[36:39]
 buffer_load_dwordx4 v234, s[8:11], s33 offen offset:2048  lds
 v_mfma_f32_16x16x32_bf16 v[44:47], v[196:199], v[188:191], v[44:47]
 buffer_load_dwordx4 v235, s[8:11], s33 offen offset:3072  lds
 v_mfma_f32_16x16x32_bf16 v[44:47], v[164:167], v[156:159], v[44:47]
 s_waitcnt vmcnt(21) lgkmcnt(0)
 s_barrier
 v_mfma_f32_16x16x32_bf16 v[48:51], v[168:171], v[144:147], v[48:51]
 ds_read_b64_tr_b16 v[96:97], v224 offset:0
 s_add_u32 m0, s50, 114688
 v_mfma_f32_16x16x32_bf16 v[48:51], v[200:203], v[176:179], v[48:51]
 buffer_load_dwordx4 v1, s[16:19], s57 offen offset:0 sc1 lds
 v_mfma_f32_16x16x32_bf16 v[56:59], v[200:203], v[180:183], v[56:59]
 ds_read_b64_tr_b16 v[98:99], v224 offset:4096
 s_add_u32 s33, s33, 65536
 v_mfma_f32_16x16x32_bf16 v[56:59], v[168:171], v[148:151], v[56:59]
 ds_read_b64_tr_b16 v[128:129], v224 offset:8192
 v_mfma_f32_16x16x32_bf16 v[64:67], v[168:171], v[152:155], v[64:67]
 ds_read_b64_tr_b16 v[130:131], v224 offset:12288
 v_mfma_f32_16x16x32_bf16 v[64:67], v[200:203], v[184:187], v[64:67]
 buffer_load_dwordx4 v1, s[16:19], s57 offen offset:1024 sc1 lds
 v_mfma_f32_16x16x32_bf16 v[72:75], v[200:203], v[188:191], v[72:75]
 ds_read_b128 v[80:83], v2 offset:32768
 v_mfma_f32_16x16x32_bf16 v[72:75], v[168:171], v[156:159], v[72:75]
 ds_read_b128 v[112:115], v2 offset:34816
 v_mfma_f32_16x16x32_bf16 v[52:55], v[172:175], v[144:147], v[52:55]
 ds_read_b128 v[84:87], v2 offset:33792
 v_mfma_f32_16x16x32_bf16 v[52:55], v[204:207], v[176:179], v[52:55]
 buffer_load_dwordx4 v1, s[16:19], s57 offen offset:2048 sc1 lds
 v_mfma_f32_16x16x32_bf16 v[60:63], v[204:207], v[180:183], v[60:63]
 ds_read_b128 v[116:119], v2 offset:35840
 ds_read_b128 v[88:91], v3 offset:32768
 v_mfma_f32_16x16x32_bf16 v[60:63], v[172:175], v[148:151], v[60:63]
 ds_read_b128 v[120:123], v3 offset:34816
 v_mfma_f32_16x16x32_bf16 v[68:71], v[172:175], v[152:155], v[68:71]
 ds_read_b128 v[92:95], v3 offset:33792
 v_mfma_f32_16x16x32_bf16 v[68:71], v[204:207], v[184:187], v[68:71]
 buffer_load_dwordx4 v1, s[16:19], s57 offen offset:3072 sc1 lds
 v_mfma_f32_16x16x32_bf16 v[76:79], v[204:207], v[188:191], v[76:79]
 ds_read_b128 v[124:127], v3 offset:35840
 s_lshl_b32 s57, s35, 13
 v_mfma_f32_16x16x32_bf16 v[76:79], v[172:175], v[156:159], v[76:79]
 ds_read_b64_tr_b16 v[100:101], v225 offset:0
 s_waitcnt lgkmcnt(5)
 v_mfma_f32_16x16x32_bf16 v[16:19], v[96:99], v[80:83], v[16:19]
 ds_read_b64_tr_b16 v[102:103], v225 offset:4096
 s_add_u32 s57, s57, s98
 v_mfma_f32_16x16x32_bf16 v[16:19], v[128:131], v[112:115], v[16:19]
 ds_read_b64_tr_b16 v[132:133], v225 offset:8192
 s_add_u32 s35, s35, 1
 v_mfma_f32_16x16x32_bf16 v[24:27], v[128:131], v[116:119], v[24:27]
 ds_read_b64_tr_b16 v[134:135], v225 offset:12288
 s_and_b32 s35, s35, 7
 v_mfma_f32_16x16x32_bf16 v[24:27], v[96:99], v[84:87], v[24:27]
 ds_read_b64_tr_b16 v[104:105], v226 offset:0
 s_waitcnt lgkmcnt(5)
 s_add_u32 m0, s50, 16384
 v_mfma_f32_16x16x32_bf16 v[32:35], v[96:99], v[88:91], v[32:35]
 buffer_load_dwordx4 v232, s[8:11], s33 offen offset:0  lds
 v_mfma_f32_16x16x32_bf16 v[32:35], v[128:131], v[120:123], v[32:35]
 ds_read_b64_tr_b16 v[106:107], v226 offset:4096
 v_mfma_f32_16x16x32_bf16 v[40:43], v[128:131], v[124:127], v[40:43]
 ds_read_b64_tr_b16 v[136:137], v226 offset:8192
 v_mfma_f32_16x16x32_bf16 v[40:43], v[96:99], v[92:95], v[40:43]
 ds_read_b64_tr_b16 v[138:139], v226 offset:12288
 s_waitcnt lgkmcnt(4)
 v_mfma_f32_16x16x32_bf16 v[20:23], v[100:103], v[80:83], v[20:23]
 ds_read_b64_tr_b16 v[108:109], v227 offset:0
 v_mfma_f32_16x16x32_bf16 v[20:23], v[132:135], v[112:115], v[20:23]
 ds_read_b64_tr_b16 v[110:111], v227 offset:4096
 v_mfma_f32_16x16x32_bf16 v[28:31], v[132:135], v[116:119], v[28:31]
 ds_read_b64_tr_b16 v[140:141], v227 offset:8192
 v_mfma_f32_16x16x32_bf16 v[28:31], v[100:103], v[84:87], v[28:31]
 ds_read_b64_tr_b16 v[142:143], v227 offset:12288
 v_mfma_f32_16x16x32_bf16 v[36:39], v[100:103], v[88:91], v[36:39]
 buffer_load_dwordx4 v233, s[8:11], s33 offen offset:1024  lds
 v_mfma_f32_16x16x32_bf16 v[36:39], v[132:135], v[120:123], v[36:39]
 buffer_load_dwordx4 v234, s[8:11], s33 offen offset:2048  lds
 v_mfma_f32_16x16x32_bf16 v[44:47], v[132:135], v[124:127], v[44:47]
 buffer_load_dwordx4 v235, s[8:11], s33 offen offset:3072  lds
 v_mfma_f32_16x16x32_bf16 v[44:47], v[100:103], v[92:95], v[44:47]
 s_waitcnt vmcnt(20) lgkmcnt(0)
 s_barrier
 v_mfma_f32_16x16x32_bf16 v[48:51], v[104:107], v[80:83], v[48:51]
 ds_read_b64_tr_b16 v[160:161], v224 offset:16384
 s_add_u32 m0, s50, 32768
 v_mfma_f32_16x16x32_bf16 v[48:51], v[136:139], v[112:115], v[48:51]
 buffer_load_dwordx4 v1, s[16:19], s57 offen offset:0 sc1 lds
 v_mfma_f32_16x16x32_bf16 v[56:59], v[136:139], v[116:119], v[56:59]
 ds_read_b64_tr_b16 v[162:163], v224 offset:20480
 s_lshl_b32 s33, s32, 17
 v_mfma_f32_16x16x32_bf16 v[56:59], v[104:107], v[84:87], v[56:59]
 ds_read_b64_tr_b16 v[192:193], v224 offset:24576
 s_add_u32 s33, s33, s25
 v_mfma_f32_16x16x32_bf16 v[64:67], v[104:107], v[88:91], v[64:67]
 ds_read_b64_tr_b16 v[194:195], v224 offset:28672
 s_add_u32 s32, s32, 1
 v_mfma_f32_16x16x32_bf16 v[64:67], v[136:139], v[120:123], v[64:67]
 buffer_load_dwordx4 v1, s[16:19], s57 offen offset:1024 sc1 lds
 v_mfma_f32_16x16x32_bf16 v[72:75], v[136:139], v[124:127], v[72:75]
 ds_read_b128 v[144:147], v2 offset:49152
 s_and_b32 s32, s32, 7
 v_mfma_f32_16x16x32_bf16 v[72:75], v[104:107], v[92:95], v[72:75]
 ds_read_b128 v[176:179], v2 offset:51200
 v_mfma_f32_16x16x32_bf16 v[52:55], v[108:111], v[80:83], v[52:55]
 ds_read_b128 v[148:151], v2 offset:50176
 v_mfma_f32_16x16x32_bf16 v[52:55], v[140:143], v[112:115], v[52:55]
 buffer_load_dwordx4 v1, s[16:19], s57 offen offset:2048 sc1 lds
 v_mfma_f32_16x16x32_bf16 v[60:63], v[140:143], v[116:119], v[60:63]
 ds_read_b128 v[180:183], v2 offset:52224
 ds_read_b128 v[152:155], v3 offset:49152
 v_mfma_f32_16x16x32_bf16 v[60:63], v[108:111], v[84:87], v[60:63]
 ds_read_b128 v[184:187], v3 offset:51200
 v_mfma_f32_16x16x32_bf16 v[68:71], v[108:111], v[88:91], v[68:71]
 ds_read_b128 v[156:159], v3 offset:50176
 v_mfma_f32_16x16x32_bf16 v[68:71], v[140:143], v[120:123], v[68:71]
 buffer_load_dwordx4 v1, s[16:19], s57 offen offset:3072 sc1 lds
 v_mfma_f32_16x16x32_bf16 v[76:79], v[140:143], v[124:127], v[76:79]
 ds_read_b128 v[188:191], v3 offset:52224
 s_add_u32 s57, s57, 4096
 v_mfma_f32_16x16x32_bf16 v[76:79], v[108:111], v[92:95], v[76:79]
 ds_read_b64_tr_b16 v[164:165], v225 offset:16384
 s_waitcnt lgkmcnt(5)
 v_mfma_f32_16x16x32_bf16 v[16:19], v[160:163], v[144:147], v[16:19]
 ds_read_b64_tr_b16 v[166:167], v225 offset:20480
 v_mfma_f32_16x16x32_bf16 v[16:19], v[192:195], v[176:179], v[16:19]
 ds_read_b64_tr_b16 v[196:197], v225 offset:24576
 v_mfma_f32_16x16x32_bf16 v[24:27], v[192:195], v[180:183], v[24:27]
 ds_read_b64_tr_b16 v[198:199], v225 offset:28672
 v_mfma_f32_16x16x32_bf16 v[24:27], v[160:163], v[148:151], v[24:27]
 ds_read_b64_tr_b16 v[168:169], v226 offset:16384
 s_waitcnt lgkmcnt(5)
 s_add_u32 m0, s50, 65536
 v_mfma_f32_16x16x32_bf16 v[32:35], v[160:163], v[152:155], v[32:35]
 buffer_load_dwordx4 v232, s[8:11], s33 offen offset:0  lds
 v_mfma_f32_16x16x32_bf16 v[32:35], v[192:195], v[184:187], v[32:35]
 ds_read_b64_tr_b16 v[170:171], v226 offset:20480
 v_mfma_f32_16x16x32_bf16 v[40:43], v[192:195], v[188:191], v[40:43]
 ds_read_b64_tr_b16 v[200:201], v226 offset:24576
 v_mfma_f32_16x16x32_bf16 v[40:43], v[160:163], v[156:159], v[40:43]
 ds_read_b64_tr_b16 v[202:203], v226 offset:28672
 s_waitcnt lgkmcnt(4)
 v_mfma_f32_16x16x32_bf16 v[20:23], v[164:167], v[144:147], v[20:23]
 ds_read_b64_tr_b16 v[172:173], v227 offset:16384
 v_mfma_f32_16x16x32_bf16 v[20:23], v[196:199], v[176:179], v[20:23]
 ds_read_b64_tr_b16 v[174:175], v227 offset:20480
 v_mfma_f32_16x16x32_bf16 v[28:31], v[196:199], v[180:183], v[28:31]
 ds_read_b64_tr_b16 v[204:205], v227 offset:24576
 v_mfma_f32_16x16x32_bf16 v[28:31], v[164:167], v[148:151], v[28:31]
 ds_read_b64_tr_b16 v[206:207], v227 offset:28672
 v_mfma_f32_16x16x32_bf16 v[36:39], v[164:167], v[152:155], v[36:39]
 buffer_load_dwordx4 v233, s[8:11], s33 offen offset:1024  lds
 v_mfma_f32_16x16x32_bf16 v[36:39], v[196:199], v[184:187], v[36:39]
 buffer_load_dwordx4 v234, s[8:11], s33 offen offset:2048  lds
 v_mfma_f32_16x16x32_bf16 v[44:47], v[196:199], v[188:191], v[44:47]
 buffer_load_dwordx4 v235, s[8:11], s33 offen offset:3072  lds
 v_mfma_f32_16x16x32_bf16 v[44:47], v[164:167], v[156:159], v[44:47]
 s_waitcnt vmcnt(20) lgkmcnt(0)
 s_barrier
 v_mfma_f32_16x16x32_bf16 v[48:51], v[168:171], v[144:147], v[48:51]
 ds_read_b64_tr_b16 v[96:97], v228 offset:0
 s_add_u32 m0, s50, 49152
 v_mfma_f32_16x16x32_bf16 v[48:51], v[200:203], v[176:179], v[48:51]
 buffer_load_dwordx4 v1, s[16:19], s57 offen offset:0 sc1 lds
 v_mfma_f32_16x16x32_bf16 v[56:59], v[200:203], v[180:183], v[56:59]
 ds_read_b64_tr_b16 v[98:99], v228 offset:4096
 s_add_u32 s33, s33, 65536
 v_mfma_f32_16x16x32_bf16 v[56:59], v[168:171], v[148:151], v[56:59]
 ds_read_b64_tr_b16 v[128:129], v228 offset:8192
 v_mfma_f32_16x16x32_bf16 v[64:67], v[168:171], v[152:155], v[64:67]
 ds_read_b64_tr_b16 v[130:131], v228 offset:12288
 v_mfma_f32_16x16x32_bf16 v[64:67], v[200:203], v[184:187], v[64:67]
 buffer_load_dwordx4 v1, s[16:19], s57 offen offset:1024 sc1 lds
 v_mfma_f32_16x16x32_bf16 v[72:75], v[200:203], v[188:191], v[72:75]
 ds_read_b128 v[80:83], v236 offset:32768
 v_mfma_f32_16x16x32_bf16 v[72:75], v[168:171], v[156:159], v[72:75]
 ds_read_b128 v[112:115], v236 offset:34816
 v_mfma_f32_16x16x32_bf16 v[52:55], v[172:175], v[144:147], v[52:55]
 ds_read_b128 v[84:87], v236 offset:33792
 v_mfma_f32_16x16x32_bf16 v[52:55], v[204:207], v[176:179], v[52:55]
 buffer_load_dwordx4 v1, s[16:19], s57 offen offset:2048 sc1 lds
 v_mfma_f32_16x16x32_bf16 v[60:63], v[204:207], v[180:183], v[60:63]
 ds_read_b128 v[116:119], v236 offset:35840
 ds_read_b128 v[88:91], v237 offset:32768
 v_mfma_f32_16x16x32_bf16 v[60:63], v[172:175], v[148:151], v[60:63]
 ds_read_b128 v[120:123], v237 offset:34816
 v_mfma_f32_16x16x32_bf16 v[68:71], v[172:175], v[152:155], v[68:71]
 ds_read_b128 v[92:95], v237 offset:33792
 v_mfma_f32_16x16x32_bf16 v[68:71], v[204:207], v[184:187], v[68:71]
 buffer_load_dwordx4 v1, s[16:19], s57 offen offset:3072 sc1 lds
 v_mfma_f32_16x16x32_bf16 v[76:79], v[204:207], v[188:191], v[76:79]
 ds_read_b128 v[124:127], v237 offset:35840
 s_lshl_b32 s57, s35, 13
 v_mfma_f32_16x16x32_bf16 v[76:79], v[172:175], v[156:159], v[76:79]
 ds_read_b64_tr_b16 v[100:101], v229 offset:0
 s_waitcnt lgkmcnt(5)
 v_mfma_f32_16x16x32_bf16 v[16:19], v[96:99], v[80:83], v[16:19]
 ds_read_b64_tr_b16 v[102:103], v229 offset:4096
 s_add_u32 s57, s57, s98
 v_mfma_f32_16x16x32_bf16 v[16:19], v[128:131], v[112:115], v[16:19]
 ds_read_b64_tr_b16 v[132:133], v229 offset:8192
 s_add_u32 s35, s35, 1
 v_mfma_f32_16x16x32_bf16 v[24:27], v[128:131], v[116:119], v[24:27]
 ds_read_b64_tr_b16 v[134:135], v229 offset:12288
 s_and_b32 s35, s35, 7
 buffer_load_dword v223, v220, s[16:19], s47 offen sc1
 v_mfma_f32_16x16x32_bf16 v[24:27], v[96:99], v[84:87], v[24:27]
 ds_read_b64_tr_b16 v[104:105], v230 offset:0
 s_waitcnt lgkmcnt(5)
 s_add_u32 m0, s50, 81920
 v_mfma_f32_16x16x32_bf16 v[32:35], v[96:99], v[88:91], v[32:35]
 buffer_load_dwordx4 v232, s[8:11], s33 offen offset:0  lds
 v_mfma_f32_16x16x32_bf16 v[32:35], v[128:131], v[120:123], v[32:35]
 ds_read_b64_tr_b16 v[106:107], v230 offset:4096
 v_mfma_f32_16x16x32_bf16 v[40:43], v[128:131], v[124:127], v[40:43]
 ds_read_b64_tr_b16 v[136:137], v230 offset:8192
 v_mfma_f32_16x16x32_bf16 v[40:43], v[96:99], v[92:95], v[40:43]
 ds_read_b64_tr_b16 v[138:139], v230 offset:12288
 s_waitcnt lgkmcnt(4)
 v_mfma_f32_16x16x32_bf16 v[20:23], v[100:103], v[80:83], v[20:23]
 ds_read_b64_tr_b16 v[108:109], v231 offset:0
 v_mfma_f32_16x16x32_bf16 v[20:23], v[132:135], v[112:115], v[20:23]
 ds_read_b64_tr_b16 v[110:111], v231 offset:4096
 v_mfma_f32_16x16x32_bf16 v[28:31], v[132:135], v[116:119], v[28:31]
 ds_read_b64_tr_b16 v[140:141], v231 offset:8192
 v_mfma_f32_16x16x32_bf16 v[28:31], v[100:103], v[84:87], v[28:31]
 ds_read_b64_tr_b16 v[142:143], v231 offset:12288
 v_mfma_f32_16x16x32_bf16 v[36:39], v[100:103], v[88:91], v[36:39]
 buffer_load_dwordx4 v233, s[8:11], s33 offen offset:1024  lds
 v_mfma_f32_16x16x32_bf16 v[36:39], v[132:135], v[120:123], v[36:39]
 buffer_load_dwordx4 v234, s[8:11], s33 offen offset:2048  lds
 v_mfma_f32_16x16x32_bf16 v[44:47], v[132:135], v[124:127], v[44:47]
 buffer_load_dwordx4 v235, s[8:11], s33 offen offset:3072  lds
 v_mfma_f32_16x16x32_bf16 v[44:47], v[100:103], v[92:95], v[44:47]
 s_waitcnt vmcnt(21) lgkmcnt(0)
 s_barrier
 v_mfma_f32_16x16x32_bf16 v[48:51], v[104:107], v[80:83], v[48:51]
 ds_read_b64_tr_b16 v[168:169], v230 offset:16384
 s_add_u32 m0, s50, 98304
 v_mfma_f32_16x16x32_bf16 v[48:51], v[136:139], v[112:115], v[48:51]
 ds_read_b64_tr_b16 v[170:171], v230 offset:20480
 buffer_load_dwordx4 v1, s[16:19], s57 offen offset:0 sc1 lds
 v_mfma_f32_16x16x32_bf16 v[56:59], v[136:139], v[116:119], v[56:59]
 ds_read_b64_tr_b16 v[200:201], v230 offset:24576
 s_and_b32 s33, s25, 0xffff
 v_mfma_f32_16x16x32_bf16 v[56:59], v[104:107], v[84:87], v[56:59]
 ds_read_b64_tr_b16 v[202:203], v230 offset:28672
 s_lshr_b32 s32, s25, 20
 v_mfma_f32_16x16x32_bf16 v[64:67], v[104:107], v[88:91], v[64:67]
 ds_read_b128 a[0:3], v236 offset:49152
 s_lshl_b32 s32, s32, 17
 v_mfma_f32_16x16x32_bf16 v[64:67], v[136:139], v[120:123], v[64:67]
 ds_read_b128 a[16:19], v236 offset:51200
 buffer_load_dwordx4 v1, s[16:19], s57 offen offset:1024 sc1 lds
 v_mfma_f32_16x16x32_bf16 v[72:75], v[136:139], v[124:127], v[72:75]
 ds_read_b128 a[4:7], v236 offset:50176
 s_add_u32 s33, s33, s32
 v_mfma_f32_16x16x32_bf16 v[72:75], v[104:107], v[92:95], v[72:75]
 ds_read_b128 a[20:23], v236 offset:52224
 s_and_b32 s32, s32, 7
 v_mfma_f32_16x16x32_bf16 v[52:55], v[108:111], v[80:83], v[52:55]
 ds_read_b128 v[152:155], v237 offset:49152
 v_mfma_f32_16x16x32_bf16 v[52:55], v[140:143], v[112:115], v[52:55]
 ds_read_b128 v[184:187], v237 offset:51200
 buffer_load_dwordx4 v1, s[16:19], s57 offen offset:2048 sc1 lds
 v_mfma_f32_16x16x32_bf16 v[60:63], v[140:143], v[116:119], v[60:63]
 ds_read_b128 v[156:159], v237 offset:50176
 v_mfma_f32_16x16x32_bf16 v[60:63], v[108:111], v[84:87], v[60:63]
 ds_read_b128 v[188:191], v237 offset:52224
 v_mfma_f32_16x16x32_bf16 v[68:71], v[108:111], v[88:91], v[68:71]
 v_mfma_f32_16x16x32_bf16 v[68:71], v[140:143], v[120:123], v[68:71]
 ds_read_b64_tr_b16 v[172:173], v231 offset:16384
 buffer_load_dwordx4 v1, s[16:19], s57 offen offset:3072 sc1 lds
 v_mfma_f32_16x16x32_bf16 v[76:79], v[140:143], v[124:127], v[76:79]
 ds_read_b64_tr_b16 v[174:175], v231 offset:20480
 s_add_u32 s57, s57, 4096
 v_mfma_f32_16x16x32_bf16 v[76:79], v[108:111], v[92:95], v[76:79]
 ds_read_b64_tr_b16 v[204:205], v231 offset:24576
 s_waitcnt lgkmcnt(7)
 v_mfma_f32_16x16x32_bf16 v[48:51], v[168:171], a[0:3], v[48:51]
 ds_read_b64_tr_b16 v[206:207], v231 offset:28672
 v_mfma_f32_16x16x32_bf16 v[48:51], v[200:203], a[16:19], v[48:51]
 ds_read_b64_tr_b16 a[8:9], v228 offset:16384
 v_mfma_f32_16x16x32_bf16 v[56:59], v[200:203], a[20:23], v[56:59]
 ds_read_b64_tr_b16 a[10:11], v228 offset:20480
 v_mfma_f32_16x16x32_bf16 v[56:59], v[168:171], a[4:7], v[56:59]
 ds_read_b64_tr_b16 a[24:25], v228 offset:24576
 s_waitcnt lgkmcnt(7)
 v_mfma_f32_16x16x32_bf16 v[64:67], v[168:171], v[152:155], v[64:67]
 ds_read_b64_tr_b16 a[26:27], v228 offset:28672
 v_mfma_f32_16x16x32_bf16 v[64:67], v[200:203], v[184:187], v[64:67]
 ds_read_b64_tr_b16 a[12:13], v229 offset:16384
 v_mfma_f32_16x16x32_bf16 v[72:75], v[200:203], v[188:191], v[72:75]
 ds_read_b64_tr_b16 a[14:15], v229 offset:20480
 v_mfma_f32_16x16x32_bf16 v[72:75], v[168:171], v[156:159], v[72:75]
 ds_read_b64_tr_b16 a[28:29], v229 offset:24576
 s_waitcnt lgkmcnt(7)
 s_add_u32 m0, s50, 131072
 v_mfma_f32_16x16x32_bf16 v[52:55], v[172:175], a[0:3], v[52:55]
 ds_read_b64_tr_b16 a[30:31], v229 offset:28672
 buffer_load_dwordx4 v232, s[12:15], s33 offen offset:0  lds
 v_mfma_f32_16x16x32_bf16 v[52:55], v[204:207], a[16:19], v[52:55]
 buffer_load_dwordx4 v233, s[12:15], s33 offen offset:1024  lds
 v_mfma_f32_16x16x32_bf16 v[60:63], v[204:207], a[20:23], v[60:63]
 buffer_load_dwordx4 v234, s[12:15], s33 offen offset:2048  lds
 v_mfma_f32_16x16x32_bf16 v[60:63], v[172:175], a[4:7], v[60:63]
 buffer_load_dwordx4 v235, s[12:15], s33 offen offset:3072  lds
 v_mfma_f32_16x16x32_bf16 v[68:71], v[172:175], v[152:155], v[68:71]
 s_waitcnt vmcnt(21) lgkmcnt(0)
 s_barrier
 v_mfma_f32_16x16x32_bf16 v[68:71], v[204:207], v[184:187], v[68:71]
 ds_read_b64_tr_b16 v[104:105], v14 offset:0
 s_add_u32 m0, s50, 114688
 v_mfma_f32_16x16x32_bf16 v[76:79], v[204:207], v[188:191], v[76:79]
 ds_read_b64_tr_b16 v[106:107], v14 offset:4096
 buffer_load_dwordx4 v1, s[16:19], s57 offen offset:0 sc1 lds
 v_mfma_f32_16x16x32_bf16 v[76:79], v[172:175], v[156:159], v[76:79]
 ds_read_b64_tr_b16 v[136:137], v14 offset:8192
 v_mfma_f32_16x16x32_bf16 v[32:35], a[8:11], v[152:155], v[32:35]
 ds_read_b64_tr_b16 v[138:139], v14 offset:12288
 s_add_u32 s33, s33, 65536
 v_mfma_f32_16x16x32_bf16 v[32:35], a[24:27], v[184:187], v[32:35]
 ds_read_b128 a[32:35], v2 offset:32768
 v_mfma_f32_16x16x32_bf16 v[40:43], a[24:27], v[188:191], v[40:43]
 ds_read_b128 a[48:51], v2 offset:34816
 buffer_load_dwordx4 v1, s[16:19], s57 offen offset:1024 sc1 lds
 v_mfma_f32_16x16x32_bf16 v[40:43], a[8:11], v[156:159], v[40:43]
 ds_read_b128 a[36:39], v2 offset:33792
 v_mfma_f32_16x16x32_bf16 v[36:39], a[12:15], v[152:155], v[36:39]
 ds_read_b128 a[52:55], v2 offset:35840
 ds_read_b128 v[88:91], v3 offset:32768
 v_mfma_f32_16x16x32_bf16 v[36:39], a[28:31], v[184:187], v[36:39]
 ds_read_b128 v[120:123], v3 offset:34816
 v_mfma_f32_16x16x32_bf16 v[44:47], a[28:31], v[188:191], v[44:47]
 ds_read_b128 v[92:95], v3 offset:33792
 buffer_load_dwordx4 v1, s[16:19], s57 offen offset:2048 sc1 lds
 v_mfma_f32_16x16x32_bf16 v[44:47], a[12:15], v[156:159], v[44:47]
 ds_read_b128 v[124:127], v3 offset:35840
 s_waitcnt lgkmcnt(4)
 v_mfma_f32_16x16x32_bf16 v[48:51], v[104:107], a[32:35], v[48:51]
 ds_read_b64_tr_b16 v[108:109], v15 offset:0
 v_mfma_f32_16x16x32_bf16 v[48:51], v[136:139], a[48:51], v[48:51]
 ds_read_b64_tr_b16 v[110:111], v15 offset:4096
 v_mfma_f32_16x16x32_bf16 v[56:59], v[136:139], a[52:55], v[56:59]
 ds_read_b64_tr_b16 v[140:141], v15 offset:8192
 buffer_load_dwordx4 v1, s[16:19], s57 offen offset:3072 sc1 lds
 v_mfma_f32_16x16x32_bf16 v[56:59], v[104:107], a[36:39], v[56:59]
 ds_read_b64_tr_b16 v[142:143], v15 offset:12288
 ds_read_b64_tr_b16 a[40:41], v4 offset:0
 s_waitcnt lgkmcnt(5)
 v_mfma_f32_16x16x32_bf16 v[64:67], v[104:107], v[88:91], v[64:67]
 ds_read_b64_tr_b16 a[42:43], v4 offset:4096
 s_lshr_b32 s35, s20, 3
 v_mfma_f32_16x16x32_bf16 v[64:67], v[136:139], v[120:123], v[64:67]
 ds_read_b64_tr_b16 a[56:57], v4 offset:8192
 s_mul_i32 s35, s35, 57344
 v_mfma_f32_16x16x32_bf16 v[72:75], v[136:139], v[124:127], v[72:75]
 ds_read_b64_tr_b16 a[58:59], v4 offset:12288
 s_sub_u32 s57, s98, s35
 v_mfma_f32_16x16x32_bf16 v[72:75], v[104:107], v[92:95], v[72:75]
 ds_read_b64_tr_b16 a[44:45], v5 offset:0
 s_waitcnt lgkmcnt(5)
 s_add_u32 m0, s50, 147456
 v_mfma_f32_16x16x32_bf16 v[52:55], v[108:111], a[32:35], v[52:55]
 ds_read_b64_tr_b16 a[46:47], v5 offset:4096
 buffer_load_dwordx4 v232, s[12:15], s33 offen offset:0  lds
 v_mfma_f32_16x16x32_bf16 v[52:55], v[140:143], a[48:51], v[52:55]
 ds_read_b64_tr_b16 a[60:61], v5 offset:8192
 buffer_load_dwordx4 v233, s[12:15], s33 offen offset:1024  lds
 v_mfma_f32_16x16x32_bf16 v[60:63], v[140:143], a[52:55], v[60:63]
 ds_read_b64_tr_b16 a[62:63], v5 offset:12288
 buffer_load_dwordx4 v234, s[12:15], s33 offen offset:2048  lds
 s_add_u32 s57, s57, 262144
 s_and_b32 s35, s35, 7
 v_mfma_f32_16x16x32_bf16 v[60:63], v[108:111], a[36:39], v[60:63]
 buffer_load_dwordx4 v235, s[12:15], s33 offen offset:3072  lds
 v_mfma_f32_16x16x32_bf16 v[68:71], v[108:111], v[88:91], v[68:71]
 s_waitcnt vmcnt(20) lgkmcnt(0)
 v_cmp_gt_u32 vcc, s46, v223
 s_cbranch_vccnz L_spin_100
L_spun_101:
 s_barrier
 v_mfma_f32_16x16x32_bf16 v[68:71], v[140:143], v[120:123], v[68:71]
 ds_read_b64_tr_b16 v[168:169], v14 offset:16384
 s_add_u32 m0, s50, 32768
 v_mfma_f32_16x16x32_bf16 v[76:79], v[140:143], v[124:127], v[76:79]
 ds_read_b64_tr_b16 v[170:171], v14 offset:20480
 buffer_load_dwordx4 v1, s[16:19], s57 offen offset:0 sc1 lds
 v_mfma_f32_16x16x32_bf16 v[76:79], v[108:111], v[92:95], v[76:79]
 ds_read_b64_tr_b16 v[200:201], v14 offset:24576
 v_mfma_f32_16x16x32_bf16 v[32:35], a[40:43], v[88:91], v[32:35]
 ds_read_b64_tr_b16 v[202:203], v14 offset:28672
 v_mfma_f32_16x16x32_bf16 v[32:35], a[56:59], v[120:123], v[32:35]
 ds_read_b128 a[64:67], v2 offset:49152
 v_mfma_f32_16x16x32_bf16 v[40:43], a[56:59], v[124:127], v[40:43]
 ds_read_b128 a[80:83], v2 offset:51200
 buffer_load_dwordx4 v1, s[16:19], s57 offen offset:1024 sc1 lds
 v_mfma_f32_16x16x32_bf16 v[40:43], a[40:43], v[92:95], v[40:43]
 ds_read_b128 a[68:71], v2 offset:50176
 v_mfma_f32_16x16x32_bf16 v[36:39], a[44:47], v[88:91], v[36:39]
 ds_read_b128 a[84:87], v2 offset:52224
 ds_read_b128 v[152:155], v3 offset:49152
 v_mfma_f32_16x16x32_bf16 v[36:39], a[60:63], v[120:123], v[36:39]
 ds_read_b128 v[184:187], v3 offset:51200
 v_mfma_f32_16x16x32_bf16 v[44:47], a[60:63], v[124:127], v[44:47]
 ds_read_b128 v[156:159], v3 offset:50176
 buffer_load_dwordx4 v1, s[16:19], s57 offen offset:2048 sc1 lds
 v_mfma_f32_16x16x32_bf16 v[44:47], a[44:47], v[92:95], v[44:47]
 ds_read_b128 v[188:191], v3 offset:52224
 s_waitcnt lgkmcnt(4)
 v_mfma_f32_16x16x32_bf16 v[48:51], v[168:171], a[64:67], v[48:51]
 ds_read_b64_tr_b16 v[172:173], v15 offset:16384
 v_mfma_f32_16x16x32_bf16 v[48:51], v[200:203], a[80:83], v[48:51]
 ds_read_b64_tr_b16 v[174:175], v15 offset:20480
 v_mfma_f32_16x16x32_bf16 v[56:59], v[200:203], a[84:87], v[56:59]
 ds_read_b64_tr_b16 v[204:205], v15 offset:24576
 buffer_load_dwordx4 v1, s[16:19], s57 offen offset:3072 sc1 lds
 v_mfma_f32_16x16x32_bf16 v[56:59], v[168:171], a[68:71], v[56:59]
 ds_read_b64_tr_b16 v[206:207], v15 offset:28672
 ds_read_b64_tr_b16 a[72:73], v4 offset:16384
 s_waitcnt lgkmcnt(5)
 v_mfma_f32_16x16x32_bf16 v[64:67], v[168:171], v[152:155], v[64:67]
 ds_read_b64_tr_b16 a[74:75], v4 offset:20480
 s_add_u32 s57, s57, 4096
 v_mfma_f32_16x16x32_bf16 v[64:67], v[200:203], v[184:187], v[64:67]
 ds_read_b64_tr_b16 a[88:89], v4 offset:24576
 v_mfma_f32_16x16x32_bf16 v[72:75], v[200:203], v[188:191], v[72:75]
 ds_read_b64_tr_b16 a[90:91], v4 offset:28672
 v_mfma_f32_16x16x32_bf16 v[72:75], v[168:171], v[156:159], v[72:75]
 ds_read_b64_tr_b16 a[76:77], v5 offset:16384
 s_waitcnt lgkmcnt(5)
 v_mfma_f32_16x16x32_bf16 v[52:55], v[172:175], a[64:67], v[52:55]
 ds_read_b64_tr_b16 a[78:79], v5 offset:20480
 v_mfma_f32_16x16x32_bf16 v[52:55], v[204:207], a[80:83], v[52:55]
 ds_read_b64_tr_b16 a[92:93], v5 offset:24576
 v_mfma_f32_16x16x32_bf16 v[60:63], v[204:207], a[84:87], v[60:63]
 ds_read_b64_tr_b16 a[94:95], v5 offset:28672
 v_mfma_f32_16x16x32_bf16 v[60:63], v[172:175], a[68:71], v[60:63]
 v_mfma_f32_16x16x32_bf16 v[68:71], v[172:175], v[152:155], v[68:71]
 s_waitcnt vmcnt(16) lgkmcnt(0)
 s_barrier
 v_mfma_f32_16x16x32_bf16 v[68:71], v[204:207], v[184:187], v[68:71]
 ds_read_b64_tr_b16 v[104:105], v226 offset:0
 s_add_u32 m0, s50, 49152
 v_mfma_f32_16x16x32_bf16 v[76:79], v[204:207], v[188:191], v[76:79]
 ds_read_b64_tr_b16 v[106:107], v226 offset:4096
 buffer_load_dwordx4 v1, s[16:19], s57 offen offset:0 sc1 lds
 v_mfma_f32_16x16x32_bf16 v[76:79], v[172:175], v[156:159], v[76:79]
 ds_read_b64_tr_b16 v[136:137], v226 offset:8192
 v_mfma_f32_16x16x32_bf16 v[32:35], a[72:75], v[152:155], v[32:35]
 ds_read_b64_tr_b16 v[138:139], v226 offset:12288
 v_mfma_f32_16x16x32_bf16 v[32:35], a[88:91], v[184:187], v[32:35]
 ds_read_b128 a[96:99], v236 offset:32768
 v_mfma_f32_16x16x32_bf16 v[40:43], a[88:91], v[188:191], v[40:43]
 ds_read_b128 a[112:115], v236 offset:34816
 buffer_load_dwordx4 v1, s[16:19], s57 offen offset:1024 sc1 lds
 v_mfma_f32_16x16x32_bf16 v[40:43], a[72:75], v[156:159], v[40:43]
 ds_read_b128 a[100:103], v236 offset:33792
 v_mfma_f32_16x16x32_bf16 v[36:39], a[76:79], v[152:155], v[36:39]
 ds_read_b128 a[116:119], v236 offset:35840
 ds_read_b128 v[88:91], v237 offset:32768
 v_mfma_f32_16x16x32_bf16 v[36:39], a[92:95], v[184:187], v[36:39]
 ds_read_b128 v[120:123], v237 offset:34816
 v_mfma_f32_16x16x32_bf16 v[44:47], a[92:95], v[188:191], v[44:47]
 ds_read_b128 v[92:95], v237 offset:33792
 buffer_load_dwordx4 v1, s[16:19], s57 offen offset:2048 sc1 lds
 v_mfma_f32_16x16x32_bf16 v[44:47], a[76:79], v[156:159], v[44:47]
 ds_read_b128 v[124:127], v237 offset:35840
 s_waitcnt lgkmcnt(4)
 v_mfma_f32_16x16x32_bf16 v[48:51], v[104:107], a[96:99], v[48:51]
 ds_read_b64_tr_b16 v[108:109], v227 offset:0
 v_mfma_f32_16x16x32_bf16 v[48:51], v[136:139], a[112:115], v[48:51]
 ds_read_b64_tr_b16 v[110:111], v227 offset:4096
 v_mfma_f32_16x16x32_bf16 v[56:59], v[136:139], a[116:119], v[56:59]
 ds_read_b64_tr_b16 v[140:141], v227 offset:8192
 buffer_load_dwordx4 v1, s[16:19], s57 offen offset:3072 sc1 lds
 v_mfma_f32_16x16x32_bf16 v[56:59], v[104:107], a[100:103], v[56:59]
 ds_read_b64_tr_b16 v[142:143], v227 offset:12288
 ds_read_b64_tr_b16 a[104:105], v224 offset:0
 s_waitcnt lgkmcnt(5)
 v_mfma_f32_16x16x32_bf16 v[64:67], v[104:107], v[88:91], v[64:67]
 ds_read_b64_tr_b16 a[106:107], v224 offset:4096
 v_mfma_f32_16x16x32_bf16 v[64:67], v[136:139], v[120:123], v[64:67]
 ds_read_b64_tr_b16 a[120:121], v224 offset:8192
 v_mfma_f32_16x16x32_bf16 v[72:75], v[136:139], v[124:127], v[72:75]
 ds_read_b64_tr_b16 a[122:123], v224 offset:12288
 v_mfma_f32_16x16x32_bf16 v[72:75], v[104:107], v[92:95], v[72:75]
 ds_read_b64_tr_b16 a[108:109], v225 offset:0
 s_waitcnt lgkmcnt(5)
 v_mfma_f32_16x16x32_bf16 v[52:55], v[108:111], a[96:99], v[52:55]
 ds_read_b64_tr_b16 a[110:111], v225 offset:4096
 v_mfma_f32_16x16x32_bf16 v[52:55], v[140:143], a[112:115], v[52:55]
 ds_read_b64_tr_b16 a[124:125], v225 offset:8192
 v_mfma_f32_16x16x32_bf16 v[60:63], v[140:143], a[116:119], v[60:63]
 ds_read_b64_tr_b16 a[126:127], v225 offset:12288
 v_mfma_f32_16x16x32_bf16 v[60:63], v[108:111], a[100:103], v[60:63]
 v_mfma_f32_16x16x32_bf16 v[68:71], v[108:111], v[88:91], v[68:71]
 s_waitcnt vmcnt(12) lgkmcnt(0)
 s_barrier
 v_mfma_f32_16x16x32_bf16 v[68:71], v[140:143], v[120:123], v[68:71]
 ds_read_b64_tr_b16 v[168:169], v226 offset:16384
 v_mfma_f32_16x16x32_bf16 v[76:79], v[140:143], v[124:127], v[76:79]
 ds_read_b64_tr_b16 v[170:171], v226 offset:20480
 v_mfma_f32_16x16x32_bf16 v[76:79], v[108:111], v[92:95], v[76:79]
 ds_read_b64_tr_b16 v[200:201], v226 offset:24576
 v_mfma_f32_16x16x32_bf16 v[32:35], a[104:107], v[88:91], v[32:35]
 ds_read_b64_tr_b16 v[202:203], v226 offset:28672
 v_mfma_f32_16x16x32_bf16 v[32:35], a[120:123], v[120:123], v[32:35]
 ds_read_b128 a[128:131], v236 offset:49152
 v_mfma_f32_16x16x32_bf16 v[40:43], a[120:123], v[124:127], v[40:43]
 ds_read_b128 a[144:147], v236 offset:51200
 v_mfma_f32_16x16x32_bf16 v[40:43], a[104:107], v[92:95], v[40:43]
 ds_read_b128 a[132:135], v236 offset:50176
 v_mfma_f32_16x16x32_bf16 v[36:39], a[108:111], v[88:91], v[36:39]
 ds_read_b128 a[148:151], v236 offset:52224
 ds_read_b128 v[152:155], v237 offset:49152
 v_mfma_f32_16x16x32_bf16 v[36:39], a[124:127], v[120:123], v[36:39]
 ds_read_b128 v[184:187], v237 offset:51200
 v_mfma_f32_16x16x32_bf16 v[44:47], a[124:127], v[124:127], v[44:47]
 ds_read_b128 v[156:159], v237 offset:50176
 v_mfma_f32_16x16x32_bf16 v[44:47], a[108:111], v[92:95], v[44:47]
 ds_read_b128 v[188:191], v237 offset:52224
 s_waitcnt lgkmcnt(4)
 v_mfma_f32_16x16x32_bf16 v[48:51], v[168:171], a[128:131], v[48:51]
 ds_read_b64_tr_b16 v[172:173], v227 offset:16384
 v_mfma_f32_16x16x32_bf16 v[48:51], v[200:203], a[144:147], v[48:51]
 ds_read_b64_tr_b16 v[174:175], v227 offset:20480
 v_mfma_f32_16x16x32_bf16 v[56:59], v[200:203], a[148:151], v[56:59]
 ds_read_b64_tr_b16 v[204:205], v227 offset:24576
 v_mfma_f32_16x16x32_bf16 v[56:59], v[168:171], a[132:135], v[56:59]
 ds_read_b64_tr_b16 v[206:207], v227 offset:28672
 ds_read_b64_tr_b16 a[136:137], v224 offset:16384
 s_waitcnt lgkmcnt(5)
 v_mfma_f32_16x16x32_bf16 v[64:67], v[168:171], v[152:155], v[64:67]
 ds_read_b64_tr_b16 a[138:139], v224 offset:20480
 v_mfma_f32_16x16x32_bf16 v[64:67], v[200:203], v[184:187], v[64:67]
 ds_read_b64_tr_b16 a[152:153], v224 offset:24576
 v_mfma_f32_16x16x32_bf16 v[72:75], v[200:203], v[188:191], v[72:75]
 ds_read_b64_tr_b16 a[154:155], v224 offset:28672
 v_mfma_f32_16x16x32_bf16 v[72:75], v[168:171], v[156:159], v[72:75]
 ds_read_b64_tr_b16 a[140:141], v225 offset:16384
 s_waitcnt lgkmcnt(5)
 v_mfma_f32_16x16x32_bf16 v[52:55], v[172:175], a[128:131], v[52:55]
 ds_read_b64_tr_b16 a[142:143], v225 offset:20480
 v_mfma_f32_16x16x32_bf16 v[52:55], v[204:207], a[144:147], v[52:55]
 ds_read_b64_tr_b16 a[156:157], v225 offset:24576
 v_mfma_f32_16x16x32_bf16 v[60:63], v[204:207], a[148:151], v[60:63]
 ds_read_b64_tr_b16 a[158:159], v225 offset:28672
 v_mfma_f32_16x16x32_bf16 v[60:63], v[172:175], a[132:135], v[60:63]
 v_mfma_f32_16x16x32_bf16 v[68:71], v[172:175], v[152:155], v[68:71]
 s_waitcnt vmcnt(4) lgkmcnt(0)
 s_barrier
 v_mfma_f32_16x16x32_bf16 v[68:71], v[204:207], v[184:187], v[68:71]
 ds_read_b64_tr_b16 v[104:105], v230 offset:0
 v_mfma_f32_16x16x32_bf16 v[76:79], v[204:207], v[188:191], v[76:79]
 ds_read_b64_tr_b16 v[106:107], v230 offset:4096
 v_mfma_f32_16x16x32_bf16 v[76:79], v[172:175], v[156:159], v[76:79]
 ds_read_b64_tr_b16 v[136:137], v230 offset:8192
 v_mfma_f32_16x16x32_bf16 v[32:35], a[136:139], v[152:155], v[32:35]
 ds_read_b64_tr_b16 v[138:139], v230 offset:12288
 v_mfma_f32_16x16x32_bf16 v[32:35], a[152:155], v[184:187], v[32:35]
 ds_read_b128 a[160:163], v2 offset:32768
 v_mfma_f32_16x16x32_bf16 v[40:43], a[152:155], v[188:191], v[40:43]
 ds_read_b128 a[176:179], v2 offset:34816
 v_mfma_f32_16x16x32_bf16 v[40:43], a[136:139], v[156:159], v[40:43]
 ds_read_b128 a[164:167], v2 offset:33792
 v_mfma_f32_16x16x32_bf16 v[36:39], a[140:143], v[152:155], v[36:39]
 ds_read_b128 a[180:183], v2 offset:35840
 ds_read_b128 v[88:91], v3 offset:32768
 v_mfma_f32_16x16x32_bf16 v[36:39], a[156:159], v[184:187], v[36:39]
 ds_read_b128 v[120:123], v3 offset:34816
 v_mfma_f32_16x16x32_bf16 v[44:47], a[156:159], v[188:191], v[44:47]
 ds_read_b128 v[92:95], v3 offset:33792
 v_mfma_f32_16x16x32_bf16 v[44:47], a[140:143], v[156:159], v[44:47]
 ds_read_b128 v[124:127], v3 offset:35840
 s_waitcnt lgkmcnt(4)
 v_mfma_f32_16x16x32_bf16 v[48:51], v[104:107], a[160:163], v[48:51]
 ds_read_b64_tr_b16 v[108:109], v231 offset:0
 v_mfma_f32_16x16x32_bf16 v[48:51], v[136:139], a[176:179], v[48:51]
 ds_read_b64_tr_b16 v[110:111], v231 offset:4096
 v_mfma_f32_16x16x32_bf16 v[56:59], v[136:139], a[180:183], v[56:59]
 ds_read_b64_tr_b16 v[140:141], v231 offset:8192
 v_mfma_f32_16x16x32_bf16 v[56:59], v[104:107], a[164:167], v[56:59]
 ds_read_b64_tr_b16 v[142:143], v231 offset:12288
 ds_read_b64_tr_b16 a[168:169], v228 offset:0
 s_waitcnt lgkmcnt(5)
 v_mfma_f32_16x16x32_bf16 v[64:67], v[104:107], v[88:91], v[64:67]
 ds_read_b64_tr_b16 a[170:171], v228 offset:4096
 v_mfma_f32_16x16x32_bf16 v[64:67], v[136:139], v[120:123], v[64:67]
 ds_read_b64_tr_b16 a[184:185], v228 offset:8192
 v_mfma_f32_16x16x32_bf16 v[72:75], v[136:139], v[124:127], v[72:75]
 ds_read_b64_tr_b16 a[186:187], v228 offset:12288
 v_mfma_f32_16x16x32_bf16 v[72:75], v[104:107], v[92:95], v[72:75]
 ds_read_b64_tr_b16 a[172:173], v229 offset:0
 s_waitcnt lgkmcnt(5)
 v_mfma_f32_16x16x32_bf16 v[52:55], v[108:111], a[160:163], v[52:55]
 ds_read_b64_tr_b16 a[174:175], v229 offset:4096
 v_mfma_f32_16x16x32_bf16 v[52:55], v[140:143], a[176:179], v[52:55]
 ds_read_b64_tr_b16 a[188:189], v229 offset:8192
 v_mfma_f32_16x16x32_bf16 v[60:63], v[140:143], a[180:183], v[60:63]
 ds_read_b64_tr_b16 a[190:191], v229 offset:12288
 v_mfma_f32_16x16x32_bf16 v[60:63], v[108:111], a[164:167], v[60:63]
 v_mfma_f32_16x16x32_bf16 v[68:71], v[108:111], v[88:91], v[68:71]
 s_waitcnt vmcnt(0) lgkmcnt(0)
 s_barrier
 v_mfma_f32_16x16x32_bf16 v[68:71], v[140:143], v[120:123], v[68:71]
 ds_read_b64_tr_b16 v[168:169], v230 offset:16384
 v_mfma_f32_16x16x32_bf16 v[76:79], v[140:143], v[124:127], v[76:79]
 ds_read_b64_tr_b16 v[170:171], v230 offset:20480
 v_mfma_f32_16x16x32_bf16 v[76:79], v[108:111], v[92:95], v[76:79]
 ds_read_b64_tr_b16 v[200:201], v230 offset:24576
 v_mfma_f32_16x16x32_bf16 v[32:35], a[168:171], v[88:91], v[32:35]
 ds_read_b64_tr_b16 v[202:203], v230 offset:28672
 v_mfma_f32_16x16x32_bf16 v[32:35], a[184:187], v[120:123], v[32:35]
 ds_read_b128 a[192:195], v2 offset:49152
 v_mfma_f32_16x16x32_bf16 v[40:43], a[184:187], v[124:127], v[40:43]
 ds_read_b128 a[208:211], v2 offset:51200
 v_mfma_f32_16x16x32_bf16 v[40:43], a[168:171], v[92:95], v[40:43]
 v_mfma_f32_16x16x32_bf16 v[36:39], a[172:175], v[88:91], v[36:39]
 ds_read_b128 a[196:199], v2 offset:50176
 v_mfma_f32_16x16x32_bf16 v[36:39], a[188:191], v[120:123], v[36:39]
 ds_read_b128 a[212:215], v2 offset:52224
 v_mfma_f32_16x16x32_bf16 v[44:47], a[188:191], v[124:127], v[44:47]
 ds_read_b128 v[152:155], v3 offset:49152
 v_mfma_f32_16x16x32_bf16 v[44:47], a[172:175], v[92:95], v[44:47]
 ds_read_b128 v[184:187], v3 offset:51200
 s_waitcnt lgkmcnt(2)
 v_mfma_f32_16x16x32_bf16 v[48:51], v[168:171], a[192:195], v[48:51]
 ds_read_b128 v[156:159], v3 offset:50176
 v_mfma_f32_16x16x32_bf16 v[48:51], v[200:203], a[208:211], v[48:51]
 ds_read_b128 v[188:191], v3 offset:52224
 v_mfma_f32_16x16x32_bf16 v[56:59], v[200:203], a[212:215], v[56:59]
 v_mfma_f32_16x16x32_bf16 v[56:59], v[168:171], a[196:199], v[56:59]
 ds_read_b64_tr_b16 v[172:173], v231 offset:16384
 s_waitcnt lgkmcnt(1)
 v_mfma_f32_16x16x32_bf16 v[64:67], v[168:171], v[152:155], v[64:67]
 ds_read_b64_tr_b16 v[174:175], v231 offset:20480
 v_mfma_f32_16x16x32_bf16 v[64:67], v[200:203], v[184:187], v[64:67]
 ds_read_b64_tr_b16 v[204:205], v231 offset:24576
 v_mfma_f32_16x16x32_bf16 v[72:75], v[200:203], v[188:191], v[72:75]
 ds_read_b64_tr_b16 v[206:207], v231 offset:28672
 v_mfma_f32_16x16x32_bf16 v[72:75], v[168:171], v[156:159], v[72:75]
 ds_read_b64_tr_b16 a[200:201], v228 offset:16384
 s_waitcnt lgkmcnt(1)
 v_mfma_f32_16x16x32_bf16 v[52:55], v[172:175], a[192:195], v[52:55]
 ds_read_b64_tr_b16 a[202:203], v228 offset:20480
 v_mfma_f32_16x16x32_bf16 v[52:55], v[204:207], a[208:211], v[52:55]
 v_mfma_f32_16x16x32_bf16 v[60:63], v[204:207], a[212:215], v[60:63]
 ds_read_b64_tr_b16 a[216:217], v228 offset:24576
 v_mfma_f32_16x16x32_bf16 v[60:63], v[172:175], a[196:199], v[60:63]
 ds_read_b64_tr_b16 a[218:219], v228 offset:28672
 v_mfma_f32_16x16x32_bf16 v[68:71], v[172:175], v[152:155], v[68:71]
 ds_read_b64_tr_b16 a[204:205], v229 offset:16384
 v_mfma_f32_16x16x32_bf16 v[68:71], v[204:207], v[184:187], v[68:71]
 ds_read_b64_tr_b16 a[206:207], v229 offset:20480
 v_mfma_f32_16x16x32_bf16 v[76:79], v[204:207], v[188:191], v[76:79]
 ds_read_b64_tr_b16 a[220:221], v229 offset:24576
 v_mfma_f32_16x16x32_bf16 v[76:79], v[172:175], v[156:159], v[76:79]
 ds_read_b64_tr_b16 a[222:223], v229 offset:28672
 s_waitcnt lgkmcnt(0)
 v_mfma_f32_16x16x32_bf16 v[32:35], a[200:203], v[152:155], v[32:35]
 v_mfma_f32_16x16x32_bf16 v[32:35], a[216:219], v[184:187], v[32:35]
 v_mfma_f32_16x16x32_bf16 v[40:43], a[216:219], v[188:191], v[40:43]
 v_mfma_f32_16x16x32_bf16 v[40:43], a[200:203], v[156:159], v[40:43]
 v_mfma_f32_16x16x32_bf16 v[36:39], a[204:207], v[152:155], v[36:39]
 v_mfma_f32_16x16x32_bf16 v[36:39], a[220:223], v[184:187], v[36:39]
 v_mfma_f32_16x16x32_bf16 v[44:47], a[220:223], v[188:191], v[44:47]
 v_mfma_f32_16x16x32_bf16 v[44:47], a[204:207], v[156:159], v[44:47]
 s_nop 3
 s_xor_b32 s22, s26, 2
 s_mul_i32 s22, s22, 49152
 s_add_u32 s22, s22, s62
 s_add_u32 s22, s22, 16384
 v_cvt_pk_bf16_f32 v96, v48, v49
 v_cvt_pk_bf16_f32 v97, v50, v51
 v_cvt_pk_bf16_f32 v98, v52, v53
 v_cvt_pk_bf16_f32 v99, v54, v55
 v_cvt_pk_bf16_f32 v100, v56, v57
 v_cvt_pk_bf16_f32 v101, v58, v59
 v_cvt_pk_bf16_f32 v102, v60, v61
 v_cvt_pk_bf16_f32 v103, v62, v63
 buffer_store_dwordx4 v[96:99], v1, s[16:19], s22 offen offset:0 sc1
 buffer_store_dwordx4 v[100:103], v1, s[16:19], s22 offen offset:1024 sc1
 s_xor_b32 s22, s26, 3
 s_mul_i32 s22, s22, 49152
 s_add_u32 s22, s22, s62
 s_add_u32 s22, s22, 32768
 v_cvt_pk_bf16_f32 v104, v64, v65
 v_cvt_pk_bf16_f32 v105, v66, v67
 v_cvt_pk_bf16_f32 v106, v68, v69
 v_cvt_pk_bf16_f32 v107, v70, v71
 v_cvt_pk_bf16_f32 v108, v72, v73
 v_cvt_pk_bf16_f32 v109, v74, v75
 v_cvt_pk_bf16_f32 v110, v76, v77
 v_cvt_pk_bf16_f32 v111, v78, v79
 buffer_store_dwordx4 v[104:107], v1, s[16:19], s22 offen offset:0 sc1
 buffer_store_dwordx4 v[108:111], v1, s[16:19], s22 offen offset:1024 sc1
 s_xor_b32 s22, s26, 1
 s_mul_i32 s22, s22, 49152
 s_add_u32 s22, s22, s62
 s_add_u32 s22, s22, 0
 v_cvt_pk_bf16_f32 v88, v32, v33
 v_cvt_pk_bf16_f32 v89, v34, v35
 v_cvt_pk_bf16_f32 v90, v36, v37
 v_cvt_pk_bf16_f32 v91, v38, v39
 v_cvt_pk_bf16_f32 v92, v40, v41
 v_cvt_pk_bf16_f32 v93, v42, v43
 v_cvt_pk_bf16_f32 v94, v44, v45
 v_cvt_pk_bf16_f32 v95, v46, v47
 buffer_store_dwordx4 v[88:91], v1, s[16:19], s22 offen offset:0 sc1
 buffer_store_dwordx4 v[92:95], v1, s[16:19], s22 offen offset:1024 sc1
 v_mfma_f32_16x16x32_bf16 v[16:19], a[8:11], a[0:3], v[16:19]
 v_mfma_f32_16x16x32_bf16 v[16:19], a[24:27], a[16:19], v[16:19]
 v_mfma_f32_16x16x32_bf16 v[16:19], a[40:43], a[32:35], v[16:19]
 v_mfma_f32_16x16x32_bf16 v[16:19], a[56:59], a[48:51], v[16:19]
 v_mfma_f32_16x16x32_bf16 v[16:19], a[72:75], a[64:67], v[16:19]
 v_mfma_f32_16x16x32_bf16 v[16:19], a[88:91], a[80:83], v[16:19]
 v_mfma_f32_16x16x32_bf16 v[16:19], a[104:107], a[96:99], v[16:19]
 v_mfma_f32_16x16x32_bf16 v[16:19], a[120:123], a[112:115], v[16:19]
 v_mfma_f32_16x16x32_bf16 v[16:19], a[136:139], a[128:131], v[16:19]
 v_mfma_f32_16x16x32_bf16 v[16:19], a[152:155], a[144:147], v[16:19]
 v_mfma_f32_16x16x32_bf16 v[16:19], a[168:171], a[160:163], v[16:19]
 v_mfma_f32_16x16x32_bf16 v[16:19], a[184:187], a[176:179], v[16:19]
 v_mfma_f32_16x16x32_bf16 v[16:19], a[200:203], a[192:195], v[16:19]
 v_mfma_f32_16x16x32_bf16 v[16:19], a[216:219], a[208:211], v[16:19]
 v_mfma_f32_16x16x32_bf16 v[24:27], a[24:27], a[20:23], v[24:27]
 v_mfma_f32_16x16x32_bf16 v[24:27], a[8:11], a[4:7], v[24:27]
 s_waitcnt vmcnt(0)
 s_barrier
 buffer_store_dword v10, v221, s[16:19], s97 offen sc1
 v_mfma_f32_16x16x32_bf16 v[24:27], a[56:59], a[52:55], v[24:27]
 v_mfma_f32_16x16x32_bf16 v[24:27], a[40:43], a[36:39], v[24:27]
 v_mfma_f32_16x16x32_bf16 v[24:27], a[88:91], a[84:87], v[24:27]
 v_mfma_f32_16x16x32_bf16 v[24:27], a[72:75], a[68:71], v[24:27]
 v_mfma_f32_16x16x32_bf16 v[24:27], a[120:123], a[116:119], v[24:27]
 v_mfma_f32_16x16x32_bf16 v[24:27], a[104:107], a[100:103], v[24:27]
 v_mfma_f32_16x16x32_bf16 v[24:27], a[152:155], a[148:151], v[24:27]
 v_mfma_f32_16x16x32_bf16 v[24:27], a[136:139], a[132:135], v[24:27]
 v_mfma_f32_16x16x32_bf16 v[24:27], a[184:187], a[180:183], v[24:27]
 v_mfma_f32_16x16x32_bf16 v[24:27], a[168:171], a[164:167], v[24:27]
 v_mfma_f32_16x16x32_bf16 v[24:27], a[216:219], a[212:215], v[24:27]
 v_mfma_f32_16x16x32_bf16 v[24:27], a[200:203], a[196:199], v[24:27]
 v_mfma_f32_16x16x32_bf16 v[20:23], a[12:15], a[0:3], v[20:23]
 v_mfma_f32_16x16x32_bf16 v[20:23], a[28:31], a[16:19], v[20:23]
 v_mfma_f32_16x16x32_bf16 v[20:23], a[44:47], a[32:35], v[20:23]
 v_mfma_f32_16x16x32_bf16 v[20:23], a[60:63], a[48:51], v[20:23]
 buffer_load_dword v12, v11, s[16:19], s30 offen sc1
 v_mfma_f32_16x16x32_bf16 v[20:23], a[76:79], a[64:67], v[20:23]
 v_mfma_f32_16x16x32_bf16 v[20:23], a[92:95], a[80:83], v[20:23]
 v_mfma_f32_16x16x32_bf16 v[20:23], a[108:111], a[96:99], v[20:23]
 v_mfma_f32_16x16x32_bf16 v[20:23], a[124:127], a[112:115], v[20:23]
 v_mfma_f32_16x16x32_bf16 v[20:23], a[140:143], a[128:131], v[20:23]
 v_mfma_f32_16x16x32_bf16 v[20:23], a[156:159], a[144:147], v[20:23]
 v_mfma_f32_16x16x32_bf16 v[20:23], a[172:175], a[160:163], v[20:23]
 v_mfma_f32_16x16x32_bf16 v[20:23], a[188:191], a[176:179], v[20:23]
 v_mfma_f32_16x16x32_bf16 v[20:23], a[204:207], a[192:195], v[20:23]
 v_mfma_f32_16x16x32_bf16 v[20:23], a[220:223], a[208:211], v[20:23]
 v_mfma_f32_16x16x32_bf16 v[28:31], a[28:31], a[20:23], v[28:31]
 v_mfma_f32_16x16x32_bf16 v[28:31], a[12:15], a[4:7], v[28:31]
 s_waitcnt vmcnt(0)
 v_cmp_gt_u32 vcc, s29, v12
 s_cbranch_vccnz L_spin_102
L_spun_103:
 s_barrier
 s_mov_b32 s22, s95
 buffer_load_dwordx4 v[32:35], v1, s[16:19], s22 offen offset:0 sc1
 buffer_load_dwordx4 v[36:39], v1, s[16:19], s22 offen offset:1024 sc1
 s_add_u32 s22, s22, 16384
 buffer_load_dwordx4 v[48:51], v1, s[16:19], s22 offen offset:0 sc1
 buffer_load_dwordx4 v[52:55], v1, s[16:19], s22 offen offset:1024 sc1
 s_add_u32 s22, s22, 16384
 buffer_load_dwordx4 v[64:67], v1, s[16:19], s22 offen offset:0 sc1
 buffer_load_dwordx4 v[68:71], v1, s[16:19], s22 offen offset:1024 sc1
 v_mfma_f32_16x16x32_bf16 v[28:31], a[60:63], a[52:55], v[28:31]
 v_mfma_f32_16x16x32_bf16 v[28:31], a[44:47], a[36:39], v[28:31]
 v_mfma_f32_16x16x32_bf16 v[28:31], a[92:95], a[84:87], v[28:31]
 v_mfma_f32_16x16x32_bf16 v[28:31], a[76:79], a[68:71], v[28:31]
 v_mfma_f32_16x16x32_bf16 v[28:31], a[124:127], a[116:119], v[28:31]
 v_mfma_f32_16x16x32_bf16 v[28:31], a[108:111], a[100:103], v[28:31]
 v_mfma_f32_16x16x32_bf16 v[28:31], a[156:159], a[148:151], v[28:31]
 v_mfma_f32_16x16x32_bf16 v[28:31], a[140:143], a[132:135], v[28:31]
 v_mfma_f32_16x16x32_bf16 v[28:31], a[188:191], a[180:183], v[28:31]
 v_mfma_f32_16x16x32_bf16 v[28:31], a[172:175], a[164:167], v[28:31]
 v_mfma_f32_16x16x32_bf16 v[28:31], a[220:223], a[212:215], v[28:31]
 v_mfma_f32_16x16x32_bf16 v[28:31], a[204:207], a[196:199], v[28:31]
 s_nop 7
 s_waitcnt vmcnt(4)
 v_lshlrev_b32 v12, 16, v32
 v_and_b32 v13, 0xffff0000, v32
 v_add_f32 v16, v16, v12
 v_add_f32 v17, v17, v13
 v_lshlrev_b32 v12, 16, v33
 v_and_b32 v13, 0xffff0000, v33
 v_add_f32 v18, v18, v12
 v_add_f32 v19, v19, v13
 v_lshlrev_b32 v12, 16, v34
 v_and_b32 v13, 0xffff0000, v34
 v_add_f32 v20, v20, v12
 v_add_f32 v21, v21, v13
 v_lshlrev_b32 v12, 16, v35
 v_and_b32 v13, 0xffff0000, v35
 v_add_f32 v22, v22, v12
 v_add_f32 v23, v23, v13
 v_lshlrev_b32 v12, 16, v36
 v_and_b32 v13, 0xffff0000, v36
 v_add_f32 v24, v24, v12
 v_add_f32 v25, v25, v13
 v_lshlrev_b32 v12, 16, v37
 v_and_b32 v13, 0xffff0000, v37
 v_add_f32 v26, v26, v12
 v_add_f32 v27, v27, v13
 v_lshlrev_b32 v12, 16, v38
 v_and_b32 v13, 0xffff0000, v38
 v_add_f32 v28, v28, v12
 v_add_f32 v29, v29, v13
 v_lshlrev_b32 v12, 16, v39
 v_and_b32 v13, 0xffff0000, v39
 v_add_f32 v30, v30, v12
 v_add_f32 v31, v31, v13
 s_waitcnt vmcnt(2)
 v_lshlrev_b32 v12, 16, v48
 v_and_b32 v13, 0xffff0000, v48
 v_add_f32 v16, v16, v12
 v_add_f32 v17, v17, v13
 v_lshlrev_b32 v12, 16, v49
 v_and_b32 v13, 0xffff0000, v49
 v_add_f32 v18, v18, v12
 v_add_f32 v19, v19, v13
 v_lshlrev_b32 v12, 16, v50
 v_and_b32 v13, 0xffff0000, v50
 v_add_f32 v20, v20, v12
 v_add_f32 v21, v21, v13
 v_lshlrev_b32 v12, 16, v51
 v_and_b32 v13, 0xffff0000, v51
 v_add_f32 v22, v22, v12
 v_add_f32 v23, v23, v13
 v_lshlrev_b32 v12, 16, v52
 v_and_b32 v13, 0xffff0000, v52
 v_add_f32 v24, v24, v12
 v_add_f32 v25, v25, v13
 v_lshlrev_b32 v12, 16, v53
 v_and_b32 v13, 0xffff0000, v53
 v_add_f32 v26, v26, v12
 v_add_f32 v27, v27, v13
 v_lshlrev_b32 v12, 16, v54
 v_and_b32 v13, 0xffff0000, v54
 v_add_f32 v28, v28, v12
 v_add_f32 v29, v29, v13
 v_lshlrev_b32 v12, 16, v55
 v_and_b32 v13, 0xffff0000, v55
 v_add_f32 v30, v30, v12
 v_add_f32 v31, v31, v13
 s_waitcnt vmcnt(0)
 v_lshlrev_b32 v12, 16, v64
 v_and_b32 v13, 0xffff0000, v64
 v_add_f32 v16, v16, v12
 v_add_f32 v17, v17, v13
 v_lshlrev_b32 v12, 16, v65
 v_and_b32 v13, 0xffff0000, v65
 v_add_f32 v18, v18, v12
 v_add_f32 v19, v19, v13
 v_lshlrev_b32 v12, 16, v66
 v_and_b32 v13, 0xffff0000, v66
 v_add_f32 v20, v20, v12
 v_add_f32 v21, v21, v13
 v_lshlrev_b32 v12, 16, v67
 v_and_b32 v13, 0xffff0000, v67
 v_add_f32 v22, v22, v12
 v_add_f32 v23, v23, v13
 v_lshlrev_b32 v12, 16, v68
 v_and_b32 v13, 0xffff0000, v68
 v_add_f32 v24, v24, v12
 v_add_f32 v25, v25, v13
 v_lshlrev_b32 v12, 16, v69
 v_and_b32 v13, 0xffff0000, v69
 v_add_f32 v26, v26, v12
 v_add_f32 v27, v27, v13
 v_lshlrev_b32 v12, 16, v70
 v_and_b32 v13, 0xffff0000, v70
 v_add_f32 v28, v28, v12
 v_add_f32 v29, v29, v13
 v_lshlrev_b32 v12, 16, v71
 v_and_b32 v13, 0xffff0000, v71
 v_add_f32 v30, v30, v12
 v_add_f32 v31, v31, v13
 v_cvt_pk_bf16_f32 v80, v16, v17
 v_cvt_pk_bf16_f32 v81, v18, v19
 v_cvt_pk_bf16_f32 v82, v20, v21
 v_cvt_pk_bf16_f32 v83, v22, v23
 v_cvt_pk_bf16_f32 v84, v24, v25
 v_cvt_pk_bf16_f32 v85, v26, v27
 v_cvt_pk_bf16_f32 v86, v28, v29
 v_cvt_pk_bf16_f32 v87, v30, v31
 s_nop 1
 v_permlane16_swap_b32 v80, v82
 v_permlane16_swap_b32 v81, v83
 v_permlane16_swap_b32 v84, v86
 v_permlane16_swap_b32 v85, v87
 buffer_store_dwordx4 v[80:83], v6, s[4:7], s28 offen
 s_add_u32 s28, s28, 16384
 buffer_store_dwordx4 v[84:87], v6, s[4:7], s28 offen
L_fdone_1:
 s_endpgm
L_rarecode_3:
L_spin_7:
 s_mov_b32 s44, 0x40000
L_sp_104:
 s_sleep 8
 buffer_load_dword v125, v126, s[40:43], 0 offen sc1
 s_waitcnt vmcnt(0)
 v_and_b32 v120, 0xff, v125
 v_cmp_gt_u32 vcc, s45, v120
 s_cbranch_vccz L_spun_8
 s_sub_u32 s44, s44, 1
 s_cmp_lg_u32 s44, 0
 s_cbranch_scc1 L_sp_104
 s_branch L_spun_8
L_spin_9:
 s_mov_b32 s44, 0x40000
L_sp_105:
 s_sleep 8
 buffer_load_dword v125, v126, s[40:43], 0 offen sc1
 s_waitcnt vmcnt(0)
 v_and_b32 v120, 0xff, v125
 v_cmp_gt_u32 vcc, s45, v120
 s_cbranch_vccz L_spun_10
 s_sub_u32 s44, s44, 1
 s_cmp_lg_u32 s44, 0
 s_cbranch_scc1 L_sp_105
 s_branch L_spun_10
L_spin_13:
 s_mov_b32 s44, 0x40000
L_sp_106:
 s_sleep 8
 buffer_load_dword v122, v124, s[16:19], s55 offen sc1
 s_waitcnt vmcnt(0)
 v_cmp_gt_u32 vcc, s46, v122
 s_cbranch_vccz L_spun_14
 s_sub_u32 s44, s44, 1
 s_cmp_lg_u32 s44, 0
 s_cbranch_scc1 L_sp_106
 s_branch L_spun_14
L_spin_43:
 s_mov_b32 s44, 0x40000
L_sp_107:
 s_sleep 8
 buffer_load_dword v251, v250, s[16:19], s55 offen sc1
 s_waitcnt vmcnt(0)
 v_cmp_gt_u32 vcc, s47, v251
 s_cbranch_vccz L_spun_44
 s_sub_u32 s44, s44, 1
 s_cmp_lg_u32 s44, 0
 s_cbranch_scc1 L_sp_107
 s_branch L_spun_44
L_spin_59:
 s_mov_b32 s44, 0x40000
L_sp_108:
 s_sleep 8
 buffer_load_dword v251, v250, s[16:19], s55 offen sc1
 s_waitcnt vmcnt(0)
 v_cmp_gt_u32 vcc, s47, v251
 s_cbranch_vccz L_spun_60
 s_sub_u32 s44, s44, 1
 s_cmp_lg_u32 s44, 0
 s_cbranch_scc1 L_sp_108
 s_branch L_spun_60
L_spin_98:
 s_mov_b32 s44, 0x40000
L_sp_109:
 s_sleep 4
 buffer_load_dword v12, v220, s[16:19], s47 offen sc1
 s_waitcnt vmcnt(0)
 v_cmp_gt_u32 vcc, s29, v12
 s_cbranch_vccz L_spun_99
 s_sub_u32 s44, s44, 1
 s_cmp_lg_u32 s44, 0
 s_cbranch_scc1 L_sp_109
 s_branch L_spun_99
L_spin_100:
 s_mov_b32 s44, 0x40000
L_sp_110:
 s_sleep 8
 buffer_load_dword v223, v220, s[16:19], s47 offen sc1
 s_waitcnt vmcnt(0)
 v_cmp_gt_u32 vcc, s46, v223
 s_cbranch_vccz L_spun_101
 s_sub_u32 s44, s44, 1
 s_cmp_lg_u32 s44, 0
 s_cbranch_scc1 L_sp_110
 s_branch L_spun_101
L_spin_102:
 s_mov_b32 s44, 0x40000
L_sp_111:
 s_sleep 4
 buffer_load_dword v12, v11, s[16:19], s30 offen sc1
 s_waitcnt vmcnt(0)
 v_cmp_gt_u32 vcc, s29, v12
 s_cbranch_vccz L_spun_103
 s_sub_u32 s44, s44, 1
 s_cmp_lg_u32 s44, 0
 s_cbranch_scc1 L_sp_111
 s_branch L_spun_103
L_rel_11:
 buffer_wbl2 sc1
 s_waitcnt vmcnt(0)
 s_branch L_reld_12
L_rel_27:
 buffer_wbl2 sc1
 s_waitcnt vmcnt(0)
 s_branch L_reld_28
L_jr_26:
 s_mov_b32 s44, 0
 s_branch L_rare_24
L_jr_42:
 s_mov_b32 s44, 1
 s_branch L_rare_24
L_jr_46:
 s_mov_b32 s44, 2
 s_branch L_rare_24
L_rare_24:
 s_nop 7
 s_nop 7
 v_max3_f32 v10, v16, v17, v18
 v_max3_f32 v10, v10, v19, v20
 v_max3_f32 v10, v10, v21, v22
 v_max3_f32 v10, v10, v23, v48
 v_max3_f32 v10, v10, v49, v50
 v_max3_f32 v10, v10, v51, v52
 v_max3_f32 v10, v10, v53, v54
 v_max_f32 v10, v10, v55
 v_mov_b32 v11, v10
 s_nop 1
 v_permlane16_swap_b32 v10, v11
 v_max_f32 v10, v10, v11
 v_mov_b32 v11, v10
 s_nop 1
 v_permlane32_swap_b32 v10, v11
 v_max_f32 v10, v10, v11
 v_max_f32 v10, 0, v10
 v_exp_f32 v12, -v10
 v_sub_f32 v16, v16, v10
 v_sub_f32 v17, v17, v10
 v_sub_f32 v18, v18, v10
 v_sub_f32 v19, v19, v10
 v_sub_f32 v20, v20, v10
 v_sub_f32 v21, v21, v10
 v_sub_f32 v22, v22, v10
 v_sub_f32 v23, v23, v10
 v_sub_f32 v48, v48, v10
 v_sub_f32 v49, v49, v10
 v_sub_f32 v50, v50, v10
 v_sub_f32 v51, v51, v10
 v_sub_f32 v52, v52, v10
 v_sub_f32 v53, v53, v10
 v_sub_f32 v54, v54, v10
 v_sub_f32 v55, v55, v10
 v_sub_f32 v208, v208, v10
 v_sub_f32 v209, v209, v10
 v_sub_f32 v210, v210, v10
 v_sub_f32 v211, v211, v10
 v_sub_f32 v80, v80, v10
 v_sub_f32 v81, v81, v10
 v_sub_f32 v82, v82, v10
 v_sub_f32 v83, v83, v10
 v_sub_f32 v84, v84, v10
 v_sub_f32 v85, v85, v10
 v_sub_f32 v86, v86, v10
 v_sub_f32 v87, v87, v10
 v_sub_f32 v112, v112, v10
 v_sub_f32 v113, v113, v10
 v_sub_f32 v114, v114, v10
 v_sub_f32 v115, v115, v10
 v_sub_f32 v116, v116, v10
 v_sub_f32 v117, v117, v10
 v_sub_f32 v118, v118, v10
 v_sub_f32 v119, v119, v10
 v_mul_f32 v4, v4, v12
 v_accvgpr_read_b32 v240, a0
 v_accvgpr_read_b32 v241, a1
 v_accvgpr_read_b32 v242, a2
 v_accvgpr_read_b32 v243, a3
 v_mul_f32 v240, v240, v12
 v_mul_f32 v241, v241, v12
 v_mul_f32 v242, v242, v12
 v_mul_f32 v243, v243, v12
 v_accvgpr_write_b32 a0, v240
 v_accvgpr_write_b32 a1, v241
 v_accvgpr_write_b32 a2, v242
 v_accvgpr_write_b32 a3, v243
 v_accvgpr_read_b32 v240, a4
 v_accvgpr_read_b32 v241, a5
 v_accvgpr_read_b32 v242, a6
 v_accvgpr_read_b32 v243, a7
 v_mul_f32 v240, v240, v12
 v_mul_f32 v241, v241, v12
 v_mul_f32 v242, v242, v12
 v_mul_f32 v243, v243, v12
 v_accvgpr_write_b32 a4, v240
 v_accvgpr_write_b32 a5, v241
 v_accvgpr_write_b32 a6, v242
 v_accvgpr_write_b32 a7, v243
 v_accvgpr_read_b32 v240, a8
 v_accvgpr_read_b32 v241, a9
 v_accvgpr_read_b32 v242, a10
 v_accvgpr_read_b32 v243, a11
 v_mul_f32 v240, v240, v12
 v_mul_f32 v241, v241, v12
 v_mul_f32 v242, v242, v12
 v_mul_f32 v243, v243, v12
 v_accvgpr_write_b32 a8, v240
 v_accvgpr_write_b32 a9, v241
 v_accvgpr_write_b32 a10, v242
 v_accvgpr_write_b32 a11, v243
 v_accvgpr_read_b32 v240, a12
 v_accvgpr_read_b32 v241, a13
 v_accvgpr_read_b32 v242, a14
 v_accvgpr_read_b32 v243, a15
 v_mul_f32 v240, v240, v12
 v_mul_f32 v241, v241, v12
 v_mul_f32 v242, v242, v12
 v_mul_f32 v243, v243, v12
 v_accvgpr_write_b32 a12, v240
 v_accvgpr_write_b32 a13, v241
 v_accvgpr_write_b32 a14, v242
 v_accvgpr_write_b32 a15, v243
 v_accvgpr_read_b32 v240, a16
 v_accvgpr_read_b32 v241, a17
 v_accvgpr_read_b32 v242, a18
 v_accvgpr_read_b32 v243, a19
 v_mul_f32 v240, v240, v12
 v_mul_f32 v241, v241, v12
 v_mul_f32 v242, v242, v12
 v_mul_f32 v243, v243, v12
 v_accvgpr_write_b32 a16, v240
 v_accvgpr_write_b32 a17, v241
 v_accvgpr_write_b32 a18, v242
 v_accvgpr_write_b32 a19, v243
 v_accvgpr_read_b32 v240, a20
 v_accvgpr_read_b32 v241, a21
 v_accvgpr_read_b32 v242, a22
 v_accvgpr_read_b32 v243, a23
 v_mul_f32 v240, v240, v12
 v_mul_f32 v241, v241, v12
 v_mul_f32 v242, v242, v12
 v_mul_f32 v243, v243, v12
 v_accvgpr_write_b32 a20, v240
 v_accvgpr_write_b32 a21, v241
 v_accvgpr_write_b32 a22, v242
 v_accvgpr_write_b32 a23, v243
 v_accvgpr_read_b32 v240, a24
 v_accvgpr_read_b32 v241, a25
 v_accvgpr_read_b32 v242, a26
 v_accvgpr_read_b32 v243, a27
 v_mul_f32 v240, v240, v12
 v_mul_f32 v241, v241, v12
 v_mul_f32 v242, v242, v12
 v_mul_f32 v243, v243, v12
 v_accvgpr_write_b32 a24, v240
 v_accvgpr_write_b32 a25, v241
 v_accvgpr_write_b32 a26, v242
 v_accvgpr_write_b32 a27, v243
 v_accvgpr_read_b32 v240, a28
 v_accvgpr_read_b32 v241, a29
 v_accvgpr_read_b32 v242, a30
 v_accvgpr_read_b32 v243, a31
 v_mul_f32 v240, v240, v12
 v_mul_f32 v241, v241, v12
 v_mul_f32 v242, v242, v12
 v_mul_f32 v243, v243, v12
 v_accvgpr_write_b32 a28, v240
 v_accvgpr_write_b32 a29, v241
 v_accvgpr_write_b32 a30, v242
 v_accvgpr_write_b32 a31, v243
 v_max3_f32 v10, v24, v25, v26
 v_max3_f32 v10, v10, v27, v28
 v_max3_f32 v10, v10, v29, v30
 v_max3_f32 v10, v10, v31, v56
 v_max3_f32 v10, v10, v57, v58
 v_max3_f32 v10, v10, v59, v60
 v_max3_f32 v10, v10, v61, v62
 v_max_f32 v10, v10, v63
 v_mov_b32 v11, v10
 s_nop 1
 v_permlane16_swap_b32 v10, v11
 v_max_f32 v10, v10, v11
 v_mov_b32 v11, v10
 s_nop 1
 v_permlane32_swap_b32 v10, v11
 v_max_f32 v10, v10, v11
 v_max_f32 v10, 0, v10
 v_exp_f32 v12, -v10
 v_sub_f32 v24, v24, v10
 v_sub_f32 v25, v25, v10
 v_sub_f32 v26, v26, v10
 v_sub_f32 v27, v27, v10
 v_sub_f32 v28, v28, v10
 v_sub_f32 v29, v29, v10
 v_sub_f32 v30, v30, v10
 v_sub_f32 v31, v31, v10
 v_sub_f32 v56, v56, v10
 v_sub_f32 v57, v57, v10
 v_sub_f32 v58, v58, v10
 v_sub_f32 v59, v59, v10
 v_sub_f32 v60, v60, v10
 v_sub_f32 v61, v61, v10
 v_sub_f32 v62, v62, v10
 v_sub_f32 v63, v63, v10
 v_sub_f32 v212, v212, v10
 v_sub_f32 v213, v213, v10
 v_sub_f32 v214, v214, v10
 v_sub_f32 v215, v215, v10
 v_sub_f32 v88, v88, v10
 v_sub_f32 v89, v89, v10
 v_sub_f32 v90, v90, v10
 v_sub_f32 v91, v91, v10
 v_sub_f32 v92, v92, v10
 v_sub_f32 v93, v93, v10
 v_sub_f32 v94, v94, v10
 v_sub_f32 v95, v95, v10
 v_sub_f32 v120, v120, v10
 v_sub_f32 v121, v121, v10
 v_sub_f32 v122, v122, v10
 v_sub_f32 v123, v123, v10
 v_sub_f32 v124, v124, v10
 v_sub_f32 v125, v125, v10
 v_sub_f32 v126, v126, v10
 v_sub_f32 v127, v127, v10
 v_mul_f32 v5, v5, v12
 v_accvgpr_read_b32 v240, a32
 v_accvgpr_read_b32 v241, a33
 v_accvgpr_read_b32 v242, a34
 v_accvgpr_read_b32 v243, a35
 v_mul_f32 v240, v240, v12
 v_mul_f32 v241, v241, v12
 v_mul_f32 v242, v242, v12
 v_mul_f32 v243, v243, v12
 v_accvgpr_write_b32 a32, v240
 v_accvgpr_write_b32 a33, v241
 v_accvgpr_write_b32 a34, v242
 v_accvgpr_write_b32 a35, v243
 v_accvgpr_read_b32 v240, a36
 v_accvgpr_read_b32 v241, a37
 v_accvgpr_read_b32 v242, a38
 v_accvgpr_read_b32 v243, a39
 v_mul_f32 v240, v240, v12
 v_mul_f32 v241, v241, v12
 v_mul_f32 v242, v242, v12
 v_mul_f32 v243, v243, v12
 v_accvgpr_write_b32 a36, v240
 v_accvgpr_write_b32 a37, v241
 v_accvgpr_write_b32 a38, v242
 v_accvgpr_write_b32 a39, v243
 v_accvgpr_read_b32 v240, a40
 v_accvgpr_read_b32 v241, a41
 v_accvgpr_read_b32 v242, a42
 v_accvgpr_read_b32 v243, a43
 v_mul_f32 v240, v240, v12
 v_mul_f32 v241, v241, v12
 v_mul_f32 v242, v242, v12
 v_mul_f32 v243, v243, v12
 v_accvgpr_write_b32 a40, v240
 v_accvgpr_write_b32 a41, v241
 v_accvgpr_write_b32 a42, v242
 v_accvgpr_write_b32 a43, v243
 v_accvgpr_read_b32 v240, a44
 v_accvgpr_read_b32 v241, a45
 v_accvgpr_read_b32 v242, a46
 v_accvgpr_read_b32 v243, a47
 v_mul_f32 v240, v240, v12
 v_mul_f32 v241, v241, v12
 v_mul_f32 v242, v242, v12
 v_mul_f32 v243, v243, v12
 v_accvgpr_write_b32 a44, v240
 v_accvgpr_write_b32 a45, v241
 v_accvgpr_write_b32 a46, v242
 v_accvgpr_write_b32 a47, v243
 v_accvgpr_read_b32 v240, a48
 v_accvgpr_read_b32 v241, a49
 v_accvgpr_read_b32 v242, a50
 v_accvgpr_read_b32 v243, a51
 v_mul_f32 v240, v240, v12
 v_mul_f32 v241, v241, v12
 v_mul_f32 v242, v242, v12
 v_mul_f32 v243, v243, v12
 v_accvgpr_write_b32 a48, v240
 v_accvgpr_write_b32 a49, v241
 v_accvgpr_write_b32 a50, v242
 v_accvgpr_write_b32 a51, v243
 v_accvgpr_read_b32 v240, a52
 v_accvgpr_read_b32 v241, a53
 v_accvgpr_read_b32 v242, a54
 v_accvgpr_read_b32 v243, a55
 v_mul_f32 v240, v240, v12
 v_mul_f32 v241, v241, v12
 v_mul_f32 v242, v242, v12
 v_mul_f32 v243, v243, v12
 v_accvgpr_write_b32 a52, v240
 v_accvgpr_write_b32 a53, v241
 v_accvgpr_write_b32 a54, v242
 v_accvgpr_write_b32 a55, v243
 v_accvgpr_read_b32 v240, a56
 v_accvgpr_read_b32 v241, a57
 v_accvgpr_read_b32 v242, a58
 v_accvgpr_read_b32 v243, a59
 v_mul_f32 v240, v240, v12
 v_mul_f32 v241, v241, v12
 v_mul_f32 v242, v242, v12
 v_mul_f32 v243, v243, v12
 v_accvgpr_write_b32 a56, v240
 v_accvgpr_write_b32 a57, v241
 v_accvgpr_write_b32 a58, v242
 v_accvgpr_write_b32 a59, v243
 v_accvgpr_read_b32 v240, a60
 v_accvgpr_read_b32 v241, a61
 v_accvgpr_read_b32 v242, a62
 v_accvgpr_read_b32 v243, a63
 v_mul_f32 v240, v240, v12
 v_mul_f32 v241, v241, v12
 v_mul_f32 v242, v242, v12
 v_mul_f32 v243, v243, v12
 v_accvgpr_write_b32 a60, v240
 v_accvgpr_write_b32 a61, v241
 v_accvgpr_write_b32 a62, v242
 v_accvgpr_write_b32 a63, v243
 v_max3_f32 v10, v32, v33, v34
 v_max3_f32 v10, v10, v35, v36
 v_max3_f32 v10, v10, v37, v38
 v_max3_f32 v10, v10, v39, v64
 v_max3_f32 v10, v10, v65, v66
 v_max3_f32 v10, v10, v67, v68
 v_max3_f32 v10, v10, v69, v70
 v_max_f32 v10, v10, v71
 v_mov_b32 v11, v10
 s_nop 1
 v_permlane16_swap_b32 v10, v11
 v_max_f32 v10, v10, v11
 v_mov_b32 v11, v10
 s_nop 1
 v_permlane32_swap_b32 v10, v11
 v_max_f32 v10, v10, v11
 v_max_f32 v10, 0, v10
 v_exp_f32 v12, -v10
 v_sub_f32 v32, v32, v10
 v_sub_f32 v33, v33, v10
 v_sub_f32 v34, v34, v10
 v_sub_f32 v35, v35, v10
 v_sub_f32 v36, v36, v10
 v_sub_f32 v37, v37, v10
 v_sub_f32 v38, v38, v10
 v_sub_f32 v39, v39, v10
 v_sub_f32 v64, v64, v10
 v_sub_f32 v65, v65, v10
 v_sub_f32 v66, v66, v10
 v_sub_f32 v67, v67, v10
 v_sub_f32 v68, v68, v10
 v_sub_f32 v69, v69, v10
 v_sub_f32 v70, v70, v10
 v_sub_f32 v71, v71, v10
 v_sub_f32 v216, v216, v10
 v_sub_f32 v217, v217, v10
 v_sub_f32 v218, v218, v10
 v_sub_f32 v219, v219, v10
 v_sub_f32 v96, v96, v10
 v_sub_f32 v97, v97, v10
 v_sub_f32 v98, v98, v10
 v_sub_f32 v99, v99, v10
 v_sub_f32 v100, v100, v10
 v_sub_f32 v101, v101, v10
 v_sub_f32 v102, v102, v10
 v_sub_f32 v103, v103, v10
 v_sub_f32 v128, v128, v10
 v_sub_f32 v129, v129, v10
 v_sub_f32 v130, v130, v10
 v_sub_f32 v131, v131, v10
 v_sub_f32 v132, v132, v10
 v_sub_f32 v133, v133, v10
 v_sub_f32 v134, v134, v10
 v_sub_f32 v135, v135, v10
 v_mul_f32 v6, v6, v12
 v_accvgpr_read_b32 v240, a64
 v_accvgpr_read_b32 v241, a65
 v_accvgpr_read_b32 v242, a66
 v_accvgpr_read_b32 v243, a67
 v_mul_f32 v240, v240, v12
 v_mul_f32 v241, v241, v12
 v_mul_f32 v242, v242, v12
 v_mul_f32 v243, v243, v12
 v_accvgpr_write_b32 a64, v240
 v_accvgpr_write_b32 a65, v241
 v_accvgpr_write_b32 a66, v242
 v_accvgpr_write_b32 a67, v243
 v_accvgpr_read_b32 v240, a68
 v_accvgpr_read_b32 v241, a69
 v_accvgpr_read_b32 v242, a70
 v_accvgpr_read_b32 v243, a71
 v_mul_f32 v240, v240, v12
 v_mul_f32 v241, v241, v12
 v_mul_f32 v242, v242, v12
 v_mul_f32 v243, v243, v12
 v_accvgpr_write_b32 a68, v240
 v_accvgpr_write_b32 a69, v241
 v_accvgpr_write_b32 a70, v242
 v_accvgpr_write_b32 a71, v243
 v_accvgpr_read_b32 v240, a72
 v_accvgpr_read_b32 v241, a73
 v_accvgpr_read_b32 v242, a74
 v_accvgpr_read_b32 v243, a75
 v_mul_f32 v240, v240, v12
 v_mul_f32 v241, v241, v12
 v_mul_f32 v242, v242, v12
 v_mul_f32 v243, v243, v12
 v_accvgpr_write_b32 a72, v240
 v_accvgpr_write_b32 a73, v241
 v_accvgpr_write_b32 a74, v242
 v_accvgpr_write_b32 a75, v243
 v_accvgpr_read_b32 v240, a76
 v_accvgpr_read_b32 v241, a77
 v_accvgpr_read_b32 v242, a78
 v_accvgpr_read_b32 v243, a79
 v_mul_f32 v240, v240, v12
 v_mul_f32 v241, v241, v12
 v_mul_f32 v242, v242, v12
 v_mul_f32 v243, v243, v12
 v_accvgpr_write_b32 a76, v240
 v_accvgpr_write_b32 a77, v241
 v_accvgpr_write_b32 a78, v242
 v_accvgpr_write_b32 a79, v243
 v_accvgpr_read_b32 v240, a80
 v_accvgpr_read_b32 v241, a81
 v_accvgpr_read_b32 v242, a82
 v_accvgpr_read_b32 v243, a83
 v_mul_f32 v240, v240, v12
 v_mul_f32 v241, v241, v12
 v_mul_f32 v242, v242, v12
 v_mul_f32 v243, v243, v12
 v_accvgpr_write_b32 a80, v240
 v_accvgpr_write_b32 a81, v241
 v_accvgpr_write_b32 a82, v242
 v_accvgpr_write_b32 a83, v243
 v_accvgpr_read_b32 v240, a84
 v_accvgpr_read_b32 v241, a85
 v_accvgpr_read_b32 v242, a86
 v_accvgpr_read_b32 v243, a87
 v_mul_f32 v240, v240, v12
 v_mul_f32 v241, v241, v12
 v_mul_f32 v242, v242, v12
 v_mul_f32 v243, v243, v12
 v_accvgpr_write_b32 a84, v240
 v_accvgpr_write_b32 a85, v241
 v_accvgpr_write_b32 a86, v242
 v_accvgpr_write_b32 a87, v243
 v_accvgpr_read_b32 v240, a88
 v_accvgpr_read_b32 v241, a89
 v_accvgpr_read_b32 v242, a90
 v_accvgpr_read_b32 v243, a91
 v_mul_f32 v240, v240, v12
 v_mul_f32 v241, v241, v12
 v_mul_f32 v242, v242, v12
 v_mul_f32 v243, v243, v12
 v_accvgpr_write_b32 a88, v240
 v_accvgpr_write_b32 a89, v241
 v_accvgpr_write_b32 a90, v242
 v_accvgpr_write_b32 a91, v243
 v_accvgpr_read_b32 v240, a92
 v_accvgpr_read_b32 v241, a93
 v_accvgpr_read_b32 v242, a94
 v_accvgpr_read_b32 v243, a95
 v_mul_f32 v240, v240, v12
 v_mul_f32 v241, v241, v12
 v_mul_f32 v242, v242, v12
 v_mul_f32 v243, v243, v12
 v_accvgpr_write_b32 a92, v240
 v_accvgpr_write_b32 a93, v241
 v_accvgpr_write_b32 a94, v242
 v_accvgpr_write_b32 a95, v243
 v_max3_f32 v10, v40, v41, v42
 v_max3_f32 v10, v10, v43, v44
 v_max3_f32 v10, v10, v45, v46
 v_max3_f32 v10, v10, v47, v72
 v_max3_f32 v10, v10, v73, v74
 v_max3_f32 v10, v10, v75, v76
 v_max3_f32 v10, v10, v77, v78
 v_max_f32 v10, v10, v79
 v_mov_b32 v11, v10
 s_nop 1
 v_permlane16_swap_b32 v10, v11
 v_max_f32 v10, v10, v11
 v_mov_b32 v11, v10
 s_nop 1
 v_permlane32_swap_b32 v10, v11
 v_max_f32 v10, v10, v11
 v_max_f32 v10, 0, v10
 v_exp_f32 v12, -v10
 v_sub_f32 v40, v40, v10
 v_sub_f32 v41, v41, v10
 v_sub_f32 v42, v42, v10
 v_sub_f32 v43, v43, v10
 v_sub_f32 v44, v44, v10
 v_sub_f32 v45, v45, v10
 v_sub_f32 v46, v46, v10
 v_sub_f32 v47, v47, v10
 v_sub_f32 v72, v72, v10
 v_sub_f32 v73, v73, v10
 v_sub_f32 v74, v74, v10
 v_sub_f32 v75, v75, v10
 v_sub_f32 v76, v76, v10
 v_sub_f32 v77, v77, v10
 v_sub_f32 v78, v78, v10
 v_sub_f32 v79, v79, v10
 v_sub_f32 v220, v220, v10
 v_sub_f32 v221, v221, v10
 v_sub_f32 v222, v222, v10
 v_sub_f32 v223, v223, v10
 v_sub_f32 v104, v104, v10
 v_sub_f32 v105, v105, v10
 v_sub_f32 v106, v106, v10
 v_sub_f32 v107, v107, v10
 v_sub_f32 v108, v108, v10
 v_sub_f32 v109, v109, v10
 v_sub_f32 v110, v110, v10
 v_sub_f32 v111, v111, v10
 v_sub_f32 v136, v136, v10
 v_sub_f32 v137, v137, v10
 v_sub_f32 v138, v138, v10
 v_sub_f32 v139, v139, v10
 v_sub_f32 v140, v140, v10
 v_sub_f32 v141, v141, v10
 v_sub_f32 v142, v142, v10
 v_sub_f32 v143, v143, v10
 v_mul_f32 v7, v7, v12
 v_accvgpr_read_b32 v240, a96
 v_accvgpr_read_b32 v241, a97
 v_accvgpr_read_b32 v242, a98
 v_accvgpr_read_b32 v243, a99
 v_mul_f32 v240, v240, v12
 v_mul_f32 v241, v241, v12
 v_mul_f32 v242, v242, v12
 v_mul_f32 v243, v243, v12
 v_accvgpr_write_b32 a96, v240
 v_accvgpr_write_b32 a97, v241
 v_accvgpr_write_b32 a98, v242
 v_accvgpr_write_b32 a99, v243
 v_accvgpr_read_b32 v240, a100
 v_accvgpr_read_b32 v241, a101
 v_accvgpr_read_b32 v242, a102
 v_accvgpr_read_b32 v243, a103
 v_mul_f32 v240, v240, v12
 v_mul_f32 v241, v241, v12
 v_mul_f32 v242, v242, v12
 v_mul_f32 v243, v243, v12
 v_accvgpr_write_b32 a100, v240
 v_accvgpr_write_b32 a101, v241
 v_accvgpr_write_b32 a102, v242
 v_accvgpr_write_b32 a103, v243
 v_accvgpr_read_b32 v240, a104
 v_accvgpr_read_b32 v241, a105
 v_accvgpr_read_b32 v242, a106
 v_accvgpr_read_b32 v243, a107
 v_mul_f32 v240, v240, v12
 v_mul_f32 v241, v241, v12
 v_mul_f32 v242, v242, v12
 v_mul_f32 v243, v243, v12
 v_accvgpr_write_b32 a104, v240
 v_accvgpr_write_b32 a105, v241
 v_accvgpr_write_b32 a106, v242
 v_accvgpr_write_b32 a107, v243
 v_accvgpr_read_b32 v240, a108
 v_accvgpr_read_b32 v241, a109
 v_accvgpr_read_b32 v242, a110
 v_accvgpr_read_b32 v243, a111
 v_mul_f32 v240, v240, v12
 v_mul_f32 v241, v241, v12
 v_mul_f32 v242, v242, v12
 v_mul_f32 v243, v243, v12
 v_accvgpr_write_b32 a108, v240
 v_accvgpr_write_b32 a109, v241
 v_accvgpr_write_b32 a110, v242
 v_accvgpr_write_b32 a111, v243
 v_accvgpr_read_b32 v240, a112
 v_accvgpr_read_b32 v241, a113
 v_accvgpr_read_b32 v242, a114
 v_accvgpr_read_b32 v243, a115
 v_mul_f32 v240, v240, v12
 v_mul_f32 v241, v241, v12
 v_mul_f32 v242, v242, v12
 v_mul_f32 v243, v243, v12
 v_accvgpr_write_b32 a112, v240
 v_accvgpr_write_b32 a113, v241
 v_accvgpr_write_b32 a114, v242
 v_accvgpr_write_b32 a115, v243
 v_accvgpr_read_b32 v240, a116
 v_accvgpr_read_b32 v241, a117
 v_accvgpr_read_b32 v242, a118
 v_accvgpr_read_b32 v243, a119
 v_mul_f32 v240, v240, v12
 v_mul_f32 v241, v241, v12
 v_mul_f32 v242, v242, v12
 v_mul_f32 v243, v243, v12
 v_accvgpr_write_b32 a116, v240
 v_accvgpr_write_b32 a117, v241
 v_accvgpr_write_b32 a118, v242
 v_accvgpr_write_b32 a119, v243
 v_accvgpr_read_b32 v240, a120
 v_accvgpr_read_b32 v241, a121
 v_accvgpr_read_b32 v242, a122
 v_accvgpr_read_b32 v243, a123
 v_mul_f32 v240, v240, v12
 v_mul_f32 v241, v241, v12
 v_mul_f32 v242, v242, v12
 v_mul_f32 v243, v243, v12
 v_accvgpr_write_b32 a120, v240
 v_accvgpr_write_b32 a121, v241
 v_accvgpr_write_b32 a122, v242
 v_accvgpr_write_b32 a123, v243
 v_accvgpr_read_b32 v240, a124
 v_accvgpr_read_b32 v241, a125
 v_accvgpr_read_b32 v242, a126
 v_accvgpr_read_b32 v243, a127
 v_mul_f32 v240, v240, v12
 v_mul_f32 v241, v241, v12
 v_mul_f32 v242, v242, v12
 v_mul_f32 v243, v243, v12
 v_accvgpr_write_b32 a124, v240
 v_accvgpr_write_b32 a125, v241
 v_accvgpr_write_b32 a126, v242
 v_accvgpr_write_b32 a127, v243
 v_exp_f32 v240, v16
 v_exp_f32 v241, v17
 v_exp_f32 v242, v18
 v_exp_f32 v243, v19
 v_exp_f32 v244, v20
 v_exp_f32 v245, v21
 v_exp_f32 v246, v22
 v_exp_f32 v247, v23
 v_cvt_pk_bf16_f32 v144, v240, v241
 v_cvt_pk_bf16_f32 v145, v242, v243
 v_cvt_pk_bf16_f32 v146, v244, v245
 v_cvt_pk_bf16_f32 v147, v246, v247
 v_exp_f32 v240, v24
 v_exp_f32 v241, v25
 v_exp_f32 v242, v26
 v_exp_f32 v243, v27
 v_exp_f32 v244, v28
 v_exp_f32 v245, v29
 v_exp_f32 v246, v30
 v_exp_f32 v247, v31
 v_cvt_pk_bf16_f32 v148, v240, v241
 v_cvt_pk_bf16_f32 v149, v242, v243
 v_cvt_pk_bf16_f32 v150, v244, v245
 v_cvt_pk_bf16_f32 v151, v246, v247
 v_exp_f32 v240, v32
 v_exp_f32 v241, v33
 v_exp_f32 v242, v34
 v_exp_f32 v243, v35
 v_exp_f32 v244, v36
 v_exp_f32 v245, v37
 v_exp_f32 v246, v38
 v_exp_f32 v247, v39
 v_cvt_pk_bf16_f32 v152, v240, v241
 v_cvt_pk_bf16_f32 v153, v242, v243
 v_cvt_pk_bf16_f32 v154, v244, v245
 v_cvt_pk_bf16_f32 v155, v246, v247
 v_exp_f32 v240, v40
 v_exp_f32 v241, v41
 v_exp_f32 v242, v42
 v_exp_f32 v243, v43
 v_exp_f32 v244, v44
 v_exp_f32 v245, v45
 v_exp_f32 v246, v46
 v_exp_f32 v247, v47
 v_cvt_pk_bf16_f32 v156, v240, v241
 v_cvt_pk_bf16_f32 v157, v242, v243
 v_cvt_pk_bf16_f32 v158, v244, v245
 v_cvt_pk_bf16_f32 v159, v246, v247
 v_exp_f32 v240, v48
 v_exp_f32 v241, v49
 v_exp_f32 v242, v50
 v_exp_f32 v243, v51
 v_exp_f32 v244, v52
 v_exp_f32 v245, v53
 v_exp_f32 v246, v54
 v_exp_f32 v247, v55
 v_cvt_pk_bf16_f32 v160, v240, v241
 v_cvt_pk_bf16_f32 v161, v242, v243
 v_cvt_pk_bf16_f32 v162, v244, v245
 v_cvt_pk_bf16_f32 v163, v246, v247
 v_exp_f32 v240, v56
 v_exp_f32 v241, v57
 v_exp_f32 v242, v58
 v_exp_f32 v243, v59
 v_exp_f32 v244, v60
 v_exp_f32 v245, v61
 v_exp_f32 v246, v62
 v_exp_f32 v247, v63
 v_cvt_pk_bf16_f32 v164, v240, v241
 v_cvt_pk_bf16_f32 v165, v242, v243
 v_cvt_pk_bf16_f32 v166, v244, v245
 v_cvt_pk_bf16_f32 v167, v246, v247
 v_exp_f32 v240, v64
 v_exp_f32 v241, v65
 v_exp_f32 v242, v66
 v_exp_f32 v243, v67
 v_exp_f32 v244, v68
 v_exp_f32 v245, v69
 v_exp_f32 v246, v70
 v_exp_f32 v247, v71
 v_cvt_pk_bf16_f32 v168, v240, v241
 v_cvt_pk_bf16_f32 v169, v242, v243
 v_cvt_pk_bf16_f32 v170, v244, v245
 v_cvt_pk_bf16_f32 v171, v246, v247
 v_exp_f32 v240, v72
 v_exp_f32 v241, v73
 v_exp_f32 v242, v74
 v_exp_f32 v243, v75
 v_exp_f32 v244, v76
 v_exp_f32 v245, v77
 v_exp_f32 v246, v78
 v_exp_f32 v247, v79
 v_cvt_pk_bf16_f32 v172, v240, v241
 v_cvt_pk_bf16_f32 v173, v242, v243
 v_cvt_pk_bf16_f32 v174, v244, v245
 v_cvt_pk_bf16_f32 v175, v246, v247
 s_nop 1
 v_mfma_f32_16x16x32_bf16 v[224:227], v[252:255], v[144:147], 0
 v_mfma_f32_16x16x32_bf16 v[228:231], v[252:255], v[148:151], 0
 v_mfma_f32_16x16x32_bf16 v[232:235], v[252:255], v[152:155], 0
 v_mfma_f32_16x16x32_bf16 v[236:239], v[252:255], v[156:159], 0
 v_mfma_f32_16x16x32_bf16 v[224:227], v[252:255], v[160:163], v[224:227]
 v_mfma_f32_16x16x32_bf16 v[228:231], v[252:255], v[164:167], v[228:231]
 v_mfma_f32_16x16x32_bf16 v[232:235], v[252:255], v[168:171], v[232:235]
 v_mfma_f32_16x16x32_bf16 v[236:239], v[252:255], v[172:175], v[236:239]
 s_nop 7
 s_cmp_eq_u32 s44, 0
 s_cbranch_scc1 L_back_25
 s_cmp_eq_u32 s44, 1
 s_cbranch_scc1 L_back_41
 s_branch L_back_45
L_jr_40:
 s_mov_b32 s44, 0
 s_branch L_rare_38
L_rare_38:
 s_nop 7
 s_nop 7
 v_max3_f32 v10, v80, v81, v82
 v_max3_f32 v10, v10, v83, v84
 v_max3_f32 v10, v10, v85, v86
 v_max3_f32 v10, v10, v87, v112
 v_max3_f32 v10, v10, v113, v114
 v_max3_f32 v10, v10, v115, v116
 v_max3_f32 v10, v10, v117, v118
 v_max_f32 v10, v10, v119
 v_mov_b32 v11, v10
 s_nop 1
 v_permlane16_swap_b32 v10, v11
 v_max_f32 v10, v10, v11
 v_mov_b32 v11, v10
 s_nop 1
 v_permlane32_swap_b32 v10, v11
 v_max_f32 v10, v10, v11
 v_max_f32 v10, 0, v10
 v_exp_f32 v12, -v10
 v_sub_f32 v80, v80, v10
 v_sub_f32 v81, v81, v10
 v_sub_f32 v82, v82, v10
 v_sub_f32 v83, v83, v10
 v_sub_f32 v84, v84, v10
 v_sub_f32 v85, v85, v10
 v_sub_f32 v86, v86, v10
 v_sub_f32 v87, v87, v10
 v_sub_f32 v112, v112, v10
 v_sub_f32 v113, v113, v10
 v_sub_f32 v114, v114, v10
 v_sub_f32 v115, v115, v10
 v_sub_f32 v116, v116, v10
 v_sub_f32 v117, v117, v10
 v_sub_f32 v118, v118, v10
 v_sub_f32 v119, v119, v10
 v_sub_f32 v208, v208, v10
 v_sub_f32 v209, v209, v10
 v_sub_f32 v210, v210, v10
 v_sub_f32 v211, v211, v10
 v_sub_f32 v16, v16, v10
 v_sub_f32 v17, v17, v10
 v_sub_f32 v18, v18, v10
 v_sub_f32 v19, v19, v10
 v_sub_f32 v20, v20, v10
 v_sub_f32 v21, v21, v10
 v_sub_f32 v22, v22, v10
 v_sub_f32 v23, v23, v10
 v_sub_f32 v48, v48, v10
 v_sub_f32 v49, v49, v10
 v_sub_f32 v50, v50, v10
 v_sub_f32 v51, v51, v10
 v_sub_f32 v52, v52, v10
 v_sub_f32 v53, v53, v10
 v_sub_f32 v54, v54, v10
 v_sub_f32 v55, v55, v10
 v_mul_f32 v4, v4, v12
 v_accvgpr_read_b32 v240, a0
 v_accvgpr_read_b32 v241, a1
 v_accvgpr_read_b32 v242, a2
 v_accvgpr_read_b32 v243, a3
 v_mul_f32 v240, v240, v12
 v_mul_f32 v241, v241, v12
 v_mul_f32 v242, v242, v12
 v_mul_f32 v243, v243, v12
 v_accvgpr_write_b32 a0, v240
 v_accvgpr_write_b32 a1, v241
 v_accvgpr_write_b32 a2, v242
 v_accvgpr_write_b32 a3, v243
 v_accvgpr_read_b32 v240, a4
 v_accvgpr_read_b32 v241, a5
 v_accvgpr_read_b32 v242, a6
 v_accvgpr_read_b32 v243, a7
 v_mul_f32 v240, v240, v12
 v_mul_f32 v241, v241, v12
 v_mul_f32 v242, v242, v12
 v_mul_f32 v243, v243, v12
 v_accvgpr_write_b32 a4, v240
 v_accvgpr_write_b32 a5, v241
 v_accvgpr_write_b32 a6, v242
 v_accvgpr_write_b32 a7, v243
 v_accvgpr_read_b32 v240, a8
 v_accvgpr_read_b32 v241, a9
 v_accvgpr_read_b32 v242, a10
 v_accvgpr_read_b32 v243, a11
 v_mul_f32 v240, v240, v12
 v_mul_f32 v241, v241, v12
 v_mul_f32 v242, v242, v12
 v_mul_f32 v243, v243, v12
 v_accvgpr_write_b32 a8, v240
 v_accvgpr_write_b32 a9, v241
 v_accvgpr_write_b32 a10, v242
 v_accvgpr_write_b32 a11, v243
 v_accvgpr_read_b32 v240, a12
 v_accvgpr_read_b32 v241, a13
 v_accvgpr_read_b32 v242, a14
 v_accvgpr_read_b32 v243, a15
 v_mul_f32 v240, v240, v12
 v_mul_f32 v241, v241, v12
 v_mul_f32 v242, v242, v12
 v_mul_f32 v243, v243, v12
 v_accvgpr_write_b32 a12, v240
 v_accvgpr_write_b32 a13, v241
 v_accvgpr_write_b32 a14, v242
 v_accvgpr_write_b32 a15, v243
 v_accvgpr_read_b32 v240, a16
 v_accvgpr_read_b32 v241, a17
 v_accvgpr_read_b32 v242, a18
 v_accvgpr_read_b32 v243, a19
 v_mul_f32 v240, v240, v12
 v_mul_f32 v241, v241, v12
 v_mul_f32 v242, v242, v12
 v_mul_f32 v243, v243, v12
 v_accvgpr_write_b32 a16, v240
 v_accvgpr_write_b32 a17, v241
 v_accvgpr_write_b32 a18, v242
 v_accvgpr_write_b32 a19, v243
 v_accvgpr_read_b32 v240, a20
 v_accvgpr_read_b32 v241, a21
 v_accvgpr_read_b32 v242, a22
 v_accvgpr_read_b32 v243, a23
 v_mul_f32 v240, v240, v12
 v_mul_f32 v241, v241, v12
 v_mul_f32 v242, v242, v12
 v_mul_f32 v243, v243, v12
 v_accvgpr_write_b32 a20, v240
 v_accvgpr_write_b32 a21, v241
 v_accvgpr_write_b32 a22, v242
 v_accvgpr_write_b32 a23, v243
 v_accvgpr_read_b32 v240, a24
 v_accvgpr_read_b32 v241, a25
 v_accvgpr_read_b32 v242, a26
 v_accvgpr_read_b32 v243, a27
 v_mul_f32 v240, v240, v12
 v_mul_f32 v241, v241, v12
 v_mul_f32 v242, v242, v12
 v_mul_f32 v243, v243, v12
 v_accvgpr_write_b32 a24, v240
 v_accvgpr_write_b32 a25, v241
 v_accvgpr_write_b32 a26, v242
 v_accvgpr_write_b32 a27, v243
 v_accvgpr_read_b32 v240, a28
 v_accvgpr_read_b32 v241, a29
 v_accvgpr_read_b32 v242, a30
 v_accvgpr_read_b32 v243, a31
 v_mul_f32 v240, v240, v12
 v_mul_f32 v241, v241, v12
 v_mul_f32 v242, v242, v12
 v_mul_f32 v243, v243, v12
 v_accvgpr_write_b32 a28, v240
 v_accvgpr_write_b32 a29, v241
 v_accvgpr_write_b32 a30, v242
 v_accvgpr_write_b32 a31, v243
 v_max3_f32 v10, v88, v89, v90
 v_max3_f32 v10, v10, v91, v92
 v_max3_f32 v10, v10, v93, v94
 v_max3_f32 v10, v10, v95, v120
 v_max3_f32 v10, v10, v121, v122
 v_max3_f32 v10, v10, v123, v124
 v_max3_f32 v10, v10, v125, v126
 v_max_f32 v10, v10, v127
 v_mov_b32 v11, v10
 s_nop 1
 v_permlane16_swap_b32 v10, v11
 v_max_f32 v10, v10, v11
 v_mov_b32 v11, v10
 s_nop 1
 v_permlane32_swap_b32 v10, v11
 v_max_f32 v10, v10, v11
 v_max_f32 v10, 0, v10
 v_exp_f32 v12, -v10
 v_sub_f32 v88, v88, v10
 v_sub_f32 v89, v89, v10
 v_sub_f32 v90, v90, v10
 v_sub_f32 v91, v91, v10
 v_sub_f32 v92, v92, v10
 v_sub_f32 v93, v93, v10
 v_sub_f32 v94, v94, v10
 v_sub_f32 v95, v95, v10
 v_sub_f32 v120, v120, v10
 v_sub_f32 v121, v121, v10
 v_sub_f32 v122, v122, v10
 v_sub_f32 v123, v123, v10
 v_sub_f32 v124, v124, v10
 v_sub_f32 v125, v125, v10
 v_sub_f32 v126, v126, v10
 v_sub_f32 v127, v127, v10
 v_sub_f32 v212, v212, v10
 v_sub_f32 v213, v213, v10
 v_sub_f32 v214, v214, v10
 v_sub_f32 v215, v215, v10
 v_sub_f32 v24, v24, v10
 v_sub_f32 v25, v25, v10
 v_sub_f32 v26, v26, v10
 v_sub_f32 v27, v27, v10
 v_sub_f32 v28, v28, v10
 v_sub_f32 v29, v29, v10
 v_sub_f32 v30, v30, v10
 v_sub_f32 v31, v31, v10
 v_sub_f32 v56, v56, v10
 v_sub_f32 v57, v57, v10
 v_sub_f32 v58, v58, v10
 v_sub_f32 v59, v59, v10
 v_sub_f32 v60, v60, v10
 v_sub_f32 v61, v61, v10
 v_sub_f32 v62, v62, v10
 v_sub_f32 v63, v63, v10
 v_mul_f32 v5, v5, v12
 v_accvgpr_read_b32 v240, a32
 v_accvgpr_read_b32 v241, a33
 v_accvgpr_read_b32 v242, a34
 v_accvgpr_read_b32 v243, a35
 v_mul_f32 v240, v240, v12
 v_mul_f32 v241, v241, v12
 v_mul_f32 v242, v242, v12
 v_mul_f32 v243, v243, v12
 v_accvgpr_write_b32 a32, v240
 v_accvgpr_write_b32 a33, v241
 v_accvgpr_write_b32 a34, v242
 v_accvgpr_write_b32 a35, v243
 v_accvgpr_read_b32 v240, a36
 v_accvgpr_read_b32 v241, a37
 v_accvgpr_read_b32 v242, a38
 v_accvgpr_read_b32 v243, a39
 v_mul_f32 v240, v240, v12
 v_mul_f32 v241, v241, v12
 v_mul_f32 v242, v242, v12
 v_mul_f32 v243, v243, v12
 v_accvgpr_write_b32 a36, v240
 v_accvgpr_write_b32 a37, v241
 v_accvgpr_write_b32 a38, v242
 v_accvgpr_write_b32 a39, v243
 v_accvgpr_read_b32 v240, a40
 v_accvgpr_read_b32 v241, a41
 v_accvgpr_read_b32 v242, a42
 v_accvgpr_read_b32 v243, a43
 v_mul_f32 v240, v240, v12
 v_mul_f32 v241, v241, v12
 v_mul_f32 v242, v242, v12
 v_mul_f32 v243, v243, v12
 v_accvgpr_write_b32 a40, v240
 v_accvgpr_write_b32 a41, v241
 v_accvgpr_write_b32 a42, v242
 v_accvgpr_write_b32 a43, v243
 v_accvgpr_read_b32 v240, a44
 v_accvgpr_read_b32 v241, a45
 v_accvgpr_read_b32 v242, a46
 v_accvgpr_read_b32 v243, a47
 v_mul_f32 v240, v240, v12
 v_mul_f32 v241, v241, v12
 v_mul_f32 v242, v242, v12
 v_mul_f32 v243, v243, v12
 v_accvgpr_write_b32 a44, v240
 v_accvgpr_write_b32 a45, v241
 v_accvgpr_write_b32 a46, v242
 v_accvgpr_write_b32 a47, v243
 v_accvgpr_read_b32 v240, a48
 v_accvgpr_read_b32 v241, a49
 v_accvgpr_read_b32 v242, a50
 v_accvgpr_read_b32 v243, a51
 v_mul_f32 v240, v240, v12
 v_mul_f32 v241, v241, v12
 v_mul_f32 v242, v242, v12
 v_mul_f32 v243, v243, v12
 v_accvgpr_write_b32 a48, v240
 v_accvgpr_write_b32 a49, v241
 v_accvgpr_write_b32 a50, v242
 v_accvgpr_write_b32 a51, v243
 v_accvgpr_read_b32 v240, a52
 v_accvgpr_read_b32 v241, a53
 v_accvgpr_read_b32 v242, a54
 v_accvgpr_read_b32 v243, a55
 v_mul_f32 v240, v240, v12
 v_mul_f32 v241, v241, v12
 v_mul_f32 v242, v242, v12
 v_mul_f32 v243, v243, v12
 v_accvgpr_write_b32 a52, v240
 v_accvgpr_write_b32 a53, v241
 v_accvgpr_write_b32 a54, v242
 v_accvgpr_write_b32 a55, v243
 v_accvgpr_read_b32 v240, a56
 v_accvgpr_read_b32 v241, a57
 v_accvgpr_read_b32 v242, a58
 v_accvgpr_read_b32 v243, a59
 v_mul_f32 v240, v240, v12
 v_mul_f32 v241, v241, v12
 v_mul_f32 v242, v242, v12
 v_mul_f32 v243, v243, v12
 v_accvgpr_write_b32 a56, v240
 v_accvgpr_write_b32 a57, v241
 v_accvgpr_write_b32 a58, v242
 v_accvgpr_write_b32 a59, v243
 v_accvgpr_read_b32 v240, a60
 v_accvgpr_read_b32 v241, a61
 v_accvgpr_read_b32 v242, a62
 v_accvgpr_read_b32 v243, a63
 v_mul_f32 v240, v240, v12
 v_mul_f32 v241, v241, v12
 v_mul_f32 v242, v242, v12
 v_mul_f32 v243, v243, v12
 v_accvgpr_write_b32 a60, v240
 v_accvgpr_write_b32 a61, v241
 v_accvgpr_write_b32 a62, v242
 v_accvgpr_write_b32 a63, v243
 v_max3_f32 v10, v96, v97, v98
 v_max3_f32 v10, v10, v99, v100
 v_max3_f32 v10, v10, v101, v102
 v_max3_f32 v10, v10, v103, v128
 v_max3_f32 v10, v10, v129, v130
 v_max3_f32 v10, v10, v131, v132
 v_max3_f32 v10, v10, v133, v134
 v_max_f32 v10, v10, v135
 v_mov_b32 v11, v10
 s_nop 1
 v_permlane16_swap_b32 v10, v11
 v_max_f32 v10, v10, v11
 v_mov_b32 v11, v10
 s_nop 1
 v_permlane32_swap_b32 v10, v11
 v_max_f32 v10, v10, v11
 v_max_f32 v10, 0, v10
 v_exp_f32 v12, -v10
 v_sub_f32 v96, v96, v10
 v_sub_f32 v97, v97, v10
 v_sub_f32 v98, v98, v10
 v_sub_f32 v99, v99, v10
 v_sub_f32 v100, v100, v10
 v_sub_f32 v101, v101, v10
 v_sub_f32 v102, v102, v10
 v_sub_f32 v103, v103, v10
 v_sub_f32 v128, v128, v10
 v_sub_f32 v129, v129, v10
 v_sub_f32 v130, v130, v10
 v_sub_f32 v131, v131, v10
 v_sub_f32 v132, v132, v10
 v_sub_f32 v133, v133, v10
 v_sub_f32 v134, v134, v10
 v_sub_f32 v135, v135, v10
 v_sub_f32 v216, v216, v10
 v_sub_f32 v217, v217, v10
 v_sub_f32 v218, v218, v10
 v_sub_f32 v219, v219, v10
 v_sub_f32 v32, v32, v10
 v_sub_f32 v33, v33, v10
 v_sub_f32 v34, v34, v10
 v_sub_f32 v35, v35, v10
 v_sub_f32 v36, v36, v10
 v_sub_f32 v37, v37, v10
 v_sub_f32 v38, v38, v10
 v_sub_f32 v39, v39, v10
 v_sub_f32 v64, v64, v10
 v_sub_f32 v65, v65, v10
 v_sub_f32 v66, v66, v10
 v_sub_f32 v67, v67, v10
 v_sub_f32 v68, v68, v10
 v_sub_f32 v69, v69, v10
 v_sub_f32 v70, v70, v10
 v_sub_f32 v71, v71, v10
 v_mul_f32 v6, v6, v12
 v_accvgpr_read_b32 v240, a64
 v_accvgpr_read_b32 v241, a65
 v_accvgpr_read_b32 v242, a66
 v_accvgpr_read_b32 v243, a67
 v_mul_f32 v240, v240, v12
 v_mul_f32 v241, v241, v12
 v_mul_f32 v242, v242, v12
 v_mul_f32 v243, v243, v12
 v_accvgpr_write_b32 a64, v240
 v_accvgpr_write_b32 a65, v241
 v_accvgpr_write_b32 a66, v242
 v_accvgpr_write_b32 a67, v243
 v_accvgpr_read_b32 v240, a68
 v_accvgpr_read_b32 v241, a69
 v_accvgpr_read_b32 v242, a70
 v_accvgpr_read_b32 v243, a71
 v_mul_f32 v240, v240, v12
 v_mul_f32 v241, v241, v12
 v_mul_f32 v242, v242, v12
 v_mul_f32 v243, v243, v12
 v_accvgpr_write_b32 a68, v240
 v_accvgpr_write_b32 a69, v241
 v_accvgpr_write_b32 a70, v242
 v_accvgpr_write_b32 a71, v243
 v_accvgpr_read_b32 v240, a72
 v_accvgpr_read_b32 v241, a73
 v_accvgpr_read_b32 v242, a74
 v_accvgpr_read_b32 v243, a75
 v_mul_f32 v240, v240, v12
 v_mul_f32 v241, v241, v12
 v_mul_f32 v242, v242, v12
 v_mul_f32 v243, v243, v12
 v_accvgpr_write_b32 a72, v240
 v_accvgpr_write_b32 a73, v241
 v_accvgpr_write_b32 a74, v242
 v_accvgpr_write_b32 a75, v243
 v_accvgpr_read_b32 v240, a76
 v_accvgpr_read_b32 v241, a77
 v_accvgpr_read_b32 v242, a78
 v_accvgpr_read_b32 v243, a79
 v_mul_f32 v240, v240, v12
 v_mul_f32 v241, v241, v12
 v_mul_f32 v242, v242, v12
 v_mul_f32 v243, v243, v12
 v_accvgpr_write_b32 a76, v240
 v_accvgpr_write_b32 a77, v241
 v_accvgpr_write_b32 a78, v242
 v_accvgpr_write_b32 a79, v243
 v_accvgpr_read_b32 v240, a80
 v_accvgpr_read_b32 v241, a81
 v_accvgpr_read_b32 v242, a82
 v_accvgpr_read_b32 v243, a83
 v_mul_f32 v240, v240, v12
 v_mul_f32 v241, v241, v12
 v_mul_f32 v242, v242, v12
 v_mul_f32 v243, v243, v12
 v_accvgpr_write_b32 a80, v240
 v_accvgpr_write_b32 a81, v241
 v_accvgpr_write_b32 a82, v242
 v_accvgpr_write_b32 a83, v243
 v_accvgpr_read_b32 v240, a84
 v_accvgpr_read_b32 v241, a85
 v_accvgpr_read_b32 v242, a86
 v_accvgpr_read_b32 v243, a87
 v_mul_f32 v240, v240, v12
 v_mul_f32 v241, v241, v12
 v_mul_f32 v242, v242, v12
 v_mul_f32 v243, v243, v12
 v_accvgpr_write_b32 a84, v240
 v_accvgpr_write_b32 a85, v241
 v_accvgpr_write_b32 a86, v242
 v_accvgpr_write_b32 a87, v243
 v_accvgpr_read_b32 v240, a88
 v_accvgpr_read_b32 v241, a89
 v_accvgpr_read_b32 v242, a90
 v_accvgpr_read_b32 v243, a91
 v_mul_f32 v240, v240, v12
 v_mul_f32 v241, v241, v12
 v_mul_f32 v242, v242, v12
 v_mul_f32 v243, v243, v12
 v_accvgpr_write_b32 a88, v240
 v_accvgpr_write_b32 a89, v241
 v_accvgpr_write_b32 a90, v242
 v_accvgpr_write_b32 a91, v243
 v_accvgpr_read_b32 v240, a92
 v_accvgpr_read_b32 v241, a93
 v_accvgpr_read_b32 v242, a94
 v_accvgpr_read_b32 v243, a95
 v_mul_f32 v240, v240, v12
 v_mul_f32 v241, v241, v12
 v_mul_f32 v242, v242, v12
 v_mul_f32 v243, v243, v12
 v_accvgpr_write_b32 a92, v240
 v_accvgpr_write_b32 a93, v241
 v_accvgpr_write_b32 a94, v242
 v_accvgpr_write_b32 a95, v243
 v_max3_f32 v10, v104, v105, v106
 v_max3_f32 v10, v10, v107, v108
 v_max3_f32 v10, v10, v109, v110
 v_max3_f32 v10, v10, v111, v136
 v_max3_f32 v10, v10, v137, v138
 v_max3_f32 v10, v10, v139, v140
 v_max3_f32 v10, v10, v141, v142
 v_max_f32 v10, v10, v143
 v_mov_b32 v11, v10
 s_nop 1
 v_permlane16_swap_b32 v10, v11
 v_max_f32 v10, v10, v11
 v_mov_b32 v11, v10
 s_nop 1
 v_permlane32_swap_b32 v10, v11
 v_max_f32 v10, v10, v11
 v_max_f32 v10, 0, v10
 v_exp_f32 v12, -v10
 v_sub_f32 v104, v104, v10
 v_sub_f32 v105, v105, v10
 v_sub_f32 v106, v106, v10
 v_sub_f32 v107, v107, v10
 v_sub_f32 v108, v108, v10
 v_sub_f32 v109, v109, v10
 v_sub_f32 v110, v110, v10
 v_sub_f32 v111, v111, v10
 v_sub_f32 v136, v136, v10
 v_sub_f32 v137, v137, v10
 v_sub_f32 v138, v138, v10
 v_sub_f32 v139, v139, v10
 v_sub_f32 v140, v140, v10
 v_sub_f32 v141, v141, v10
 v_sub_f32 v142, v142, v10
 v_sub_f32 v143, v143, v10
 v_sub_f32 v220, v220, v10
 v_sub_f32 v221, v221, v10
 v_sub_f32 v222, v222, v10
 v_sub_f32 v223, v223, v10
 v_sub_f32 v40, v40, v10
 v_sub_f32 v41, v41, v10
 v_sub_f32 v42, v42, v10
 v_sub_f32 v43, v43, v10
 v_sub_f32 v44, v44, v10
 v_sub_f32 v45, v45, v10
 v_sub_f32 v46, v46, v10
 v_sub_f32 v47, v47, v10
 v_sub_f32 v72, v72, v10
 v_sub_f32 v73, v73, v10
 v_sub_f32 v74, v74, v10
 v_sub_f32 v75, v75, v10
 v_sub_f32 v76, v76, v10
 v_sub_f32 v77, v77, v10
 v_sub_f32 v78, v78, v10
 v_sub_f32 v79, v79, v10
 v_mul_f32 v7, v7, v12
 v_accvgpr_read_b32 v240, a96
 v_accvgpr_read_b32 v241, a97
 v_accvgpr_read_b32 v242, a98
 v_accvgpr_read_b32 v243, a99
 v_mul_f32 v240, v240, v12
 v_mul_f32 v241, v241, v12
 v_mul_f32 v242, v242, v12
 v_mul_f32 v243, v243, v12
 v_accvgpr_write_b32 a96, v240
 v_accvgpr_write_b32 a97, v241
 v_accvgpr_write_b32 a98, v242
 v_accvgpr_write_b32 a99, v243
 v_accvgpr_read_b32 v240, a100
 v_accvgpr_read_b32 v241, a101
 v_accvgpr_read_b32 v242, a102
 v_accvgpr_read_b32 v243, a103
 v_mul_f32 v240, v240, v12
 v_mul_f32 v241, v241, v12
 v_mul_f32 v242, v242, v12
 v_mul_f32 v243, v243, v12
 v_accvgpr_write_b32 a100, v240
 v_accvgpr_write_b32 a101, v241
 v_accvgpr_write_b32 a102, v242
 v_accvgpr_write_b32 a103, v243
 v_accvgpr_read_b32 v240, a104
 v_accvgpr_read_b32 v241, a105
 v_accvgpr_read_b32 v242, a106
 v_accvgpr_read_b32 v243, a107
 v_mul_f32 v240, v240, v12
 v_mul_f32 v241, v241, v12
 v_mul_f32 v242, v242, v12
 v_mul_f32 v243, v243, v12
 v_accvgpr_write_b32 a104, v240
 v_accvgpr_write_b32 a105, v241
 v_accvgpr_write_b32 a106, v242
 v_accvgpr_write_b32 a107, v243
 v_accvgpr_read_b32 v240, a108
 v_accvgpr_read_b32 v241, a109
 v_accvgpr_read_b32 v242, a110
 v_accvgpr_read_b32 v243, a111
 v_mul_f32 v240, v240, v12
 v_mul_f32 v241, v241, v12
 v_mul_f32 v242, v242, v12
 v_mul_f32 v243, v243, v12
 v_accvgpr_write_b32 a108, v240
 v_accvgpr_write_b32 a109, v241
 v_accvgpr_write_b32 a110, v242
 v_accvgpr_write_b32 a111, v243
 v_accvgpr_read_b32 v240, a112
 v_accvgpr_read_b32 v241, a113
 v_accvgpr_read_b32 v242, a114
 v_accvgpr_read_b32 v243, a115
 v_mul_f32 v240, v240, v12
 v_mul_f32 v241, v241, v12
 v_mul_f32 v242, v242, v12
 v_mul_f32 v243, v243, v12
 v_accvgpr_write_b32 a112, v240
 v_accvgpr_write_b32 a113, v241
 v_accvgpr_write_b32 a114, v242
 v_accvgpr_write_b32 a115, v243
 v_accvgpr_read_b32 v240, a116
 v_accvgpr_read_b32 v241, a117
 v_accvgpr_read_b32 v242, a118
 v_accvgpr_read_b32 v243, a119
 v_mul_f32 v240, v240, v12
 v_mul_f32 v241, v241, v12
 v_mul_f32 v242, v242, v12
 v_mul_f32 v243, v243, v12
 v_accvgpr_write_b32 a116, v240
 v_accvgpr_write_b32 a117, v241
 v_accvgpr_write_b32 a118, v242
 v_accvgpr_write_b32 a119, v243
 v_accvgpr_read_b32 v240, a120
 v_accvgpr_read_b32 v241, a121
 v_accvgpr_read_b32 v242, a122
 v_accvgpr_read_b32 v243, a123
 v_mul_f32 v240, v240, v12
 v_mul_f32 v241, v241, v12
 v_mul_f32 v242, v242, v12
 v_mul_f32 v243, v243, v12
 v_accvgpr_write_b32 a120, v240
 v_accvgpr_write_b32 a121, v241
 v_accvgpr_write_b32 a122, v242
 v_accvgpr_write_b32 a123, v243
 v_accvgpr_read_b32 v240, a124
 v_accvgpr_read_b32 v241, a125
 v_accvgpr_read_b32 v242, a126
 v_accvgpr_read_b32 v243, a127
 v_mul_f32 v240, v240, v12
 v_mul_f32 v241, v241, v12
 v_mul_f32 v242, v242, v12
 v_mul_f32 v243, v243, v12
 v_accvgpr_write_b32 a124, v240
 v_accvgpr_write_b32 a125, v241
 v_accvgpr_write_b32 a126, v242
 v_accvgpr_write_b32 a127, v243
 v_exp_f32 v240, v80
 v_exp_f32 v241, v81
 v_exp_f32 v242, v82
 v_exp_f32 v243, v83
 v_exp_f32 v244, v84
 v_exp_f32 v245, v85
 v_exp_f32 v246, v86
 v_exp_f32 v247, v87
 v_cvt_pk_bf16_f32 v176, v240, v241
 v_cvt_pk_bf16_f32 v177, v242, v243
 v_cvt_pk_bf16_f32 v178, v244, v245
 v_cvt_pk_bf16_f32 v179, v246, v247
 v_exp_f32 v240, v88
 v_exp_f32 v241, v89
 v_exp_f32 v242, v90
 v_exp_f32 v243, v91
 v_exp_f32 v244, v92
 v_exp_f32 v245, v93
 v_exp_f32 v246, v94
 v_exp_f32 v247, v95
 v_cvt_pk_bf16_f32 v180, v240, v241
 v_cvt_pk_bf16_f32 v181, v242, v243
 v_cvt_pk_bf16_f32 v182, v244, v245
 v_cvt_pk_bf16_f32 v183, v246, v247
 v_exp_f32 v240, v96
 v_exp_f32 v241, v97
 v_exp_f32 v242, v98
 v_exp_f32 v243, v99
 v_exp_f32 v244, v100
 v_exp_f32 v245, v101
 v_exp_f32 v246, v102
 v_exp_f32 v247, v103
 v_cvt_pk_bf16_f32 v184, v240, v241
 v_cvt_pk_bf16_f32 v185, v242, v243
 v_cvt_pk_bf16_f32 v186, v244, v245
 v_cvt_pk_bf16_f32 v187, v246, v247
 v_exp_f32 v240, v104
 v_exp_f32 v241, v105
 v_exp_f32 v242, v106
 v_exp_f32 v243, v107
 v_exp_f32 v244, v108
 v_exp_f32 v245, v109
 v_exp_f32 v246, v110
 v_exp_f32 v247, v111
 v_cvt_pk_bf16_f32 v188, v240, v241
 v_cvt_pk_bf16_f32 v189, v242, v243
 v_cvt_pk_bf16_f32 v190, v244, v245
 v_cvt_pk_bf16_f32 v191, v246, v247
 v_exp_f32 v240, v112
 v_exp_f32 v241, v113
 v_exp_f32 v242, v114
 v_exp_f32 v243, v115
 v_exp_f32 v244, v116
 v_exp_f32 v245, v117
 v_exp_f32 v246, v118
 v_exp_f32 v247, v119
 v_cvt_pk_bf16_f32 v192, v240, v241
 v_cvt_pk_bf16_f32 v193, v242, v243
 v_cvt_pk_bf16_f32 v194, v244, v245
 v_cvt_pk_bf16_f32 v195, v246, v247
 v_exp_f32 v240, v120
 v_exp_f32 v241, v121
 v_exp_f32 v242, v122
 v_exp_f32 v243, v123
 v_exp_f32 v244, v124
 v_exp_f32 v245, v125
 v_exp_f32 v246, v126
 v_exp_f32 v247, v127
 v_cvt_pk_bf16_f32 v196, v240, v241
 v_cvt_pk_bf16_f32 v197, v242, v243
 v_cvt_pk_bf16_f32 v198, v244, v245
 v_cvt_pk_bf16_f32 v199, v246, v247
 v_exp_f32 v240, v128
 v_exp_f32 v241, v129
 v_exp_f32 v242, v130
 v_exp_f32 v243, v131
 v_exp_f32 v244, v132
 v_exp_f32 v245, v133
 v_exp_f32 v246, v134
 v_exp_f32 v247, v135
 v_cvt_pk_bf16_f32 v200, v240, v241
 v_cvt_pk_bf16_f32 v201, v242, v243
 v_cvt_pk_bf16_f32 v202, v244, v245
 v_cvt_pk_bf16_f32 v203, v246, v247
 v_exp_f32 v240, v136
 v_exp_f32 v241, v137
 v_exp_f32 v242, v138
 v_exp_f32 v243, v139
 v_exp_f32 v244, v140
 v_exp_f32 v245, v141
 v_exp_f32 v246, v142
 v_exp_f32 v247, v143
 v_cvt_pk_bf16_f32 v204, v240, v241
 v_cvt_pk_bf16_f32 v205, v242, v243
 v_cvt_pk_bf16_f32 v206, v244, v245
 v_cvt_pk_bf16_f32 v207, v246, v247
 s_nop 1
 v_mfma_f32_16x16x32_bf16 v[224:227], v[252:255], v[176:179], 0
 v_mfma_f32_16x16x32_bf16 v[228:231], v[252:255], v[180:183], 0
 v_mfma_f32_16x16x32_bf16 v[232:235], v[252:255], v[184:187], 0
 v_mfma_f32_16x16x32_bf16 v[236:239], v[252:255], v[188:191], 0
 v_mfma_f32_16x16x32_bf16 v[224:227], v[252:255], v[192:195], v[224:227]
 v_mfma_f32_16x16x32_bf16 v[228:231], v[252:255], v[196:199], v[228:231]
 v_mfma_f32_16x16x32_bf16 v[232:235], v[252:255], v[200:203], v[232:235]
 v_mfma_f32_16x16x32_bf16 v[236:239], v[252:255], v[204:207], v[236:239]
 s_nop 7
 s_branch L_back_39
L_jr_58:
 s_mov_b32 s44, 0
 s_branch L_rare_56
L_jr_73:
 s_mov_b32 s44, 1
 s_branch L_rare_56
L_rare_56:
 s_nop 7
 s_nop 7
 v_max3_f32 v10, v80, v81, v82
 v_max3_f32 v10, v10, v83, v84
 v_max3_f32 v10, v10, v85, v86
 v_max3_f32 v10, v10, v87, v112
 v_max3_f32 v10, v10, v113, v114
 v_max3_f32 v10, v10, v115, v116
 v_max3_f32 v10, v10, v117, v118
 v_max_f32 v10, v10, v119
 v_mov_b32 v11, v10
 s_nop 1
 v_permlane16_swap_b32 v10, v11
 v_max_f32 v10, v10, v11
 v_mov_b32 v11, v10
 s_nop 1
 v_permlane32_swap_b32 v10, v11
 v_max_f32 v10, v10, v11
 v_max_f32 v10, 0, v10
 v_exp_f32 v12, -v10
 v_sub_f32 v80, v80, v10
 v_sub_f32 v81, v81, v10
 v_sub_f32 v82, v82, v10
 v_sub_f32 v83, v83, v10
 v_sub_f32 v84, v84, v10
 v_sub_f32 v85, v85, v10
 v_sub_f32 v86, v86, v10
 v_sub_f32 v87, v87, v10
 v_sub_f32 v112, v112, v10
 v_sub_f32 v113, v113, v10
 v_sub_f32 v114, v114, v10
 v_sub_f32 v115, v115, v10
 v_sub_f32 v116, v116, v10
 v_sub_f32 v117, v117, v10
 v_sub_f32 v118, v118, v10
 v_sub_f32 v119, v119, v10
 v_sub_f32 v208, v208, v10
 v_sub_f32 v209, v209, v10
 v_sub_f32 v210, v210, v10
 v_sub_f32 v211, v211, v10
 v_sub_f32 v16, v16, v10
 v_sub_f32 v17, v17, v10
 v_sub_f32 v18, v18, v10
 v_sub_f32 v19, v19, v10
 v_sub_f32 v20, v20, v10
 v_sub_f32 v21, v21, v10
 v_sub_f32 v22, v22, v10
 v_sub_f32 v23, v23, v10
 v_sub_f32 v32, v32, v10
 v_sub_f32 v33, v33, v10
 v_sub_f32 v34, v34, v10
 v_sub_f32 v35, v35, v10
 v_sub_f32 v36, v36, v10
 v_sub_f32 v37, v37, v10
 v_sub_f32 v38, v38, v10
 v_sub_f32 v39, v39, v10
 v_sub_f32 v48, v48, v10
 v_sub_f32 v49, v49, v10
 v_sub_f32 v50, v50, v10
 v_sub_f32 v51, v51, v10
 v_sub_f32 v52, v52, v10
 v_sub_f32 v53, v53, v10
 v_sub_f32 v54, v54, v10
 v_sub_f32 v55, v55, v10
 v_sub_f32 v64, v64, v10
 v_sub_f32 v65, v65, v10
 v_sub_f32 v66, v66, v10
 v_sub_f32 v67, v67, v10
 v_sub_f32 v68, v68, v10
 v_sub_f32 v69, v69, v10
 v_sub_f32 v70, v70, v10
 v_sub_f32 v71, v71, v10
 v_mul_f32 v4, v4, v12
 v_accvgpr_read_b32 v240, a0
 v_accvgpr_read_b32 v241, a1
 v_accvgpr_read_b32 v242, a2
 v_accvgpr_read_b32 v243, a3
 v_mul_f32 v240, v240, v12
 v_mul_f32 v241, v241, v12
 v_mul_f32 v242, v242, v12
 v_mul_f32 v243, v243, v12
 v_accvgpr_write_b32 a0, v240
 v_accvgpr_write_b32 a1, v241
 v_accvgpr_write_b32 a2, v242
 v_accvgpr_write_b32 a3, v243
 v_accvgpr_read_b32 v240, a4
 v_accvgpr_read_b32 v241, a5
 v_accvgpr_read_b32 v242, a6
 v_accvgpr_read_b32 v243, a7
 v_mul_f32 v240, v240, v12
 v_mul_f32 v241, v241, v12
 v_mul_f32 v242, v242, v12
 v_mul_f32 v243, v243, v12
 v_accvgpr_write_b32 a4, v240
 v_accvgpr_write_b32 a5, v241
 v_accvgpr_write_b32 a6, v242
 v_accvgpr_write_b32 a7, v243
 v_accvgpr_read_b32 v240, a8
 v_accvgpr_read_b32 v241, a9
 v_accvgpr_read_b32 v242, a10
 v_accvgpr_read_b32 v243, a11
 v_mul_f32 v240, v240, v12
 v_mul_f32 v241, v241, v12
 v_mul_f32 v242, v242, v12
 v_mul_f32 v243, v243, v12
 v_accvgpr_write_b32 a8, v240
 v_accvgpr_write_b32 a9, v241
 v_accvgpr_write_b32 a10, v242
 v_accvgpr_write_b32 a11, v243
 v_accvgpr_read_b32 v240, a12
 v_accvgpr_read_b32 v241, a13
 v_accvgpr_read_b32 v242, a14
 v_accvgpr_read_b32 v243, a15
 v_mul_f32 v240, v240, v12
 v_mul_f32 v241, v241, v12
 v_mul_f32 v242, v242, v12
 v_mul_f32 v243, v243, v12
 v_accvgpr_write_b32 a12, v240
 v_accvgpr_write_b32 a13, v241
 v_accvgpr_write_b32 a14, v242
 v_accvgpr_write_b32 a15, v243
 v_accvgpr_read_b32 v240, a16
 v_accvgpr_read_b32 v241, a17
 v_accvgpr_read_b32 v242, a18
 v_accvgpr_read_b32 v243, a19
 v_mul_f32 v240, v240, v12
 v_mul_f32 v241, v241, v12
 v_mul_f32 v242, v242, v12
 v_mul_f32 v243, v243, v12
 v_accvgpr_write_b32 a16, v240
 v_accvgpr_write_b32 a17, v241
 v_accvgpr_write_b32 a18, v242
 v_accvgpr_write_b32 a19, v243
 v_accvgpr_read_b32 v240, a20
 v_accvgpr_read_b32 v241, a21
 v_accvgpr_read_b32 v242, a22
 v_accvgpr_read_b32 v243, a23
 v_mul_f32 v240, v240, v12
 v_mul_f32 v241, v241, v12
 v_mul_f32 v242, v242, v12
 v_mul_f32 v243, v243, v12
 v_accvgpr_write_b32 a20, v240
 v_accvgpr_write_b32 a21, v241
 v_accvgpr_write_b32 a22, v242
 v_accvgpr_write_b32 a23, v243
 v_accvgpr_read_b32 v240, a24
 v_accvgpr_read_b32 v241, a25
 v_accvgpr_read_b32 v242, a26
 v_accvgpr_read_b32 v243, a27
 v_mul_f32 v240, v240, v12
 v_mul_f32 v241, v241, v12
 v_mul_f32 v242, v242, v12
 v_mul_f32 v243, v243, v12
 v_accvgpr_write_b32 a24, v240
 v_accvgpr_write_b32 a25, v241
 v_accvgpr_write_b32 a26, v242
 v_accvgpr_write_b32 a27, v243
 v_accvgpr_read_b32 v240, a28
 v_accvgpr_read_b32 v241, a29
 v_accvgpr_read_b32 v242, a30
 v_accvgpr_read_b32 v243, a31
 v_mul_f32 v240, v240, v12
 v_mul_f32 v241, v241, v12
 v_mul_f32 v242, v242, v12
 v_mul_f32 v243, v243, v12
 v_accvgpr_write_b32 a28, v240
 v_accvgpr_write_b32 a29, v241
 v_accvgpr_write_b32 a30, v242
 v_accvgpr_write_b32 a31, v243
 v_max3_f32 v10, v88, v89, v90
 v_max3_f32 v10, v10, v91, v92
 v_max3_f32 v10, v10, v93, v94
 v_max3_f32 v10, v10, v95, v120
 v_max3_f32 v10, v10, v121, v122
 v_max3_f32 v10, v10, v123, v124
 v_max3_f32 v10, v10, v125, v126
 v_max_f32 v10, v10, v127
 v_mov_b32 v11, v10
 s_nop 1
 v_permlane16_swap_b32 v10, v11
 v_max_f32 v10, v10, v11
 v_mov_b32 v11, v10
 s_nop 1
 v_permlane32_swap_b32 v10, v11
 v_max_f32 v10, v10, v11
 v_max_f32 v10, 0, v10
 v_exp_f32 v12, -v10
 v_sub_f32 v88, v88, v10
 v_sub_f32 v89, v89, v10
 v_sub_f32 v90, v90, v10
 v_sub_f32 v91, v91, v10
 v_sub_f32 v92, v92, v10
 v_sub_f32 v93, v93, v10
 v_sub_f32 v94, v94, v10
 v_sub_f32 v95, v95, v10
 v_sub_f32 v120, v120, v10
 v_sub_f32 v121, v121, v10
 v_sub_f32 v122, v122, v10
 v_sub_f32 v123, v123, v10
 v_sub_f32 v124, v124, v10
 v_sub_f32 v125, v125, v10
 v_sub_f32 v126, v126, v10
 v_sub_f32 v127, v127, v10
 v_sub_f32 v212, v212, v10
 v_sub_f32 v213, v213, v10
 v_sub_f32 v214, v214, v10
 v_sub_f32 v215, v215, v10
 v_sub_f32 v24, v24, v10
 v_sub_f32 v25, v25, v10
 v_sub_f32 v26, v26, v10
 v_sub_f32 v27, v27, v10
 v_sub_f32 v28, v28, v10
 v_sub_f32 v29, v29, v10
 v_sub_f32 v30, v30, v10
 v_sub_f32 v31, v31, v10
 v_sub_f32 v40, v40, v10
 v_sub_f32 v41, v41, v10
 v_sub_f32 v42, v42, v10
 v_sub_f32 v43, v43, v10
 v_sub_f32 v44, v44, v10
 v_sub_f32 v45, v45, v10
 v_sub_f32 v46, v46, v10
 v_sub_f32 v47, v47, v10
 v_sub_f32 v56, v56, v10
 v_sub_f32 v57, v57, v10
 v_sub_f32 v58, v58, v10
 v_sub_f32 v59, v59, v10
 v_sub_f32 v60, v60, v10
 v_sub_f32 v61, v61, v10
 v_sub_f32 v62, v62, v10
 v_sub_f32 v63, v63, v10
 v_sub_f32 v72, v72, v10
 v_sub_f32 v73, v73, v10
 v_sub_f32 v74, v74, v10
 v_sub_f32 v75, v75, v10
 v_sub_f32 v76, v76, v10
 v_sub_f32 v77, v77, v10
 v_sub_f32 v78, v78, v10
 v_sub_f32 v79, v79, v10
 v_mul_f32 v5, v5, v12
 v_accvgpr_read_b32 v240, a32
 v_accvgpr_read_b32 v241, a33
 v_accvgpr_read_b32 v242, a34
 v_accvgpr_read_b32 v243, a35
 v_mul_f32 v240, v240, v12
 v_mul_f32 v241, v241, v12
 v_mul_f32 v242, v242, v12
 v_mul_f32 v243, v243, v12
 v_accvgpr_write_b32 a32, v240
 v_accvgpr_write_b32 a33, v241
 v_accvgpr_write_b32 a34, v242
 v_accvgpr_write_b32 a35, v243
 v_accvgpr_read_b32 v240, a36
 v_accvgpr_read_b32 v241, a37
 v_accvgpr_read_b32 v242, a38
 v_accvgpr_read_b32 v243, a39
 v_mul_f32 v240, v240, v12
 v_mul_f32 v241, v241, v12
 v_mul_f32 v242, v242, v12
 v_mul_f32 v243, v243, v12
 v_accvgpr_write_b32 a36, v240
 v_accvgpr_write_b32 a37, v241
 v_accvgpr_write_b32 a38, v242
 v_accvgpr_write_b32 a39, v243
 v_accvgpr_read_b32 v240, a40
 v_accvgpr_read_b32 v241, a41
 v_accvgpr_read_b32 v242, a42
 v_accvgpr_read_b32 v243, a43
 v_mul_f32 v240, v240, v12
 v_mul_f32 v241, v241, v12
 v_mul_f32 v242, v242, v12
 v_mul_f32 v243, v243, v12
 v_accvgpr_write_b32 a40, v240
 v_accvgpr_write_b32 a41, v241
 v_accvgpr_write_b32 a42, v242
 v_accvgpr_write_b32 a43, v243
 v_accvgpr_read_b32 v240, a44
 v_accvgpr_read_b32 v241, a45
 v_accvgpr_read_b32 v242, a46
 v_accvgpr_read_b32 v243, a47
 v_mul_f32 v240, v240, v12
 v_mul_f32 v241, v241, v12
 v_mul_f32 v242, v242, v12
 v_mul_f32 v243, v243, v12
 v_accvgpr_write_b32 a44, v240
 v_accvgpr_write_b32 a45, v241
 v_accvgpr_write_b32 a46, v242
 v_accvgpr_write_b32 a47, v243
 v_accvgpr_read_b32 v240, a48
 v_accvgpr_read_b32 v241, a49
 v_accvgpr_read_b32 v242, a50
 v_accvgpr_read_b32 v243, a51
 v_mul_f32 v240, v240, v12
 v_mul_f32 v241, v241, v12
 v_mul_f32 v242, v242, v12
 v_mul_f32 v243, v243, v12
 v_accvgpr_write_b32 a48, v240
 v_accvgpr_write_b32 a49, v241
 v_accvgpr_write_b32 a50, v242
 v_accvgpr_write_b32 a51, v243
 v_accvgpr_read_b32 v240, a52
 v_accvgpr_read_b32 v241, a53
 v_accvgpr_read_b32 v242, a54
 v_accvgpr_read_b32 v243, a55
 v_mul_f32 v240, v240, v12
 v_mul_f32 v241, v241, v12
 v_mul_f32 v242, v242, v12
 v_mul_f32 v243, v243, v12
 v_accvgpr_write_b32 a52, v240
 v_accvgpr_write_b32 a53, v241
 v_accvgpr_write_b32 a54, v242
 v_accvgpr_write_b32 a55, v243
 v_accvgpr_read_b32 v240, a56
 v_accvgpr_read_b32 v241, a57
 v_accvgpr_read_b32 v242, a58
 v_accvgpr_read_b32 v243, a59
 v_mul_f32 v240, v240, v12
 v_mul_f32 v241, v241, v12
 v_mul_f32 v242, v242, v12
 v_mul_f32 v243, v243, v12
 v_accvgpr_write_b32 a56, v240
 v_accvgpr_write_b32 a57, v241
 v_accvgpr_write_b32 a58, v242
 v_accvgpr_write_b32 a59, v243
 v_accvgpr_read_b32 v240, a60
 v_accvgpr_read_b32 v241, a61
 v_accvgpr_read_b32 v242, a62
 v_accvgpr_read_b32 v243, a63
 v_mul_f32 v240, v240, v12
 v_mul_f32 v241, v241, v12
 v_mul_f32 v242, v242, v12
 v_mul_f32 v243, v243, v12
 v_accvgpr_write_b32 a60, v240
 v_accvgpr_write_b32 a61, v241
 v_accvgpr_write_b32 a62, v242
 v_accvgpr_write_b32 a63, v243
 v_max3_f32 v10, v104, v105, v106
 v_max3_f32 v10, v10, v107, v108
 v_max3_f32 v10, v10, v109, v110
 v_max3_f32 v10, v10, v111, v136
 v_max3_f32 v10, v10, v137, v138
 v_max3_f32 v10, v10, v139, v140
 v_max3_f32 v10, v10, v141, v142
 v_max_f32 v10, v10, v143
 v_mov_b32 v11, v10
 s_nop 1
 v_permlane16_swap_b32 v10, v11
 v_max_f32 v10, v10, v11
 v_mov_b32 v11, v10
 s_nop 1
 v_permlane32_swap_b32 v10, v11
 v_max_f32 v10, v10, v11
 v_max_f32 v10, 0, v10
 v_exp_f32 v12, -v10
 v_sub_f32 v104, v104, v10
 v_sub_f32 v105, v105, v10
 v_sub_f32 v106, v106, v10
 v_sub_f32 v107, v107, v10
 v_sub_f32 v108, v108, v10
 v_sub_f32 v109, v109, v10
 v_sub_f32 v110, v110, v10
 v_sub_f32 v111, v111, v10
 v_sub_f32 v136, v136, v10
 v_sub_f32 v137, v137, v10
 v_sub_f32 v138, v138, v10
 v_sub_f32 v139, v139, v10
 v_sub_f32 v140, v140, v10
 v_sub_f32 v141, v141, v10
 v_sub_f32 v142, v142, v10
 v_sub_f32 v143, v143, v10
 v_sub_f32 v220, v220, v10
 v_sub_f32 v221, v221, v10
 v_sub_f32 v222, v222, v10
 v_sub_f32 v223, v223, v10
 v_mul_f32 v7, v7, v12
 v_accvgpr_read_b32 v240, a96
 v_accvgpr_read_b32 v241, a97
 v_accvgpr_read_b32 v242, a98
 v_accvgpr_read_b32 v243, a99
 v_mul_f32 v240, v240, v12
 v_mul_f32 v241, v241, v12
 v_mul_f32 v242, v242, v12
 v_mul_f32 v243, v243, v12
 v_accvgpr_write_b32 a96, v240
 v_accvgpr_write_b32 a97, v241
 v_accvgpr_write_b32 a98, v242
 v_accvgpr_write_b32 a99, v243
 v_accvgpr_read_b32 v240, a100
 v_accvgpr_read_b32 v241, a101
 v_accvgpr_read_b32 v242, a102
 v_accvgpr_read_b32 v243, a103
 v_mul_f32 v240, v240, v12
 v_mul_f32 v241, v241, v12
 v_mul_f32 v242, v242, v12
 v_mul_f32 v243, v243, v12
 v_accvgpr_write_b32 a100, v240
 v_accvgpr_write_b32 a101, v241
 v_accvgpr_write_b32 a102, v242
 v_accvgpr_write_b32 a103, v243
 v_accvgpr_read_b32 v240, a104
 v_accvgpr_read_b32 v241, a105
 v_accvgpr_read_b32 v242, a106
 v_accvgpr_read_b32 v243, a107
 v_mul_f32 v240, v240, v12
 v_mul_f32 v241, v241, v12
 v_mul_f32 v242, v242, v12
 v_mul_f32 v243, v243, v12
 v_accvgpr_write_b32 a104, v240
 v_accvgpr_write_b32 a105, v241
 v_accvgpr_write_b32 a106, v242
 v_accvgpr_write_b32 a107, v243
 v_accvgpr_read_b32 v240, a108
 v_accvgpr_read_b32 v241, a109
 v_accvgpr_read_b32 v242, a110
 v_accvgpr_read_b32 v243, a111
 v_mul_f32 v240, v240, v12
 v_mul_f32 v241, v241, v12
 v_mul_f32 v242, v242, v12
 v_mul_f32 v243, v243, v12
 v_accvgpr_write_b32 a108, v240
 v_accvgpr_write_b32 a109, v241
 v_accvgpr_write_b32 a110, v242
 v_accvgpr_write_b32 a111, v243
 v_accvgpr_read_b32 v240, a112
 v_accvgpr_read_b32 v241, a113
 v_accvgpr_read_b32 v242, a114
 v_accvgpr_read_b32 v243, a115
 v_mul_f32 v240, v240, v12
 v_mul_f32 v241, v241, v12
 v_mul_f32 v242, v242, v12
 v_mul_f32 v243, v243, v12
 v_accvgpr_write_b32 a112, v240
 v_accvgpr_write_b32 a113, v241
 v_accvgpr_write_b32 a114, v242
 v_accvgpr_write_b32 a115, v243
 v_accvgpr_read_b32 v240, a116
 v_accvgpr_read_b32 v241, a117
 v_accvgpr_read_b32 v242, a118
 v_accvgpr_read_b32 v243, a119
 v_mul_f32 v240, v240, v12
 v_mul_f32 v241, v241, v12
 v_mul_f32 v242, v242, v12
 v_mul_f32 v243, v243, v12
 v_accvgpr_write_b32 a116, v240
 v_accvgpr_write_b32 a117, v241
 v_accvgpr_write_b32 a118, v242
 v_accvgpr_write_b32 a119, v243
 v_accvgpr_read_b32 v240, a120
 v_accvgpr_read_b32 v241, a121
 v_accvgpr_read_b32 v242, a122
 v_accvgpr_read_b32 v243, a123
 v_mul_f32 v240, v240, v12
 v_mul_f32 v241, v241, v12
 v_mul_f32 v242, v242, v12
 v_mul_f32 v243, v243, v12
 v_accvgpr_write_b32 a120, v240
 v_accvgpr_write_b32 a121, v241
 v_accvgpr_write_b32 a122, v242
 v_accvgpr_write_b32 a123, v243
 v_accvgpr_read_b32 v240, a124
 v_accvgpr_read_b32 v241, a125
 v_accvgpr_read_b32 v242, a126
 v_accvgpr_read_b32 v243, a127
 v_mul_f32 v240, v240, v12
 v_mul_f32 v241, v241, v12
 v_mul_f32 v242, v242, v12
 v_mul_f32 v243, v243, v12
 v_accvgpr_write_b32 a124, v240
 v_accvgpr_write_b32 a125, v241
 v_accvgpr_write_b32 a126, v242
 v_accvgpr_write_b32 a127, v243
 v_exp_f32 v240, v80
 v_exp_f32 v241, v81
 v_exp_f32 v242, v82
 v_exp_f32 v243, v83
 v_exp_f32 v244, v84
 v_exp_f32 v245, v85
 v_exp_f32 v246, v86
 v_exp_f32 v247, v87
 v_cvt_pk_bf16_f32 v176, v240, v241
 v_cvt_pk_bf16_f32 v177, v242, v243
 v_cvt_pk_bf16_f32 v178, v244, v245
 v_cvt_pk_bf16_f32 v179, v246, v247
 v_exp_f32 v240, v88
 v_exp_f32 v241, v89
 v_exp_f32 v242, v90
 v_exp_f32 v243, v91
 v_exp_f32 v244, v92
 v_exp_f32 v245, v93
 v_exp_f32 v246, v94
 v_exp_f32 v247, v95
 v_cvt_pk_bf16_f32 v180, v240, v241
 v_cvt_pk_bf16_f32 v181, v242, v243
 v_cvt_pk_bf16_f32 v182, v244, v245
 v_cvt_pk_bf16_f32 v183, v246, v247
 v_exp_f32 v240, v104
 v_exp_f32 v241, v105
 v_exp_f32 v242, v106
 v_exp_f32 v243, v107
 v_exp_f32 v244, v108
 v_exp_f32 v245, v109
 v_exp_f32 v246, v110
 v_exp_f32 v247, v111
 v_cvt_pk_bf16_f32 v188, v240, v241
 v_cvt_pk_bf16_f32 v189, v242, v243
 v_cvt_pk_bf16_f32 v190, v244, v245
 v_cvt_pk_bf16_f32 v191, v246, v247
 v_exp_f32 v240, v112
 v_exp_f32 v241, v113
 v_exp_f32 v242, v114
 v_exp_f32 v243, v115
 v_exp_f32 v244, v116
 v_exp_f32 v245, v117
 v_exp_f32 v246, v118
 v_exp_f32 v247, v119
 v_cvt_pk_bf16_f32 v192, v240, v241
 v_cvt_pk_bf16_f32 v193, v242, v243
 v_cvt_pk_bf16_f32 v194, v244, v245
 v_cvt_pk_bf16_f32 v195, v246, v247
 v_exp_f32 v240, v120
 v_exp_f32 v241, v121
 v_exp_f32 v242, v122
 v_exp_f32 v243, v123
 v_exp_f32 v244, v124
 v_exp_f32 v245, v125
 v_exp_f32 v246, v126
 v_exp_f32 v247, v127
 v_cvt_pk_bf16_f32 v196, v240, v241
 v_cvt_pk_bf16_f32 v197, v242, v243
 v_cvt_pk_bf16_f32 v198, v244, v245
 v_cvt_pk_bf16_f32 v199, v246, v247
 v_exp_f32 v240, v136
 v_exp_f32 v241, v137
 v_exp_f32 v242, v138
 v_exp_f32 v243, v139
 v_exp_f32 v244, v140
 v_exp_f32 v245, v141
 v_exp_f32 v246, v142
 v_exp_f32 v247, v143
 v_cvt_pk_bf16_f32 v204, v240, v241
 v_cvt_pk_bf16_f32 v205, v242, v243
 v_cvt_pk_bf16_f32 v206, v244, v245
 v_cvt_pk_bf16_f32 v207, v246, v247
 s_nop 1
 v_mfma_f32_16x16x32_bf16 v[224:227], v[252:255], v[176:179], 0
 v_mfma_f32_16x16x32_bf16 v[228:231], v[252:255], v[180:183], 0
 v_mfma_f32_16x16x32_bf16 v[236:239], v[252:255], v[188:191], 0
 v_mfma_f32_16x16x32_bf16 v[224:227], v[252:255], v[192:195], v[224:227]
 v_mfma_f32_16x16x32_bf16 v[228:231], v[252:255], v[196:199], v[228:231]
 v_mfma_f32_16x16x32_bf16 v[236:239], v[252:255], v[204:207], v[236:239]
 s_nop 7
 s_cmp_eq_u32 s44, 0
 s_cbranch_scc1 L_back_57
 s_branch L_back_72
L_jr_63:
 s_mov_b32 s44, 0
 s_branch L_rare_61
L_jr_69:
 s_mov_b32 s44, 1
 s_branch L_rare_61
L_rare_61:
 s_nop 7
 s_nop 7
 v_max3_f32 v10, v16, v17, v18
 v_max3_f32 v10, v10, v19, v20
 v_max3_f32 v10, v10, v21, v22
 v_max3_f32 v10, v10, v23, v32
 v_max3_f32 v10, v10, v33, v34
 v_max3_f32 v10, v10, v35, v36
 v_max3_f32 v10, v10, v37, v38
 v_max3_f32 v10, v10, v39, v48
 v_max3_f32 v10, v10, v49, v50
 v_max3_f32 v10, v10, v51, v52
 v_max3_f32 v10, v10, v53, v54
 v_max3_f32 v10, v10, v55, v64
 v_max3_f32 v10, v10, v65, v66
 v_max3_f32 v10, v10, v67, v68
 v_max3_f32 v10, v10, v69, v70
 v_max_f32 v10, v10, v71
 v_mov_b32 v11, v10
 s_nop 1
 v_permlane16_swap_b32 v10, v11
 v_max_f32 v10, v10, v11
 v_mov_b32 v11, v10
 s_nop 1
 v_permlane32_swap_b32 v10, v11
 v_max_f32 v10, v10, v11
 v_max_f32 v10, 0, v10
 v_exp_f32 v12, -v10
 v_sub_f32 v16, v16, v10
 v_sub_f32 v17, v17, v10
 v_sub_f32 v18, v18, v10
 v_sub_f32 v19, v19, v10
 v_sub_f32 v20, v20, v10
 v_sub_f32 v21, v21, v10
 v_sub_f32 v22, v22, v10
 v_sub_f32 v23, v23, v10
 v_sub_f32 v32, v32, v10
 v_sub_f32 v33, v33, v10
 v_sub_f32 v34, v34, v10
 v_sub_f32 v35, v35, v10
 v_sub_f32 v36, v36, v10
 v_sub_f32 v37, v37, v10
 v_sub_f32 v38, v38, v10
 v_sub_f32 v39, v39, v10
 v_sub_f32 v48, v48, v10
 v_sub_f32 v49, v49, v10
 v_sub_f32 v50, v50, v10
 v_sub_f32 v51, v51, v10
 v_sub_f32 v52, v52, v10
 v_sub_f32 v53, v53, v10
 v_sub_f32 v54, v54, v10
 v_sub_f32 v55, v55, v10
 v_sub_f32 v64, v64, v10
 v_sub_f32 v65, v65, v10
 v_sub_f32 v66, v66, v10
 v_sub_f32 v67, v67, v10
 v_sub_f32 v68, v68, v10
 v_sub_f32 v69, v69, v10
 v_sub_f32 v70, v70, v10
 v_sub_f32 v71, v71, v10
 v_sub_f32 v208, v208, v10
 v_sub_f32 v209, v209, v10
 v_sub_f32 v210, v210, v10
 v_sub_f32 v211, v211, v10
 v_sub_f32 v80, v80, v10
 v_sub_f32 v81, v81, v10
 v_sub_f32 v82, v82, v10
 v_sub_f32 v83, v83, v10
 v_sub_f32 v84, v84, v10
 v_sub_f32 v85, v85, v10
 v_sub_f32 v86, v86, v10
 v_sub_f32 v87, v87, v10
 v_sub_f32 v96, v96, v10
 v_sub_f32 v97, v97, v10
 v_sub_f32 v98, v98, v10
 v_sub_f32 v99, v99, v10
 v_sub_f32 v100, v100, v10
 v_sub_f32 v101, v101, v10
 v_sub_f32 v102, v102, v10
 v_sub_f32 v103, v103, v10
 v_sub_f32 v112, v112, v10
 v_sub_f32 v113, v113, v10
 v_sub_f32 v114, v114, v10
 v_sub_f32 v115, v115, v10
 v_sub_f32 v116, v116, v10
 v_sub_f32 v117, v117, v10
 v_sub_f32 v118, v118, v10
 v_sub_f32 v119, v119, v10
 v_sub_f32 v128, v128, v10
 v_sub_f32 v129, v129, v10
 v_sub_f32 v130, v130, v10
 v_sub_f32 v131, v131, v10
 v_sub_f32 v132, v132, v10
 v_sub_f32 v133, v133, v10
 v_sub_f32 v134, v134, v10
 v_sub_f32 v135, v135, v10
 v_mul_f32 v4, v4, v12
 v_accvgpr_read_b32 v240, a0
 v_accvgpr_read_b32 v241, a1
 v_accvgpr_read_b32 v242, a2
 v_accvgpr_read_b32 v243, a3
 v_mul_f32 v240, v240, v12
 v_mul_f32 v241, v241, v12
 v_mul_f32 v242, v242, v12
 v_mul_f32 v243, v243, v12
 v_accvgpr_write_b32 a0, v240
 v_accvgpr_write_b32 a1, v241
 v_accvgpr_write_b32 a2, v242
 v_accvgpr_write_b32 a3, v243
 v_accvgpr_read_b32 v240, a4
 v_accvgpr_read_b32 v241, a5
 v_accvgpr_read_b32 v242, a6
 v_accvgpr_read_b32 v243, a7
 v_mul_f32 v240, v240, v12
 v_mul_f32 v241, v241, v12
 v_mul_f32 v242, v242, v12
 v_mul_f32 v243, v243, v12
 v_accvgpr_write_b32 a4, v240
 v_accvgpr_write_b32 a5, v241
 v_accvgpr_write_b32 a6, v242
 v_accvgpr_write_b32 a7, v243
 v_accvgpr_read_b32 v240, a8
 v_accvgpr_read_b32 v241, a9
 v_accvgpr_read_b32 v242, a10
 v_accvgpr_read_b32 v243, a11
 v_mul_f32 v240, v240, v12
 v_mul_f32 v241, v241, v12
 v_mul_f32 v242, v242, v12
 v_mul_f32 v243, v243, v12
 v_accvgpr_write_b32 a8, v240
 v_accvgpr_write_b32 a9, v241
 v_accvgpr_write_b32 a10, v242
 v_accvgpr_write_b32 a11, v243
 v_accvgpr_read_b32 v240, a12
 v_accvgpr_read_b32 v241, a13
 v_accvgpr_read_b32 v242, a14
 v_accvgpr_read_b32 v243, a15
 v_mul_f32 v240, v240, v12
 v_mul_f32 v241, v241, v12
 v_mul_f32 v242, v242, v12
 v_mul_f32 v243, v243, v12
 v_accvgpr_write_b32 a12, v240
 v_accvgpr_write_b32 a13, v241
 v_accvgpr_write_b32 a14, v242
 v_accvgpr_write_b32 a15, v243
 v_accvgpr_read_b32 v240, a16
 v_accvgpr_read_b32 v241, a17
 v_accvgpr_read_b32 v242, a18
 v_accvgpr_read_b32 v243, a19
 v_mul_f32 v240, v240, v12
 v_mul_f32 v241, v241, v12
 v_mul_f32 v242, v242, v12
 v_mul_f32 v243, v243, v12
 v_accvgpr_write_b32 a16, v240
 v_accvgpr_write_b32 a17, v241
 v_accvgpr_write_b32 a18, v242
 v_accvgpr_write_b32 a19, v243
 v_accvgpr_read_b32 v240, a20
 v_accvgpr_read_b32 v241, a21
 v_accvgpr_read_b32 v242, a22
 v_accvgpr_read_b32 v243, a23
 v_mul_f32 v240, v240, v12
 v_mul_f32 v241, v241, v12
 v_mul_f32 v242, v242, v12
 v_mul_f32 v243, v243, v12
 v_accvgpr_write_b32 a20, v240
 v_accvgpr_write_b32 a21, v241
 v_accvgpr_write_b32 a22, v242
 v_accvgpr_write_b32 a23, v243
 v_accvgpr_read_b32 v240, a24
 v_accvgpr_read_b32 v241, a25
 v_accvgpr_read_b32 v242, a26
 v_accvgpr_read_b32 v243, a27
 v_mul_f32 v240, v240, v12
 v_mul_f32 v241, v241, v12
 v_mul_f32 v242, v242, v12
 v_mul_f32 v243, v243, v12
 v_accvgpr_write_b32 a24, v240
 v_accvgpr_write_b32 a25, v241
 v_accvgpr_write_b32 a26, v242
 v_accvgpr_write_b32 a27, v243
 v_accvgpr_read_b32 v240, a28
 v_accvgpr_read_b32 v241, a29
 v_accvgpr_read_b32 v242, a30
 v_accvgpr_read_b32 v243, a31
 v_mul_f32 v240, v240, v12
 v_mul_f32 v241, v241, v12
 v_mul_f32 v242, v242, v12
 v_mul_f32 v243, v243, v12
 v_accvgpr_write_b32 a28, v240
 v_accvgpr_write_b32 a29, v241
 v_accvgpr_write_b32 a30, v242
 v_accvgpr_write_b32 a31, v243
 v_max3_f32 v10, v24, v25, v26
 v_max3_f32 v10, v10, v27, v28
 v_max3_f32 v10, v10, v29, v30
 v_max3_f32 v10, v10, v31, v40
 v_max3_f32 v10, v10, v41, v42
 v_max3_f32 v10, v10, v43, v44
 v_max3_f32 v10, v10, v45, v46
 v_max3_f32 v10, v10, v47, v56
 v_max3_f32 v10, v10, v57, v58
 v_max3_f32 v10, v10, v59, v60
 v_max3_f32 v10, v10, v61, v62
 v_max3_f32 v10, v10, v63, v72
 v_max3_f32 v10, v10, v73, v74
 v_max3_f32 v10, v10, v75, v76
 v_max3_f32 v10, v10, v77, v78
 v_max_f32 v10, v10, v79
 v_mov_b32 v11, v10
 s_nop 1
 v_permlane16_swap_b32 v10, v11
 v_max_f32 v10, v10, v11
 v_mov_b32 v11, v10
 s_nop 1
 v_permlane32_swap_b32 v10, v11
 v_max_f32 v10, v10, v11
 v_max_f32 v10, 0, v10
 v_exp_f32 v12, -v10
 v_sub_f32 v24, v24, v10
 v_sub_f32 v25, v25, v10
 v_sub_f32 v26, v26, v10
 v_sub_f32 v27, v27, v10
 v_sub_f32 v28, v28, v10
 v_sub_f32 v29, v29, v10
 v_sub_f32 v30, v30, v10
 v_sub_f32 v31, v31, v10
 v_sub_f32 v40, v40, v10
 v_sub_f32 v41, v41, v10
 v_sub_f32 v42, v42, v10
 v_sub_f32 v43, v43, v10
 v_sub_f32 v44, v44, v10
 v_sub_f32 v45, v45, v10
 v_sub_f32 v46, v46, v10
 v_sub_f32 v47, v47, v10
 v_sub_f32 v56, v56, v10
 v_sub_f32 v57, v57, v10
 v_sub_f32 v58, v58, v10
 v_sub_f32 v59, v59, v10
 v_sub_f32 v60, v60, v10
 v_sub_f32 v61, v61, v10
 v_sub_f32 v62, v62, v10
 v_sub_f32 v63, v63, v10
 v_sub_f32 v72, v72, v10
 v_sub_f32 v73, v73, v10
 v_sub_f32 v74, v74, v10
 v_sub_f32 v75, v75, v10
 v_sub_f32 v76, v76, v10
 v_sub_f32 v77, v77, v10
 v_sub_f32 v78, v78, v10
 v_sub_f32 v79, v79, v10
 v_sub_f32 v212, v212, v10
 v_sub_f32 v213, v213, v10
 v_sub_f32 v214, v214, v10
 v_sub_f32 v215, v215, v10
 v_sub_f32 v88, v88, v10
 v_sub_f32 v89, v89, v10
 v_sub_f32 v90, v90, v10
 v_sub_f32 v91, v91, v10
 v_sub_f32 v92, v92, v10
 v_sub_f32 v93, v93, v10
 v_sub_f32 v94, v94, v10
 v_sub_f32 v95, v95, v10
 v_sub_f32 v104, v104, v10
 v_sub_f32 v105, v105, v10
 v_sub_f32 v106, v106, v10
 v_sub_f32 v107, v107, v10
 v_sub_f32 v108, v108, v10
 v_sub_f32 v109, v109, v10
 v_sub_f32 v110, v110, v10
 v_sub_f32 v111, v111, v10
 v_sub_f32 v120, v120, v10
 v_sub_f32 v121, v121, v10
 v_sub_f32 v122, v122, v10
 v_sub_f32 v123, v123, v10
 v_sub_f32 v124, v124, v10
 v_sub_f32 v125, v125, v10
 v_sub_f32 v126, v126, v10
 v_sub_f32 v127, v127, v10
 v_sub_f32 v136, v136, v10
 v_sub_f32 v137, v137, v10
 v_sub_f32 v138, v138, v10
 v_sub_f32 v139, v139, v10
 v_sub_f32 v140, v140, v10
 v_sub_f32 v141, v141, v10
 v_sub_f32 v142, v142, v10
 v_sub_f32 v143, v143, v10
 v_mul_f32 v5, v5, v12
 v_accvgpr_read_b32 v240, a32
 v_accvgpr_read_b32 v241, a33
 v_accvgpr_read_b32 v242, a34
 v_accvgpr_read_b32 v243, a35
 v_mul_f32 v240, v240, v12
 v_mul_f32 v241, v241, v12
 v_mul_f32 v242, v242, v12
 v_mul_f32 v243, v243, v12
 v_accvgpr_write_b32 a32, v240
 v_accvgpr_write_b32 a33, v241
 v_accvgpr_write_b32 a34, v242
 v_accvgpr_write_b32 a35, v243
 v_accvgpr_read_b32 v240, a36
 v_accvgpr_read_b32 v241, a37
 v_accvgpr_read_b32 v242, a38
 v_accvgpr_read_b32 v243, a39
 v_mul_f32 v240, v240, v12
 v_mul_f32 v241, v241, v12
 v_mul_f32 v242, v242, v12
 v_mul_f32 v243, v243, v12
 v_accvgpr_write_b32 a36, v240
 v_accvgpr_write_b32 a37, v241
 v_accvgpr_write_b32 a38, v242
 v_accvgpr_write_b32 a39, v243
 v_accvgpr_read_b32 v240, a40
 v_accvgpr_read_b32 v241, a41
 v_accvgpr_read_b32 v242, a42
 v_accvgpr_read_b32 v243, a43
 v_mul_f32 v240, v240, v12
 v_mul_f32 v241, v241, v12
 v_mul_f32 v242, v242, v12
 v_mul_f32 v243, v243, v12
 v_accvgpr_write_b32 a40, v240
 v_accvgpr_write_b32 a41, v241
 v_accvgpr_write_b32 a42, v242
 v_accvgpr_write_b32 a43, v243
 v_accvgpr_read_b32 v240, a44
 v_accvgpr_read_b32 v241, a45
 v_accvgpr_read_b32 v242, a46
 v_accvgpr_read_b32 v243, a47
 v_mul_f32 v240, v240, v12
 v_mul_f32 v241, v241, v12
 v_mul_f32 v242, v242, v12
 v_mul_f32 v243, v243, v12
 v_accvgpr_write_b32 a44, v240
 v_accvgpr_write_b32 a45, v241
 v_accvgpr_write_b32 a46, v242
 v_accvgpr_write_b32 a47, v243
 v_accvgpr_read_b32 v240, a48
 v_accvgpr_read_b32 v241, a49
 v_accvgpr_read_b32 v242, a50
 v_accvgpr_read_b32 v243, a51
 v_mul_f32 v240, v240, v12
 v_mul_f32 v241, v241, v12
 v_mul_f32 v242, v242, v12
 v_mul_f32 v243, v243, v12
 v_accvgpr_write_b32 a48, v240
 v_accvgpr_write_b32 a49, v241
 v_accvgpr_write_b32 a50, v242
 v_accvgpr_write_b32 a51, v243
 v_accvgpr_read_b32 v240, a52
 v_accvgpr_read_b32 v241, a53
 v_accvgpr_read_b32 v242, a54
 v_accvgpr_read_b32 v243, a55
 v_mul_f32 v240, v240, v12
 v_mul_f32 v241, v241, v12
 v_mul_f32 v242, v242, v12
 v_mul_f32 v243, v243, v12
 v_accvgpr_write_b32 a52, v240
 v_accvgpr_write_b32 a53, v241
 v_accvgpr_write_b32 a54, v242
 v_accvgpr_write_b32 a55, v243
 v_accvgpr_read_b32 v240, a56
 v_accvgpr_read_b32 v241, a57
 v_accvgpr_read_b32 v242, a58
 v_accvgpr_read_b32 v243, a59
 v_mul_f32 v240, v240, v12
 v_mul_f32 v241, v241, v12
 v_mul_f32 v242, v242, v12
 v_mul_f32 v243, v243, v12
 v_accvgpr_write_b32 a56, v240
 v_accvgpr_write_b32 a57, v241
 v_accvgpr_write_b32 a58, v242
 v_accvgpr_write_b32 a59, v243
 v_accvgpr_read_b32 v240, a60
 v_accvgpr_read_b32 v241, a61
 v_accvgpr_read_b32 v242, a62
 v_accvgpr_read_b32 v243, a63
 v_mul_f32 v240, v240, v12
 v_mul_f32 v241, v241, v12
 v_mul_f32 v242, v242, v12
 v_mul_f32 v243, v243, v12
 v_accvgpr_write_b32 a60, v240
 v_accvgpr_write_b32 a61, v241
 v_accvgpr_write_b32 a62, v242
 v_accvgpr_write_b32 a63, v243
 v_exp_f32 v240, v16
 v_exp_f32 v241, v17
 v_exp_f32 v242, v18
 v_exp_f32 v243, v19
 v_exp_f32 v244, v20
 v_exp_f32 v245, v21
 v_exp_f32 v246, v22
 v_exp_f32 v247, v23
 v_cvt_pk_bf16_f32 v144, v240, v241
 v_cvt_pk_bf16_f32 v145, v242, v243
 v_cvt_pk_bf16_f32 v146, v244, v245
 v_cvt_pk_bf16_f32 v147, v246, v247
 v_exp_f32 v240, v24
 v_exp_f32 v241, v25
 v_exp_f32 v242, v26
 v_exp_f32 v243, v27
 v_exp_f32 v244, v28
 v_exp_f32 v245, v29
 v_exp_f32 v246, v30
 v_exp_f32 v247, v31
 v_cvt_pk_bf16_f32 v148, v240, v241
 v_cvt_pk_bf16_f32 v149, v242, v243
 v_cvt_pk_bf16_f32 v150, v244, v245
 v_cvt_pk_bf16_f32 v151, v246, v247
 v_exp_f32 v240, v32
 v_exp_f32 v241, v33
 v_exp_f32 v242, v34
 v_exp_f32 v243, v35
 v_exp_f32 v244, v36
 v_exp_f32 v245, v37
 v_exp_f32 v246, v38
 v_exp_f32 v247, v39
 v_cvt_pk_bf16_f32 v152, v240, v241
 v_cvt_pk_bf16_f32 v153, v242, v243
 v_cvt_pk_bf16_f32 v154, v244, v245
 v_cvt_pk_bf16_f32 v155, v246, v247
 v_exp_f32 v240, v40
 v_exp_f32 v241, v41
 v_exp_f32 v242, v42
 v_exp_f32 v243, v43
 v_exp_f32 v244, v44
 v_exp_f32 v245, v45
 v_exp_f32 v246, v46
 v_exp_f32 v247, v47
 v_cvt_pk_bf16_f32 v156, v240, v241
 v_cvt_pk_bf16_f32 v157, v242, v243
 v_cvt_pk_bf16_f32 v158, v244, v245
 v_cvt_pk_bf16_f32 v159, v246, v247
 v_exp_f32 v240, v48
 v_exp_f32 v241, v49
 v_exp_f32 v242, v50
 v_exp_f32 v243, v51
 v_exp_f32 v244, v52
 v_exp_f32 v245, v53
 v_exp_f32 v246, v54
 v_exp_f32 v247, v55
 v_cvt_pk_bf16_f32 v160, v240, v241
 v_cvt_pk_bf16_f32 v161, v242, v243
 v_cvt_pk_bf16_f32 v162, v244, v245
 v_cvt_pk_bf16_f32 v163, v246, v247
 v_exp_f32 v240, v56
 v_exp_f32 v241, v57
 v_exp_f32 v242, v58
 v_exp_f32 v243, v59
 v_exp_f32 v244, v60
 v_exp_f32 v245, v61
 v_exp_f32 v246, v62
 v_exp_f32 v247, v63
 v_cvt_pk_bf16_f32 v164, v240, v241
 v_cvt_pk_bf16_f32 v165, v242, v243
 v_cvt_pk_bf16_f32 v166, v244, v245
 v_cvt_pk_bf16_f32 v167, v246, v247
 v_exp_f32 v240, v64
 v_exp_f32 v241, v65
 v_exp_f32 v242, v66
 v_exp_f32 v243, v67
 v_exp_f32 v244, v68
 v_exp_f32 v245, v69
 v_exp_f32 v246, v70
 v_exp_f32 v247, v71
 v_cvt_pk_bf16_f32 v168, v240, v241
 v_cvt_pk_bf16_f32 v169, v242, v243
 v_cvt_pk_bf16_f32 v170, v244, v245
 v_cvt_pk_bf16_f32 v171, v246, v247
 v_exp_f32 v240, v72
 v_exp_f32 v241, v73
 v_exp_f32 v242, v74
 v_exp_f32 v243, v75
 v_exp_f32 v244, v76
 v_exp_f32 v245, v77
 v_exp_f32 v246, v78
 v_exp_f32 v247, v79
 v_cvt_pk_bf16_f32 v172, v240, v241
 v_cvt_pk_bf16_f32 v173, v242, v243
 v_cvt_pk_bf16_f32 v174, v244, v245
 v_cvt_pk_bf16_f32 v175, v246, v247
 s_nop 1
 v_mfma_f32_16x16x32_bf16 v[224:227], v[252:255], v[144:147], 0
 v_mfma_f32_16x16x32_bf16 v[228:231], v[252:255], v[148:151], 0
 v_mfma_f32_16x16x32_bf16 v[224:227], v[252:255], v[152:155], v[224:227]
 v_mfma_f32_16x16x32_bf16 v[228:231], v[252:255], v[156:159], v[228:231]
 v_mfma_f32_16x16x32_bf16 v[224:227], v[252:255], v[160:163], v[224:227]
 v_mfma_f32_16x16x32_bf16 v[228:231], v[252:255], v[164:167], v[228:231]
 v_mfma_f32_16x16x32_bf16 v[224:227], v[252:255], v[168:171], v[224:227]
 v_mfma_f32_16x16x32_bf16 v[228:231], v[252:255], v[172:175], v[228:231]
 s_nop 7
 s_cmp_eq_u32 s44, 0
 s_cbranch_scc1 L_back_62
 s_branch L_back_68
L_jr_67:
 s_mov_b32 s44, 0
 s_branch L_rare_65
L_jr_71:
 s_mov_b32 s44, 1
 s_branch L_rare_65
L_rare_65:
 s_nop 7
 s_nop 7
 v_max3_f32 v10, v80, v81, v82
 v_max3_f32 v10, v10, v83, v84
 v_max3_f32 v10, v10, v85, v86
 v_max3_f32 v10, v10, v87, v96
 v_max3_f32 v10, v10, v97, v98
 v_max3_f32 v10, v10, v99, v100
 v_max3_f32 v10, v10, v101, v102
 v_max3_f32 v10, v10, v103, v112
 v_max3_f32 v10, v10, v113, v114
 v_max3_f32 v10, v10, v115, v116
 v_max3_f32 v10, v10, v117, v118
 v_max3_f32 v10, v10, v119, v128
 v_max3_f32 v10, v10, v129, v130
 v_max3_f32 v10, v10, v131, v132
 v_max3_f32 v10, v10, v133, v134
 v_max_f32 v10, v10, v135
 v_mov_b32 v11, v10
 s_nop 1
 v_permlane16_swap_b32 v10, v11
 v_max_f32 v10, v10, v11
 v_mov_b32 v11, v10
 s_nop 1
 v_permlane32_swap_b32 v10, v11
 v_max_f32 v10, v10, v11
 v_max_f32 v10, 0, v10
 v_exp_f32 v12, -v10
 v_sub_f32 v80, v80, v10
 v_sub_f32 v81, v81, v10
 v_sub_f32 v82, v82, v10
 v_sub_f32 v83, v83, v10
 v_sub_f32 v84, v84, v10
 v_sub_f32 v85, v85, v10
 v_sub_f32 v86, v86, v10
 v_sub_f32 v87, v87, v10
 v_sub_f32 v96, v96, v10
 v_sub_f32 v97, v97, v10
 v_sub_f32 v98, v98, v10
 v_sub_f32 v99, v99, v10
 v_sub_f32 v100, v100, v10
 v_sub_f32 v101, v101, v10
 v_sub_f32 v102, v102, v10
 v_sub_f32 v103, v103, v10
 v_sub_f32 v112, v112, v10
 v_sub_f32 v113, v113, v10
 v_sub_f32 v114, v114, v10
 v_sub_f32 v115, v115, v10
 v_sub_f32 v116, v116, v10
 v_sub_f32 v117, v117, v10
 v_sub_f32 v118, v118, v10
 v_sub_f32 v119, v119, v10
 v_sub_f32 v128, v128, v10
 v_sub_f32 v129, v129, v10
 v_sub_f32 v130, v130, v10
 v_sub_f32 v131, v131, v10
 v_sub_f32 v132, v132, v10
 v_sub_f32 v133, v133, v10
 v_sub_f32 v134, v134, v10
 v_sub_f32 v135, v135, v10
 v_sub_f32 v208, v208, v10
 v_sub_f32 v209, v209, v10
 v_sub_f32 v210, v210, v10
 v_sub_f32 v211, v211, v10
 v_sub_f32 v16, v16, v10
 v_sub_f32 v17, v17, v10
 v_sub_f32 v18, v18, v10
 v_sub_f32 v19, v19, v10
 v_sub_f32 v20, v20, v10
 v_sub_f32 v21, v21, v10
 v_sub_f32 v22, v22, v10
 v_sub_f32 v23, v23, v10
 v_sub_f32 v32, v32, v10
 v_sub_f32 v33, v33, v10
 v_sub_f32 v34, v34, v10
 v_sub_f32 v35, v35, v10
 v_sub_f32 v36, v36, v10
 v_sub_f32 v37, v37, v10
 v_sub_f32 v38, v38, v10
 v_sub_f32 v39, v39, v10
 v_sub_f32 v48, v48, v10
 v_sub_f32 v49, v49, v10
 v_sub_f32 v50, v50, v10
 v_sub_f32 v51, v51, v10
 v_sub_f32 v52, v52, v10
 v_sub_f32 v53, v53, v10
 v_sub_f32 v54, v54, v10
 v_sub_f32 v55, v55, v10
 v_sub_f32 v64, v64, v10
 v_sub_f32 v65, v65, v10
 v_sub_f32 v66, v66, v10
 v_sub_f32 v67, v67, v10
 v_sub_f32 v68, v68, v10
 v_sub_f32 v69, v69, v10
 v_sub_f32 v70, v70, v10
 v_sub_f32 v71, v71, v10
 v_mul_f32 v4, v4, v12
 v_accvgpr_read_b32 v240, a0
 v_accvgpr_read_b32 v241, a1
 v_accvgpr_read_b32 v242, a2
 v_accvgpr_read_b32 v243, a3
 v_mul_f32 v240, v240, v12
 v_mul_f32 v241, v241, v12
 v_mul_f32 v242, v242, v12
 v_mul_f32 v243, v243, v12
 v_accvgpr_write_b32 a0, v240
 v_accvgpr_write_b32 a1, v241
 v_accvgpr_write_b32 a2, v242
 v_accvgpr_write_b32 a3, v243
 v_accvgpr_read_b32 v240, a4
 v_accvgpr_read_b32 v241, a5
 v_accvgpr_read_b32 v242, a6
 v_accvgpr_read_b32 v243, a7
 v_mul_f32 v240, v240, v12
 v_mul_f32 v241, v241, v12
 v_mul_f32 v242, v242, v12
 v_mul_f32 v243, v243, v12
 v_accvgpr_write_b32 a4, v240
 v_accvgpr_write_b32 a5, v241
 v_accvgpr_write_b32 a6, v242
 v_accvgpr_write_b32 a7, v243
 v_accvgpr_read_b32 v240, a8
 v_accvgpr_read_b32 v241, a9
 v_accvgpr_read_b32 v242, a10
 v_accvgpr_read_b32 v243, a11
 v_mul_f32 v240, v240, v12
 v_mul_f32 v241, v241, v12
 v_mul_f32 v242, v242, v12
 v_mul_f32 v243, v243, v12
 v_accvgpr_write_b32 a8, v240
 v_accvgpr_write_b32 a9, v241
 v_accvgpr_write_b32 a10, v242
 v_accvgpr_write_b32 a11, v243
 v_accvgpr_read_b32 v240, a12
 v_accvgpr_read_b32 v241, a13
 v_accvgpr_read_b32 v242, a14
 v_accvgpr_read_b32 v243, a15
 v_mul_f32 v240, v240, v12
 v_mul_f32 v241, v241, v12
 v_mul_f32 v242, v242, v12
 v_mul_f32 v243, v243, v12
 v_accvgpr_write_b32 a12, v240
 v_accvgpr_write_b32 a13, v241
 v_accvgpr_write_b32 a14, v242
 v_accvgpr_write_b32 a15, v243
 v_accvgpr_read_b32 v240, a16
 v_accvgpr_read_b32 v241, a17
 v_accvgpr_read_b32 v242, a18
 v_accvgpr_read_b32 v243, a19
 v_mul_f32 v240, v240, v12
 v_mul_f32 v241, v241, v12
 v_mul_f32 v242, v242, v12
 v_mul_f32 v243, v243, v12
 v_accvgpr_write_b32 a16, v240
 v_accvgpr_write_b32 a17, v241
 v_accvgpr_write_b32 a18, v242
 v_accvgpr_write_b32 a19, v243
 v_accvgpr_read_b32 v240, a20
 v_accvgpr_read_b32 v241, a21
 v_accvgpr_read_b32 v242, a22
 v_accvgpr_read_b32 v243, a23
 v_mul_f32 v240, v240, v12
 v_mul_f32 v241, v241, v12
 v_mul_f32 v242, v242, v12
 v_mul_f32 v243, v243, v12
 v_accvgpr_write_b32 a20, v240
 v_accvgpr_write_b32 a21, v241
 v_accvgpr_write_b32 a22, v242
 v_accvgpr_write_b32 a23, v243
 v_accvgpr_read_b32 v240, a24
 v_accvgpr_read_b32 v241, a25
 v_accvgpr_read_b32 v242, a26
 v_accvgpr_read_b32 v243, a27
 v_mul_f32 v240, v240, v12
 v_mul_f32 v241, v241, v12
 v_mul_f32 v242, v242, v12
 v_mul_f32 v243, v243, v12
 v_accvgpr_write_b32 a24, v240
 v_accvgpr_write_b32 a25, v241
 v_accvgpr_write_b32 a26, v242
 v_accvgpr_write_b32 a27, v243
 v_accvgpr_read_b32 v240, a28
 v_accvgpr_read_b32 v241, a29
 v_accvgpr_read_b32 v242, a30
 v_accvgpr_read_b32 v243, a31
 v_mul_f32 v240, v240, v12
 v_mul_f32 v241, v241, v12
 v_mul_f32 v242, v242, v12
 v_mul_f32 v243, v243, v12
 v_accvgpr_write_b32 a28, v240
 v_accvgpr_write_b32 a29, v241
 v_accvgpr_write_b32 a30, v242
 v_accvgpr_write_b32 a31, v243
 v_max3_f32 v10, v88, v89, v90
 v_max3_f32 v10, v10, v91, v92
 v_max3_f32 v10, v10, v93, v94
 v_max3_f32 v10, v10, v95, v104
 v_max3_f32 v10, v10, v105, v106
 v_max3_f32 v10, v10, v107, v108
 v_max3_f32 v10, v10, v109, v110
 v_max3_f32 v10, v10, v111, v120
 v_max3_f32 v10, v10, v121, v122
 v_max3_f32 v10, v10, v123, v124
 v_max3_f32 v10, v10, v125, v126
 v_max3_f32 v10, v10, v127, v136
 v_max3_f32 v10, v10, v137, v138
 v_max3_f32 v10, v10, v139, v140
 v_max3_f32 v10, v10, v141, v142
 v_max_f32 v10, v10, v143
 v_mov_b32 v11, v10
 s_nop 1
 v_permlane16_swap_b32 v10, v11
 v_max_f32 v10, v10, v11
 v_mov_b32 v11, v10
 s_nop 1
 v_permlane32_swap_b32 v10, v11
 v_max_f32 v10, v10, v11
 v_max_f32 v10, 0, v10
 v_exp_f32 v12, -v10
 v_sub_f32 v88, v88, v10
 v_sub_f32 v89, v89, v10
 v_sub_f32 v90, v90, v10
 v_sub_f32 v91, v91, v10
 v_sub_f32 v92, v92, v10
 v_sub_f32 v93, v93, v10
 v_sub_f32 v94, v94, v10
 v_sub_f32 v95, v95, v10
 v_sub_f32 v104, v104, v10
 v_sub_f32 v105, v105, v10
 v_sub_f32 v106, v106, v10
 v_sub_f32 v107, v107, v10
 v_sub_f32 v108, v108, v10
 v_sub_f32 v109, v109, v10
 v_sub_f32 v110, v110, v10
 v_sub_f32 v111, v111, v10
 v_sub_f32 v120, v120, v10
 v_sub_f32 v121, v121, v10
 v_sub_f32 v122, v122, v10
 v_sub_f32 v123, v123, v10
 v_sub_f32 v124, v124, v10
 v_sub_f32 v125, v125, v10
 v_sub_f32 v126, v126, v10
 v_sub_f32 v127, v127, v10
 v_sub_f32 v136, v136, v10
 v_sub_f32 v137, v137, v10
 v_sub_f32 v138, v138, v10
 v_sub_f32 v139, v139, v10
 v_sub_f32 v140, v140, v10
 v_sub_f32 v141, v141, v10
 v_sub_f32 v142, v142, v10
 v_sub_f32 v143, v143, v10
 v_sub_f32 v212, v212, v10
 v_sub_f32 v213, v213, v10
 v_sub_f32 v214, v214, v10
 v_sub_f32 v215, v215, v10
 v_sub_f32 v24, v24, v10
 v_sub_f32 v25, v25, v10
 v_sub_f32 v26, v26, v10
 v_sub_f32 v27, v27, v10
 v_sub_f32 v28, v28, v10
 v_sub_f32 v29, v29, v10
 v_sub_f32 v30, v30, v10
 v_sub_f32 v31, v31, v10
 v_sub_f32 v40, v40, v10
 v_sub_f32 v41, v41, v10
 v_sub_f32 v42, v42, v10
 v_sub_f32 v43, v43, v10
 v_sub_f32 v44, v44, v10
 v_sub_f32 v45, v45, v10
 v_sub_f32 v46, v46, v10
 v_sub_f32 v47, v47, v10
 v_sub_f32 v56, v56, v10
 v_sub_f32 v57, v57, v10
 v_sub_f32 v58, v58, v10
 v_sub_f32 v59, v59, v10
 v_sub_f32 v60, v60, v10
 v_sub_f32 v61, v61, v10
 v_sub_f32 v62, v62, v10
 v_sub_f32 v63, v63, v10
 v_sub_f32 v72, v72, v10
 v_sub_f32 v73, v73, v10
 v_sub_f32 v74, v74, v10
 v_sub_f32 v75, v75, v10
 v_sub_f32 v76, v76, v10
 v_sub_f32 v77, v77, v10
 v_sub_f32 v78, v78, v10
 v_sub_f32 v79, v79, v10
 v_mul_f32 v5, v5, v12
 v_accvgpr_read_b32 v240, a32
 v_accvgpr_read_b32 v241, a33
 v_accvgpr_read_b32 v242, a34
 v_accvgpr_read_b32 v243, a35
 v_mul_f32 v240, v240, v12
 v_mul_f32 v241, v241, v12
 v_mul_f32 v242, v242, v12
 v_mul_f32 v243, v243, v12
 v_accvgpr_write_b32 a32, v240
 v_accvgpr_write_b32 a33, v241
 v_accvgpr_write_b32 a34, v242
 v_accvgpr_write_b32 a35, v243
 v_accvgpr_read_b32 v240, a36
 v_accvgpr_read_b32 v241, a37
 v_accvgpr_read_b32 v242, a38
 v_accvgpr_read_b32 v243, a39
 v_mul_f32 v240, v240, v12
 v_mul_f32 v241, v241, v12
 v_mul_f32 v242, v242, v12
 v_mul_f32 v243, v243, v12
 v_accvgpr_write_b32 a36, v240
 v_accvgpr_write_b32 a37, v241
 v_accvgpr_write_b32 a38, v242
 v_accvgpr_write_b32 a39, v243
 v_accvgpr_read_b32 v240, a40
 v_accvgpr_read_b32 v241, a41
 v_accvgpr_read_b32 v242, a42
 v_accvgpr_read_b32 v243, a43
 v_mul_f32 v240, v240, v12
 v_mul_f32 v241, v241, v12
 v_mul_f32 v242, v242, v12
 v_mul_f32 v243, v243, v12
 v_accvgpr_write_b32 a40, v240
 v_accvgpr_write_b32 a41, v241
 v_accvgpr_write_b32 a42, v242
 v_accvgpr_write_b32 a43, v243
 v_accvgpr_read_b32 v240, a44
 v_accvgpr_read_b32 v241, a45
 v_accvgpr_read_b32 v242, a46
 v_accvgpr_read_b32 v243, a47
 v_mul_f32 v240, v240, v12
 v_mul_f32 v241, v241, v12
 v_mul_f32 v242, v242, v12
 v_mul_f32 v243, v243, v12
 v_accvgpr_write_b32 a44, v240
 v_accvgpr_write_b32 a45, v241
 v_accvgpr_write_b32 a46, v242
 v_accvgpr_write_b32 a47, v243
 v_accvgpr_read_b32 v240, a48
 v_accvgpr_read_b32 v241, a49
 v_accvgpr_read_b32 v242, a50
 v_accvgpr_read_b32 v243, a51
 v_mul_f32 v240, v240, v12
 v_mul_f32 v241, v241, v12
 v_mul_f32 v242, v242, v12
 v_mul_f32 v243, v243, v12
 v_accvgpr_write_b32 a48, v240
 v_accvgpr_write_b32 a49, v241
 v_accvgpr_write_b32 a50, v242
 v_accvgpr_write_b32 a51, v243
 v_accvgpr_read_b32 v240, a52
 v_accvgpr_read_b32 v241, a53
 v_accvgpr_read_b32 v242, a54
 v_accvgpr_read_b32 v243, a55
 v_mul_f32 v240, v240, v12
 v_mul_f32 v241, v241, v12
 v_mul_f32 v242, v242, v12
 v_mul_f32 v243, v243, v12
 v_accvgpr_write_b32 a52, v240
 v_accvgpr_write_b32 a53, v241
 v_accvgpr_write_b32 a54, v242
 v_accvgpr_write_b32 a55, v243
 v_accvgpr_read_b32 v240, a56
 v_accvgpr_read_b32 v241, a57
 v_accvgpr_read_b32 v242, a58
 v_accvgpr_read_b32 v243, a59
 v_mul_f32 v240, v240, v12
 v_mul_f32 v241, v241, v12
 v_mul_f32 v242, v242, v12
 v_mul_f32 v243, v243, v12
 v_accvgpr_write_b32 a56, v240
 v_accvgpr_write_b32 a57, v241
 v_accvgpr_write_b32 a58, v242
 v_accvgpr_write_b32 a59, v243
 v_accvgpr_read_b32 v240, a60
 v_accvgpr_read_b32 v241, a61
 v_accvgpr_read_b32 v242, a62
 v_accvgpr_read_b32 v243, a63
 v_mul_f32 v240, v240, v12
 v_mul_f32 v241, v241, v12
 v_mul_f32 v242, v242, v12
 v_mul_f32 v243, v243, v12
 v_accvgpr_write_b32 a60, v240
 v_accvgpr_write_b32 a61, v241
 v_accvgpr_write_b32 a62, v242
 v_accvgpr_write_b32 a63, v243
 v_exp_f32 v240, v80
 v_exp_f32 v241, v81
 v_exp_f32 v242, v82
 v_exp_f32 v243, v83
 v_exp_f32 v244, v84
 v_exp_f32 v245, v85
 v_exp_f32 v246, v86
 v_exp_f32 v247, v87
 v_cvt_pk_bf16_f32 v176, v240, v241
 v_cvt_pk_bf16_f32 v177, v242, v243
 v_cvt_pk_bf16_f32 v178, v244, v245
 v_cvt_pk_bf16_f32 v179, v246, v247
 v_exp_f32 v240, v88
 v_exp_f32 v241, v89
 v_exp_f32 v242, v90
 v_exp_f32 v243, v91
 v_exp_f32 v244, v92
 v_exp_f32 v245, v93
 v_exp_f32 v246, v94
 v_exp_f32 v247, v95
 v_cvt_pk_bf16_f32 v180, v240, v241
 v_cvt_pk_bf16_f32 v181, v242, v243
 v_cvt_pk_bf16_f32 v182, v244, v245
 v_cvt_pk_bf16_f32 v183, v246, v247
 v_exp_f32 v240, v96
 v_exp_f32 v241, v97
 v_exp_f32 v242, v98
 v_exp_f32 v243, v99
 v_exp_f32 v244, v100
 v_exp_f32 v245, v101
 v_exp_f32 v246, v102
 v_exp_f32 v247, v103
 v_cvt_pk_bf16_f32 v184, v240, v241
 v_cvt_pk_bf16_f32 v185, v242, v243
 v_cvt_pk_bf16_f32 v186, v244, v245
 v_cvt_pk_bf16_f32 v187, v246, v247
 v_exp_f32 v240, v104
 v_exp_f32 v241, v105
 v_exp_f32 v242, v106
 v_exp_f32 v243, v107
 v_exp_f32 v244, v108
 v_exp_f32 v245, v109
 v_exp_f32 v246, v110
 v_exp_f32 v247, v111
 v_cvt_pk_bf16_f32 v188, v240, v241
 v_cvt_pk_bf16_f32 v189, v242, v243
 v_cvt_pk_bf16_f32 v190, v244, v245
 v_cvt_pk_bf16_f32 v191, v246, v247
 v_exp_f32 v240, v112
 v_exp_f32 v241, v113
 v_exp_f32 v242, v114
 v_exp_f32 v243, v115
 v_exp_f32 v244, v116
 v_exp_f32 v245, v117
 v_exp_f32 v246, v118
 v_exp_f32 v247, v119
 v_cvt_pk_bf16_f32 v192, v240, v241
 v_cvt_pk_bf16_f32 v193, v242, v243
 v_cvt_pk_bf16_f32 v194, v244, v245
 v_cvt_pk_bf16_f32 v195, v246, v247
 v_exp_f32 v240, v120
 v_exp_f32 v241, v121
 v_exp_f32 v242, v122
 v_exp_f32 v243, v123
 v_exp_f32 v244, v124
 v_exp_f32 v245, v125
 v_exp_f32 v246, v126
 v_exp_f32 v247, v127
 v_cvt_pk_bf16_f32 v196, v240, v241
 v_cvt_pk_bf16_f32 v197, v242, v243
 v_cvt_pk_bf16_f32 v198, v244, v245
 v_cvt_pk_bf16_f32 v199, v246, v247
 v_exp_f32 v240, v128
 v_exp_f32 v241, v129
 v_exp_f32 v242, v130
 v_exp_f32 v243, v131
 v_exp_f32 v244, v132
 v_exp_f32 v245, v133
 v_exp_f32 v246, v134
 v_exp_f32 v247, v135
 v_cvt_pk_bf16_f32 v200, v240, v241
 v_cvt_pk_bf16_f32 v201, v242, v243
 v_cvt_pk_bf16_f32 v202, v244, v245
 v_cvt_pk_bf16_f32 v203, v246, v247
 v_exp_f32 v240, v136
 v_exp_f32 v241, v137
 v_exp_f32 v242, v138
 v_exp_f32 v243, v139
 v_exp_f32 v244, v140
 v_exp_f32 v245, v141
 v_exp_f32 v246, v142
 v_exp_f32 v247, v143
 v_cvt_pk_bf16_f32 v204, v240, v241
 v_cvt_pk_bf16_f32 v205, v242, v243
 v_cvt_pk_bf16_f32 v206, v244, v245
 v_cvt_pk_bf16_f32 v207, v246, v247
 s_nop 1
 v_mfma_f32_16x16x32_bf16 v[224:227], v[252:255], v[176:179], 0
 v_mfma_f32_16x16x32_bf16 v[228:231], v[252:255], v[180:183], 0
 v_mfma_f32_16x16x32_bf16 v[224:227], v[252:255], v[184:187], v[224:227]
 v_mfma_f32_16x16x32_bf16 v[228:231], v[252:255], v[188:191], v[228:231]
 v_mfma_f32_16x16x32_bf16 v[224:227], v[252:255], v[192:195], v[224:227]
 v_mfma_f32_16x16x32_bf16 v[228:231], v[252:255], v[196:199], v[228:231]
 v_mfma_f32_16x16x32_bf16 v[224:227], v[252:255], v[200:203], v[224:227]
 v_mfma_f32_16x16x32_bf16 v[228:231], v[252:255], v[204:207], v[228:231]
 s_nop 7
 s_cmp_eq_u32 s44, 0
 s_cbranch_scc1 L_back_66
 s_branch L_back_70
L_jr_95:
 s_mov_b32 s44, 0
 s_branch L_rare_93
L_jr_97:
 s_mov_b32 s44, 1
 s_branch L_rare_93
L_rare_93:
 s_nop 7
 s_nop 7
 v_max3_f32 v10, v16, v17, v18
 v_max3_f32 v10, v10, v19, v20
 v_max3_f32 v10, v10, v21, v22
 v_max3_f32 v10, v10, v23, v32
 v_max3_f32 v10, v10, v33, v34
 v_max3_f32 v10, v10, v35, v36
 v_max3_f32 v10, v10, v37, v38
 v_max_f32 v10, v10, v39
 v_mov_b32 v11, v10
 s_nop 1
 v_permlane16_swap_b32 v10, v11
 v_max_f32 v10, v10, v11
 v_mov_b32 v11, v10
 s_nop 1
 v_permlane32_swap_b32 v10, v11
 v_max_f32 v10, v10, v11
 v_max_f32 v10, 0, v10
 v_exp_f32 v12, -v10
 v_sub_f32 v16, v16, v10
 v_sub_f32 v17, v17, v10
 v_sub_f32 v18, v18, v10
 v_sub_f32 v19, v19, v10
 v_sub_f32 v20, v20, v10
 v_sub_f32 v21, v21, v10
 v_sub_f32 v22, v22, v10
 v_sub_f32 v23, v23, v10
 v_sub_f32 v32, v32, v10
 v_sub_f32 v33, v33, v10
 v_sub_f32 v34, v34, v10
 v_sub_f32 v35, v35, v10
 v_sub_f32 v36, v36, v10
 v_sub_f32 v37, v37, v10
 v_sub_f32 v38, v38, v10
 v_sub_f32 v39, v39, v10
 v_sub_f32 v208, v208, v10
 v_sub_f32 v209, v209, v10
 v_sub_f32 v210, v210, v10
 v_sub_f32 v211, v211, v10
 v_sub_f32 v80, v80, v10
 v_sub_f32 v81, v81, v10
 v_sub_f32 v82, v82, v10
 v_sub_f32 v83, v83, v10
 v_sub_f32 v84, v84, v10
 v_sub_f32 v85, v85, v10
 v_sub_f32 v86, v86, v10
 v_sub_f32 v87, v87, v10
 v_sub_f32 v96, v96, v10
 v_sub_f32 v97, v97, v10
 v_sub_f32 v98, v98, v10
 v_sub_f32 v99, v99, v10
 v_sub_f32 v100, v100, v10
 v_sub_f32 v101, v101, v10
 v_sub_f32 v102, v102, v10
 v_sub_f32 v103, v103, v10
 v_sub_f32 v112, v112, v10
 v_sub_f32 v113, v113, v10
 v_sub_f32 v114, v114, v10
 v_sub_f32 v115, v115, v10
 v_sub_f32 v116, v116, v10
 v_sub_f32 v117, v117, v10
 v_sub_f32 v118, v118, v10
 v_sub_f32 v119, v119, v10
 v_sub_f32 v128, v128, v10
 v_sub_f32 v129, v129, v10
 v_sub_f32 v130, v130, v10
 v_sub_f32 v131, v131, v10
 v_sub_f32 v132, v132, v10
 v_sub_f32 v133, v133, v10
 v_sub_f32 v134, v134, v10
 v_sub_f32 v135, v135, v10
 v_mul_f32 v4, v4, v12
 v_accvgpr_read_b32 v240, a0
 v_accvgpr_read_b32 v241, a1
 v_accvgpr_read_b32 v242, a2
 v_accvgpr_read_b32 v243, a3
 v_mul_f32 v240, v240, v12
 v_mul_f32 v241, v241, v12
 v_mul_f32 v242, v242, v12
 v_mul_f32 v243, v243, v12
 v_accvgpr_write_b32 a0, v240
 v_accvgpr_write_b32 a1, v241
 v_accvgpr_write_b32 a2, v242
 v_accvgpr_write_b32 a3, v243
 v_accvgpr_read_b32 v240, a4
 v_accvgpr_read_b32 v241, a5
 v_accvgpr_read_b32 v242, a6
 v_accvgpr_read_b32 v243, a7
 v_mul_f32 v240, v240, v12
 v_mul_f32 v241, v241, v12
 v_mul_f32 v242, v242, v12
 v_mul_f32 v243, v243, v12
 v_accvgpr_write_b32 a4, v240
 v_accvgpr_write_b32 a5, v241
 v_accvgpr_write_b32 a6, v242
 v_accvgpr_write_b32 a7, v243
 v_accvgpr_read_b32 v240, a8
 v_accvgpr_read_b32 v241, a9
 v_accvgpr_read_b32 v242, a10
 v_accvgpr_read_b32 v243, a11
 v_mul_f32 v240, v240, v12
 v_mul_f32 v241, v241, v12
 v_mul_f32 v242, v242, v12
 v_mul_f32 v243, v243, v12
 v_accvgpr_write_b32 a8, v240
 v_accvgpr_write_b32 a9, v241
 v_accvgpr_write_b32 a10, v242
 v_accvgpr_write_b32 a11, v243
 v_accvgpr_read_b32 v240, a12
 v_accvgpr_read_b32 v241, a13
 v_accvgpr_read_b32 v242, a14
 v_accvgpr_read_b32 v243, a15
 v_mul_f32 v240, v240, v12
 v_mul_f32 v241, v241, v12
 v_mul_f32 v242, v242, v12
 v_mul_f32 v243, v243, v12
 v_accvgpr_write_b32 a12, v240
 v_accvgpr_write_b32 a13, v241
 v_accvgpr_write_b32 a14, v242
 v_accvgpr_write_b32 a15, v243
 v_accvgpr_read_b32 v240, a16
 v_accvgpr_read_b32 v241, a17
 v_accvgpr_read_b32 v242, a18
 v_accvgpr_read_b32 v243, a19
 v_mul_f32 v240, v240, v12
 v_mul_f32 v241, v241, v12
 v_mul_f32 v242, v242, v12
 v_mul_f32 v243, v243, v12
 v_accvgpr_write_b32 a16, v240
 v_accvgpr_write_b32 a17, v241
 v_accvgpr_write_b32 a18, v242
 v_accvgpr_write_b32 a19, v243
 v_accvgpr_read_b32 v240, a20
 v_accvgpr_read_b32 v241, a21
 v_accvgpr_read_b32 v242, a22
 v_accvgpr_read_b32 v243, a23
 v_mul_f32 v240, v240, v12
 v_mul_f32 v241, v241, v12
 v_mul_f32 v242, v242, v12
 v_mul_f32 v243, v243, v12
 v_accvgpr_write_b32 a20, v240
 v_accvgpr_write_b32 a21, v241
 v_accvgpr_write_b32 a22, v242
 v_accvgpr_write_b32 a23, v243
 v_accvgpr_read_b32 v240, a24
 v_accvgpr_read_b32 v241, a25
 v_accvgpr_read_b32 v242, a26
 v_accvgpr_read_b32 v243, a27
 v_mul_f32 v240, v240, v12
 v_mul_f32 v241, v241, v12
 v_mul_f32 v242, v242, v12
 v_mul_f32 v243, v243, v12
 v_accvgpr_write_b32 a24, v240
 v_accvgpr_write_b32 a25, v241
 v_accvgpr_write_b32 a26, v242
 v_accvgpr_write_b32 a27, v243
 v_accvgpr_read_b32 v240, a28
 v_accvgpr_read_b32 v241, a29
 v_accvgpr_read_b32 v242, a30
 v_accvgpr_read_b32 v243, a31
 v_mul_f32 v240, v240, v12
 v_mul_f32 v241, v241, v12
 v_mul_f32 v242, v242, v12
 v_mul_f32 v243, v243, v12
 v_accvgpr_write_b32 a28, v240
 v_accvgpr_write_b32 a29, v241
 v_accvgpr_write_b32 a30, v242
 v_accvgpr_write_b32 a31, v243
 v_max3_f32 v10, v24, v25, v26
 v_max3_f32 v10, v10, v27, v28
 v_max3_f32 v10, v10, v29, v30
 v_max3_f32 v10, v10, v31, v40
 v_max3_f32 v10, v10, v41, v42
 v_max3_f32 v10, v10, v43, v44
 v_max3_f32 v10, v10, v45, v46
 v_max3_f32 v10, v10, v47, v56
 v_max3_f32 v10, v10, v57, v58
 v_max3_f32 v10, v10, v59, v60
 v_max3_f32 v10, v10, v61, v62
 v_max3_f32 v10, v10, v63, v72
 v_max3_f32 v10, v10, v73, v74
 v_max3_f32 v10, v10, v75, v76
 v_max3_f32 v10, v10, v77, v78
 v_max_f32 v10, v10, v79
 v_mov_b32 v11, v10
 s_nop 1
 v_permlane16_swap_b32 v10, v11
 v_max_f32 v10, v10, v11
 v_mov_b32 v11, v10
 s_nop 1
 v_permlane32_swap_b32 v10, v11
 v_max_f32 v10, v10, v11
 v_max_f32 v10, 0, v10
 v_exp_f32 v12, -v10
 v_sub_f32 v24, v24, v10
 v_sub_f32 v25, v25, v10
 v_sub_f32 v26, v26, v10
 v_sub_f32 v27, v27, v10
 v_sub_f32 v28, v28, v10
 v_sub_f32 v29, v29, v10
 v_sub_f32 v30, v30, v10
 v_sub_f32 v31, v31, v10
 v_sub_f32 v40, v40, v10
 v_sub_f32 v41, v41, v10
 v_sub_f32 v42, v42, v10
 v_sub_f32 v43, v43, v10
 v_sub_f32 v44, v44, v10
 v_sub_f32 v45, v45, v10
 v_sub_f32 v46, v46, v10
 v_sub_f32 v47, v47, v10
 v_sub_f32 v56, v56, v10
 v_sub_f32 v57, v57, v10
 v_sub_f32 v58, v58, v10
 v_sub_f32 v59, v59, v10
 v_sub_f32 v60, v60, v10
 v_sub_f32 v61, v61, v10
 v_sub_f32 v62, v62, v10
 v_sub_f32 v63, v63, v10
 v_sub_f32 v72, v72, v10
 v_sub_f32 v73, v73, v10
 v_sub_f32 v74, v74, v10
 v_sub_f32 v75, v75, v10
 v_sub_f32 v76, v76, v10
 v_sub_f32 v77, v77, v10
 v_sub_f32 v78, v78, v10
 v_sub_f32 v79, v79, v10
 v_sub_f32 v212, v212, v10
 v_sub_f32 v213, v213, v10
 v_sub_f32 v214, v214, v10
 v_sub_f32 v215, v215, v10
 v_sub_f32 v88, v88, v10
 v_sub_f32 v89, v89, v10
 v_sub_f32 v90, v90, v10
 v_sub_f32 v91, v91, v10
 v_sub_f32 v92, v92, v10
 v_sub_f32 v93, v93, v10
 v_sub_f32 v94, v94, v10
 v_sub_f32 v95, v95, v10
 v_sub_f32 v104, v104, v10
 v_sub_f32 v105, v105, v10
 v_sub_f32 v106, v106, v10
 v_sub_f32 v107, v107, v10
 v_sub_f32 v108, v108, v10
 v_sub_f32 v109, v109, v10
 v_sub_f32 v110, v110, v10
 v_sub_f32 v111, v111, v10
 v_sub_f32 v120, v120, v10
 v_sub_f32 v121, v121, v10
 v_sub_f32 v122, v122, v10
 v_sub_f32 v123, v123, v10
 v_sub_f32 v124, v124, v10
 v_sub_f32 v125, v125, v10
 v_sub_f32 v126, v126, v10
 v_sub_f32 v127, v127, v10
 v_sub_f32 v136, v136, v10
 v_sub_f32 v137, v137, v10
 v_sub_f32 v138, v138, v10
 v_sub_f32 v139, v139, v10
 v_sub_f32 v140, v140, v10
 v_sub_f32 v141, v141, v10
 v_sub_f32 v142, v142, v10
 v_sub_f32 v143, v143, v10
 v_mul_f32 v5, v5, v12
 v_accvgpr_read_b32 v240, a32
 v_accvgpr_read_b32 v241, a33
 v_accvgpr_read_b32 v242, a34
 v_accvgpr_read_b32 v243, a35
 v_mul_f32 v240, v240, v12
 v_mul_f32 v241, v241, v12
 v_mul_f32 v242, v242, v12
 v_mul_f32 v243, v243, v12
 v_accvgpr_write_b32 a32, v240
 v_accvgpr_write_b32 a33, v241
 v_accvgpr_write_b32 a34, v242
 v_accvgpr_write_b32 a35, v243
 v_accvgpr_read_b32 v240, a36
 v_accvgpr_read_b32 v241, a37
 v_accvgpr_read_b32 v242, a38
 v_accvgpr_read_b32 v243, a39
 v_mul_f32 v240, v240, v12
 v_mul_f32 v241, v241, v12
 v_mul_f32 v242, v242, v12
 v_mul_f32 v243, v243, v12
 v_accvgpr_write_b32 a36, v240
 v_accvgpr_write_b32 a37, v241
 v_accvgpr_write_b32 a38, v242
 v_accvgpr_write_b32 a39, v243
 v_accvgpr_read_b32 v240, a40
 v_accvgpr_read_b32 v241, a41
 v_accvgpr_read_b32 v242, a42
 v_accvgpr_read_b32 v243, a43
 v_mul_f32 v240, v240, v12
 v_mul_f32 v241, v241, v12
 v_mul_f32 v242, v242, v12
 v_mul_f32 v243, v243, v12
 v_accvgpr_write_b32 a40, v240
 v_accvgpr_write_b32 a41, v241
 v_accvgpr_write_b32 a42, v242
 v_accvgpr_write_b32 a43, v243
 v_accvgpr_read_b32 v240, a44
 v_accvgpr_read_b32 v241, a45
 v_accvgpr_read_b32 v242, a46
 v_accvgpr_read_b32 v243, a47
 v_mul_f32 v240, v240, v12
 v_mul_f32 v241, v241, v12
 v_mul_f32 v242, v242, v12
 v_mul_f32 v243, v243, v12
 v_accvgpr_write_b32 a44, v240
 v_accvgpr_write_b32 a45, v241
 v_accvgpr_write_b32 a46, v242
 v_accvgpr_write_b32 a47, v243
 v_accvgpr_read_b32 v240, a48
 v_accvgpr_read_b32 v241, a49
 v_accvgpr_read_b32 v242, a50
 v_accvgpr_read_b32 v243, a51
 v_mul_f32 v240, v240, v12
 v_mul_f32 v241, v241, v12
 v_mul_f32 v242, v242, v12
 v_mul_f32 v243, v243, v12
 v_accvgpr_write_b32 a48, v240
 v_accvgpr_write_b32 a49, v241
 v_accvgpr_write_b32 a50, v242
 v_accvgpr_write_b32 a51, v243
 v_accvgpr_read_b32 v240, a52
 v_accvgpr_read_b32 v241, a53
 v_accvgpr_read_b32 v242, a54
 v_accvgpr_read_b32 v243, a55
 v_mul_f32 v240, v240, v12
 v_mul_f32 v241, v241, v12
 v_mul_f32 v242, v242, v12
 v_mul_f32 v243, v243, v12
 v_accvgpr_write_b32 a52, v240
 v_accvgpr_write_b32 a53, v241
 v_accvgpr_write_b32 a54, v242
 v_accvgpr_write_b32 a55, v243
 v_accvgpr_read_b32 v240, a56
 v_accvgpr_read_b32 v241, a57
 v_accvgpr_read_b32 v242, a58
 v_accvgpr_read_b32 v243, a59
 v_mul_f32 v240, v240, v12
 v_mul_f32 v241, v241, v12
 v_mul_f32 v242, v242, v12
 v_mul_f32 v243, v243, v12
 v_accvgpr_write_b32 a56, v240
 v_accvgpr_write_b32 a57, v241
 v_accvgpr_write_b32 a58, v242
 v_accvgpr_write_b32 a59, v243
 v_accvgpr_read_b32 v240, a60
 v_accvgpr_read_b32 v241, a61
 v_accvgpr_read_b32 v242, a62
 v_accvgpr_read_b32 v243, a63
 v_mul_f32 v240, v240, v12
 v_mul_f32 v241, v241, v12
 v_mul_f32 v242, v242, v12
 v_mul_f32 v243, v243, v12
 v_accvgpr_write_b32 a60, v240
 v_accvgpr_write_b32 a61, v241
 v_accvgpr_write_b32 a62, v242
 v_accvgpr_write_b32 a63, v243
 v_exp_f32 v240, v16
 v_exp_f32 v241, v17
 v_exp_f32 v242, v18
 v_exp_f32 v243, v19
 v_exp_f32 v244, v20
 v_exp_f32 v245, v21
 v_exp_f32 v246, v22
 v_exp_f32 v247, v23
 v_cvt_pk_bf16_f32 v144, v240, v241
 v_cvt_pk_bf16_f32 v145, v242, v243
 v_cvt_pk_bf16_f32 v146, v244, v245
 v_cvt_pk_bf16_f32 v147, v246, v247
 v_exp_f32 v240, v24
 v_exp_f32 v241, v25
 v_exp_f32 v242, v26
 v_exp_f32 v243, v27
 v_exp_f32 v244, v28
 v_exp_f32 v245, v29
 v_exp_f32 v246, v30
 v_exp_f32 v247, v31
 v_cvt_pk_bf16_f32 v148, v240, v241
 v_cvt_pk_bf16_f32 v149, v242, v243
 v_cvt_pk_bf16_f32 v150, v244, v245
 v_cvt_pk_bf16_f32 v151, v246, v247
 v_exp_f32 v240, v32
 v_exp_f32 v241, v33
 v_exp_f32 v242, v34
 v_exp_f32 v243, v35
 v_exp_f32 v244, v36
 v_exp_f32 v245, v37
 v_exp_f32 v246, v38
 v_exp_f32 v247, v39
 v_cvt_pk_bf16_f32 v152, v240, v241
 v_cvt_pk_bf16_f32 v153, v242, v243
 v_cvt_pk_bf16_f32 v154, v244, v245
 v_cvt_pk_bf16_f32 v155, v246, v247
 v_exp_f32 v240, v40
 v_exp_f32 v241, v41
 v_exp_f32 v242, v42
 v_exp_f32 v243, v43
 v_exp_f32 v244, v44
 v_exp_f32 v245, v45
 v_exp_f32 v246, v46
 v_exp_f32 v247, v47
 v_cvt_pk_bf16_f32 v156, v240, v241
 v_cvt_pk_bf16_f32 v157, v242, v243
 v_cvt_pk_bf16_f32 v158, v244, v245
 v_cvt_pk_bf16_f32 v159, v246, v247
 v_exp_f32 v240, v56
 v_exp_f32 v241, v57
 v_exp_f32 v242, v58
 v_exp_f32 v243, v59
 v_exp_f32 v244, v60
 v_exp_f32 v245, v61
 v_exp_f32 v246, v62
 v_exp_f32 v247, v63
 v_cvt_pk_bf16_f32 v164, v240, v241
 v_cvt_pk_bf16_f32 v165, v242, v243
 v_cvt_pk_bf16_f32 v166, v244, v245
 v_cvt_pk_bf16_f32 v167, v246, v247
 v_exp_f32 v240, v72
 v_exp_f32 v241, v73
 v_exp_f32 v242, v74
 v_exp_f32 v243, v75
 v_exp_f32 v244, v76
 v_exp_f32 v245, v77
 v_exp_f32 v246, v78
 v_exp_f32 v247, v79
 v_cvt_pk_bf16_f32 v172, v240, v241
 v_cvt_pk_bf16_f32 v173, v242, v243
 v_cvt_pk_bf16_f32 v174, v244, v245
 v_cvt_pk_bf16_f32 v175, v246, v247
 s_nop 1
 v_mfma_f32_16x16x32_bf16 v[224:227], v[252:255], v[144:147], 0
 v_mfma_f32_16x16x32_bf16 v[228:231], v[252:255], v[148:151], 0
 v_mfma_f32_16x16x32_bf16 v[224:227], v[252:255], v[152:155], v[224:227]
 v_mfma_f32_16x16x32_bf16 v[228:231], v[252:255], v[156:159], v[228:231]
 v_mfma_f32_16x16x32_bf16 v[228:231], v[252:255], v[164:167], v[228:231]
 v_mfma_f32_16x16x32_bf16 v[228:231], v[252:255], v[172:175], v[228:231]
 s_nop 7
 s_cmp_eq_u32 s44, 0
 s_cbranch_scc1 L_back_94
 s_branch L_back_96
.section .rodata,"a"
.p2align 6
.amdhsa_kernel gated_mix__sliding_local_dilated__compressed_kv_cla__prompt_kernel
  .amdhsa_next_free_vgpr 512
  .amdhsa_next_free_sgpr 102
  .amdhsa_accum_offset 256
  .amdhsa_group_segment_fixed_size 0
  .amdhsa_kernarg_size 104
  .amdhsa_user_sgpr_count 2
  .amdhsa_user_sgpr_kernarg_segment_ptr 1
  .amdhsa_system_sgpr_workgroup_id_x 1
.end_amdhsa_kernel
```
